```python
import torch

def _softmax(x, axis=-1):
    return torch.softmax(x, dim=axis)

def _gelu(x):
    return torch.nn.functional.gelu(x, approximate='tanh')

def _silu(x):
    return torch.nn.functional.silu(x)

def _sigmoid(x):
    return torch.sigmoid(x)

def _layernorm(x, axis=-1, eps=1e-05):
    m = x.mean(dim=axis, keepdim=True)
    v = x.var(dim=axis, keepdim=True, unbiased=False)
    return (x - m) / torch.sqrt(v + eps)

def _scatter_add(tgt, idx, src, axis=0):
    return tgt.clone().index_add_(axis, idx, src)

def _segment_sum(src, seg, n):
    out = torch.zeros((n,) + src.shape[1:], dtype=src.dtype)
    return out.index_add_(0, seg, src)

def _pad(x, pw):
    flat = tuple((v for pair in reversed(pw) for v in pair))
    return torch.nn.functional.pad(x, flat)
kernel_name = 'adaLN_cond__mha_block_cached__glu_gated_swiglu__prompt'

def setup_inputs():

    _w = lambda a: (lambda t: t.to(torch.bfloat16) if t.is_floating_point() else t)(torch.as_tensor(a))

    def _A_setup():
        B, Sq, D = (1, 2048, 512)
        H, Sk, Dh = (32, 2048, 128)
        return {'x': _w((lambda *s: torch.randn(*s, dtype=torch.bfloat16) * 0.1)(B, Sq, D)), 'k_cache': _w((lambda *s: torch.randn(*s, dtype=torch.bfloat16) * 0.8)(B, H, Sk, Dh)), 'v_cache': _w((lambda *s: torch.randn(*s, dtype=torch.bfloat16) * 3.2)(B, H, Sk, Dh)), 'wq': _w((lambda *s: torch.randn(*s, dtype=torch.bfloat16) * 0.8)(D, H * Dh) * D ** (-0.5)), 'wo': _w((lambda *s: torch.randn(*s, dtype=torch.bfloat16) * 3.2)(H * Dh, D) * (H * Dh) ** (-0.5))}
    _A_in = _A_setup()

    def _B_setup():
        B, S, D, F = (1, 2048, 512, 1792)
        return {'x': _w((lambda *s: torch.randn(*s, dtype=torch.bfloat16) * 0.1)(B, S, D)), 'w1': _w((lambda *s: torch.randn(*s, dtype=torch.bfloat16) * 3.2)(D, F) * (2.0 / D) ** 0.5), 'w3': _w((lambda *s: torch.randn(*s, dtype=torch.bfloat16) * 3.2)(D, F) * (2.0 / D) ** 0.5), 'w2': _w((lambda *s: torch.randn(*s, dtype=torch.bfloat16) * 3.2)(F, D) * (2.0 / F) ** 0.5)}
    _B_in = _B_setup()
    return {'A_x': _A_in['x'], 'A_k_cache': _A_in['k_cache'], 'A_v_cache': _A_in['v_cache'], 'A_wq': _A_in['wq'], 'A_wo': _A_in['wo'], 'B_x': _B_in['x'], 'B_w1': _B_in['w1'], 'B_w3': _B_in['w3'], 'B_w2': _B_in['w2'], 'c': _w((lambda *s: torch.randn(*s, dtype=torch.bfloat16) * 0.8)(1, 512) * 8.0), 'w_mod': _w((lambda *s: torch.randn(*s, dtype=torch.bfloat16) * 0.8)(512, 6 * 512) * 512 ** (-0.5) * 8.0)}

def reference(A_x, A_k_cache, A_v_cache, A_wq, A_wo, B_x, B_w1, B_w3, B_w2, c, w_mod):

    def _A_ref(x, k_cache, v_cache, wq, wo):
        B, Sq, D = x.shape
        H, Dh = (32, 128)
        q = (lambda x, *d: x.permute(*d))((x @ wq).reshape(B, Sq, H, Dh), 0, 2, 1, 3)
        scores = torch.einsum('bhqd,bhkd->bhqk', q, k_cache) * Dh ** (-0.5)
        p = _softmax(scores, axis=-1)
        o = torch.einsum('bhqk,bhkd->bhqd', p, v_cache)
        return (lambda x, *d: x.permute(*d))(o, 0, 2, 1, 3).reshape(B, Sq, H * Dh) @ wo

    def _B_ref(x, w1, w3, w2):
        gate = torch.einsum('bsd,df->bsf', x, w1)
        up = torch.einsum('bsd,df->bsf', x, w3)
        h = _silu(gate) * up
        out = torch.einsum('bsf,fd->bsd', h, w2)
        return out
    x = A_x
    mod = (_silu(c) @ w_mod).reshape(c.shape[0], 6, 1, -1)
    sa, ca, ga, sb, cb, gb = (mod[:, 0].clone(), mod[:, 1].clone(), mod[:, 2].clone(), mod[:, 3].clone(), mod[:, 4].clone(), mod[:, 5].clone())
    h = _layernorm(x, axis=-1) * (1 + ca) + sa
    x = x + ga * _A_ref(h, A_k_cache, A_v_cache, A_wq, A_wo)
    h = _layernorm(x, axis=-1) * (1 + cb) + sb
    x = x + gb * _B_ref(h, B_w1, B_w3, B_w2)
    return x
```

```asm
; @launch kernel=prep_kernel grid=(224,1,1) block=(256,1,1) lds=9216
; @launch kernel=attn_kernel grid=(256,1,1) block=(256,1,1) lds=135168
.amdgcn_target "amdgcn-amd-amdhsa--gfx950"
.text
.globl prep_kernel
.p2align 8
.type prep_kernel,@function
prep_kernel:
    s_cmp_ge_u32 s2, 224
    s_cbranch_scc1 prep_end
    s_load_dwordx2 s[4:5], s[0:1], 104
    s_load_dwordx2 s[6:7], s[0:1], 0
    s_load_dwordx4 s[20:23], s[0:1], 72
    s_load_dwordx4 s[36:39], s[0:1], 8
    s_load_dwordx2 s[40:41], s[0:1], 24
    s_cmp_ge_u32 s2, 96
    s_cbranch_scc1 prep_ln
    v_and_b32 v1, 3, v0
    v_lshrrev_b32 v2, 2, v0
    s_mov_b32 s3, 49152
    v_mul_lo_u32 v3, v2, s3
    v_lshl_add_u32 v3, v1, 4, v3
    s_and_b32 s34, s2, 0x70
    s_and_b32 s3, s2, 7
    s_lshl_b32 s3, s3, 1
    s_add_u32 s34, s34, s3
    s_bfe_u32 s3, s2, 0x10003
    s_add_u32 s34, s34, s3
    s_lshl_b32 s3, s34, 6
    v_add_u32 v3, s3, v3
    v_lshlrev_b32 v4, 4, v2
    s_waitcnt lgkmcnt(0)
    s_mov_b32 s8, s20
    s_and_b32 s9, s21, 0xffff
    s_mov_b32 s10, 1024
    s_mov_b32 s11, 0x00020000
    s_mov_b32 s12, s22
    s_and_b32 s13, s23, 0xffff
    s_mov_b32 s14, 3145728
    s_mov_b32 s15, 0x00020000
    s_mov_b32 s16, s4
    s_and_b32 s17, s5, 0xffff
    s_mov_b32 s18, 67108864
    s_mov_b32 s19, 0x00020000
    buffer_load_dwordx4 v[8:11], v4, s[8:11], 0 offen
    s_mov_b32 s24, 0
    buffer_load_dwordx4 v[16:19], v3, s[12:15], s24 offen
    s_mov_b32 s25, 6144
    buffer_load_dwordx4 v[20:23], v3, s[12:15], s25 offen
    s_mov_b32 s26, 12288
    buffer_load_dwordx4 v[24:27], v3, s[12:15], s26 offen
    s_mov_b32 s27, 18432
    buffer_load_dwordx4 v[28:31], v3, s[12:15], s27 offen
    s_mov_b32 s28, 24576
    buffer_load_dwordx4 v[32:35], v3, s[12:15], s28 offen
    s_mov_b32 s29, 30720
    buffer_load_dwordx4 v[36:39], v3, s[12:15], s29 offen
    s_mov_b32 s30, 36864
    buffer_load_dwordx4 v[40:43], v3, s[12:15], s30 offen
    s_mov_b32 s31, 43008
    buffer_load_dwordx4 v[44:47], v3, s[12:15], s31 offen
    v_lshrrev_b32 v72, 6, v0
    v_and_b32 v73, 63, v0
    v_readfirstlane_b32 s42, v72
    s_lshr_b32 s43, s2, 3
    s_lshl_b32 s43, s43, 2
    s_add_u32 s43, s43, s42
    s_cmp_ge_u32 s43, (code_end-attn_kernel+8191)/8192
    s_cbranch_scc1 prep_kernel_nocpf_1
    s_getpc_b64 s[44:45]
prep_kernel_pc_2:
    s_add_u32 s44, s44, attn_kernel-prep_kernel_pc_2
    s_addc_u32 s45, s45, 0
    s_lshl_b32 s43, s43, 13
    v_lshlrev_b32 v74, 7, v73
    v_add_u32 v74, s43, v74
    v_min_u32 v74, code_end-attn_kernel-4, v74
    v_mov_b32 v75, s45
    v_add_co_u32 v74, vcc, s44, v74
    s_nop 1
    v_addc_co_u32 v75, vcc, 0, v75, vcc
    global_load_dword v76, v[74:75], off
prep_kernel_nocpf_1:
    s_waitcnt vmcnt(8)
    s_mov_b32 s3, 0xbfb8aa3b
    v_lshlrev_b32 v48, 16, v8
    v_and_b32 v49, 0xffff0000, v8
    v_lshlrev_b32 v50, 16, v9
    v_and_b32 v51, 0xffff0000, v9
    v_lshlrev_b32 v52, 16, v10
    v_and_b32 v53, 0xffff0000, v10
    v_lshlrev_b32 v54, 16, v11
    v_and_b32 v55, 0xffff0000, v11
    v_mul_f32 v56, s3, v48
    v_mul_f32 v57, s3, v49
    v_mul_f32 v58, s3, v50
    v_mul_f32 v59, s3, v51
    v_mul_f32 v60, s3, v52
    v_mul_f32 v61, s3, v53
    v_mul_f32 v62, s3, v54
    v_mul_f32 v63, s3, v55
    v_exp_f32 v56, v56
    v_exp_f32 v57, v57
    v_exp_f32 v58, v58
    v_exp_f32 v59, v59
    v_exp_f32 v60, v60
    v_exp_f32 v61, v61
    v_exp_f32 v62, v62
    v_exp_f32 v63, v63
    v_add_f32 v56, 1.0, v56
    v_add_f32 v57, 1.0, v57
    v_add_f32 v58, 1.0, v58
    v_add_f32 v59, 1.0, v59
    v_add_f32 v60, 1.0, v60
    v_add_f32 v61, 1.0, v61
    v_add_f32 v62, 1.0, v62
    v_add_f32 v63, 1.0, v63
    v_rcp_f32 v56, v56
    v_rcp_f32 v57, v57
    v_rcp_f32 v58, v58
    v_rcp_f32 v59, v59
    v_rcp_f32 v60, v60
    v_rcp_f32 v61, v61
    v_rcp_f32 v62, v62
    v_rcp_f32 v63, v63
    v_mul_f32 v48, v48, v56
    v_mul_f32 v49, v49, v57
    v_mul_f32 v50, v50, v58
    v_mul_f32 v51, v51, v59
    v_mul_f32 v52, v52, v60
    v_mul_f32 v53, v53, v61
    v_mul_f32 v54, v54, v62
    v_mul_f32 v55, v55, v63
    v_cvt_pk_bf16_f32 v48, 0, v48
    v_cvt_pk_bf16_f32 v49, 0, v49
    v_cvt_pk_bf16_f32 v50, 0, v50
    v_cvt_pk_bf16_f32 v51, 0, v51
    v_cvt_pk_bf16_f32 v52, 0, v52
    v_cvt_pk_bf16_f32 v53, 0, v53
    v_cvt_pk_bf16_f32 v54, 0, v54
    v_cvt_pk_bf16_f32 v55, 0, v55
    s_waitcnt vmcnt(7)
    v_lshlrev_b32 v56, 16, v16
    v_and_b32 v57, 0xffff0000, v16
    v_mul_f32 v64, v48, v56
    v_mul_f32 v65, v48, v57
    v_lshlrev_b32 v56, 16, v17
    v_and_b32 v57, 0xffff0000, v17
    v_mul_f32 v66, v48, v56
    v_mul_f32 v67, v48, v57
    v_lshlrev_b32 v56, 16, v18
    v_and_b32 v57, 0xffff0000, v18
    v_mul_f32 v68, v48, v56
    v_mul_f32 v69, v48, v57
    v_lshlrev_b32 v56, 16, v19
    v_and_b32 v57, 0xffff0000, v19
    v_mul_f32 v70, v48, v56
    v_mul_f32 v71, v48, v57
    s_waitcnt vmcnt(6)
    v_lshlrev_b32 v56, 16, v20
    v_and_b32 v57, 0xffff0000, v20
    v_fmac_f32 v64, v49, v56
    v_fmac_f32 v65, v49, v57
    v_lshlrev_b32 v56, 16, v21
    v_and_b32 v57, 0xffff0000, v21
    v_fmac_f32 v66, v49, v56
    v_fmac_f32 v67, v49, v57
    v_lshlrev_b32 v56, 16, v22
    v_and_b32 v57, 0xffff0000, v22
    v_fmac_f32 v68, v49, v56
    v_fmac_f32 v69, v49, v57
    v_lshlrev_b32 v56, 16, v23
    v_and_b32 v57, 0xffff0000, v23
    v_fmac_f32 v70, v49, v56
    v_fmac_f32 v71, v49, v57
    s_waitcnt vmcnt(5)
    v_lshlrev_b32 v56, 16, v24
    v_and_b32 v57, 0xffff0000, v24
    v_fmac_f32 v64, v50, v56
    v_fmac_f32 v65, v50, v57
    v_lshlrev_b32 v56, 16, v25
    v_and_b32 v57, 0xffff0000, v25
    v_fmac_f32 v66, v50, v56
    v_fmac_f32 v67, v50, v57
    v_lshlrev_b32 v56, 16, v26
    v_and_b32 v57, 0xffff0000, v26
    v_fmac_f32 v68, v50, v56
    v_fmac_f32 v69, v50, v57
    v_lshlrev_b32 v56, 16, v27
    v_and_b32 v57, 0xffff0000, v27
    v_fmac_f32 v70, v50, v56
    v_fmac_f32 v71, v50, v57
    s_waitcnt vmcnt(4)
    v_lshlrev_b32 v56, 16, v28
    v_and_b32 v57, 0xffff0000, v28
    v_fmac_f32 v64, v51, v56
    v_fmac_f32 v65, v51, v57
    v_lshlrev_b32 v56, 16, v29
    v_and_b32 v57, 0xffff0000, v29
    v_fmac_f32 v66, v51, v56
    v_fmac_f32 v67, v51, v57
    v_lshlrev_b32 v56, 16, v30
    v_and_b32 v57, 0xffff0000, v30
    v_fmac_f32 v68, v51, v56
    v_fmac_f32 v69, v51, v57
    v_lshlrev_b32 v56, 16, v31
    v_and_b32 v57, 0xffff0000, v31
    v_fmac_f32 v70, v51, v56
    v_fmac_f32 v71, v51, v57
    s_waitcnt vmcnt(3)
    v_lshlrev_b32 v56, 16, v32
    v_and_b32 v57, 0xffff0000, v32
    v_fmac_f32 v64, v52, v56
    v_fmac_f32 v65, v52, v57
    v_lshlrev_b32 v56, 16, v33
    v_and_b32 v57, 0xffff0000, v33
    v_fmac_f32 v66, v52, v56
    v_fmac_f32 v67, v52, v57
    v_lshlrev_b32 v56, 16, v34
    v_and_b32 v57, 0xffff0000, v34
    v_fmac_f32 v68, v52, v56
    v_fmac_f32 v69, v52, v57
    v_lshlrev_b32 v56, 16, v35
    v_and_b32 v57, 0xffff0000, v35
    v_fmac_f32 v70, v52, v56
    v_fmac_f32 v71, v52, v57
    s_waitcnt vmcnt(2)
    v_lshlrev_b32 v56, 16, v36
    v_and_b32 v57, 0xffff0000, v36
    v_fmac_f32 v64, v53, v56
    v_fmac_f32 v65, v53, v57
    v_lshlrev_b32 v56, 16, v37
    v_and_b32 v57, 0xffff0000, v37
    v_fmac_f32 v66, v53, v56
    v_fmac_f32 v67, v53, v57
    v_lshlrev_b32 v56, 16, v38
    v_and_b32 v57, 0xffff0000, v38
    v_fmac_f32 v68, v53, v56
    v_fmac_f32 v69, v53, v57
    v_lshlrev_b32 v56, 16, v39
    v_and_b32 v57, 0xffff0000, v39
    v_fmac_f32 v70, v53, v56
    v_fmac_f32 v71, v53, v57
    s_waitcnt vmcnt(1)
    v_lshlrev_b32 v56, 16, v40
    v_and_b32 v57, 0xffff0000, v40
    v_fmac_f32 v64, v54, v56
    v_fmac_f32 v65, v54, v57
    v_lshlrev_b32 v56, 16, v41
    v_and_b32 v57, 0xffff0000, v41
    v_fmac_f32 v66, v54, v56
    v_fmac_f32 v67, v54, v57
    v_lshlrev_b32 v56, 16, v42
    v_and_b32 v57, 0xffff0000, v42
    v_fmac_f32 v68, v54, v56
    v_fmac_f32 v69, v54, v57
    v_lshlrev_b32 v56, 16, v43
    v_and_b32 v57, 0xffff0000, v43
    v_fmac_f32 v70, v54, v56
    v_fmac_f32 v71, v54, v57
    s_waitcnt vmcnt(0)
    v_lshlrev_b32 v56, 16, v44
    v_and_b32 v57, 0xffff0000, v44
    v_fmac_f32 v64, v55, v56
    v_fmac_f32 v65, v55, v57
    v_lshlrev_b32 v56, 16, v45
    v_and_b32 v57, 0xffff0000, v45
    v_fmac_f32 v66, v55, v56
    v_fmac_f32 v67, v55, v57
    v_lshlrev_b32 v56, 16, v46
    v_and_b32 v57, 0xffff0000, v46
    v_fmac_f32 v68, v55, v56
    v_fmac_f32 v69, v55, v57
    v_lshlrev_b32 v56, 16, v47
    v_and_b32 v57, 0xffff0000, v47
    v_fmac_f32 v70, v55, v56
    v_fmac_f32 v71, v55, v57
    v_lshlrev_b32 v5, 5, v0
    ds_write_b128 v5, v[64:67]
    ds_write_b128 v5, v[68:71] offset:16
    s_waitcnt lgkmcnt(0)
    s_barrier
    v_and_b32 v6, 31, v0
    v_lshrrev_b32 v7, 5, v0
    v_lshlrev_b32 v5, 10, v7
    v_lshl_add_u32 v5, v6, 2, v5
    ds_read_b32 v16, v5 offset:0
    ds_read_b32 v17, v5 offset:128
    ds_read_b32 v18, v5 offset:256
    ds_read_b32 v19, v5 offset:384
    ds_read_b32 v20, v5 offset:512
    ds_read_b32 v21, v5 offset:640
    ds_read_b32 v22, v5 offset:768
    ds_read_b32 v23, v5 offset:896
    s_waitcnt lgkmcnt(0)
    v_add_f32 v16, v16, v17
    v_add_f32 v16, v16, v18
    v_add_f32 v16, v16, v19
    v_add_f32 v16, v16, v20
    v_add_f32 v16, v16, v21
    v_add_f32 v16, v16, v22
    v_add_f32 v16, v16, v23
    v_lshlrev_b32 v5, 2, v0
    ds_write_b32 v5, v16 offset:8192
    s_waitcnt lgkmcnt(0)
    s_barrier
    v_cmp_gt_u32 vcc, 32, v0
    s_nop 0
    s_and_saveexec_b64 s[32:33], vcc
    s_cbranch_execz prep_end
    ds_read_b32 v16, v5 offset:8192
    ds_read_b32 v17, v5 offset:8320
    ds_read_b32 v18, v5 offset:8448
    ds_read_b32 v19, v5 offset:8576
    ds_read_b32 v20, v5 offset:8704
    ds_read_b32 v21, v5 offset:8832
    ds_read_b32 v22, v5 offset:8960
    ds_read_b32 v23, v5 offset:9088
    s_waitcnt lgkmcnt(0)
    v_add_f32 v16, v16, v17
    v_add_f32 v16, v16, v18
    v_add_f32 v16, v16, v19
    v_add_f32 v16, v16, v20
    v_add_f32 v16, v16, v21
    v_add_f32 v16, v16, v22
    v_add_f32 v16, v16, v23
    v_cvt_pk_bf16_f32 v16, 0, v16
    v_add_f32 v17, 1.0, v16
    v_cvt_pk_bf16_f32 v17, 0, v17
    s_lshr_b32 s24, s34, 4
    s_and_b32 s25, s34, 15
    s_lshl_b32 s25, s25, 5
    v_add_u32 v6, s25, v0
    s_cmp_ge_u32 s24, 3
    s_cselect_b32 s26, 8192, 0
    s_cselect_b32 s27, 3, 0
    s_sub_u32 s24, s24, s27
    v_lshrrev_b32 v7, 3, v6
    v_lshlrev_b32 v7, 6, v7
    v_and_b32 v8, 7, v6
    v_lshl_add_u32 v7, v8, 2, v7
    v_lshlrev_b32 v8, 2, v6
    s_cmp_eq_u32 s24, 2
    s_cbranch_scc1 prep_gate
    s_cmp_eq_u32 s24, 1
    s_cbranch_scc1 prep_scale
    buffer_store_dword v16, v7, s[16:19], s26 offen offset:32
    s_endpgm
prep_scale:
    buffer_store_dword v17, v7, s[16:19], s26 offen
    s_endpgm
prep_gate:
    s_add_u32 s26, s26, 4096
    buffer_store_dword v16, v8, s[16:19], s26 offen
    s_endpgm
prep_ln:
    s_sub_u32 s3, s2, 96
    s_lshl_b32 s3, s3, 4
    v_lshrrev_b32 v1, 4, v0
    v_add_u32 v1, s3, v1
    v_and_b32 v2, 15, v0
    v_lshlrev_b32 v3, 10, v1
    v_lshl_add_u32 v3, v2, 4, v3
    s_waitcnt lgkmcnt(0)
    s_mov_b32 s8, s6
    s_and_b32 s9, s7, 0xffff
    s_mov_b32 s10, 2097152
    s_mov_b32 s11, 0x00020000
    s_mov_b32 s16, s4
    s_and_b32 s17, s5, 0xffff
    s_mov_b32 s18, 67108864
    s_mov_b32 s19, 0x00020000
    buffer_load_dwordx4 v[8:11], v3, s[8:11], 0 offen offset:0
    buffer_load_dwordx4 v[12:15], v3, s[8:11], 0 offen offset:256
    buffer_load_dwordx4 v[16:19], v3, s[8:11], 0 offen offset:512
    buffer_load_dwordx4 v[20:23], v3, s[8:11], 0 offen offset:768
    v_lshrrev_b32 v72, 6, v0
    v_and_b32 v73, 63, v0
    v_readfirstlane_b32 s42, v72
    s_lshr_b32 s43, s2, 3
    s_lshl_b32 s43, s43, 2
    s_add_u32 s43, s43, s42
    s_cmp_ge_u32 s43, (code_end-attn_kernel+8191)/8192
    s_cbranch_scc1 prep_kernel_nocpf_3
    s_getpc_b64 s[44:45]
prep_kernel_pc_4:
    s_add_u32 s44, s44, attn_kernel-prep_kernel_pc_4
    s_addc_u32 s45, s45, 0
    s_lshl_b32 s43, s43, 13
    v_lshlrev_b32 v74, 7, v73
    v_add_u32 v74, s43, v74
    v_min_u32 v74, code_end-attn_kernel-4, v74
    v_mov_b32 v75, s45
    v_add_co_u32 v74, vcc, s44, v74
    s_nop 1
    v_addc_co_u32 v75, vcc, 0, v75, vcc
    global_load_dword v76, v[74:75], off
prep_kernel_nocpf_3:
    v_lshrrev_b32 v72, 6, v0
    v_and_b32 v73, 63, v0
    v_readfirstlane_b32 s42, v72
    v_lshrrev_b32 v77, 3, v73
    v_and_b32 v78, 7, v73
    v_lshlrev_b32 v77, 13, v77
    v_lshl_add_u32 v77, v78, 7, v77
    s_sub_u32 s43, s2, 96
    s_lshr_b32 s43, s43, 3
    s_lshl_b32 s43, s43, 2
    s_add_u32 s43, s43, s42
    s_lshl_b32 s43, s43, 16
    s_and_b32 s44, s2, 7
    s_lshl_b32 s44, s44, 10
    s_add_u32 s43, s43, s44
    s_mov_b32 s48, s40
    s_and_b32 s49, s41, 0xffff
    s_mov_b32 s50, 4194304
    s_mov_b32 s51, 0x00020000
    buffer_load_dword v78, v77, s[48:51], s43 offen
    s_sub_u32 s43, s2, 96
    s_cmp_ge_u32 s43, 16
    s_cbranch_scc1 prep_nofl
    s_lshl_b32 s43, s43, 10
    s_add_u32 s43, s43, 16384
    v_lshlrev_b32 v72, 2, v0
    v_mov_b32 v73, 0
    buffer_store_dword v73, v72, s[16:19], s43 offen
prep_nofl:
    v_lshrrev_b32 v4, 5, v1
    v_lshlrev_b32 v4, 15, v4
    v_lshrrev_b32 v5, 1, v2
    v_lshl_add_u32 v4, v5, 10, v4
    v_and_b32 v5, 1, v2
    v_lshl_add_u32 v4, v5, 9, v4
    v_and_b32 v5, 31, v1
    v_lshl_add_u32 v4, v5, 4, v4
    s_waitcnt vmcnt(4)
    v_lshlrev_b32 v32, 16, v8
    v_and_b32 v33, 0xffff0000, v8
    v_lshlrev_b32 v34, 16, v9
    v_and_b32 v35, 0xffff0000, v9
    v_lshlrev_b32 v36, 16, v10
    v_and_b32 v37, 0xffff0000, v10
    v_lshlrev_b32 v38, 16, v11
    v_and_b32 v39, 0xffff0000, v11
    s_waitcnt vmcnt(3)
    v_lshlrev_b32 v40, 16, v12
    v_and_b32 v41, 0xffff0000, v12
    v_lshlrev_b32 v42, 16, v13
    v_and_b32 v43, 0xffff0000, v13
    v_lshlrev_b32 v44, 16, v14
    v_and_b32 v45, 0xffff0000, v14
    v_lshlrev_b32 v46, 16, v15
    v_and_b32 v47, 0xffff0000, v15
    s_waitcnt vmcnt(2)
    v_lshlrev_b32 v48, 16, v16
    v_and_b32 v49, 0xffff0000, v16
    v_lshlrev_b32 v50, 16, v17
    v_and_b32 v51, 0xffff0000, v17
    v_lshlrev_b32 v52, 16, v18
    v_and_b32 v53, 0xffff0000, v18
    v_lshlrev_b32 v54, 16, v19
    v_and_b32 v55, 0xffff0000, v19
    s_waitcnt vmcnt(1)
    v_lshlrev_b32 v56, 16, v20
    v_and_b32 v57, 0xffff0000, v20
    v_lshlrev_b32 v58, 16, v21
    v_and_b32 v59, 0xffff0000, v21
    v_lshlrev_b32 v60, 16, v22
    v_and_b32 v61, 0xffff0000, v22
    v_lshlrev_b32 v62, 16, v23
    v_and_b32 v63, 0xffff0000, v23
    v_add_f32 v24, v32, v33
    v_add_f32 v25, v34, v35
    v_add_f32 v24, v24, v36
    v_add_f32 v25, v25, v37
    v_add_f32 v24, v24, v38
    v_add_f32 v25, v25, v39
    v_add_f32 v24, v24, v40
    v_add_f32 v25, v25, v41
    v_add_f32 v24, v24, v42
    v_add_f32 v25, v25, v43
    v_add_f32 v24, v24, v44
    v_add_f32 v25, v25, v45
    v_add_f32 v24, v24, v46
    v_add_f32 v25, v25, v47
    v_add_f32 v24, v24, v48
    v_add_f32 v25, v25, v49
    v_add_f32 v24, v24, v50
    v_add_f32 v25, v25, v51
    v_add_f32 v24, v24, v52
    v_add_f32 v25, v25, v53
    v_add_f32 v24, v24, v54
    v_add_f32 v25, v25, v55
    v_add_f32 v24, v24, v56
    v_add_f32 v25, v25, v57
    v_add_f32 v24, v24, v58
    v_add_f32 v25, v25, v59
    v_add_f32 v24, v24, v60
    v_add_f32 v25, v25, v61
    v_add_f32 v24, v24, v62
    v_add_f32 v25, v25, v63
    v_add_f32 v24, v24, v25
    s_nop 1
    v_add_f32_dpp v25, v24, v24 quad_perm:[1,0,3,2] row_mask:0xf bank_mask:0xf
    s_nop 1
    v_add_f32_dpp v24, v25, v25 quad_perm:[2,3,0,1] row_mask:0xf bank_mask:0xf
    s_nop 1
    v_add_f32_dpp v25, v24, v24 row_half_mirror row_mask:0xf bank_mask:0xf
    s_nop 1
    v_add_f32_dpp v24, v25, v25 row_mirror row_mask:0xf bank_mask:0xf
    s_mov_b32 s3, 0x3b000000
    v_mul_f32 v24, s3, v24
    v_sub_f32 v64, v32, v24
    v_mul_f32 v26, v64, v64
    v_sub_f32 v65, v33, v24
    v_mul_f32 v27, v65, v65
    v_sub_f32 v66, v34, v24
    v_fmac_f32 v26, v66, v66
    v_sub_f32 v67, v35, v24
    v_fmac_f32 v27, v67, v67
    v_sub_f32 v64, v36, v24
    v_fmac_f32 v26, v64, v64
    v_sub_f32 v65, v37, v24
    v_fmac_f32 v27, v65, v65
    v_sub_f32 v66, v38, v24
    v_fmac_f32 v26, v66, v66
    v_sub_f32 v67, v39, v24
    v_fmac_f32 v27, v67, v67
    v_sub_f32 v64, v40, v24
    v_fmac_f32 v26, v64, v64
    v_sub_f32 v65, v41, v24
    v_fmac_f32 v27, v65, v65
    v_sub_f32 v66, v42, v24
    v_fmac_f32 v26, v66, v66
    v_sub_f32 v67, v43, v24
    v_fmac_f32 v27, v67, v67
    v_sub_f32 v64, v44, v24
    v_fmac_f32 v26, v64, v64
    v_sub_f32 v65, v45, v24
    v_fmac_f32 v27, v65, v65
    v_sub_f32 v66, v46, v24
    v_fmac_f32 v26, v66, v66
    v_sub_f32 v67, v47, v24
    v_fmac_f32 v27, v67, v67
    v_sub_f32 v64, v48, v24
    v_fmac_f32 v26, v64, v64
    v_sub_f32 v65, v49, v24
    v_fmac_f32 v27, v65, v65
    v_sub_f32 v66, v50, v24
    v_fmac_f32 v26, v66, v66
    v_sub_f32 v67, v51, v24
    v_fmac_f32 v27, v67, v67
    v_sub_f32 v64, v52, v24
    v_fmac_f32 v26, v64, v64
    v_sub_f32 v65, v53, v24
    v_fmac_f32 v27, v65, v65
    v_sub_f32 v66, v54, v24
    v_fmac_f32 v26, v66, v66
    v_sub_f32 v67, v55, v24
    v_fmac_f32 v27, v67, v67
    v_sub_f32 v64, v56, v24
    v_fmac_f32 v26, v64, v64
    v_sub_f32 v65, v57, v24
    v_fmac_f32 v27, v65, v65
    v_sub_f32 v66, v58, v24
    v_fmac_f32 v26, v66, v66
    v_sub_f32 v67, v59, v24
    v_fmac_f32 v27, v67, v67
    v_sub_f32 v64, v60, v24
    v_fmac_f32 v26, v64, v64
    v_sub_f32 v65, v61, v24
    v_fmac_f32 v27, v65, v65
    v_sub_f32 v66, v62, v24
    v_fmac_f32 v26, v66, v66
    v_sub_f32 v67, v63, v24
    v_fmac_f32 v27, v67, v67
    v_add_f32 v26, v26, v27
    s_nop 1
    v_add_f32_dpp v27, v26, v26 quad_perm:[1,0,3,2] row_mask:0xf bank_mask:0xf
    s_nop 1
    v_add_f32_dpp v26, v27, v27 quad_perm:[2,3,0,1] row_mask:0xf bank_mask:0xf
    s_nop 1
    v_add_f32_dpp v27, v26, v26 row_half_mirror row_mask:0xf bank_mask:0xf
    s_nop 1
    v_add_f32_dpp v26, v27, v27 row_mirror row_mask:0xf bank_mask:0xf
    v_mul_f32 v26, s3, v26
    v_cvt_pk_bf16_f32 v24, 0, v24
    v_cvt_pk_bf16_f32 v26, 0, v26
    v_add_f32 v26, 0x3727c5ac, v26
    v_cvt_pk_bf16_f32 v26, 0, v26
    v_sqrt_f32 v26, v26
    s_nop 0
    v_cvt_pk_bf16_f32 v26, 0, v26
    v_rcp_f32 v26, v26
    s_mov_b32 s24, 65536
    v_sub_f32 v32, v32, v24
    v_sub_f32 v33, v33, v24
    v_sub_f32 v34, v34, v24
    v_sub_f32 v35, v35, v24
    v_sub_f32 v36, v36, v24
    v_sub_f32 v37, v37, v24
    v_sub_f32 v38, v38, v24
    v_sub_f32 v39, v39, v24
    v_cvt_pk_bf16_f32 v32, 0, v32
    v_cvt_pk_bf16_f32 v33, 0, v33
    v_cvt_pk_bf16_f32 v34, 0, v34
    v_cvt_pk_bf16_f32 v35, 0, v35
    v_cvt_pk_bf16_f32 v36, 0, v36
    v_cvt_pk_bf16_f32 v37, 0, v37
    v_cvt_pk_bf16_f32 v38, 0, v38
    v_cvt_pk_bf16_f32 v39, 0, v39
    v_mul_f32 v32, v32, v26
    v_mul_f32 v33, v33, v26
    v_mul_f32 v34, v34, v26
    v_mul_f32 v35, v35, v26
    v_mul_f32 v36, v36, v26
    v_mul_f32 v37, v37, v26
    v_mul_f32 v38, v38, v26
    v_mul_f32 v39, v39, v26
    v_cvt_pk_bf16_f32 v32, 0, v32
    v_cvt_pk_bf16_f32 v33, 0, v33
    v_cvt_pk_bf16_f32 v34, 0, v34
    v_cvt_pk_bf16_f32 v35, 0, v35
    v_cvt_pk_bf16_f32 v36, 0, v36
    v_cvt_pk_bf16_f32 v37, 0, v37
    v_cvt_pk_bf16_f32 v38, 0, v38
    v_cvt_pk_bf16_f32 v39, 0, v39
    v_cvt_pkrtz_f16_f32 v8, v32, v33
    v_cvt_pkrtz_f16_f32 v9, v34, v35
    v_cvt_pkrtz_f16_f32 v10, v36, v37
    v_cvt_pkrtz_f16_f32 v11, v38, v39
    buffer_store_dwordx4 v[8:11], v4, s[16:19], s24 offen
    s_add_u32 s24, s24, 8192
    v_sub_f32 v40, v40, v24
    v_sub_f32 v41, v41, v24
    v_sub_f32 v42, v42, v24
    v_sub_f32 v43, v43, v24
    v_sub_f32 v44, v44, v24
    v_sub_f32 v45, v45, v24
    v_sub_f32 v46, v46, v24
    v_sub_f32 v47, v47, v24
    v_cvt_pk_bf16_f32 v40, 0, v40
    v_cvt_pk_bf16_f32 v41, 0, v41
    v_cvt_pk_bf16_f32 v42, 0, v42
    v_cvt_pk_bf16_f32 v43, 0, v43
    v_cvt_pk_bf16_f32 v44, 0, v44
    v_cvt_pk_bf16_f32 v45, 0, v45
    v_cvt_pk_bf16_f32 v46, 0, v46
    v_cvt_pk_bf16_f32 v47, 0, v47
    v_mul_f32 v40, v40, v26
    v_mul_f32 v41, v41, v26
    v_mul_f32 v42, v42, v26
    v_mul_f32 v43, v43, v26
    v_mul_f32 v44, v44, v26
    v_mul_f32 v45, v45, v26
    v_mul_f32 v46, v46, v26
    v_mul_f32 v47, v47, v26
    v_cvt_pk_bf16_f32 v40, 0, v40
    v_cvt_pk_bf16_f32 v41, 0, v41
    v_cvt_pk_bf16_f32 v42, 0, v42
    v_cvt_pk_bf16_f32 v43, 0, v43
    v_cvt_pk_bf16_f32 v44, 0, v44
    v_cvt_pk_bf16_f32 v45, 0, v45
    v_cvt_pk_bf16_f32 v46, 0, v46
    v_cvt_pk_bf16_f32 v47, 0, v47
    v_cvt_pkrtz_f16_f32 v12, v40, v41
    v_cvt_pkrtz_f16_f32 v13, v42, v43
    v_cvt_pkrtz_f16_f32 v14, v44, v45
    v_cvt_pkrtz_f16_f32 v15, v46, v47
    buffer_store_dwordx4 v[12:15], v4, s[16:19], s24 offen
    s_add_u32 s24, s24, 8192
    v_sub_f32 v48, v48, v24
    v_sub_f32 v49, v49, v24
    v_sub_f32 v50, v50, v24
    v_sub_f32 v51, v51, v24
    v_sub_f32 v52, v52, v24
    v_sub_f32 v53, v53, v24
    v_sub_f32 v54, v54, v24
    v_sub_f32 v55, v55, v24
    v_cvt_pk_bf16_f32 v48, 0, v48
    v_cvt_pk_bf16_f32 v49, 0, v49
    v_cvt_pk_bf16_f32 v50, 0, v50
    v_cvt_pk_bf16_f32 v51, 0, v51
    v_cvt_pk_bf16_f32 v52, 0, v52
    v_cvt_pk_bf16_f32 v53, 0, v53
    v_cvt_pk_bf16_f32 v54, 0, v54
    v_cvt_pk_bf16_f32 v55, 0, v55
    v_mul_f32 v48, v48, v26
    v_mul_f32 v49, v49, v26
    v_mul_f32 v50, v50, v26
    v_mul_f32 v51, v51, v26
    v_mul_f32 v52, v52, v26
    v_mul_f32 v53, v53, v26
    v_mul_f32 v54, v54, v26
    v_mul_f32 v55, v55, v26
    v_cvt_pk_bf16_f32 v48, 0, v48
    v_cvt_pk_bf16_f32 v49, 0, v49
    v_cvt_pk_bf16_f32 v50, 0, v50
    v_cvt_pk_bf16_f32 v51, 0, v51
    v_cvt_pk_bf16_f32 v52, 0, v52
    v_cvt_pk_bf16_f32 v53, 0, v53
    v_cvt_pk_bf16_f32 v54, 0, v54
    v_cvt_pk_bf16_f32 v55, 0, v55
    v_cvt_pkrtz_f16_f32 v16, v48, v49
    v_cvt_pkrtz_f16_f32 v17, v50, v51
    v_cvt_pkrtz_f16_f32 v18, v52, v53
    v_cvt_pkrtz_f16_f32 v19, v54, v55
    buffer_store_dwordx4 v[16:19], v4, s[16:19], s24 offen
    s_add_u32 s24, s24, 8192
    v_sub_f32 v56, v56, v24
    v_sub_f32 v57, v57, v24
    v_sub_f32 v58, v58, v24
    v_sub_f32 v59, v59, v24
    v_sub_f32 v60, v60, v24
    v_sub_f32 v61, v61, v24
    v_sub_f32 v62, v62, v24
    v_sub_f32 v63, v63, v24
    v_cvt_pk_bf16_f32 v56, 0, v56
    v_cvt_pk_bf16_f32 v57, 0, v57
    v_cvt_pk_bf16_f32 v58, 0, v58
    v_cvt_pk_bf16_f32 v59, 0, v59
    v_cvt_pk_bf16_f32 v60, 0, v60
    v_cvt_pk_bf16_f32 v61, 0, v61
    v_cvt_pk_bf16_f32 v62, 0, v62
    v_cvt_pk_bf16_f32 v63, 0, v63
    v_mul_f32 v56, v56, v26
    v_mul_f32 v57, v57, v26
    v_mul_f32 v58, v58, v26
    v_mul_f32 v59, v59, v26
    v_mul_f32 v60, v60, v26
    v_mul_f32 v61, v61, v26
    v_mul_f32 v62, v62, v26
    v_mul_f32 v63, v63, v26
    v_cvt_pk_bf16_f32 v56, 0, v56
    v_cvt_pk_bf16_f32 v57, 0, v57
    v_cvt_pk_bf16_f32 v58, 0, v58
    v_cvt_pk_bf16_f32 v59, 0, v59
    v_cvt_pk_bf16_f32 v60, 0, v60
    v_cvt_pk_bf16_f32 v61, 0, v61
    v_cvt_pk_bf16_f32 v62, 0, v62
    v_cvt_pk_bf16_f32 v63, 0, v63
    v_cvt_pkrtz_f16_f32 v20, v56, v57
    v_cvt_pkrtz_f16_f32 v21, v58, v59
    v_cvt_pkrtz_f16_f32 v22, v60, v61
    v_cvt_pkrtz_f16_f32 v23, v62, v63
    buffer_store_dwordx4 v[20:23], v4, s[16:19], s24 offen
prep_end:
    s_endpgm

.globl attn_kernel
.p2align 8
.type attn_kernel,@function
attn_kernel:
    s_cmp_ge_u32 s2, 256
    s_cbranch_scc1 attn_end
    s_load_dwordx4 s[4:7], s[0:1], 8
    s_load_dwordx2 s[24:25], s[0:1], 24
    s_load_dwordx2 s[26:27], s[0:1], 104
    s_load_dwordx2 s[48:49], s[0:1], 32
    s_load_dwordx4 s[52:55], s[0:1], 56
    s_load_dwordx2 s[50:51], s[0:1], 48
    s_load_dwordx2 s[60:61], s[0:1], 0
    s_load_dwordx4 s[56:59], s[0:1], 48
    s_load_dwordx2 s[62:63], s[0:1], 88
    s_and_b32 s28, s2, 7
    s_lshl_b32 s28, s28, 2
    s_lshr_b32 s29, s2, 3
    s_and_b32 s30, s29, 3
    s_add_u32 s28, s28, s30
    s_lshr_b32 s29, s29, 2
    v_lshrrev_b32 v1, 6, v0
    v_and_b32 v235, 63, v0
    v_readfirstlane_b32 s32, v1
    v_lshlrev_b32 v233, 4, v235
    s_lshl_b32 s33, s32, 12
    v_lshrrev_b32 v2, 4, v235
    v_and_b32 v3, 15, v235
    v_lshrrev_b32 v4, 5, v235
    v_and_b32 v5, 31, v235
    v_lshlrev_b32 v6, 2, v2
    v_xor_b32 v6, v6, v3
    v_lshlrev_b32 v6, 4, v6
    v_lshl_add_u32 v232, v2, 8, v6
    v_add_u32 v232, s33, v232
    s_lshl_b32 s3, s32, 17
    v_lshl_add_u32 v7, v2, 13, v6
    v_add_u32 v7, s3, v7
    s_waitcnt lgkmcnt(0)
    s_lshl_b32 s3, s28, 19
    s_add_u32 s4, s4, s3
    s_addc_u32 s5, s5, 0
    s_add_u32 s6, s6, s3
    s_addc_u32 s7, s7, 0
    s_mov_b32 s8, s4
    s_and_b32 s9, s5, 0xffff
    s_mov_b32 s10, 524288
    s_mov_b32 s11, 0x00020000
    s_mov_b32 s12, s6
    s_and_b32 s13, s7, 0xffff
    s_mov_b32 s14, 524288
    s_mov_b32 s15, 0x00020000
    s_lshl_b32 s3, s28, 8
    s_add_u32 s24, s24, s3
    s_addc_u32 s25, s25, 0
    s_mov_b32 s16, s24
    s_and_b32 s17, s25, 0xffff
    s_sub_u32 s18, 4194304, s3
    s_mov_b32 s19, 0x00020000
    s_mov_b32 s20, s26
    s_and_b32 s21, s27, 0xffff
    s_mov_b32 s22, 67108864
    s_mov_b32 s23, 0x00020000
    s_lshl_b32 s3, s29, 3
    s_lshl_b32 s39, s32, 1
    s_add_u32 s3, s3, s39
    s_lshl_b32 s38, s3, 15
    s_add_u32 s38, s38, 65536
    s_lshl_b32 s41, s3, 18
    s_lshl_b32 s39, s28, 13
    s_add_u32 s41, s41, s39
    s_add_u32 s41, s41, 4194304
    s_lshl_b32 s39, s32, 10
    s_add_u32 m0, s39, 131072
    s_add_u32 s39, s39, 0
    buffer_load_dwordx4 v233, s[20:23], s39 offen lds
    s_add_u32 m0, s33, 0
    s_mov_b32 s39, 0
    buffer_load_dwordx4 v7, s[16:19], s39 offen offset:0 lds
    s_mov_b32 s39, 31744
    buffer_load_dwordx4 v7, s[16:19], s39 offen offset:1024 lds
    s_mov_b32 s39, 63488
    buffer_load_dwordx4 v7, s[16:19], s39 offen offset:2048 lds
    s_mov_b32 s39, 95232
    buffer_load_dwordx4 v7, s[16:19], s39 offen offset:3072 lds
    s_add_u32 s40, s38, 0
    buffer_load_dwordx4 v[8:11], v233, s[20:23], s40 offen offset:0
    s_add_u32 s43, s38, 32768
    buffer_load_dwordx4 v[12:15], v233, s[20:23], s43 offen offset:0
    buffer_load_dwordx4 v[16:19], v233, s[20:23], s40 offen offset:1024
    buffer_load_dwordx4 v[20:23], v233, s[20:23], s43 offen offset:1024
    buffer_load_dwordx4 v[24:27], v233, s[20:23], s40 offen offset:2048
    buffer_load_dwordx4 v[28:31], v233, s[20:23], s43 offen offset:2048
    buffer_load_dwordx4 v[32:35], v233, s[20:23], s40 offen offset:3072
    buffer_load_dwordx4 v[36:39], v233, s[20:23], s43 offen offset:3072
    v_lshrrev_b32 v236, 2, v3
    v_and_b32 v237, 3, v235
    v_and_b32 v238, 1, v2
    v_lshlrev_b32 v238, 5, v238
    v_and_b32 v239, 1, v237
    v_lshl_add_u32 v238, v239, 4, v238
    v_lshrrev_b32 v239, 1, v237
    v_lshl_add_u32 v238, v239, 3, v238
    v_lshl_add_u32 v238, v236, 8, v238
    v_xor_b32 v239, 0, v236
    v_lshl_add_u32 v239, v239, 6, v238
    v_lshl_add_u32 v200, v4, 11, v239
    v_add_u32 v204, 65536, v200
    v_lshl_add_u32 v224, v4, 10, v239
    v_add_u32 v224, 65536, v224
    v_xor_b32 v239, 1, v236
    v_lshl_add_u32 v239, v239, 6, v238
    v_lshl_add_u32 v201, v4, 11, v239
    v_add_u32 v205, 65536, v201
    v_lshl_add_u32 v225, v4, 10, v239
    v_add_u32 v225, 65536, v225
    v_xor_b32 v239, 2, v236
    v_lshl_add_u32 v239, v239, 6, v238
    v_lshl_add_u32 v202, v4, 11, v239
    v_add_u32 v206, 65536, v202
    v_lshl_add_u32 v226, v4, 10, v239
    v_add_u32 v226, 65536, v226
    v_xor_b32 v239, 3, v236
    v_lshl_add_u32 v239, v239, 6, v238
    v_lshl_add_u32 v203, v4, 11, v239
    v_add_u32 v207, 65536, v203
    v_lshl_add_u32 v227, v4, 10, v239
    v_add_u32 v227, 65536, v227
    v_add_u32 v239, 0, v4
    v_xor_b32 v239, v239, v3
    v_lshlrev_b32 v239, 4, v239
    v_lshl_add_u32 v216, v5, 8, v239
    v_add_u32 v239, 2, v4
    v_xor_b32 v239, v239, v3
    v_lshlrev_b32 v239, 4, v239
    v_lshl_add_u32 v217, v5, 8, v239
    v_add_u32 v239, 4, v4
    v_xor_b32 v239, v239, v3
    v_lshlrev_b32 v239, 4, v239
    v_lshl_add_u32 v218, v5, 8, v239
    v_add_u32 v239, 6, v4
    v_xor_b32 v239, v239, v3
    v_lshlrev_b32 v239, 4, v239
    v_lshl_add_u32 v219, v5, 8, v239
    v_add_u32 v239, 8, v4
    v_xor_b32 v239, v239, v3
    v_lshlrev_b32 v239, 4, v239
    v_lshl_add_u32 v220, v5, 8, v239
    v_add_u32 v239, 10, v4
    v_xor_b32 v239, v239, v3
    v_lshlrev_b32 v239, 4, v239
    v_lshl_add_u32 v221, v5, 8, v239
    v_add_u32 v239, 12, v4
    v_xor_b32 v239, v239, v3
    v_lshlrev_b32 v239, 4, v239
    v_lshl_add_u32 v222, v5, 8, v239
    v_add_u32 v239, 14, v4
    v_xor_b32 v239, v239, v3
    v_lshlrev_b32 v239, 4, v239
    v_lshl_add_u32 v223, v5, 8, v239
    v_add_u32 v239, 0, v2
    v_xor_b32 v239, v239, v3
    v_lshlrev_b32 v239, 4, v239
    v_lshl_add_u32 v239, v2, 8, v239
    v_add_u32 v228, s33, v239
    v_add_u32 v239, 4, v2
    v_xor_b32 v239, v239, v3
    v_lshlrev_b32 v239, 4, v239
    v_lshl_add_u32 v239, v2, 8, v239
    v_add_u32 v229, s33, v239
    v_add_u32 v239, 8, v2
    v_xor_b32 v239, v239, v3
    v_lshlrev_b32 v239, 4, v239
    v_lshl_add_u32 v239, v2, 8, v239
    v_add_u32 v230, s33, v239
    v_add_u32 v239, 12, v2
    v_xor_b32 v239, v239, v3
    v_lshlrev_b32 v239, 4, v239
    v_lshl_add_u32 v239, v2, 8, v239
    v_add_u32 v231, s33, v239
    v_lshlrev_b32 v234, 6, v4
    v_add_u32 v234, 131072, v234
    s_mov_b32 s37, 0x6c800000
    s_waitcnt vmcnt(8)
    s_barrier
    ds_read_b128 v[152:155], v234 offset:0
    ds_read_b128 v[156:159], v234 offset:16
    ds_read_b128 v[160:163], v234 offset:32
    ds_read_b128 v[164:167], v234 offset:48
    ds_read_b64_tr_b16 a[128:129], v200 offset:0
    ds_read_b64_tr_b16 a[130:131], v200 offset:1024
    ds_read_b64_tr_b16 a[132:133], v201 offset:0
    ds_read_b64_tr_b16 a[134:135], v201 offset:1024
    ds_read_b64_tr_b16 a[136:137], v202 offset:0
    ds_read_b64_tr_b16 a[138:139], v202 offset:1024
    ds_read_b64_tr_b16 a[140:141], v203 offset:0
    ds_read_b64_tr_b16 a[142:143], v203 offset:1024
    ds_read_b128 v[168:171], v234 offset:128
    ds_read_b128 v[172:175], v234 offset:144
    ds_read_b128 v[176:179], v234 offset:160
    ds_read_b128 v[180:183], v234 offset:176
    s_waitcnt vmcnt(6) lgkmcnt(12)
    v_fma_mix_f32 v184, v8, v152, v160 op_sel_hi:[1,0,0]
    v_fma_mix_f32 v185, v8, v153, v161 op_sel:[1,0,0] op_sel_hi:[1,0,0]
    v_cvt_pk_bf16_f32 v136, v184, v185
    v_fma_mix_f32 v186, v9, v154, v162 op_sel_hi:[1,0,0]
    v_fma_mix_f32 v187, v9, v155, v163 op_sel:[1,0,0] op_sel_hi:[1,0,0]
    v_cvt_pk_bf16_f32 v137, v186, v187
    v_fma_mix_f32 v188, v10, v156, v164 op_sel_hi:[1,0,0]
    v_fma_mix_f32 v189, v10, v157, v165 op_sel:[1,0,0] op_sel_hi:[1,0,0]
    v_cvt_pk_bf16_f32 v138, v188, v189
    v_fma_mix_f32 v190, v11, v158, v166 op_sel_hi:[1,0,0]
    v_fma_mix_f32 v191, v11, v159, v167 op_sel:[1,0,0] op_sel_hi:[1,0,0]
    v_cvt_pk_bf16_f32 v139, v190, v191
    v_fma_mix_f32 v192, v12, v152, v160 op_sel_hi:[1,0,0]
    v_fma_mix_f32 v193, v12, v153, v161 op_sel:[1,0,0] op_sel_hi:[1,0,0]
    v_cvt_pk_bf16_f32 v140, v192, v193
    v_fma_mix_f32 v194, v13, v154, v162 op_sel_hi:[1,0,0]
    v_fma_mix_f32 v195, v13, v155, v163 op_sel:[1,0,0] op_sel_hi:[1,0,0]
    v_cvt_pk_bf16_f32 v141, v194, v195
    v_fma_mix_f32 v196, v14, v156, v164 op_sel_hi:[1,0,0]
    v_fma_mix_f32 v197, v14, v157, v165 op_sel:[1,0,0] op_sel_hi:[1,0,0]
    v_cvt_pk_bf16_f32 v142, v196, v197
    v_fma_mix_f32 v198, v15, v158, v166 op_sel_hi:[1,0,0]
    v_fma_mix_f32 v199, v15, v159, v167 op_sel:[1,0,0] op_sel_hi:[1,0,0]
    v_cvt_pk_bf16_f32 v143, v198, v199
    s_waitcnt lgkmcnt(4)
    v_mfma_f32_32x32x16_bf16 a[0:15], a[128:131], v[136:139], 0
    s_waitcnt vmcnt(4) lgkmcnt(0)
    ds_read_b128 v[152:155], v234 offset:256
    ds_read_b128 v[156:159], v234 offset:272
    ds_read_b128 v[160:163], v234 offset:288
    v_fma_mix_f32 v184, v16, v168, v176 op_sel_hi:[1,0,0]
    v_fma_mix_f32 v185, v16, v169, v177 op_sel:[1,0,0] op_sel_hi:[1,0,0]
    v_cvt_pk_bf16_f32 v144, v184, v185
    v_fma_mix_f32 v186, v17, v170, v178 op_sel_hi:[1,0,0]
    v_mfma_f32_32x32x16_bf16 a[16:31], a[128:131], v[140:143], 0
    ds_read_b128 v[164:167], v234 offset:304
    ds_read_b64_tr_b16 a[144:145], v200 offset:4096
    ds_read_b64_tr_b16 a[146:147], v200 offset:5120
    v_fma_mix_f32 v187, v17, v171, v179 op_sel:[1,0,0] op_sel_hi:[1,0,0]
    v_cvt_pk_bf16_f32 v145, v186, v187
    v_fma_mix_f32 v188, v18, v172, v180 op_sel_hi:[1,0,0]
    v_fma_mix_f32 v189, v18, v173, v181 op_sel:[1,0,0] op_sel_hi:[1,0,0]
    v_mfma_f32_32x32x16_bf16 a[32:47], a[132:135], v[136:139], 0
    ds_read_b64_tr_b16 a[148:149], v201 offset:4096
    ds_read_b64_tr_b16 a[150:151], v201 offset:5120
    ds_read_b64_tr_b16 a[152:153], v202 offset:4096
    v_cvt_pk_bf16_f32 v146, v188, v189
    v_fma_mix_f32 v190, v19, v174, v182 op_sel_hi:[1,0,0]
    v_fma_mix_f32 v191, v19, v175, v183 op_sel:[1,0,0] op_sel_hi:[1,0,0]
    v_cvt_pk_bf16_f32 v147, v190, v191
    v_mfma_f32_32x32x16_bf16 a[48:63], a[132:135], v[140:143], 0
    ds_read_b64_tr_b16 a[154:155], v202 offset:5120
    ds_read_b64_tr_b16 a[156:157], v203 offset:4096
    ds_read_b64_tr_b16 a[158:159], v203 offset:5120
    v_fma_mix_f32 v192, v20, v168, v176 op_sel_hi:[1,0,0]
    v_fma_mix_f32 v193, v20, v169, v177 op_sel:[1,0,0] op_sel_hi:[1,0,0]
    s_add_u32 m0, s33, 16384
    s_mov_b32 s39, 524288
    v_mfma_f32_32x32x16_bf16 a[64:79], a[136:139], v[136:139], 0
    buffer_load_dwordx4 v7, s[16:19], s39 offen offset:0 lds
    v_cvt_pk_bf16_f32 v148, v192, v193
    v_fma_mix_f32 v194, v21, v170, v178 op_sel_hi:[1,0,0]
    v_fma_mix_f32 v195, v21, v171, v179 op_sel:[1,0,0] op_sel_hi:[1,0,0]
    s_mov_b32 s39, 556032
    v_mfma_f32_32x32x16_bf16 a[80:95], a[136:139], v[140:143], 0
    buffer_load_dwordx4 v7, s[16:19], s39 offen offset:1024 lds
    v_cvt_pk_bf16_f32 v149, v194, v195
    v_fma_mix_f32 v196, v22, v172, v180 op_sel_hi:[1,0,0]
    v_fma_mix_f32 v197, v22, v173, v181 op_sel:[1,0,0] op_sel_hi:[1,0,0]
    v_cvt_pk_bf16_f32 v150, v196, v197
    s_mov_b32 s39, 587776
    v_mfma_f32_32x32x16_bf16 a[96:111], a[140:143], v[136:139], 0
    buffer_load_dwordx4 v7, s[16:19], s39 offen offset:2048 lds
    v_fma_mix_f32 v198, v23, v174, v182 op_sel_hi:[1,0,0]
    v_fma_mix_f32 v199, v23, v175, v183 op_sel:[1,0,0] op_sel_hi:[1,0,0]
    v_cvt_pk_bf16_f32 v151, v198, v199
    s_mov_b32 s39, 619520
    v_mfma_f32_32x32x16_bf16 a[112:127], a[140:143], v[140:143], 0
    s_waitcnt lgkmcnt(0)
    buffer_load_dwordx4 v7, s[16:19], s39 offen offset:3072 lds
    v_mfma_f32_32x32x16_bf16 a[0:15], a[144:147], v[144:147], a[0:15]
    s_waitcnt vmcnt(6)
    ds_read_b128 v[168:171], v234 offset:384
    ds_read_b128 v[172:175], v234 offset:400
    ds_read_b128 v[176:179], v234 offset:416
    v_fma_mix_f32 v184, v24, v152, v160 op_sel_hi:[1,0,0]
    v_fma_mix_f32 v185, v24, v153, v161 op_sel:[1,0,0] op_sel_hi:[1,0,0]
    v_cvt_pk_bf16_f32 v136, v184, v185
    v_mfma_f32_32x32x16_bf16 a[16:31], a[144:147], v[148:151], a[16:31]
    ds_read_b128 v[180:183], v234 offset:432
    ds_read_b64_tr_b16 a[128:129], v200 offset:8192
    ds_read_b64_tr_b16 a[130:131], v200 offset:9216
    v_fma_mix_f32 v186, v25, v154, v162 op_sel_hi:[1,0,0]
    v_fma_mix_f32 v187, v25, v155, v163 op_sel:[1,0,0] op_sel_hi:[1,0,0]
    v_cvt_pk_bf16_f32 v137, v186, v187
    v_fma_mix_f32 v188, v26, v156, v164 op_sel_hi:[1,0,0]
    v_mfma_f32_32x32x16_bf16 a[32:47], a[148:151], v[144:147], a[32:47]
    ds_read_b64_tr_b16 a[132:133], v201 offset:8192
    ds_read_b64_tr_b16 a[134:135], v201 offset:9216
    ds_read_b64_tr_b16 a[136:137], v202 offset:8192
    v_fma_mix_f32 v189, v26, v157, v165 op_sel:[1,0,0] op_sel_hi:[1,0,0]
    v_cvt_pk_bf16_f32 v138, v188, v189
    v_fma_mix_f32 v190, v27, v158, v166 op_sel_hi:[1,0,0]
    v_mfma_f32_32x32x16_bf16 a[48:63], a[148:151], v[148:151], a[48:63]
    ds_read_b64_tr_b16 a[138:139], v202 offset:9216
    ds_read_b64_tr_b16 a[140:141], v203 offset:8192
    ds_read_b64_tr_b16 a[142:143], v203 offset:9216
    v_fma_mix_f32 v191, v27, v159, v167 op_sel:[1,0,0] op_sel_hi:[1,0,0]
    v_cvt_pk_bf16_f32 v139, v190, v191
    v_fma_mix_f32 v192, v28, v152, v160 op_sel_hi:[1,0,0]
    s_add_u32 s40, s38, 4096
    v_mfma_f32_32x32x16_bf16 a[64:79], a[152:155], v[144:147], a[64:79]
    buffer_load_dwordx4 v[40:43], v233, s[20:23], s40 offen offset:0
    v_fma_mix_f32 v193, v28, v153, v161 op_sel:[1,0,0] op_sel_hi:[1,0,0]
    v_cvt_pk_bf16_f32 v140, v192, v193
    v_fma_mix_f32 v194, v29, v154, v162 op_sel_hi:[1,0,0]
    s_add_u32 s43, s38, 36864
    v_mfma_f32_32x32x16_bf16 a[80:95], a[152:155], v[148:151], a[80:95]
    buffer_load_dwordx4 v[44:47], v233, s[20:23], s43 offen offset:0
    v_fma_mix_f32 v195, v29, v155, v163 op_sel:[1,0,0] op_sel_hi:[1,0,0]
    v_cvt_pk_bf16_f32 v141, v194, v195
    v_fma_mix_f32 v196, v30, v156, v164 op_sel_hi:[1,0,0]
    v_fma_mix_f32 v197, v30, v157, v165 op_sel:[1,0,0] op_sel_hi:[1,0,0]
    v_mfma_f32_32x32x16_bf16 a[96:111], a[156:159], v[144:147], a[96:111]
    buffer_load_dwordx4 v[48:51], v233, s[20:23], s40 offen offset:1024
    v_cvt_pk_bf16_f32 v142, v196, v197
    v_fma_mix_f32 v198, v31, v158, v166 op_sel_hi:[1,0,0]
    v_fma_mix_f32 v199, v31, v159, v167 op_sel:[1,0,0] op_sel_hi:[1,0,0]
    v_cvt_pk_bf16_f32 v143, v198, v199
    v_mfma_f32_32x32x16_bf16 a[112:127], a[156:159], v[148:151], a[112:127]
    s_waitcnt lgkmcnt(0)
    buffer_load_dwordx4 v[52:55], v233, s[20:23], s43 offen offset:1024
    v_mfma_f32_32x32x16_bf16 a[0:15], a[128:131], v[136:139], a[0:15]
    s_waitcnt vmcnt(8)
    ds_read_b128 v[152:155], v234 offset:512
    ds_read_b128 v[156:159], v234 offset:528
    ds_read_b128 v[160:163], v234 offset:544
    v_fma_mix_f32 v184, v32, v168, v176 op_sel_hi:[1,0,0]
    v_fma_mix_f32 v185, v32, v169, v177 op_sel:[1,0,0] op_sel_hi:[1,0,0]
    v_cvt_pk_bf16_f32 v144, v184, v185
    v_mfma_f32_32x32x16_bf16 a[16:31], a[128:131], v[140:143], a[16:31]
    ds_read_b128 v[164:167], v234 offset:560
    ds_read_b64_tr_b16 a[144:145], v200 offset:12288
    ds_read_b64_tr_b16 a[146:147], v200 offset:13312
    v_fma_mix_f32 v186, v33, v170, v178 op_sel_hi:[1,0,0]
    v_fma_mix_f32 v187, v33, v171, v179 op_sel:[1,0,0] op_sel_hi:[1,0,0]
    v_cvt_pk_bf16_f32 v145, v186, v187
    v_fma_mix_f32 v188, v34, v172, v180 op_sel_hi:[1,0,0]
    v_mfma_f32_32x32x16_bf16 a[32:47], a[132:135], v[136:139], a[32:47]
    ds_read_b64_tr_b16 a[148:149], v201 offset:12288
    ds_read_b64_tr_b16 a[150:151], v201 offset:13312
    ds_read_b64_tr_b16 a[152:153], v202 offset:12288
    v_fma_mix_f32 v189, v34, v173, v181 op_sel:[1,0,0] op_sel_hi:[1,0,0]
    v_cvt_pk_bf16_f32 v146, v188, v189
    v_fma_mix_f32 v190, v35, v174, v182 op_sel_hi:[1,0,0]
    v_mfma_f32_32x32x16_bf16 a[48:63], a[132:135], v[140:143], a[48:63]
    ds_read_b64_tr_b16 a[154:155], v202 offset:13312
    ds_read_b64_tr_b16 a[156:157], v203 offset:12288
    ds_read_b64_tr_b16 a[158:159], v203 offset:13312
    v_fma_mix_f32 v191, v35, v175, v183 op_sel:[1,0,0] op_sel_hi:[1,0,0]
    v_cvt_pk_bf16_f32 v147, v190, v191
    v_fma_mix_f32 v192, v36, v168, v176 op_sel_hi:[1,0,0]
    v_mfma_f32_32x32x16_bf16 a[64:79], a[136:139], v[136:139], a[64:79]
    buffer_load_dwordx4 v[56:59], v233, s[20:23], s40 offen offset:2048
    v_fma_mix_f32 v193, v36, v169, v177 op_sel:[1,0,0] op_sel_hi:[1,0,0]
    v_cvt_pk_bf16_f32 v148, v192, v193
    v_fma_mix_f32 v194, v37, v170, v178 op_sel_hi:[1,0,0]
    v_fma_mix_f32 v195, v37, v171, v179 op_sel:[1,0,0] op_sel_hi:[1,0,0]
    v_mfma_f32_32x32x16_bf16 a[80:95], a[136:139], v[140:143], a[80:95]
    buffer_load_dwordx4 v[60:63], v233, s[20:23], s43 offen offset:2048
    v_cvt_pk_bf16_f32 v149, v194, v195
    v_fma_mix_f32 v196, v38, v172, v180 op_sel_hi:[1,0,0]
    v_fma_mix_f32 v197, v38, v173, v181 op_sel:[1,0,0] op_sel_hi:[1,0,0]
    v_mfma_f32_32x32x16_bf16 a[96:111], a[140:143], v[136:139], a[96:111]
    buffer_load_dwordx4 v[64:67], v233, s[20:23], s40 offen offset:3072
    v_cvt_pk_bf16_f32 v150, v196, v197
    v_fma_mix_f32 v198, v39, v174, v182 op_sel_hi:[1,0,0]
    v_fma_mix_f32 v199, v39, v175, v183 op_sel:[1,0,0] op_sel_hi:[1,0,0]
    v_cvt_pk_bf16_f32 v151, v198, v199
    v_mfma_f32_32x32x16_bf16 a[112:127], a[140:143], v[140:143], a[112:127]
    s_waitcnt lgkmcnt(0)
    buffer_load_dwordx4 v[68:71], v233, s[20:23], s43 offen offset:3072
    v_mfma_f32_32x32x16_bf16 a[0:15], a[144:147], v[144:147], a[0:15]
    s_waitcnt vmcnt(6)
    s_barrier
    v_fma_mix_f32 v184, v40, v152, v160 op_sel_hi:[1,0,0]
    v_fma_mix_f32 v185, v40, v153, v161 op_sel:[1,0,0] op_sel_hi:[1,0,0]
    v_mfma_f32_32x32x16_bf16 a[16:31], a[144:147], v[148:151], a[16:31]
    ds_read_b128 v[168:171], v234 offset:640
    ds_read_b128 v[172:175], v234 offset:656
    ds_read_b128 v[176:179], v234 offset:672
    v_cvt_pk_bf16_f32 v136, v184, v185
    v_mfma_f32_32x32x16_bf16 a[32:47], a[148:151], v[144:147], a[32:47]
    ds_read_b128 v[180:183], v234 offset:688
    ds_read_b64_tr_b16 a[128:129], v200 offset:16384
    ds_read_b64_tr_b16 a[130:131], v200 offset:17408
    v_fma_mix_f32 v186, v41, v154, v162 op_sel_hi:[1,0,0]
    v_fma_mix_f32 v187, v41, v155, v163 op_sel:[1,0,0] op_sel_hi:[1,0,0]
    v_cvt_pk_bf16_f32 v137, v186, v187
    v_fma_mix_f32 v188, v42, v156, v164 op_sel_hi:[1,0,0]
    v_fma_mix_f32 v189, v42, v157, v165 op_sel:[1,0,0] op_sel_hi:[1,0,0]
    v_cvt_pk_bf16_f32 v138, v188, v189
    v_mfma_f32_32x32x16_bf16 a[48:63], a[148:151], v[148:151], a[48:63]
    ds_read_b64_tr_b16 a[132:133], v201 offset:16384
    ds_read_b64_tr_b16 a[134:135], v201 offset:17408
    ds_read_b64_tr_b16 a[136:137], v202 offset:16384
    v_fma_mix_f32 v190, v43, v158, v166 op_sel_hi:[1,0,0]
    v_fma_mix_f32 v191, v43, v159, v167 op_sel:[1,0,0] op_sel_hi:[1,0,0]
    v_cvt_pk_bf16_f32 v139, v190, v191
    s_add_u32 m0, s33, 65536
    s_mov_b32 s39, 1048576
    v_mfma_f32_32x32x16_bf16 a[64:79], a[152:155], v[144:147], a[64:79]
    buffer_load_dwordx4 v7, s[16:19], s39 offen offset:0 lds
    ds_read_b64_tr_b16 a[138:139], v202 offset:17408
    ds_read_b64_tr_b16 a[140:141], v203 offset:16384
    ds_read_b64_tr_b16 a[142:143], v203 offset:17408
    v_fma_mix_f32 v192, v44, v152, v160 op_sel_hi:[1,0,0]
    s_mov_b32 s39, 1080320
    v_mfma_f32_32x32x16_bf16 a[80:95], a[152:155], v[148:151], a[80:95]
    buffer_load_dwordx4 v7, s[16:19], s39 offen offset:1024 lds
    v_fma_mix_f32 v193, v44, v153, v161 op_sel:[1,0,0] op_sel_hi:[1,0,0]
    v_cvt_pk_bf16_f32 v140, v192, v193
    v_fma_mix_f32 v194, v45, v154, v162 op_sel_hi:[1,0,0]
    v_fma_mix_f32 v195, v45, v155, v163 op_sel:[1,0,0] op_sel_hi:[1,0,0]
    v_cvt_pk_bf16_f32 v141, v194, v195
    v_fma_mix_f32 v196, v46, v156, v164 op_sel_hi:[1,0,0]
    s_mov_b32 s39, 1112064
    v_mfma_f32_32x32x16_bf16 a[96:111], a[156:159], v[144:147], a[96:111]
    buffer_load_dwordx4 v7, s[16:19], s39 offen offset:2048 lds
    v_fma_mix_f32 v197, v46, v157, v165 op_sel:[1,0,0] op_sel_hi:[1,0,0]
    v_cvt_pk_bf16_f32 v142, v196, v197
    v_fma_mix_f32 v198, v47, v158, v166 op_sel_hi:[1,0,0]
    v_fma_mix_f32 v199, v47, v159, v167 op_sel:[1,0,0] op_sel_hi:[1,0,0]
    v_cvt_pk_bf16_f32 v143, v198, v199
    s_mov_b32 s39, 1143808
    v_mfma_f32_32x32x16_bf16 a[112:127], a[156:159], v[148:151], a[112:127]
    s_waitcnt lgkmcnt(0)
    buffer_load_dwordx4 v7, s[16:19], s39 offen offset:3072 lds
    v_mfma_f32_32x32x16_bf16 a[0:15], a[128:131], v[136:139], a[0:15]
    s_waitcnt vmcnt(8)
    ds_read_b128 v[152:155], v234 offset:768
    ds_read_b128 v[156:159], v234 offset:784
    ds_read_b128 v[160:163], v234 offset:800
    v_fma_mix_f32 v184, v48, v168, v176 op_sel_hi:[1,0,0]
    v_fma_mix_f32 v185, v48, v169, v177 op_sel:[1,0,0] op_sel_hi:[1,0,0]
    v_cvt_pk_bf16_f32 v144, v184, v185
    v_mfma_f32_32x32x16_bf16 a[16:31], a[128:131], v[140:143], a[16:31]
    ds_read_b128 v[164:167], v234 offset:816
    ds_read_b64_tr_b16 a[144:145], v200 offset:20480
    ds_read_b64_tr_b16 a[146:147], v200 offset:21504
    v_fma_mix_f32 v186, v49, v170, v178 op_sel_hi:[1,0,0]
    v_fma_mix_f32 v187, v49, v171, v179 op_sel:[1,0,0] op_sel_hi:[1,0,0]
    v_cvt_pk_bf16_f32 v145, v186, v187
    v_fma_mix_f32 v188, v50, v172, v180 op_sel_hi:[1,0,0]
    v_mfma_f32_32x32x16_bf16 a[32:47], a[132:135], v[136:139], a[32:47]
    ds_read_b64_tr_b16 a[148:149], v201 offset:20480
    ds_read_b64_tr_b16 a[150:151], v201 offset:21504
    ds_read_b64_tr_b16 a[152:153], v202 offset:20480
    v_fma_mix_f32 v189, v50, v173, v181 op_sel:[1,0,0] op_sel_hi:[1,0,0]
    v_cvt_pk_bf16_f32 v146, v188, v189
    v_fma_mix_f32 v190, v51, v174, v182 op_sel_hi:[1,0,0]
    v_mfma_f32_32x32x16_bf16 a[48:63], a[132:135], v[140:143], a[48:63]
    ds_read_b64_tr_b16 a[154:155], v202 offset:21504
    ds_read_b64_tr_b16 a[156:157], v203 offset:20480
    ds_read_b64_tr_b16 a[158:159], v203 offset:21504
    v_fma_mix_f32 v191, v51, v175, v183 op_sel:[1,0,0] op_sel_hi:[1,0,0]
    v_cvt_pk_bf16_f32 v147, v190, v191
    v_fma_mix_f32 v192, v52, v168, v176 op_sel_hi:[1,0,0]
    s_add_u32 s40, s38, 8192
    v_mfma_f32_32x32x16_bf16 a[64:79], a[136:139], v[136:139], a[64:79]
    buffer_load_dwordx4 v[72:75], v233, s[20:23], s40 offen offset:0
    v_fma_mix_f32 v193, v52, v169, v177 op_sel:[1,0,0] op_sel_hi:[1,0,0]
    v_cvt_pk_bf16_f32 v148, v192, v193
    v_fma_mix_f32 v194, v53, v170, v178 op_sel_hi:[1,0,0]
    s_add_u32 s43, s38, 40960
    v_mfma_f32_32x32x16_bf16 a[80:95], a[136:139], v[140:143], a[80:95]
    buffer_load_dwordx4 v[76:79], v233, s[20:23], s43 offen offset:0
    v_fma_mix_f32 v195, v53, v171, v179 op_sel:[1,0,0] op_sel_hi:[1,0,0]
    v_cvt_pk_bf16_f32 v149, v194, v195
    v_fma_mix_f32 v196, v54, v172, v180 op_sel_hi:[1,0,0]
    v_fma_mix_f32 v197, v54, v173, v181 op_sel:[1,0,0] op_sel_hi:[1,0,0]
    v_mfma_f32_32x32x16_bf16 a[96:111], a[140:143], v[136:139], a[96:111]
    buffer_load_dwordx4 v[80:83], v233, s[20:23], s40 offen offset:1024
    v_cvt_pk_bf16_f32 v150, v196, v197
    v_fma_mix_f32 v198, v55, v174, v182 op_sel_hi:[1,0,0]
    v_fma_mix_f32 v199, v55, v175, v183 op_sel:[1,0,0] op_sel_hi:[1,0,0]
    v_cvt_pk_bf16_f32 v151, v198, v199
    v_mfma_f32_32x32x16_bf16 a[112:127], a[140:143], v[140:143], a[112:127]
    s_waitcnt lgkmcnt(0)
    buffer_load_dwordx4 v[84:87], v233, s[20:23], s43 offen offset:1024
    v_mfma_f32_32x32x16_bf16 a[0:15], a[144:147], v[144:147], a[0:15]
    s_waitcnt vmcnt(10)
    ds_read_b128 v[168:171], v234 offset:896
    ds_read_b128 v[172:175], v234 offset:912
    ds_read_b128 v[176:179], v234 offset:928
    v_fma_mix_f32 v184, v56, v152, v160 op_sel_hi:[1,0,0]
    v_fma_mix_f32 v185, v56, v153, v161 op_sel:[1,0,0] op_sel_hi:[1,0,0]
    v_cvt_pk_bf16_f32 v136, v184, v185
    v_mfma_f32_32x32x16_bf16 a[16:31], a[144:147], v[148:151], a[16:31]
    ds_read_b128 v[180:183], v234 offset:944
    ds_read_b64_tr_b16 a[128:129], v200 offset:24576
    ds_read_b64_tr_b16 a[130:131], v200 offset:25600
    v_fma_mix_f32 v186, v57, v154, v162 op_sel_hi:[1,0,0]
    v_fma_mix_f32 v187, v57, v155, v163 op_sel:[1,0,0] op_sel_hi:[1,0,0]
    v_cvt_pk_bf16_f32 v137, v186, v187
    v_fma_mix_f32 v188, v58, v156, v164 op_sel_hi:[1,0,0]
    v_mfma_f32_32x32x16_bf16 a[32:47], a[148:151], v[144:147], a[32:47]
    ds_read_b64_tr_b16 a[132:133], v201 offset:24576
    ds_read_b64_tr_b16 a[134:135], v201 offset:25600
    ds_read_b64_tr_b16 a[136:137], v202 offset:24576
    v_fma_mix_f32 v189, v58, v157, v165 op_sel:[1,0,0] op_sel_hi:[1,0,0]
    v_cvt_pk_bf16_f32 v138, v188, v189
    v_fma_mix_f32 v190, v59, v158, v166 op_sel_hi:[1,0,0]
    v_mfma_f32_32x32x16_bf16 a[48:63], a[148:151], v[148:151], a[48:63]
    ds_read_b64_tr_b16 a[138:139], v202 offset:25600
    ds_read_b64_tr_b16 a[140:141], v203 offset:24576
    ds_read_b64_tr_b16 a[142:143], v203 offset:25600
    v_fma_mix_f32 v191, v59, v159, v167 op_sel:[1,0,0] op_sel_hi:[1,0,0]
    v_cvt_pk_bf16_f32 v139, v190, v191
    v_fma_mix_f32 v192, v60, v152, v160 op_sel_hi:[1,0,0]
    v_mfma_f32_32x32x16_bf16 a[64:79], a[152:155], v[144:147], a[64:79]
    buffer_load_dwordx4 v[88:91], v233, s[20:23], s40 offen offset:2048
    v_fma_mix_f32 v193, v60, v153, v161 op_sel:[1,0,0] op_sel_hi:[1,0,0]
    v_cvt_pk_bf16_f32 v140, v192, v193
    v_fma_mix_f32 v194, v61, v154, v162 op_sel_hi:[1,0,0]
    v_fma_mix_f32 v195, v61, v155, v163 op_sel:[1,0,0] op_sel_hi:[1,0,0]
    v_mfma_f32_32x32x16_bf16 a[80:95], a[152:155], v[148:151], a[80:95]
    buffer_load_dwordx4 v[92:95], v233, s[20:23], s43 offen offset:2048
    v_cvt_pk_bf16_f32 v141, v194, v195
    v_fma_mix_f32 v196, v62, v156, v164 op_sel_hi:[1,0,0]
    v_fma_mix_f32 v197, v62, v157, v165 op_sel:[1,0,0] op_sel_hi:[1,0,0]
    v_mfma_f32_32x32x16_bf16 a[96:111], a[156:159], v[144:147], a[96:111]
    buffer_load_dwordx4 v[96:99], v233, s[20:23], s40 offen offset:3072
    v_cvt_pk_bf16_f32 v142, v196, v197
    v_fma_mix_f32 v198, v63, v158, v166 op_sel_hi:[1,0,0]
    v_fma_mix_f32 v199, v63, v159, v167 op_sel:[1,0,0] op_sel_hi:[1,0,0]
    v_cvt_pk_bf16_f32 v143, v198, v199
    v_mfma_f32_32x32x16_bf16 a[112:127], a[156:159], v[148:151], a[112:127]
    s_waitcnt lgkmcnt(0)
    buffer_load_dwordx4 v[100:103], v233, s[20:23], s43 offen offset:3072
    v_mfma_f32_32x32x16_bf16 a[0:15], a[128:131], v[136:139], a[0:15]
    s_waitcnt vmcnt(12)
    ds_read_b128 v[152:155], v234 offset:1024
    ds_read_b128 v[156:159], v234 offset:1040
    ds_read_b128 v[160:163], v234 offset:1056
    v_fma_mix_f32 v184, v64, v168, v176 op_sel_hi:[1,0,0]
    v_fma_mix_f32 v185, v64, v169, v177 op_sel:[1,0,0] op_sel_hi:[1,0,0]
    v_cvt_pk_bf16_f32 v144, v184, v185
    v_fma_mix_f32 v186, v65, v170, v178 op_sel_hi:[1,0,0]
    v_mfma_f32_32x32x16_bf16 a[16:31], a[128:131], v[140:143], a[16:31]
    ds_read_b128 v[164:167], v234 offset:1072
    ds_read_b64_tr_b16 a[144:145], v200 offset:28672
    ds_read_b64_tr_b16 a[146:147], v200 offset:29696
    v_fma_mix_f32 v187, v65, v171, v179 op_sel:[1,0,0] op_sel_hi:[1,0,0]
    v_cvt_pk_bf16_f32 v145, v186, v187
    v_fma_mix_f32 v188, v66, v172, v180 op_sel_hi:[1,0,0]
    v_fma_mix_f32 v189, v66, v173, v181 op_sel:[1,0,0] op_sel_hi:[1,0,0]
    v_mfma_f32_32x32x16_bf16 a[32:47], a[132:135], v[136:139], a[32:47]
    ds_read_b64_tr_b16 a[148:149], v201 offset:28672
    ds_read_b64_tr_b16 a[150:151], v201 offset:29696
    ds_read_b64_tr_b16 a[152:153], v202 offset:28672
    v_cvt_pk_bf16_f32 v146, v188, v189
    v_fma_mix_f32 v190, v67, v174, v182 op_sel_hi:[1,0,0]
    v_fma_mix_f32 v191, v67, v175, v183 op_sel:[1,0,0] op_sel_hi:[1,0,0]
    v_cvt_pk_bf16_f32 v147, v190, v191
    v_mfma_f32_32x32x16_bf16 a[48:63], a[132:135], v[140:143], a[48:63]
    ds_read_b64_tr_b16 a[154:155], v202 offset:29696
    ds_read_b64_tr_b16 a[156:157], v203 offset:28672
    ds_read_b64_tr_b16 a[158:159], v203 offset:29696
    v_fma_mix_f32 v192, v68, v168, v176 op_sel_hi:[1,0,0]
    v_fma_mix_f32 v193, v68, v169, v177 op_sel:[1,0,0] op_sel_hi:[1,0,0]
    s_add_u32 m0, s33, 32768
    s_mov_b32 s39, 1572864
    v_mfma_f32_32x32x16_bf16 a[64:79], a[136:139], v[136:139], a[64:79]
    buffer_load_dwordx4 v7, s[16:19], s39 offen offset:0 lds
    v_cvt_pk_bf16_f32 v148, v192, v193
    v_fma_mix_f32 v194, v69, v170, v178 op_sel_hi:[1,0,0]
    v_fma_mix_f32 v195, v69, v171, v179 op_sel:[1,0,0] op_sel_hi:[1,0,0]
    s_mov_b32 s39, 1604608
    v_mfma_f32_32x32x16_bf16 a[80:95], a[136:139], v[140:143], a[80:95]
    buffer_load_dwordx4 v7, s[16:19], s39 offen offset:1024 lds
    v_cvt_pk_bf16_f32 v149, v194, v195
    v_fma_mix_f32 v196, v70, v172, v180 op_sel_hi:[1,0,0]
    v_fma_mix_f32 v197, v70, v173, v181 op_sel:[1,0,0] op_sel_hi:[1,0,0]
    v_cvt_pk_bf16_f32 v150, v196, v197
    s_mov_b32 s39, 1636352
    v_mfma_f32_32x32x16_bf16 a[96:111], a[140:143], v[136:139], a[96:111]
    buffer_load_dwordx4 v7, s[16:19], s39 offen offset:2048 lds
    v_fma_mix_f32 v198, v71, v174, v182 op_sel_hi:[1,0,0]
    v_fma_mix_f32 v199, v71, v175, v183 op_sel:[1,0,0] op_sel_hi:[1,0,0]
    v_cvt_pk_bf16_f32 v151, v198, v199
    s_mov_b32 s39, 1668096
    v_mfma_f32_32x32x16_bf16 a[112:127], a[140:143], v[140:143], a[112:127]
    s_waitcnt lgkmcnt(0)
    buffer_load_dwordx4 v7, s[16:19], s39 offen offset:3072 lds
    v_mfma_f32_32x32x16_bf16 a[0:15], a[144:147], v[144:147], a[0:15]
    s_waitcnt vmcnt(10)
    s_barrier
    v_fma_mix_f32 v184, v72, v152, v160 op_sel_hi:[1,0,0]
    v_mfma_f32_32x32x16_bf16 a[16:31], a[144:147], v[148:151], a[16:31]
    ds_read_b128 v[168:171], v234 offset:1152
    ds_read_b128 v[172:175], v234 offset:1168
    ds_read_b128 v[176:179], v234 offset:1184
    v_fma_mix_f32 v185, v72, v153, v161 op_sel:[1,0,0] op_sel_hi:[1,0,0]
    v_cvt_pk_bf16_f32 v136, v184, v185
    v_mfma_f32_32x32x16_bf16 a[32:47], a[148:151], v[144:147], a[32:47]
    ds_read_b128 v[180:183], v234 offset:1200
    ds_read_b64_tr_b16 a[128:129], v204 offset:0
    ds_read_b64_tr_b16 a[130:131], v204 offset:1024
    v_fma_mix_f32 v186, v73, v154, v162 op_sel_hi:[1,0,0]
    v_fma_mix_f32 v187, v73, v155, v163 op_sel:[1,0,0] op_sel_hi:[1,0,0]
    v_cvt_pk_bf16_f32 v137, v186, v187
    v_fma_mix_f32 v188, v74, v156, v164 op_sel_hi:[1,0,0]
    v_fma_mix_f32 v189, v74, v157, v165 op_sel:[1,0,0] op_sel_hi:[1,0,0]
    v_mfma_f32_32x32x16_bf16 a[48:63], a[148:151], v[148:151], a[48:63]
    ds_read_b64_tr_b16 a[132:133], v205 offset:0
    ds_read_b64_tr_b16 a[134:135], v205 offset:1024
    ds_read_b64_tr_b16 a[136:137], v206 offset:0
    v_cvt_pk_bf16_f32 v138, v188, v189
    v_fma_mix_f32 v190, v75, v158, v166 op_sel_hi:[1,0,0]
    v_fma_mix_f32 v191, v75, v159, v167 op_sel:[1,0,0] op_sel_hi:[1,0,0]
    v_cvt_pk_bf16_f32 v139, v190, v191
    s_add_u32 s40, s38, 12288
    v_mfma_f32_32x32x16_bf16 a[64:79], a[152:155], v[144:147], a[64:79]
    buffer_load_dwordx4 v[104:107], v233, s[20:23], s40 offen offset:0
    ds_read_b64_tr_b16 a[138:139], v206 offset:1024
    ds_read_b64_tr_b16 a[140:141], v207 offset:0
    ds_read_b64_tr_b16 a[142:143], v207 offset:1024
    s_add_u32 s43, s38, 45056
    v_mfma_f32_32x32x16_bf16 a[80:95], a[152:155], v[148:151], a[80:95]
    buffer_load_dwordx4 v[108:111], v233, s[20:23], s43 offen offset:0
    v_fma_mix_f32 v192, v76, v152, v160 op_sel_hi:[1,0,0]
    v_fma_mix_f32 v193, v76, v153, v161 op_sel:[1,0,0] op_sel_hi:[1,0,0]
    v_cvt_pk_bf16_f32 v140, v192, v193
    v_fma_mix_f32 v194, v77, v154, v162 op_sel_hi:[1,0,0]
    v_fma_mix_f32 v195, v77, v155, v163 op_sel:[1,0,0] op_sel_hi:[1,0,0]
    v_cvt_pk_bf16_f32 v141, v194, v195
    v_mfma_f32_32x32x16_bf16 a[96:111], a[156:159], v[144:147], a[96:111]
    buffer_load_dwordx4 v[112:115], v233, s[20:23], s40 offen offset:1024
    v_fma_mix_f32 v196, v78, v156, v164 op_sel_hi:[1,0,0]
    v_fma_mix_f32 v197, v78, v157, v165 op_sel:[1,0,0] op_sel_hi:[1,0,0]
    v_cvt_pk_bf16_f32 v142, v196, v197
    v_fma_mix_f32 v198, v79, v158, v166 op_sel_hi:[1,0,0]
    v_fma_mix_f32 v199, v79, v159, v167 op_sel:[1,0,0] op_sel_hi:[1,0,0]
    v_cvt_pk_bf16_f32 v143, v198, v199
    v_mfma_f32_32x32x16_bf16 a[112:127], a[156:159], v[148:151], a[112:127]
    s_waitcnt lgkmcnt(0)
    buffer_load_dwordx4 v[116:119], v233, s[20:23], s43 offen offset:1024
    v_mfma_f32_32x32x16_bf16 a[0:15], a[128:131], v[136:139], a[0:15]
    s_waitcnt vmcnt(12)
    ds_read_b128 v[152:155], v234 offset:1280
    ds_read_b128 v[156:159], v234 offset:1296
    ds_read_b128 v[160:163], v234 offset:1312
    v_fma_mix_f32 v184, v80, v168, v176 op_sel_hi:[1,0,0]
    v_fma_mix_f32 v185, v80, v169, v177 op_sel:[1,0,0] op_sel_hi:[1,0,0]
    v_cvt_pk_bf16_f32 v144, v184, v185
    v_mfma_f32_32x32x16_bf16 a[16:31], a[128:131], v[140:143], a[16:31]
    ds_read_b128 v[164:167], v234 offset:1328
    ds_read_b64_tr_b16 a[144:145], v204 offset:4096
    ds_read_b64_tr_b16 a[146:147], v204 offset:5120
    v_fma_mix_f32 v186, v81, v170, v178 op_sel_hi:[1,0,0]
    v_fma_mix_f32 v187, v81, v171, v179 op_sel:[1,0,0] op_sel_hi:[1,0,0]
    v_cvt_pk_bf16_f32 v145, v186, v187
    v_fma_mix_f32 v188, v82, v172, v180 op_sel_hi:[1,0,0]
    v_mfma_f32_32x32x16_bf16 a[32:47], a[132:135], v[136:139], a[32:47]
    ds_read_b64_tr_b16 a[148:149], v205 offset:4096
    ds_read_b64_tr_b16 a[150:151], v205 offset:5120
    ds_read_b64_tr_b16 a[152:153], v206 offset:4096
    v_fma_mix_f32 v189, v82, v173, v181 op_sel:[1,0,0] op_sel_hi:[1,0,0]
    v_cvt_pk_bf16_f32 v146, v188, v189
    v_fma_mix_f32 v190, v83, v174, v182 op_sel_hi:[1,0,0]
    v_mfma_f32_32x32x16_bf16 a[48:63], a[132:135], v[140:143], a[48:63]
    ds_read_b64_tr_b16 a[154:155], v206 offset:5120
    ds_read_b64_tr_b16 a[156:157], v207 offset:4096
    ds_read_b64_tr_b16 a[158:159], v207 offset:5120
    v_fma_mix_f32 v191, v83, v175, v183 op_sel:[1,0,0] op_sel_hi:[1,0,0]
    v_cvt_pk_bf16_f32 v147, v190, v191
    v_fma_mix_f32 v192, v84, v168, v176 op_sel_hi:[1,0,0]
    v_mfma_f32_32x32x16_bf16 a[64:79], a[136:139], v[136:139], a[64:79]
    buffer_load_dwordx4 v[120:123], v233, s[20:23], s40 offen offset:2048
    v_fma_mix_f32 v193, v84, v169, v177 op_sel:[1,0,0] op_sel_hi:[1,0,0]
    v_cvt_pk_bf16_f32 v148, v192, v193
    v_fma_mix_f32 v194, v85, v170, v178 op_sel_hi:[1,0,0]
    v_fma_mix_f32 v195, v85, v171, v179 op_sel:[1,0,0] op_sel_hi:[1,0,0]
    v_mfma_f32_32x32x16_bf16 a[80:95], a[136:139], v[140:143], a[80:95]
    buffer_load_dwordx4 v[124:127], v233, s[20:23], s43 offen offset:2048
    v_cvt_pk_bf16_f32 v149, v194, v195
    v_fma_mix_f32 v196, v86, v172, v180 op_sel_hi:[1,0,0]
    v_fma_mix_f32 v197, v86, v173, v181 op_sel:[1,0,0] op_sel_hi:[1,0,0]
    v_mfma_f32_32x32x16_bf16 a[96:111], a[140:143], v[136:139], a[96:111]
    buffer_load_dwordx4 v[128:131], v233, s[20:23], s40 offen offset:3072
    v_cvt_pk_bf16_f32 v150, v196, v197
    v_fma_mix_f32 v198, v87, v174, v182 op_sel_hi:[1,0,0]
    v_fma_mix_f32 v199, v87, v175, v183 op_sel:[1,0,0] op_sel_hi:[1,0,0]
    v_cvt_pk_bf16_f32 v151, v198, v199
    v_mfma_f32_32x32x16_bf16 a[112:127], a[140:143], v[140:143], a[112:127]
    s_waitcnt lgkmcnt(0)
    buffer_load_dwordx4 v[132:135], v233, s[20:23], s43 offen offset:3072
    v_mfma_f32_32x32x16_bf16 a[0:15], a[144:147], v[144:147], a[0:15]
    s_waitcnt vmcnt(14)
    ds_read_b128 v[168:171], v234 offset:1408
    ds_read_b128 v[172:175], v234 offset:1424
    ds_read_b128 v[176:179], v234 offset:1440
    v_fma_mix_f32 v184, v88, v152, v160 op_sel_hi:[1,0,0]
    v_fma_mix_f32 v185, v88, v153, v161 op_sel:[1,0,0] op_sel_hi:[1,0,0]
    v_cvt_pk_bf16_f32 v136, v184, v185
    v_fma_mix_f32 v186, v89, v154, v162 op_sel_hi:[1,0,0]
    v_mfma_f32_32x32x16_bf16 a[16:31], a[144:147], v[148:151], a[16:31]
    ds_read_b128 v[180:183], v234 offset:1456
    ds_read_b64_tr_b16 a[128:129], v204 offset:8192
    ds_read_b64_tr_b16 a[130:131], v204 offset:9216
    v_fma_mix_f32 v187, v89, v155, v163 op_sel:[1,0,0] op_sel_hi:[1,0,0]
    v_cvt_pk_bf16_f32 v137, v186, v187
    v_fma_mix_f32 v188, v90, v156, v164 op_sel_hi:[1,0,0]
    v_fma_mix_f32 v189, v90, v157, v165 op_sel:[1,0,0] op_sel_hi:[1,0,0]
    v_mfma_f32_32x32x16_bf16 a[32:47], a[148:151], v[144:147], a[32:47]
    ds_read_b64_tr_b16 a[132:133], v205 offset:8192
    ds_read_b64_tr_b16 a[134:135], v205 offset:9216
    ds_read_b64_tr_b16 a[136:137], v206 offset:8192
    v_cvt_pk_bf16_f32 v138, v188, v189
    v_fma_mix_f32 v190, v91, v158, v166 op_sel_hi:[1,0,0]
    v_fma_mix_f32 v191, v91, v159, v167 op_sel:[1,0,0] op_sel_hi:[1,0,0]
    v_cvt_pk_bf16_f32 v139, v190, v191
    v_mfma_f32_32x32x16_bf16 a[48:63], a[148:151], v[148:151], a[48:63]
    ds_read_b64_tr_b16 a[138:139], v206 offset:9216
    ds_read_b64_tr_b16 a[140:141], v207 offset:8192
    ds_read_b64_tr_b16 a[142:143], v207 offset:9216
    v_fma_mix_f32 v192, v92, v152, v160 op_sel_hi:[1,0,0]
    v_fma_mix_f32 v193, v92, v153, v161 op_sel:[1,0,0] op_sel_hi:[1,0,0]
    s_add_u32 m0, s33, 49152
    s_mov_b32 s39, 2097152
    v_mfma_f32_32x32x16_bf16 a[64:79], a[152:155], v[144:147], a[64:79]
    buffer_load_dwordx4 v7, s[16:19], s39 offen offset:0 lds
    v_cvt_pk_bf16_f32 v140, v192, v193
    v_fma_mix_f32 v194, v93, v154, v162 op_sel_hi:[1,0,0]
    v_fma_mix_f32 v195, v93, v155, v163 op_sel:[1,0,0] op_sel_hi:[1,0,0]
    s_mov_b32 s39, 2128896
    v_mfma_f32_32x32x16_bf16 a[80:95], a[152:155], v[148:151], a[80:95]
    buffer_load_dwordx4 v7, s[16:19], s39 offen offset:1024 lds
    v_cvt_pk_bf16_f32 v141, v194, v195
    v_fma_mix_f32 v196, v94, v156, v164 op_sel_hi:[1,0,0]
    v_fma_mix_f32 v197, v94, v157, v165 op_sel:[1,0,0] op_sel_hi:[1,0,0]
    v_cvt_pk_bf16_f32 v142, v196, v197
    s_mov_b32 s39, 2160640
    v_mfma_f32_32x32x16_bf16 a[96:111], a[156:159], v[144:147], a[96:111]
    buffer_load_dwordx4 v7, s[16:19], s39 offen offset:2048 lds
    v_fma_mix_f32 v198, v95, v158, v166 op_sel_hi:[1,0,0]
    v_fma_mix_f32 v199, v95, v159, v167 op_sel:[1,0,0] op_sel_hi:[1,0,0]
    v_cvt_pk_bf16_f32 v143, v198, v199
    s_mov_b32 s39, 2192384
    v_mfma_f32_32x32x16_bf16 a[112:127], a[156:159], v[148:151], a[112:127]
    s_waitcnt lgkmcnt(0)
    buffer_load_dwordx4 v7, s[16:19], s39 offen offset:3072 lds
    v_mfma_f32_32x32x16_bf16 a[0:15], a[128:131], v[136:139], a[0:15]
    s_waitcnt vmcnt(16)
    ds_read_b128 v[152:155], v234 offset:1536
    ds_read_b128 v[156:159], v234 offset:1552
    ds_read_b128 v[160:163], v234 offset:1568
    v_fma_mix_f32 v184, v96, v168, v176 op_sel_hi:[1,0,0]
    v_fma_mix_f32 v185, v96, v169, v177 op_sel:[1,0,0] op_sel_hi:[1,0,0]
    v_cvt_pk_bf16_f32 v144, v184, v185
    v_mfma_f32_32x32x16_bf16 a[16:31], a[128:131], v[140:143], a[16:31]
    ds_read_b128 v[164:167], v234 offset:1584
    ds_read_b64_tr_b16 a[144:145], v204 offset:12288
    ds_read_b64_tr_b16 a[146:147], v204 offset:13312
    v_fma_mix_f32 v186, v97, v170, v178 op_sel_hi:[1,0,0]
    v_fma_mix_f32 v187, v97, v171, v179 op_sel:[1,0,0] op_sel_hi:[1,0,0]
    v_cvt_pk_bf16_f32 v145, v186, v187
    v_fma_mix_f32 v188, v98, v172, v180 op_sel_hi:[1,0,0]
    v_mfma_f32_32x32x16_bf16 a[32:47], a[132:135], v[136:139], a[32:47]
    ds_read_b64_tr_b16 a[148:149], v205 offset:12288
    ds_read_b64_tr_b16 a[150:151], v205 offset:13312
    ds_read_b64_tr_b16 a[152:153], v206 offset:12288
    v_fma_mix_f32 v189, v98, v173, v181 op_sel:[1,0,0] op_sel_hi:[1,0,0]
    v_cvt_pk_bf16_f32 v146, v188, v189
    v_fma_mix_f32 v190, v99, v174, v182 op_sel_hi:[1,0,0]
    v_mfma_f32_32x32x16_bf16 a[48:63], a[132:135], v[140:143], a[48:63]
    ds_read_b64_tr_b16 a[154:155], v206 offset:13312
    ds_read_b64_tr_b16 a[156:157], v207 offset:12288
    ds_read_b64_tr_b16 a[158:159], v207 offset:13312
    v_fma_mix_f32 v191, v99, v175, v183 op_sel:[1,0,0] op_sel_hi:[1,0,0]
    v_cvt_pk_bf16_f32 v147, v190, v191
    v_fma_mix_f32 v192, v100, v168, v176 op_sel_hi:[1,0,0]
    s_add_u32 s40, s38, 16384
    v_mfma_f32_32x32x16_bf16 a[64:79], a[136:139], v[136:139], a[64:79]
    buffer_load_dwordx4 v[8:11], v233, s[20:23], s40 offen offset:0
    v_fma_mix_f32 v193, v100, v169, v177 op_sel:[1,0,0] op_sel_hi:[1,0,0]
    v_cvt_pk_bf16_f32 v148, v192, v193
    v_fma_mix_f32 v194, v101, v170, v178 op_sel_hi:[1,0,0]
    s_add_u32 s43, s38, 49152
    v_mfma_f32_32x32x16_bf16 a[80:95], a[136:139], v[140:143], a[80:95]
    buffer_load_dwordx4 v[12:15], v233, s[20:23], s43 offen offset:0
    v_fma_mix_f32 v195, v101, v171, v179 op_sel:[1,0,0] op_sel_hi:[1,0,0]
    v_cvt_pk_bf16_f32 v149, v194, v195
    v_fma_mix_f32 v196, v102, v172, v180 op_sel_hi:[1,0,0]
    v_fma_mix_f32 v197, v102, v173, v181 op_sel:[1,0,0] op_sel_hi:[1,0,0]
    v_mfma_f32_32x32x16_bf16 a[96:111], a[140:143], v[136:139], a[96:111]
    buffer_load_dwordx4 v[16:19], v233, s[20:23], s40 offen offset:1024
    v_cvt_pk_bf16_f32 v150, v196, v197
    v_fma_mix_f32 v198, v103, v174, v182 op_sel_hi:[1,0,0]
    v_fma_mix_f32 v199, v103, v175, v183 op_sel:[1,0,0] op_sel_hi:[1,0,0]
    v_cvt_pk_bf16_f32 v151, v198, v199
    v_mfma_f32_32x32x16_bf16 a[112:127], a[140:143], v[140:143], a[112:127]
    s_waitcnt lgkmcnt(0)
    buffer_load_dwordx4 v[20:23], v233, s[20:23], s43 offen offset:1024
    v_mfma_f32_32x32x16_bf16 a[0:15], a[144:147], v[144:147], a[0:15]
    s_waitcnt vmcnt(14)
    s_barrier
    v_fma_mix_f32 v184, v104, v152, v160 op_sel_hi:[1,0,0]
    v_mfma_f32_32x32x16_bf16 a[16:31], a[144:147], v[148:151], a[16:31]
    ds_read_b128 v[168:171], v234 offset:1664
    ds_read_b128 v[172:175], v234 offset:1680
    ds_read_b128 v[176:179], v234 offset:1696
    v_fma_mix_f32 v185, v104, v153, v161 op_sel:[1,0,0] op_sel_hi:[1,0,0]
    v_mfma_f32_32x32x16_bf16 a[32:47], a[148:151], v[144:147], a[32:47]
    ds_read_b128 v[180:183], v234 offset:1712
    ds_read_b64_tr_b16 a[128:129], v200 offset:32768
    ds_read_b64_tr_b16 a[130:131], v200 offset:33792
    v_cvt_pk_bf16_f32 v136, v184, v185
    v_fma_mix_f32 v186, v105, v154, v162 op_sel_hi:[1,0,0]
    v_fma_mix_f32 v187, v105, v155, v163 op_sel:[1,0,0] op_sel_hi:[1,0,0]
    v_cvt_pk_bf16_f32 v137, v186, v187
    v_fma_mix_f32 v188, v106, v156, v164 op_sel_hi:[1,0,0]
    v_mfma_f32_32x32x16_bf16 a[48:63], a[148:151], v[148:151], a[48:63]
    ds_read_b64_tr_b16 a[132:133], v201 offset:32768
    ds_read_b64_tr_b16 a[134:135], v201 offset:33792
    ds_read_b64_tr_b16 a[136:137], v202 offset:32768
    v_fma_mix_f32 v189, v106, v157, v165 op_sel:[1,0,0] op_sel_hi:[1,0,0]
    v_cvt_pk_bf16_f32 v138, v188, v189
    v_fma_mix_f32 v190, v107, v158, v166 op_sel_hi:[1,0,0]
    v_fma_mix_f32 v191, v107, v159, v167 op_sel:[1,0,0] op_sel_hi:[1,0,0]
    v_cvt_pk_bf16_f32 v139, v190, v191
    v_mfma_f32_32x32x16_bf16 a[64:79], a[152:155], v[144:147], a[64:79]
    buffer_load_dwordx4 v[24:27], v233, s[20:23], s40 offen offset:2048
    ds_read_b64_tr_b16 a[138:139], v202 offset:33792
    ds_read_b64_tr_b16 a[140:141], v203 offset:32768
    ds_read_b64_tr_b16 a[142:143], v203 offset:33792
    v_fma_mix_f32 v192, v108, v152, v160 op_sel_hi:[1,0,0]
    v_mfma_f32_32x32x16_bf16 a[80:95], a[152:155], v[148:151], a[80:95]
    buffer_load_dwordx4 v[28:31], v233, s[20:23], s43 offen offset:2048
    v_fma_mix_f32 v193, v108, v153, v161 op_sel:[1,0,0] op_sel_hi:[1,0,0]
    v_cvt_pk_bf16_f32 v140, v192, v193
    v_fma_mix_f32 v194, v109, v154, v162 op_sel_hi:[1,0,0]
    v_fma_mix_f32 v195, v109, v155, v163 op_sel:[1,0,0] op_sel_hi:[1,0,0]
    v_cvt_pk_bf16_f32 v141, v194, v195
    v_fma_mix_f32 v196, v110, v156, v164 op_sel_hi:[1,0,0]
    v_mfma_f32_32x32x16_bf16 a[96:111], a[156:159], v[144:147], a[96:111]
    buffer_load_dwordx4 v[32:35], v233, s[20:23], s40 offen offset:3072
    v_fma_mix_f32 v197, v110, v157, v165 op_sel:[1,0,0] op_sel_hi:[1,0,0]
    v_cvt_pk_bf16_f32 v142, v196, v197
    v_fma_mix_f32 v198, v111, v158, v166 op_sel_hi:[1,0,0]
    v_fma_mix_f32 v199, v111, v159, v167 op_sel:[1,0,0] op_sel_hi:[1,0,0]
    v_cvt_pk_bf16_f32 v143, v198, v199
    v_mfma_f32_32x32x16_bf16 a[112:127], a[156:159], v[148:151], a[112:127]
    s_waitcnt lgkmcnt(0)
    buffer_load_dwordx4 v[36:39], v233, s[20:23], s43 offen offset:3072
    v_mfma_f32_32x32x16_bf16 a[0:15], a[128:131], v[136:139], a[0:15]
    s_waitcnt vmcnt(16)
    ds_read_b128 v[152:155], v234 offset:1792
    ds_read_b128 v[156:159], v234 offset:1808
    ds_read_b128 v[160:163], v234 offset:1824
    v_fma_mix_f32 v184, v112, v168, v176 op_sel_hi:[1,0,0]
    v_fma_mix_f32 v185, v112, v169, v177 op_sel:[1,0,0] op_sel_hi:[1,0,0]
    v_cvt_pk_bf16_f32 v144, v184, v185
    v_fma_mix_f32 v186, v113, v170, v178 op_sel_hi:[1,0,0]
    v_mfma_f32_32x32x16_bf16 a[16:31], a[128:131], v[140:143], a[16:31]
    ds_read_b128 v[164:167], v234 offset:1840
    ds_read_b64_tr_b16 a[144:145], v200 offset:36864
    ds_read_b64_tr_b16 a[146:147], v200 offset:37888
    v_fma_mix_f32 v187, v113, v171, v179 op_sel:[1,0,0] op_sel_hi:[1,0,0]
    v_cvt_pk_bf16_f32 v145, v186, v187
    v_fma_mix_f32 v188, v114, v172, v180 op_sel_hi:[1,0,0]
    v_fma_mix_f32 v189, v114, v173, v181 op_sel:[1,0,0] op_sel_hi:[1,0,0]
    v_mfma_f32_32x32x16_bf16 a[32:47], a[132:135], v[136:139], a[32:47]
    ds_read_b64_tr_b16 a[148:149], v201 offset:36864
    ds_read_b64_tr_b16 a[150:151], v201 offset:37888
    ds_read_b64_tr_b16 a[152:153], v202 offset:36864
    v_cvt_pk_bf16_f32 v146, v188, v189
    v_fma_mix_f32 v190, v115, v174, v182 op_sel_hi:[1,0,0]
    v_fma_mix_f32 v191, v115, v175, v183 op_sel:[1,0,0] op_sel_hi:[1,0,0]
    v_cvt_pk_bf16_f32 v147, v190, v191
    v_mfma_f32_32x32x16_bf16 a[48:63], a[132:135], v[140:143], a[48:63]
    ds_read_b64_tr_b16 a[154:155], v202 offset:37888
    ds_read_b64_tr_b16 a[156:157], v203 offset:36864
    ds_read_b64_tr_b16 a[158:159], v203 offset:37888
    v_fma_mix_f32 v192, v116, v168, v176 op_sel_hi:[1,0,0]
    v_fma_mix_f32 v193, v116, v169, v177 op_sel:[1,0,0] op_sel_hi:[1,0,0]
    s_add_u32 m0, s33, 81920
    s_mov_b32 s39, 2621440
    v_mfma_f32_32x32x16_bf16 a[64:79], a[136:139], v[136:139], a[64:79]
    buffer_load_dwordx4 v7, s[16:19], s39 offen offset:0 lds
    v_cvt_pk_bf16_f32 v148, v192, v193
    v_fma_mix_f32 v194, v117, v170, v178 op_sel_hi:[1,0,0]
    v_fma_mix_f32 v195, v117, v171, v179 op_sel:[1,0,0] op_sel_hi:[1,0,0]
    s_mov_b32 s39, 2653184
    v_mfma_f32_32x32x16_bf16 a[80:95], a[136:139], v[140:143], a[80:95]
    buffer_load_dwordx4 v7, s[16:19], s39 offen offset:1024 lds
    v_cvt_pk_bf16_f32 v149, v194, v195
    v_fma_mix_f32 v196, v118, v172, v180 op_sel_hi:[1,0,0]
    v_fma_mix_f32 v197, v118, v173, v181 op_sel:[1,0,0] op_sel_hi:[1,0,0]
    v_cvt_pk_bf16_f32 v150, v196, v197
    s_mov_b32 s39, 2684928
    v_mfma_f32_32x32x16_bf16 a[96:111], a[140:143], v[136:139], a[96:111]
    buffer_load_dwordx4 v7, s[16:19], s39 offen offset:2048 lds
    v_fma_mix_f32 v198, v119, v174, v182 op_sel_hi:[1,0,0]
    v_fma_mix_f32 v199, v119, v175, v183 op_sel:[1,0,0] op_sel_hi:[1,0,0]
    v_cvt_pk_bf16_f32 v151, v198, v199
    s_mov_b32 s39, 2716672
    v_mfma_f32_32x32x16_bf16 a[112:127], a[140:143], v[140:143], a[112:127]
    s_waitcnt lgkmcnt(0)
    buffer_load_dwordx4 v7, s[16:19], s39 offen offset:3072 lds
    v_mfma_f32_32x32x16_bf16 a[0:15], a[144:147], v[144:147], a[0:15]
    s_waitcnt vmcnt(18)
    ds_read_b128 v[168:171], v234 offset:1920
    ds_read_b128 v[172:175], v234 offset:1936
    ds_read_b128 v[176:179], v234 offset:1952
    v_fma_mix_f32 v184, v120, v152, v160 op_sel_hi:[1,0,0]
    v_fma_mix_f32 v185, v120, v153, v161 op_sel:[1,0,0] op_sel_hi:[1,0,0]
    v_cvt_pk_bf16_f32 v136, v184, v185
    v_mfma_f32_32x32x16_bf16 a[16:31], a[144:147], v[148:151], a[16:31]
    ds_read_b128 v[180:183], v234 offset:1968
    ds_read_b64_tr_b16 a[128:129], v200 offset:40960
    ds_read_b64_tr_b16 a[130:131], v200 offset:41984
    v_fma_mix_f32 v186, v121, v154, v162 op_sel_hi:[1,0,0]
    v_fma_mix_f32 v187, v121, v155, v163 op_sel:[1,0,0] op_sel_hi:[1,0,0]
    v_cvt_pk_bf16_f32 v137, v186, v187
    v_fma_mix_f32 v188, v122, v156, v164 op_sel_hi:[1,0,0]
    v_mfma_f32_32x32x16_bf16 a[32:47], a[148:151], v[144:147], a[32:47]
    ds_read_b64_tr_b16 a[132:133], v201 offset:40960
    ds_read_b64_tr_b16 a[134:135], v201 offset:41984
    ds_read_b64_tr_b16 a[136:137], v202 offset:40960
    v_fma_mix_f32 v189, v122, v157, v165 op_sel:[1,0,0] op_sel_hi:[1,0,0]
    v_cvt_pk_bf16_f32 v138, v188, v189
    v_fma_mix_f32 v190, v123, v158, v166 op_sel_hi:[1,0,0]
    v_mfma_f32_32x32x16_bf16 a[48:63], a[148:151], v[148:151], a[48:63]
    ds_read_b64_tr_b16 a[138:139], v202 offset:41984
    ds_read_b64_tr_b16 a[140:141], v203 offset:40960
    ds_read_b64_tr_b16 a[142:143], v203 offset:41984
    v_fma_mix_f32 v191, v123, v159, v167 op_sel:[1,0,0] op_sel_hi:[1,0,0]
    v_cvt_pk_bf16_f32 v139, v190, v191
    v_fma_mix_f32 v192, v124, v152, v160 op_sel_hi:[1,0,0]
    s_add_u32 s40, s38, 20480
    v_mfma_f32_32x32x16_bf16 a[64:79], a[152:155], v[144:147], a[64:79]
    buffer_load_dwordx4 v[40:43], v233, s[20:23], s40 offen offset:0
    v_fma_mix_f32 v193, v124, v153, v161 op_sel:[1,0,0] op_sel_hi:[1,0,0]
    v_cvt_pk_bf16_f32 v140, v192, v193
    v_fma_mix_f32 v194, v125, v154, v162 op_sel_hi:[1,0,0]
    s_add_u32 s43, s38, 53248
    v_mfma_f32_32x32x16_bf16 a[80:95], a[152:155], v[148:151], a[80:95]
    buffer_load_dwordx4 v[44:47], v233, s[20:23], s43 offen offset:0
    v_fma_mix_f32 v195, v125, v155, v163 op_sel:[1,0,0] op_sel_hi:[1,0,0]
    v_cvt_pk_bf16_f32 v141, v194, v195
    v_fma_mix_f32 v196, v126, v156, v164 op_sel_hi:[1,0,0]
    v_fma_mix_f32 v197, v126, v157, v165 op_sel:[1,0,0] op_sel_hi:[1,0,0]
    v_mfma_f32_32x32x16_bf16 a[96:111], a[156:159], v[144:147], a[96:111]
    buffer_load_dwordx4 v[48:51], v233, s[20:23], s40 offen offset:1024
    v_cvt_pk_bf16_f32 v142, v196, v197
    v_fma_mix_f32 v198, v127, v158, v166 op_sel_hi:[1,0,0]
    v_fma_mix_f32 v199, v127, v159, v167 op_sel:[1,0,0] op_sel_hi:[1,0,0]
    v_cvt_pk_bf16_f32 v143, v198, v199
    v_mfma_f32_32x32x16_bf16 a[112:127], a[156:159], v[148:151], a[112:127]
    s_waitcnt lgkmcnt(0)
    buffer_load_dwordx4 v[52:55], v233, s[20:23], s43 offen offset:1024
    v_mfma_f32_32x32x16_bf16 a[0:15], a[128:131], v[136:139], a[0:15]
    s_waitcnt vmcnt(20)
    ds_read_b128 v[152:155], v234 offset:2048
    ds_read_b128 v[156:159], v234 offset:2064
    ds_read_b128 v[160:163], v234 offset:2080
    v_fma_mix_f32 v184, v128, v168, v176 op_sel_hi:[1,0,0]
    v_fma_mix_f32 v185, v128, v169, v177 op_sel:[1,0,0] op_sel_hi:[1,0,0]
    v_cvt_pk_bf16_f32 v144, v184, v185
    v_mfma_f32_32x32x16_bf16 a[16:31], a[128:131], v[140:143], a[16:31]
    ds_read_b128 v[164:167], v234 offset:2096
    ds_read_b64_tr_b16 a[144:145], v200 offset:45056
    ds_read_b64_tr_b16 a[146:147], v200 offset:46080
    v_fma_mix_f32 v186, v129, v170, v178 op_sel_hi:[1,0,0]
    v_fma_mix_f32 v187, v129, v171, v179 op_sel:[1,0,0] op_sel_hi:[1,0,0]
    v_cvt_pk_bf16_f32 v145, v186, v187
    v_fma_mix_f32 v188, v130, v172, v180 op_sel_hi:[1,0,0]
    v_mfma_f32_32x32x16_bf16 a[32:47], a[132:135], v[136:139], a[32:47]
    ds_read_b64_tr_b16 a[148:149], v201 offset:45056
    ds_read_b64_tr_b16 a[150:151], v201 offset:46080
    ds_read_b64_tr_b16 a[152:153], v202 offset:45056
    v_fma_mix_f32 v189, v130, v173, v181 op_sel:[1,0,0] op_sel_hi:[1,0,0]
    v_cvt_pk_bf16_f32 v146, v188, v189
    v_fma_mix_f32 v190, v131, v174, v182 op_sel_hi:[1,0,0]
    v_mfma_f32_32x32x16_bf16 a[48:63], a[132:135], v[140:143], a[48:63]
    ds_read_b64_tr_b16 a[154:155], v202 offset:46080
    ds_read_b64_tr_b16 a[156:157], v203 offset:45056
    ds_read_b64_tr_b16 a[158:159], v203 offset:46080
    v_fma_mix_f32 v191, v131, v175, v183 op_sel:[1,0,0] op_sel_hi:[1,0,0]
    v_cvt_pk_bf16_f32 v147, v190, v191
    v_fma_mix_f32 v192, v132, v168, v176 op_sel_hi:[1,0,0]
    v_mfma_f32_32x32x16_bf16 a[64:79], a[136:139], v[136:139], a[64:79]
    buffer_load_dwordx4 v[56:59], v233, s[20:23], s40 offen offset:2048
    v_fma_mix_f32 v193, v132, v169, v177 op_sel:[1,0,0] op_sel_hi:[1,0,0]
    v_cvt_pk_bf16_f32 v148, v192, v193
    v_fma_mix_f32 v194, v133, v170, v178 op_sel_hi:[1,0,0]
    v_fma_mix_f32 v195, v133, v171, v179 op_sel:[1,0,0] op_sel_hi:[1,0,0]
    v_mfma_f32_32x32x16_bf16 a[80:95], a[136:139], v[140:143], a[80:95]
    buffer_load_dwordx4 v[60:63], v233, s[20:23], s43 offen offset:2048
    v_cvt_pk_bf16_f32 v149, v194, v195
    v_fma_mix_f32 v196, v134, v172, v180 op_sel_hi:[1,0,0]
    v_fma_mix_f32 v197, v134, v173, v181 op_sel:[1,0,0] op_sel_hi:[1,0,0]
    v_mfma_f32_32x32x16_bf16 a[96:111], a[140:143], v[136:139], a[96:111]
    buffer_load_dwordx4 v[64:67], v233, s[20:23], s40 offen offset:3072
    v_cvt_pk_bf16_f32 v150, v196, v197
    v_fma_mix_f32 v198, v135, v174, v182 op_sel_hi:[1,0,0]
    v_fma_mix_f32 v199, v135, v175, v183 op_sel:[1,0,0] op_sel_hi:[1,0,0]
    v_cvt_pk_bf16_f32 v151, v198, v199
    v_mfma_f32_32x32x16_bf16 a[112:127], a[140:143], v[140:143], a[112:127]
    s_waitcnt lgkmcnt(0)
    buffer_load_dwordx4 v[68:71], v233, s[20:23], s43 offen offset:3072
    v_mfma_f32_32x32x16_bf16 a[0:15], a[144:147], v[144:147], a[0:15]
    s_waitcnt vmcnt(18)
    s_barrier
    v_fma_mix_f32 v184, v8, v152, v160 op_sel_hi:[1,0,0]
    v_fma_mix_f32 v185, v8, v153, v161 op_sel:[1,0,0] op_sel_hi:[1,0,0]
    v_mfma_f32_32x32x16_bf16 a[16:31], a[144:147], v[148:151], a[16:31]
    ds_read_b128 v[168:171], v234 offset:2176
    ds_read_b128 v[172:175], v234 offset:2192
    ds_read_b128 v[176:179], v234 offset:2208
    v_cvt_pk_bf16_f32 v136, v184, v185
    v_mfma_f32_32x32x16_bf16 a[32:47], a[148:151], v[144:147], a[32:47]
    ds_read_b128 v[180:183], v234 offset:2224
    ds_read_b64_tr_b16 a[128:129], v200 offset:49152
    ds_read_b64_tr_b16 a[130:131], v200 offset:50176
    v_fma_mix_f32 v186, v9, v154, v162 op_sel_hi:[1,0,0]
    v_fma_mix_f32 v187, v9, v155, v163 op_sel:[1,0,0] op_sel_hi:[1,0,0]
    v_cvt_pk_bf16_f32 v137, v186, v187
    v_fma_mix_f32 v188, v10, v156, v164 op_sel_hi:[1,0,0]
    v_fma_mix_f32 v189, v10, v157, v165 op_sel:[1,0,0] op_sel_hi:[1,0,0]
    v_cvt_pk_bf16_f32 v138, v188, v189
    v_mfma_f32_32x32x16_bf16 a[48:63], a[148:151], v[148:151], a[48:63]
    ds_read_b64_tr_b16 a[132:133], v201 offset:49152
    ds_read_b64_tr_b16 a[134:135], v201 offset:50176
    ds_read_b64_tr_b16 a[136:137], v202 offset:49152
    v_fma_mix_f32 v190, v11, v158, v166 op_sel_hi:[1,0,0]
    v_fma_mix_f32 v191, v11, v159, v167 op_sel:[1,0,0] op_sel_hi:[1,0,0]
    v_cvt_pk_bf16_f32 v139, v190, v191
    s_add_u32 m0, s33, 98304
    s_mov_b32 s39, 3145728
    v_mfma_f32_32x32x16_bf16 a[64:79], a[152:155], v[144:147], a[64:79]
    buffer_load_dwordx4 v7, s[16:19], s39 offen offset:0 lds
    ds_read_b64_tr_b16 a[138:139], v202 offset:50176
    ds_read_b64_tr_b16 a[140:141], v203 offset:49152
    ds_read_b64_tr_b16 a[142:143], v203 offset:50176
    v_fma_mix_f32 v192, v12, v152, v160 op_sel_hi:[1,0,0]
    s_mov_b32 s39, 3177472
    v_mfma_f32_32x32x16_bf16 a[80:95], a[152:155], v[148:151], a[80:95]
    buffer_load_dwordx4 v7, s[16:19], s39 offen offset:1024 lds
    v_fma_mix_f32 v193, v12, v153, v161 op_sel:[1,0,0] op_sel_hi:[1,0,0]
    v_cvt_pk_bf16_f32 v140, v192, v193
    v_fma_mix_f32 v194, v13, v154, v162 op_sel_hi:[1,0,0]
    v_fma_mix_f32 v195, v13, v155, v163 op_sel:[1,0,0] op_sel_hi:[1,0,0]
    v_cvt_pk_bf16_f32 v141, v194, v195
    v_fma_mix_f32 v196, v14, v156, v164 op_sel_hi:[1,0,0]
    s_mov_b32 s39, 3209216
    v_mfma_f32_32x32x16_bf16 a[96:111], a[156:159], v[144:147], a[96:111]
    buffer_load_dwordx4 v7, s[16:19], s39 offen offset:2048 lds
    v_fma_mix_f32 v197, v14, v157, v165 op_sel:[1,0,0] op_sel_hi:[1,0,0]
    v_cvt_pk_bf16_f32 v142, v196, v197
    v_fma_mix_f32 v198, v15, v158, v166 op_sel_hi:[1,0,0]
    v_fma_mix_f32 v199, v15, v159, v167 op_sel:[1,0,0] op_sel_hi:[1,0,0]
    v_cvt_pk_bf16_f32 v143, v198, v199
    s_mov_b32 s39, 3240960
    v_mfma_f32_32x32x16_bf16 a[112:127], a[156:159], v[148:151], a[112:127]
    s_waitcnt lgkmcnt(0)
    buffer_load_dwordx4 v7, s[16:19], s39 offen offset:3072 lds
    v_mfma_f32_32x32x16_bf16 a[0:15], a[128:131], v[136:139], a[0:15]
    s_waitcnt vmcnt(20)
    ds_read_b128 v[152:155], v234 offset:2304
    ds_read_b128 v[156:159], v234 offset:2320
    ds_read_b128 v[160:163], v234 offset:2336
    v_fma_mix_f32 v184, v16, v168, v176 op_sel_hi:[1,0,0]
    v_fma_mix_f32 v185, v16, v169, v177 op_sel:[1,0,0] op_sel_hi:[1,0,0]
    v_cvt_pk_bf16_f32 v144, v184, v185
    v_mfma_f32_32x32x16_bf16 a[16:31], a[128:131], v[140:143], a[16:31]
    ds_read_b128 v[164:167], v234 offset:2352
    ds_read_b64_tr_b16 a[144:145], v200 offset:53248
    ds_read_b64_tr_b16 a[146:147], v200 offset:54272
    v_fma_mix_f32 v186, v17, v170, v178 op_sel_hi:[1,0,0]
    v_fma_mix_f32 v187, v17, v171, v179 op_sel:[1,0,0] op_sel_hi:[1,0,0]
    v_cvt_pk_bf16_f32 v145, v186, v187
    v_fma_mix_f32 v188, v18, v172, v180 op_sel_hi:[1,0,0]
    v_mfma_f32_32x32x16_bf16 a[32:47], a[132:135], v[136:139], a[32:47]
    ds_read_b64_tr_b16 a[148:149], v201 offset:53248
    ds_read_b64_tr_b16 a[150:151], v201 offset:54272
    ds_read_b64_tr_b16 a[152:153], v202 offset:53248
    v_fma_mix_f32 v189, v18, v173, v181 op_sel:[1,0,0] op_sel_hi:[1,0,0]
    v_cvt_pk_bf16_f32 v146, v188, v189
    v_fma_mix_f32 v190, v19, v174, v182 op_sel_hi:[1,0,0]
    v_mfma_f32_32x32x16_bf16 a[48:63], a[132:135], v[140:143], a[48:63]
    ds_read_b64_tr_b16 a[154:155], v202 offset:54272
    ds_read_b64_tr_b16 a[156:157], v203 offset:53248
    ds_read_b64_tr_b16 a[158:159], v203 offset:54272
    v_fma_mix_f32 v191, v19, v175, v183 op_sel:[1,0,0] op_sel_hi:[1,0,0]
    v_cvt_pk_bf16_f32 v147, v190, v191
    v_fma_mix_f32 v192, v20, v168, v176 op_sel_hi:[1,0,0]
    s_add_u32 s40, s38, 24576
    v_mfma_f32_32x32x16_bf16 a[64:79], a[136:139], v[136:139], a[64:79]
    buffer_load_dwordx4 v[72:75], v233, s[20:23], s40 offen offset:0
    v_fma_mix_f32 v193, v20, v169, v177 op_sel:[1,0,0] op_sel_hi:[1,0,0]
    v_cvt_pk_bf16_f32 v148, v192, v193
    v_fma_mix_f32 v194, v21, v170, v178 op_sel_hi:[1,0,0]
    s_add_u32 s43, s38, 57344
    v_mfma_f32_32x32x16_bf16 a[80:95], a[136:139], v[140:143], a[80:95]
    buffer_load_dwordx4 v[76:79], v233, s[20:23], s43 offen offset:0
    v_fma_mix_f32 v195, v21, v171, v179 op_sel:[1,0,0] op_sel_hi:[1,0,0]
    v_cvt_pk_bf16_f32 v149, v194, v195
    v_fma_mix_f32 v196, v22, v172, v180 op_sel_hi:[1,0,0]
    v_fma_mix_f32 v197, v22, v173, v181 op_sel:[1,0,0] op_sel_hi:[1,0,0]
    v_mfma_f32_32x32x16_bf16 a[96:111], a[140:143], v[136:139], a[96:111]
    buffer_load_dwordx4 v[80:83], v233, s[20:23], s40 offen offset:1024
    v_cvt_pk_bf16_f32 v150, v196, v197
    v_fma_mix_f32 v198, v23, v174, v182 op_sel_hi:[1,0,0]
    v_fma_mix_f32 v199, v23, v175, v183 op_sel:[1,0,0] op_sel_hi:[1,0,0]
    v_cvt_pk_bf16_f32 v151, v198, v199
    v_mfma_f32_32x32x16_bf16 a[112:127], a[140:143], v[140:143], a[112:127]
    s_waitcnt lgkmcnt(0)
    buffer_load_dwordx4 v[84:87], v233, s[20:23], s43 offen offset:1024
    v_mfma_f32_32x32x16_bf16 a[0:15], a[144:147], v[144:147], a[0:15]
    s_waitcnt vmcnt(22)
    ds_read_b128 v[168:171], v234 offset:2432
    ds_read_b128 v[172:175], v234 offset:2448
    ds_read_b128 v[176:179], v234 offset:2464
    v_fma_mix_f32 v184, v24, v152, v160 op_sel_hi:[1,0,0]
    v_fma_mix_f32 v185, v24, v153, v161 op_sel:[1,0,0] op_sel_hi:[1,0,0]
    v_cvt_pk_bf16_f32 v136, v184, v185
    v_mfma_f32_32x32x16_bf16 a[16:31], a[144:147], v[148:151], a[16:31]
    ds_read_b128 v[180:183], v234 offset:2480
    ds_read_b64_tr_b16 a[128:129], v200 offset:57344
    ds_read_b64_tr_b16 a[130:131], v200 offset:58368
    v_fma_mix_f32 v186, v25, v154, v162 op_sel_hi:[1,0,0]
    v_fma_mix_f32 v187, v25, v155, v163 op_sel:[1,0,0] op_sel_hi:[1,0,0]
    v_cvt_pk_bf16_f32 v137, v186, v187
    v_fma_mix_f32 v188, v26, v156, v164 op_sel_hi:[1,0,0]
    v_mfma_f32_32x32x16_bf16 a[32:47], a[148:151], v[144:147], a[32:47]
    ds_read_b64_tr_b16 a[132:133], v201 offset:57344
    ds_read_b64_tr_b16 a[134:135], v201 offset:58368
    ds_read_b64_tr_b16 a[136:137], v202 offset:57344
    v_fma_mix_f32 v189, v26, v157, v165 op_sel:[1,0,0] op_sel_hi:[1,0,0]
    v_cvt_pk_bf16_f32 v138, v188, v189
    v_fma_mix_f32 v190, v27, v158, v166 op_sel_hi:[1,0,0]
    v_mfma_f32_32x32x16_bf16 a[48:63], a[148:151], v[148:151], a[48:63]
    ds_read_b64_tr_b16 a[138:139], v202 offset:58368
    ds_read_b64_tr_b16 a[140:141], v203 offset:57344
    ds_read_b64_tr_b16 a[142:143], v203 offset:58368
    v_fma_mix_f32 v191, v27, v159, v167 op_sel:[1,0,0] op_sel_hi:[1,0,0]
    v_cvt_pk_bf16_f32 v139, v190, v191
    v_fma_mix_f32 v192, v28, v152, v160 op_sel_hi:[1,0,0]
    v_mfma_f32_32x32x16_bf16 a[64:79], a[152:155], v[144:147], a[64:79]
    buffer_load_dwordx4 v[88:91], v233, s[20:23], s40 offen offset:2048
    v_fma_mix_f32 v193, v28, v153, v161 op_sel:[1,0,0] op_sel_hi:[1,0,0]
    v_cvt_pk_bf16_f32 v140, v192, v193
    v_fma_mix_f32 v194, v29, v154, v162 op_sel_hi:[1,0,0]
    v_fma_mix_f32 v195, v29, v155, v163 op_sel:[1,0,0] op_sel_hi:[1,0,0]
    v_mfma_f32_32x32x16_bf16 a[80:95], a[152:155], v[148:151], a[80:95]
    buffer_load_dwordx4 v[92:95], v233, s[20:23], s43 offen offset:2048
    v_cvt_pk_bf16_f32 v141, v194, v195
    v_fma_mix_f32 v196, v30, v156, v164 op_sel_hi:[1,0,0]
    v_fma_mix_f32 v197, v30, v157, v165 op_sel:[1,0,0] op_sel_hi:[1,0,0]
    v_mfma_f32_32x32x16_bf16 a[96:111], a[156:159], v[144:147], a[96:111]
    buffer_load_dwordx4 v[96:99], v233, s[20:23], s40 offen offset:3072
    v_cvt_pk_bf16_f32 v142, v196, v197
    v_fma_mix_f32 v198, v31, v158, v166 op_sel_hi:[1,0,0]
    v_fma_mix_f32 v199, v31, v159, v167 op_sel:[1,0,0] op_sel_hi:[1,0,0]
    v_cvt_pk_bf16_f32 v143, v198, v199
    v_mfma_f32_32x32x16_bf16 a[112:127], a[156:159], v[148:151], a[112:127]
    s_waitcnt lgkmcnt(0)
    buffer_load_dwordx4 v[100:103], v233, s[20:23], s43 offen offset:3072
    v_mfma_f32_32x32x16_bf16 a[0:15], a[128:131], v[136:139], a[0:15]
    s_waitcnt vmcnt(24)
    ds_read_b128 v[152:155], v234 offset:2560
    ds_read_b128 v[156:159], v234 offset:2576
    ds_read_b128 v[160:163], v234 offset:2592
    v_fma_mix_f32 v184, v32, v168, v176 op_sel_hi:[1,0,0]
    v_fma_mix_f32 v185, v32, v169, v177 op_sel:[1,0,0] op_sel_hi:[1,0,0]
    v_cvt_pk_bf16_f32 v144, v184, v185
    v_fma_mix_f32 v186, v33, v170, v178 op_sel_hi:[1,0,0]
    v_mfma_f32_32x32x16_bf16 a[16:31], a[128:131], v[140:143], a[16:31]
    ds_read_b128 v[164:167], v234 offset:2608
    ds_read_b64_tr_b16 a[144:145], v200 offset:61440
    ds_read_b64_tr_b16 a[146:147], v200 offset:62464
    v_fma_mix_f32 v187, v33, v171, v179 op_sel:[1,0,0] op_sel_hi:[1,0,0]
    v_cvt_pk_bf16_f32 v145, v186, v187
    v_fma_mix_f32 v188, v34, v172, v180 op_sel_hi:[1,0,0]
    v_fma_mix_f32 v189, v34, v173, v181 op_sel:[1,0,0] op_sel_hi:[1,0,0]
    v_mfma_f32_32x32x16_bf16 a[32:47], a[132:135], v[136:139], a[32:47]
    ds_read_b64_tr_b16 a[148:149], v201 offset:61440
    ds_read_b64_tr_b16 a[150:151], v201 offset:62464
    ds_read_b64_tr_b16 a[152:153], v202 offset:61440
    v_cvt_pk_bf16_f32 v146, v188, v189
    v_fma_mix_f32 v190, v35, v174, v182 op_sel_hi:[1,0,0]
    v_fma_mix_f32 v191, v35, v175, v183 op_sel:[1,0,0] op_sel_hi:[1,0,0]
    v_cvt_pk_bf16_f32 v147, v190, v191
    v_mfma_f32_32x32x16_bf16 a[48:63], a[132:135], v[140:143], a[48:63]
    ds_read_b64_tr_b16 a[154:155], v202 offset:62464
    ds_read_b64_tr_b16 a[156:157], v203 offset:61440
    ds_read_b64_tr_b16 a[158:159], v203 offset:62464
    v_fma_mix_f32 v192, v36, v168, v176 op_sel_hi:[1,0,0]
    v_fma_mix_f32 v193, v36, v169, v177 op_sel:[1,0,0] op_sel_hi:[1,0,0]
    s_add_u32 m0, s33, 114688
    s_mov_b32 s39, 3670016
    v_mfma_f32_32x32x16_bf16 a[64:79], a[136:139], v[136:139], a[64:79]
    buffer_load_dwordx4 v7, s[16:19], s39 offen offset:0 lds
    v_cvt_pk_bf16_f32 v148, v192, v193
    v_fma_mix_f32 v194, v37, v170, v178 op_sel_hi:[1,0,0]
    v_fma_mix_f32 v195, v37, v171, v179 op_sel:[1,0,0] op_sel_hi:[1,0,0]
    s_mov_b32 s39, 3701760
    v_mfma_f32_32x32x16_bf16 a[80:95], a[136:139], v[140:143], a[80:95]
    buffer_load_dwordx4 v7, s[16:19], s39 offen offset:1024 lds
    v_cvt_pk_bf16_f32 v149, v194, v195
    v_fma_mix_f32 v196, v38, v172, v180 op_sel_hi:[1,0,0]
    v_fma_mix_f32 v197, v38, v173, v181 op_sel:[1,0,0] op_sel_hi:[1,0,0]
    v_cvt_pk_bf16_f32 v150, v196, v197
    s_mov_b32 s39, 3733504
    v_mfma_f32_32x32x16_bf16 a[96:111], a[140:143], v[136:139], a[96:111]
    buffer_load_dwordx4 v7, s[16:19], s39 offen offset:2048 lds
    v_fma_mix_f32 v198, v39, v174, v182 op_sel_hi:[1,0,0]
    v_fma_mix_f32 v199, v39, v175, v183 op_sel:[1,0,0] op_sel_hi:[1,0,0]
    v_cvt_pk_bf16_f32 v151, v198, v199
    s_mov_b32 s39, 3765248
    v_mfma_f32_32x32x16_bf16 a[112:127], a[140:143], v[140:143], a[112:127]
    s_waitcnt lgkmcnt(0)
    buffer_load_dwordx4 v7, s[16:19], s39 offen offset:3072 lds
    v_mfma_f32_32x32x16_bf16 a[0:15], a[144:147], v[144:147], a[0:15]
    s_waitcnt vmcnt(22)
    s_barrier
    v_fma_mix_f32 v184, v40, v152, v160 op_sel_hi:[1,0,0]
    v_mfma_f32_32x32x16_bf16 a[16:31], a[144:147], v[148:151], a[16:31]
    ds_read_b128 v[168:171], v234 offset:2688
    ds_read_b128 v[172:175], v234 offset:2704
    ds_read_b128 v[176:179], v234 offset:2720
    v_fma_mix_f32 v185, v40, v153, v161 op_sel:[1,0,0] op_sel_hi:[1,0,0]
    v_cvt_pk_bf16_f32 v136, v184, v185
    v_mfma_f32_32x32x16_bf16 a[32:47], a[148:151], v[144:147], a[32:47]
    ds_read_b128 v[180:183], v234 offset:2736
    ds_read_b64_tr_b16 a[128:129], v204 offset:16384
    ds_read_b64_tr_b16 a[130:131], v204 offset:17408
    v_fma_mix_f32 v186, v41, v154, v162 op_sel_hi:[1,0,0]
    v_fma_mix_f32 v187, v41, v155, v163 op_sel:[1,0,0] op_sel_hi:[1,0,0]
    v_cvt_pk_bf16_f32 v137, v186, v187
    v_fma_mix_f32 v188, v42, v156, v164 op_sel_hi:[1,0,0]
    v_fma_mix_f32 v189, v42, v157, v165 op_sel:[1,0,0] op_sel_hi:[1,0,0]
    v_mfma_f32_32x32x16_bf16 a[48:63], a[148:151], v[148:151], a[48:63]
    ds_read_b64_tr_b16 a[132:133], v205 offset:16384
    ds_read_b64_tr_b16 a[134:135], v205 offset:17408
    ds_read_b64_tr_b16 a[136:137], v206 offset:16384
    v_cvt_pk_bf16_f32 v138, v188, v189
    v_fma_mix_f32 v190, v43, v158, v166 op_sel_hi:[1,0,0]
    v_fma_mix_f32 v191, v43, v159, v167 op_sel:[1,0,0] op_sel_hi:[1,0,0]
    v_cvt_pk_bf16_f32 v139, v190, v191
    s_add_u32 s40, s38, 28672
    v_mfma_f32_32x32x16_bf16 a[64:79], a[152:155], v[144:147], a[64:79]
    buffer_load_dwordx4 v[104:107], v233, s[20:23], s40 offen offset:0
    ds_read_b64_tr_b16 a[138:139], v206 offset:17408
    ds_read_b64_tr_b16 a[140:141], v207 offset:16384
    ds_read_b64_tr_b16 a[142:143], v207 offset:17408
    s_add_u32 s43, s38, 61440
    v_mfma_f32_32x32x16_bf16 a[80:95], a[152:155], v[148:151], a[80:95]
    buffer_load_dwordx4 v[108:111], v233, s[20:23], s43 offen offset:0
    v_fma_mix_f32 v192, v44, v152, v160 op_sel_hi:[1,0,0]
    v_fma_mix_f32 v193, v44, v153, v161 op_sel:[1,0,0] op_sel_hi:[1,0,0]
    v_cvt_pk_bf16_f32 v140, v192, v193
    v_fma_mix_f32 v194, v45, v154, v162 op_sel_hi:[1,0,0]
    v_fma_mix_f32 v195, v45, v155, v163 op_sel:[1,0,0] op_sel_hi:[1,0,0]
    v_cvt_pk_bf16_f32 v141, v194, v195
    v_mfma_f32_32x32x16_bf16 a[96:111], a[156:159], v[144:147], a[96:111]
    buffer_load_dwordx4 v[112:115], v233, s[20:23], s40 offen offset:1024
    v_fma_mix_f32 v196, v46, v156, v164 op_sel_hi:[1,0,0]
    v_fma_mix_f32 v197, v46, v157, v165 op_sel:[1,0,0] op_sel_hi:[1,0,0]
    v_cvt_pk_bf16_f32 v142, v196, v197
    v_fma_mix_f32 v198, v47, v158, v166 op_sel_hi:[1,0,0]
    v_fma_mix_f32 v199, v47, v159, v167 op_sel:[1,0,0] op_sel_hi:[1,0,0]
    v_cvt_pk_bf16_f32 v143, v198, v199
    v_mfma_f32_32x32x16_bf16 a[112:127], a[156:159], v[148:151], a[112:127]
    s_waitcnt lgkmcnt(0)
    buffer_load_dwordx4 v[116:119], v233, s[20:23], s43 offen offset:1024
    v_mfma_f32_32x32x16_bf16 a[0:15], a[128:131], v[136:139], a[0:15]
    s_waitcnt vmcnt(24)
    ds_read_b128 v[152:155], v234 offset:2816
    ds_read_b128 v[156:159], v234 offset:2832
    ds_read_b128 v[160:163], v234 offset:2848
    v_fma_mix_f32 v184, v48, v168, v176 op_sel_hi:[1,0,0]
    v_fma_mix_f32 v185, v48, v169, v177 op_sel:[1,0,0] op_sel_hi:[1,0,0]
    v_cvt_pk_bf16_f32 v144, v184, v185
    v_mfma_f32_32x32x16_bf16 a[16:31], a[128:131], v[140:143], a[16:31]
    ds_read_b128 v[164:167], v234 offset:2864
    ds_read_b64_tr_b16 a[144:145], v204 offset:20480
    ds_read_b64_tr_b16 a[146:147], v204 offset:21504
    v_fma_mix_f32 v186, v49, v170, v178 op_sel_hi:[1,0,0]
    v_fma_mix_f32 v187, v49, v171, v179 op_sel:[1,0,0] op_sel_hi:[1,0,0]
    v_cvt_pk_bf16_f32 v145, v186, v187
    v_fma_mix_f32 v188, v50, v172, v180 op_sel_hi:[1,0,0]
    v_mfma_f32_32x32x16_bf16 a[32:47], a[132:135], v[136:139], a[32:47]
    ds_read_b64_tr_b16 a[148:149], v205 offset:20480
    ds_read_b64_tr_b16 a[150:151], v205 offset:21504
    ds_read_b64_tr_b16 a[152:153], v206 offset:20480
    v_fma_mix_f32 v189, v50, v173, v181 op_sel:[1,0,0] op_sel_hi:[1,0,0]
    v_cvt_pk_bf16_f32 v146, v188, v189
    v_fma_mix_f32 v190, v51, v174, v182 op_sel_hi:[1,0,0]
    v_mfma_f32_32x32x16_bf16 a[48:63], a[132:135], v[140:143], a[48:63]
    ds_read_b64_tr_b16 a[154:155], v206 offset:21504
    ds_read_b64_tr_b16 a[156:157], v207 offset:20480
    ds_read_b64_tr_b16 a[158:159], v207 offset:21504
    v_fma_mix_f32 v191, v51, v175, v183 op_sel:[1,0,0] op_sel_hi:[1,0,0]
    v_cvt_pk_bf16_f32 v147, v190, v191
    v_fma_mix_f32 v192, v52, v168, v176 op_sel_hi:[1,0,0]
    v_mfma_f32_32x32x16_bf16 a[64:79], a[136:139], v[136:139], a[64:79]
    buffer_load_dwordx4 v[120:123], v233, s[20:23], s40 offen offset:2048
    v_fma_mix_f32 v193, v52, v169, v177 op_sel:[1,0,0] op_sel_hi:[1,0,0]
    v_cvt_pk_bf16_f32 v148, v192, v193
    v_fma_mix_f32 v194, v53, v170, v178 op_sel_hi:[1,0,0]
    v_fma_mix_f32 v195, v53, v171, v179 op_sel:[1,0,0] op_sel_hi:[1,0,0]
    v_mfma_f32_32x32x16_bf16 a[80:95], a[136:139], v[140:143], a[80:95]
    buffer_load_dwordx4 v[124:127], v233, s[20:23], s43 offen offset:2048
    v_cvt_pk_bf16_f32 v149, v194, v195
    v_fma_mix_f32 v196, v54, v172, v180 op_sel_hi:[1,0,0]
    v_fma_mix_f32 v197, v54, v173, v181 op_sel:[1,0,0] op_sel_hi:[1,0,0]
    v_mfma_f32_32x32x16_bf16 a[96:111], a[140:143], v[136:139], a[96:111]
    buffer_load_dwordx4 v[128:131], v233, s[20:23], s40 offen offset:3072
    v_cvt_pk_bf16_f32 v150, v196, v197
    v_fma_mix_f32 v198, v55, v174, v182 op_sel_hi:[1,0,0]
    v_fma_mix_f32 v199, v55, v175, v183 op_sel:[1,0,0] op_sel_hi:[1,0,0]
    v_cvt_pk_bf16_f32 v151, v198, v199
    v_mfma_f32_32x32x16_bf16 a[112:127], a[140:143], v[140:143], a[112:127]
    s_waitcnt lgkmcnt(0)
    buffer_load_dwordx4 v[132:135], v233, s[20:23], s43 offen offset:3072
    v_mfma_f32_32x32x16_bf16 a[0:15], a[144:147], v[144:147], a[0:15]
    s_waitcnt vmcnt(26)
    ds_read_b128 v[168:171], v234 offset:2944
    ds_read_b128 v[172:175], v234 offset:2960
    ds_read_b128 v[176:179], v234 offset:2976
    v_fma_mix_f32 v184, v56, v152, v160 op_sel_hi:[1,0,0]
    v_fma_mix_f32 v185, v56, v153, v161 op_sel:[1,0,0] op_sel_hi:[1,0,0]
    v_cvt_pk_bf16_f32 v136, v184, v185
    v_mfma_f32_32x32x16_bf16 a[16:31], a[144:147], v[148:151], a[16:31]
    ds_read_b128 v[180:183], v234 offset:2992
    ds_read_b64_tr_b16 a[128:129], v204 offset:24576
    ds_read_b64_tr_b16 a[130:131], v204 offset:25600
    v_fma_mix_f32 v186, v57, v154, v162 op_sel_hi:[1,0,0]
    v_fma_mix_f32 v187, v57, v155, v163 op_sel:[1,0,0] op_sel_hi:[1,0,0]
    v_cvt_pk_bf16_f32 v137, v186, v187
    v_fma_mix_f32 v188, v58, v156, v164 op_sel_hi:[1,0,0]
    v_mfma_f32_32x32x16_bf16 a[32:47], a[148:151], v[144:147], a[32:47]
    ds_read_b64_tr_b16 a[132:133], v205 offset:24576
    ds_read_b64_tr_b16 a[134:135], v205 offset:25600
    ds_read_b64_tr_b16 a[136:137], v206 offset:24576
    v_fma_mix_f32 v189, v58, v157, v165 op_sel:[1,0,0] op_sel_hi:[1,0,0]
    v_cvt_pk_bf16_f32 v138, v188, v189
    v_fma_mix_f32 v190, v59, v158, v166 op_sel_hi:[1,0,0]
    v_mfma_f32_32x32x16_bf16 a[48:63], a[148:151], v[148:151], a[48:63]
    ds_read_b64_tr_b16 a[138:139], v206 offset:25600
    ds_read_b64_tr_b16 a[140:141], v207 offset:24576
    ds_read_b64_tr_b16 a[142:143], v207 offset:25600
    v_fma_mix_f32 v191, v59, v159, v167 op_sel:[1,0,0] op_sel_hi:[1,0,0]
    v_cvt_pk_bf16_f32 v139, v190, v191
    s_add_u32 m0, s33, 0
    s_mov_b32 s39, 0
    v_mfma_f32_32x32x16_bf16 a[64:79], a[152:155], v[144:147], a[64:79]
    buffer_load_dwordx4 v228, s[8:11], s39 offen offset:0 lds
    v_fma_mix_f32 v192, v60, v152, v160 op_sel_hi:[1,0,0]
    v_fma_mix_f32 v193, v60, v153, v161 op_sel:[1,0,0] op_sel_hi:[1,0,0]
    v_cvt_pk_bf16_f32 v140, v192, v193
    v_fma_mix_f32 v194, v61, v154, v162 op_sel_hi:[1,0,0]
    v_mfma_f32_32x32x16_bf16 a[80:95], a[152:155], v[148:151], a[80:95]
    buffer_load_dwordx4 v229, s[8:11], s39 offen offset:1024 lds
    v_fma_mix_f32 v195, v61, v155, v163 op_sel:[1,0,0] op_sel_hi:[1,0,0]
    v_cvt_pk_bf16_f32 v141, v194, v195
    v_fma_mix_f32 v196, v62, v156, v164 op_sel_hi:[1,0,0]
    v_fma_mix_f32 v197, v62, v157, v165 op_sel:[1,0,0] op_sel_hi:[1,0,0]
    v_mfma_f32_32x32x16_bf16 a[96:111], a[156:159], v[144:147], a[96:111]
    buffer_load_dwordx4 v230, s[8:11], s39 offen offset:2048 lds
    v_cvt_pk_bf16_f32 v142, v196, v197
    v_fma_mix_f32 v198, v63, v158, v166 op_sel_hi:[1,0,0]
    v_fma_mix_f32 v199, v63, v159, v167 op_sel:[1,0,0] op_sel_hi:[1,0,0]
    v_cvt_pk_bf16_f32 v143, v198, v199
    v_mfma_f32_32x32x16_bf16 a[112:127], a[156:159], v[148:151], a[112:127]
    s_waitcnt lgkmcnt(0)
    buffer_load_dwordx4 v231, s[8:11], s39 offen offset:3072 lds
    v_mfma_f32_32x32x16_bf16 a[0:15], a[128:131], v[136:139], a[0:15]
    s_waitcnt vmcnt(28)
    ds_read_b128 v[152:155], v234 offset:3072
    ds_read_b128 v[156:159], v234 offset:3088
    ds_read_b128 v[160:163], v234 offset:3104
    v_fma_mix_f32 v184, v64, v168, v176 op_sel_hi:[1,0,0]
    v_fma_mix_f32 v185, v64, v169, v177 op_sel:[1,0,0] op_sel_hi:[1,0,0]
    v_cvt_pk_bf16_f32 v144, v184, v185
    v_mfma_f32_32x32x16_bf16 a[16:31], a[128:131], v[140:143], a[16:31]
    ds_read_b128 v[164:167], v234 offset:3120
    ds_read_b64_tr_b16 a[144:145], v204 offset:28672
    ds_read_b64_tr_b16 a[146:147], v204 offset:29696
    v_fma_mix_f32 v186, v65, v170, v178 op_sel_hi:[1,0,0]
    v_fma_mix_f32 v187, v65, v171, v179 op_sel:[1,0,0] op_sel_hi:[1,0,0]
    v_cvt_pk_bf16_f32 v145, v186, v187
    v_fma_mix_f32 v188, v66, v172, v180 op_sel_hi:[1,0,0]
    v_mfma_f32_32x32x16_bf16 a[32:47], a[132:135], v[136:139], a[32:47]
    ds_read_b64_tr_b16 a[148:149], v205 offset:28672
    ds_read_b64_tr_b16 a[150:151], v205 offset:29696
    ds_read_b64_tr_b16 a[152:153], v206 offset:28672
    v_fma_mix_f32 v189, v66, v173, v181 op_sel:[1,0,0] op_sel_hi:[1,0,0]
    v_cvt_pk_bf16_f32 v146, v188, v189
    v_fma_mix_f32 v190, v67, v174, v182 op_sel_hi:[1,0,0]
    v_mfma_f32_32x32x16_bf16 a[48:63], a[132:135], v[140:143], a[48:63]
    ds_read_b64_tr_b16 a[154:155], v206 offset:29696
    ds_read_b64_tr_b16 a[156:157], v207 offset:28672
    ds_read_b64_tr_b16 a[158:159], v207 offset:29696
    v_fma_mix_f32 v191, v67, v175, v183 op_sel:[1,0,0] op_sel_hi:[1,0,0]
    v_cvt_pk_bf16_f32 v147, v190, v191
    s_add_u32 m0, s33, 16384
    s_mov_b32 s39, 16384
    v_mfma_f32_32x32x16_bf16 a[64:79], a[136:139], v[136:139], a[64:79]
    buffer_load_dwordx4 v228, s[8:11], s39 offen offset:0 lds
    v_fma_mix_f32 v192, v68, v168, v176 op_sel_hi:[1,0,0]
    v_fma_mix_f32 v193, v68, v169, v177 op_sel:[1,0,0] op_sel_hi:[1,0,0]
    v_cvt_pk_bf16_f32 v148, v192, v193
    v_fma_mix_f32 v194, v69, v170, v178 op_sel_hi:[1,0,0]
    v_mfma_f32_32x32x16_bf16 a[80:95], a[136:139], v[140:143], a[80:95]
    buffer_load_dwordx4 v229, s[8:11], s39 offen offset:1024 lds
    v_fma_mix_f32 v195, v69, v171, v179 op_sel:[1,0,0] op_sel_hi:[1,0,0]
    v_cvt_pk_bf16_f32 v149, v194, v195
    v_fma_mix_f32 v196, v70, v172, v180 op_sel_hi:[1,0,0]
    v_fma_mix_f32 v197, v70, v173, v181 op_sel:[1,0,0] op_sel_hi:[1,0,0]
    v_mfma_f32_32x32x16_bf16 a[96:111], a[140:143], v[136:139], a[96:111]
    buffer_load_dwordx4 v230, s[8:11], s39 offen offset:2048 lds
    v_cvt_pk_bf16_f32 v150, v196, v197
    v_fma_mix_f32 v198, v71, v174, v182 op_sel_hi:[1,0,0]
    v_fma_mix_f32 v199, v71, v175, v183 op_sel:[1,0,0] op_sel_hi:[1,0,0]
    v_cvt_pk_bf16_f32 v151, v198, v199
    v_mfma_f32_32x32x16_bf16 a[112:127], a[140:143], v[140:143], a[112:127]
    s_waitcnt lgkmcnt(0)
    buffer_load_dwordx4 v231, s[8:11], s39 offen offset:3072 lds
    v_mfma_f32_32x32x16_bf16 a[0:15], a[144:147], v[144:147], a[0:15]
    s_waitcnt vmcnt(26)
    s_barrier
    v_fma_mix_f32 v184, v72, v152, v160 op_sel_hi:[1,0,0]
    v_mfma_f32_32x32x16_bf16 a[16:31], a[144:147], v[148:151], a[16:31]
    ds_read_b128 v[168:171], v234 offset:3200
    ds_read_b128 v[172:175], v234 offset:3216
    ds_read_b128 v[176:179], v234 offset:3232
    v_fma_mix_f32 v185, v72, v153, v161 op_sel:[1,0,0] op_sel_hi:[1,0,0]
    v_cvt_pk_bf16_f32 v136, v184, v185
    v_mfma_f32_32x32x16_bf16 a[32:47], a[148:151], v[144:147], a[32:47]
    ds_read_b128 v[180:183], v234 offset:3248
    ds_read_b64_tr_b16 a[128:129], v204 offset:32768
    ds_read_b64_tr_b16 a[130:131], v204 offset:33792
    v_fma_mix_f32 v186, v73, v154, v162 op_sel_hi:[1,0,0]
    v_fma_mix_f32 v187, v73, v155, v163 op_sel:[1,0,0] op_sel_hi:[1,0,0]
    v_cvt_pk_bf16_f32 v137, v186, v187
    v_fma_mix_f32 v188, v74, v156, v164 op_sel_hi:[1,0,0]
    v_fma_mix_f32 v189, v74, v157, v165 op_sel:[1,0,0] op_sel_hi:[1,0,0]
    v_mfma_f32_32x32x16_bf16 a[48:63], a[148:151], v[148:151], a[48:63]
    ds_read_b64_tr_b16 a[132:133], v205 offset:32768
    ds_read_b64_tr_b16 a[134:135], v205 offset:33792
    ds_read_b64_tr_b16 a[136:137], v206 offset:32768
    v_cvt_pk_bf16_f32 v138, v188, v189
    v_fma_mix_f32 v190, v75, v158, v166 op_sel_hi:[1,0,0]
    s_add_u32 m0, s33, 65536
    s_mov_b32 s39, 0
    v_mfma_f32_32x32x16_bf16 a[64:79], a[152:155], v[144:147], a[64:79]
    buffer_load_dwordx4 v232, s[12:15], s39 offen offset:0 lds
    ds_read_b64_tr_b16 a[138:139], v206 offset:33792
    ds_read_b64_tr_b16 a[140:141], v207 offset:32768
    ds_read_b64_tr_b16 a[142:143], v207 offset:33792
    v_fma_mix_f32 v191, v75, v159, v167 op_sel:[1,0,0] op_sel_hi:[1,0,0]
    v_cvt_pk_bf16_f32 v139, v190, v191
    v_mfma_f32_32x32x16_bf16 a[80:95], a[152:155], v[148:151], a[80:95]
    buffer_load_dwordx4 v232, s[12:15], s39 offen offset:1024 lds
    v_fma_mix_f32 v192, v76, v152, v160 op_sel_hi:[1,0,0]
    v_fma_mix_f32 v193, v76, v153, v161 op_sel:[1,0,0] op_sel_hi:[1,0,0]
    v_cvt_pk_bf16_f32 v140, v192, v193
    v_fma_mix_f32 v194, v77, v154, v162 op_sel_hi:[1,0,0]
    v_fma_mix_f32 v195, v77, v155, v163 op_sel:[1,0,0] op_sel_hi:[1,0,0]
    v_cvt_pk_bf16_f32 v141, v194, v195
    v_mfma_f32_32x32x16_bf16 a[96:111], a[156:159], v[144:147], a[96:111]
    buffer_load_dwordx4 v232, s[12:15], s39 offen offset:2048 lds
    v_fma_mix_f32 v196, v78, v156, v164 op_sel_hi:[1,0,0]
    v_fma_mix_f32 v197, v78, v157, v165 op_sel:[1,0,0] op_sel_hi:[1,0,0]
    v_cvt_pk_bf16_f32 v142, v196, v197
    v_fma_mix_f32 v198, v79, v158, v166 op_sel_hi:[1,0,0]
    v_fma_mix_f32 v199, v79, v159, v167 op_sel:[1,0,0] op_sel_hi:[1,0,0]
    v_cvt_pk_bf16_f32 v143, v198, v199
    v_mfma_f32_32x32x16_bf16 a[112:127], a[156:159], v[148:151], a[112:127]
    s_waitcnt lgkmcnt(0)
    buffer_load_dwordx4 v232, s[12:15], s39 offen offset:3072 lds
    v_mfma_f32_32x32x16_bf16 a[0:15], a[128:131], v[136:139], a[0:15]
    s_waitcnt vmcnt(28)
    ds_read_b128 v[152:155], v234 offset:3328
    ds_read_b128 v[156:159], v234 offset:3344
    ds_read_b128 v[160:163], v234 offset:3360
    v_fma_mix_f32 v184, v80, v168, v176 op_sel_hi:[1,0,0]
    v_fma_mix_f32 v185, v80, v169, v177 op_sel:[1,0,0] op_sel_hi:[1,0,0]
    v_cvt_pk_bf16_f32 v144, v184, v185
    v_mfma_f32_32x32x16_bf16 a[16:31], a[128:131], v[140:143], a[16:31]
    ds_read_b128 v[164:167], v234 offset:3376
    ds_read_b64_tr_b16 a[144:145], v204 offset:36864
    ds_read_b64_tr_b16 a[146:147], v204 offset:37888
    v_fma_mix_f32 v186, v81, v170, v178 op_sel_hi:[1,0,0]
    v_fma_mix_f32 v187, v81, v171, v179 op_sel:[1,0,0] op_sel_hi:[1,0,0]
    v_mfma_f32_32x32x16_bf16 a[32:47], a[132:135], v[136:139], a[32:47]
    ds_read_b64_tr_b16 a[148:149], v205 offset:36864
    ds_read_b64_tr_b16 a[150:151], v205 offset:37888
    ds_read_b64_tr_b16 a[152:153], v206 offset:36864
    v_cvt_pk_bf16_f32 v145, v186, v187
    v_fma_mix_f32 v188, v82, v172, v180 op_sel_hi:[1,0,0]
    v_fma_mix_f32 v189, v82, v173, v181 op_sel:[1,0,0] op_sel_hi:[1,0,0]
    v_mfma_f32_32x32x16_bf16 a[48:63], a[132:135], v[140:143], a[48:63]
    ds_read_b64_tr_b16 a[154:155], v206 offset:37888
    ds_read_b64_tr_b16 a[156:157], v207 offset:36864
    ds_read_b64_tr_b16 a[158:159], v207 offset:37888
    v_cvt_pk_bf16_f32 v146, v188, v189
    v_fma_mix_f32 v190, v83, v174, v182 op_sel_hi:[1,0,0]
    v_mfma_f32_32x32x16_bf16 a[64:79], a[136:139], v[136:139], a[64:79]
    v_fma_mix_f32 v191, v83, v175, v183 op_sel:[1,0,0] op_sel_hi:[1,0,0]
    v_cvt_pk_bf16_f32 v147, v190, v191
    v_fma_mix_f32 v192, v84, v168, v176 op_sel_hi:[1,0,0]
    v_fma_mix_f32 v193, v84, v169, v177 op_sel:[1,0,0] op_sel_hi:[1,0,0]
    v_cvt_pk_bf16_f32 v148, v192, v193
    v_mfma_f32_32x32x16_bf16 a[80:95], a[136:139], v[140:143], a[80:95]
    v_fma_mix_f32 v194, v85, v170, v178 op_sel_hi:[1,0,0]
    v_fma_mix_f32 v195, v85, v171, v179 op_sel:[1,0,0] op_sel_hi:[1,0,0]
    v_cvt_pk_bf16_f32 v149, v194, v195
    v_fma_mix_f32 v196, v86, v172, v180 op_sel_hi:[1,0,0]
    v_mfma_f32_32x32x16_bf16 a[96:111], a[140:143], v[136:139], a[96:111]
    v_fma_mix_f32 v197, v86, v173, v181 op_sel:[1,0,0] op_sel_hi:[1,0,0]
    v_cvt_pk_bf16_f32 v150, v196, v197
    v_fma_mix_f32 v198, v87, v174, v182 op_sel_hi:[1,0,0]
    v_fma_mix_f32 v199, v87, v175, v183 op_sel:[1,0,0] op_sel_hi:[1,0,0]
    v_cvt_pk_bf16_f32 v151, v198, v199
    v_mfma_f32_32x32x16_bf16 a[112:127], a[140:143], v[140:143], a[112:127]
    s_waitcnt lgkmcnt(0)
    v_mfma_f32_32x32x16_bf16 a[0:15], a[144:147], v[144:147], a[0:15]
    s_waitcnt vmcnt(26)
    ds_read_b128 v[168:171], v234 offset:3456
    ds_read_b128 v[172:175], v234 offset:3472
    ds_read_b128 v[176:179], v234 offset:3488
    v_fma_mix_f32 v184, v88, v152, v160 op_sel_hi:[1,0,0]
    v_fma_mix_f32 v185, v88, v153, v161 op_sel:[1,0,0] op_sel_hi:[1,0,0]
    v_cvt_pk_bf16_f32 v136, v184, v185
    v_mfma_f32_32x32x16_bf16 a[16:31], a[144:147], v[148:151], a[16:31]
    ds_read_b128 v[180:183], v234 offset:3504
    ds_read_b64_tr_b16 a[128:129], v204 offset:40960
    ds_read_b64_tr_b16 a[130:131], v204 offset:41984
    v_fma_mix_f32 v186, v89, v154, v162 op_sel_hi:[1,0,0]
    v_fma_mix_f32 v187, v89, v155, v163 op_sel:[1,0,0] op_sel_hi:[1,0,0]
    v_mfma_f32_32x32x16_bf16 a[32:47], a[148:151], v[144:147], a[32:47]
    ds_read_b64_tr_b16 a[132:133], v205 offset:40960
    ds_read_b64_tr_b16 a[134:135], v205 offset:41984
    ds_read_b64_tr_b16 a[136:137], v206 offset:40960
    v_cvt_pk_bf16_f32 v137, v186, v187
    v_fma_mix_f32 v188, v90, v156, v164 op_sel_hi:[1,0,0]
    v_fma_mix_f32 v189, v90, v157, v165 op_sel:[1,0,0] op_sel_hi:[1,0,0]
    v_mfma_f32_32x32x16_bf16 a[48:63], a[148:151], v[148:151], a[48:63]
    ds_read_b64_tr_b16 a[138:139], v206 offset:41984
    ds_read_b64_tr_b16 a[140:141], v207 offset:40960
    ds_read_b64_tr_b16 a[142:143], v207 offset:41984
    v_cvt_pk_bf16_f32 v138, v188, v189
    v_fma_mix_f32 v190, v91, v158, v166 op_sel_hi:[1,0,0]
    v_mfma_f32_32x32x16_bf16 a[64:79], a[152:155], v[144:147], a[64:79]
    v_fma_mix_f32 v191, v91, v159, v167 op_sel:[1,0,0] op_sel_hi:[1,0,0]
    v_cvt_pk_bf16_f32 v139, v190, v191
    v_fma_mix_f32 v192, v92, v152, v160 op_sel_hi:[1,0,0]
    v_fma_mix_f32 v193, v92, v153, v161 op_sel:[1,0,0] op_sel_hi:[1,0,0]
    v_cvt_pk_bf16_f32 v140, v192, v193
    v_mfma_f32_32x32x16_bf16 a[80:95], a[152:155], v[148:151], a[80:95]
    v_fma_mix_f32 v194, v93, v154, v162 op_sel_hi:[1,0,0]
    v_fma_mix_f32 v195, v93, v155, v163 op_sel:[1,0,0] op_sel_hi:[1,0,0]
    v_cvt_pk_bf16_f32 v141, v194, v195
    v_fma_mix_f32 v196, v94, v156, v164 op_sel_hi:[1,0,0]
    v_mfma_f32_32x32x16_bf16 a[96:111], a[156:159], v[144:147], a[96:111]
    v_fma_mix_f32 v197, v94, v157, v165 op_sel:[1,0,0] op_sel_hi:[1,0,0]
    v_cvt_pk_bf16_f32 v142, v196, v197
    v_fma_mix_f32 v198, v95, v158, v166 op_sel_hi:[1,0,0]
    v_fma_mix_f32 v199, v95, v159, v167 op_sel:[1,0,0] op_sel_hi:[1,0,0]
    v_cvt_pk_bf16_f32 v143, v198, v199
    v_mfma_f32_32x32x16_bf16 a[112:127], a[156:159], v[148:151], a[112:127]
    s_waitcnt lgkmcnt(0)
    v_mfma_f32_32x32x16_bf16 a[0:15], a[128:131], v[136:139], a[0:15]
    s_waitcnt vmcnt(24)
    ds_read_b128 v[152:155], v234 offset:3584
    ds_read_b128 v[156:159], v234 offset:3600
    ds_read_b128 v[160:163], v234 offset:3616
    v_fma_mix_f32 v184, v96, v168, v176 op_sel_hi:[1,0,0]
    v_fma_mix_f32 v185, v96, v169, v177 op_sel:[1,0,0] op_sel_hi:[1,0,0]
    v_cvt_pk_bf16_f32 v144, v184, v185
    v_mfma_f32_32x32x16_bf16 a[16:31], a[128:131], v[140:143], a[16:31]
    ds_read_b128 v[164:167], v234 offset:3632
    ds_read_b64_tr_b16 a[144:145], v204 offset:45056
    ds_read_b64_tr_b16 a[146:147], v204 offset:46080
    v_fma_mix_f32 v186, v97, v170, v178 op_sel_hi:[1,0,0]
    v_fma_mix_f32 v187, v97, v171, v179 op_sel:[1,0,0] op_sel_hi:[1,0,0]
    v_mfma_f32_32x32x16_bf16 a[32:47], a[132:135], v[136:139], a[32:47]
    ds_read_b64_tr_b16 a[148:149], v205 offset:45056
    ds_read_b64_tr_b16 a[150:151], v205 offset:46080
    ds_read_b64_tr_b16 a[152:153], v206 offset:45056
    v_cvt_pk_bf16_f32 v145, v186, v187
    v_fma_mix_f32 v188, v98, v172, v180 op_sel_hi:[1,0,0]
    v_fma_mix_f32 v189, v98, v173, v181 op_sel:[1,0,0] op_sel_hi:[1,0,0]
    v_mfma_f32_32x32x16_bf16 a[48:63], a[132:135], v[140:143], a[48:63]
    ds_read_b64_tr_b16 a[154:155], v206 offset:46080
    ds_read_b64_tr_b16 a[156:157], v207 offset:45056
    ds_read_b64_tr_b16 a[158:159], v207 offset:46080
    v_cvt_pk_bf16_f32 v146, v188, v189
    v_fma_mix_f32 v190, v99, v174, v182 op_sel_hi:[1,0,0]
    v_mfma_f32_32x32x16_bf16 a[64:79], a[136:139], v[136:139], a[64:79]
    v_fma_mix_f32 v191, v99, v175, v183 op_sel:[1,0,0] op_sel_hi:[1,0,0]
    v_cvt_pk_bf16_f32 v147, v190, v191
    v_fma_mix_f32 v192, v100, v168, v176 op_sel_hi:[1,0,0]
    v_fma_mix_f32 v193, v100, v169, v177 op_sel:[1,0,0] op_sel_hi:[1,0,0]
    v_cvt_pk_bf16_f32 v148, v192, v193
    v_mfma_f32_32x32x16_bf16 a[80:95], a[136:139], v[140:143], a[80:95]
    v_fma_mix_f32 v194, v101, v170, v178 op_sel_hi:[1,0,0]
    v_fma_mix_f32 v195, v101, v171, v179 op_sel:[1,0,0] op_sel_hi:[1,0,0]
    v_cvt_pk_bf16_f32 v149, v194, v195
    v_fma_mix_f32 v196, v102, v172, v180 op_sel_hi:[1,0,0]
    v_mfma_f32_32x32x16_bf16 a[96:111], a[140:143], v[136:139], a[96:111]
    v_fma_mix_f32 v197, v102, v173, v181 op_sel:[1,0,0] op_sel_hi:[1,0,0]
    v_cvt_pk_bf16_f32 v150, v196, v197
    v_fma_mix_f32 v198, v103, v174, v182 op_sel_hi:[1,0,0]
    v_fma_mix_f32 v199, v103, v175, v183 op_sel:[1,0,0] op_sel_hi:[1,0,0]
    v_cvt_pk_bf16_f32 v151, v198, v199
    v_mfma_f32_32x32x16_bf16 a[112:127], a[140:143], v[140:143], a[112:127]
    s_waitcnt lgkmcnt(0)
    v_mfma_f32_32x32x16_bf16 a[0:15], a[144:147], v[144:147], a[0:15]
    s_waitcnt vmcnt(18)
    s_barrier
    v_fma_mix_f32 v184, v104, v152, v160 op_sel_hi:[1,0,0]
    v_mfma_f32_32x32x16_bf16 a[16:31], a[144:147], v[148:151], a[16:31]
    ds_read_b128 v[168:171], v234 offset:3712
    ds_read_b128 v[172:175], v234 offset:3728
    ds_read_b128 v[176:179], v234 offset:3744
    v_fma_mix_f32 v185, v104, v153, v161 op_sel:[1,0,0] op_sel_hi:[1,0,0]
    v_mfma_f32_32x32x16_bf16 a[32:47], a[148:151], v[144:147], a[32:47]
    ds_read_b128 v[180:183], v234 offset:3760
    ds_read_b64_tr_b16 a[128:129], v204 offset:49152
    ds_read_b64_tr_b16 a[130:131], v204 offset:50176
    v_cvt_pk_bf16_f32 v136, v184, v185
    v_fma_mix_f32 v186, v105, v154, v162 op_sel_hi:[1,0,0]
    v_fma_mix_f32 v187, v105, v155, v163 op_sel:[1,0,0] op_sel_hi:[1,0,0]
    v_mfma_f32_32x32x16_bf16 a[48:63], a[148:151], v[148:151], a[48:63]
    ds_read_b64_tr_b16 a[132:133], v205 offset:49152
    ds_read_b64_tr_b16 a[134:135], v205 offset:50176
    ds_read_b64_tr_b16 a[136:137], v206 offset:49152
    v_cvt_pk_bf16_f32 v137, v186, v187
    v_fma_mix_f32 v188, v106, v156, v164 op_sel_hi:[1,0,0]
    v_fma_mix_f32 v189, v106, v157, v165 op_sel:[1,0,0] op_sel_hi:[1,0,0]
    v_cvt_pk_bf16_f32 v138, v188, v189
    v_mfma_f32_32x32x16_bf16 a[64:79], a[152:155], v[144:147], a[64:79]
    ds_read_b64_tr_b16 a[138:139], v206 offset:50176
    ds_read_b64_tr_b16 a[140:141], v207 offset:49152
    ds_read_b64_tr_b16 a[142:143], v207 offset:50176
    v_fma_mix_f32 v190, v107, v158, v166 op_sel_hi:[1,0,0]
    v_fma_mix_f32 v191, v107, v159, v167 op_sel:[1,0,0] op_sel_hi:[1,0,0]
    v_cvt_pk_bf16_f32 v139, v190, v191
    v_mfma_f32_32x32x16_bf16 a[80:95], a[152:155], v[148:151], a[80:95]
    v_fma_mix_f32 v192, v108, v152, v160 op_sel_hi:[1,0,0]
    v_fma_mix_f32 v193, v108, v153, v161 op_sel:[1,0,0] op_sel_hi:[1,0,0]
    v_cvt_pk_bf16_f32 v140, v192, v193
    v_fma_mix_f32 v194, v109, v154, v162 op_sel_hi:[1,0,0]
    v_fma_mix_f32 v195, v109, v155, v163 op_sel:[1,0,0] op_sel_hi:[1,0,0]
    v_cvt_pk_bf16_f32 v141, v194, v195
    v_mfma_f32_32x32x16_bf16 a[96:111], a[156:159], v[144:147], a[96:111]
    v_fma_mix_f32 v196, v110, v156, v164 op_sel_hi:[1,0,0]
    v_fma_mix_f32 v197, v110, v157, v165 op_sel:[1,0,0] op_sel_hi:[1,0,0]
    v_cvt_pk_bf16_f32 v142, v196, v197
    v_fma_mix_f32 v198, v111, v158, v166 op_sel_hi:[1,0,0]
    v_fma_mix_f32 v199, v111, v159, v167 op_sel:[1,0,0] op_sel_hi:[1,0,0]
    v_cvt_pk_bf16_f32 v143, v198, v199
    v_mfma_f32_32x32x16_bf16 a[112:127], a[156:159], v[148:151], a[112:127]
    s_waitcnt lgkmcnt(0)
    v_mfma_f32_32x32x16_bf16 a[0:15], a[128:131], v[136:139], a[0:15]
    s_waitcnt vmcnt(16)
    ds_read_b128 v[152:155], v234 offset:3840
    ds_read_b128 v[156:159], v234 offset:3856
    ds_read_b128 v[160:163], v234 offset:3872
    v_fma_mix_f32 v184, v112, v168, v176 op_sel_hi:[1,0,0]
    v_fma_mix_f32 v185, v112, v169, v177 op_sel:[1,0,0] op_sel_hi:[1,0,0]
    v_cvt_pk_bf16_f32 v144, v184, v185
    v_mfma_f32_32x32x16_bf16 a[16:31], a[128:131], v[140:143], a[16:31]
    ds_read_b128 v[164:167], v234 offset:3888
    ds_read_b64_tr_b16 a[144:145], v204 offset:53248
    ds_read_b64_tr_b16 a[146:147], v204 offset:54272
    v_fma_mix_f32 v186, v113, v170, v178 op_sel_hi:[1,0,0]
    v_fma_mix_f32 v187, v113, v171, v179 op_sel:[1,0,0] op_sel_hi:[1,0,0]
    v_mfma_f32_32x32x16_bf16 a[32:47], a[132:135], v[136:139], a[32:47]
    ds_read_b64_tr_b16 a[148:149], v205 offset:53248
    ds_read_b64_tr_b16 a[150:151], v205 offset:54272
    ds_read_b64_tr_b16 a[152:153], v206 offset:53248
    v_cvt_pk_bf16_f32 v145, v186, v187
    v_fma_mix_f32 v188, v114, v172, v180 op_sel_hi:[1,0,0]
    v_fma_mix_f32 v189, v114, v173, v181 op_sel:[1,0,0] op_sel_hi:[1,0,0]
    v_mfma_f32_32x32x16_bf16 a[48:63], a[132:135], v[140:143], a[48:63]
    ds_read_b64_tr_b16 a[154:155], v206 offset:54272
    ds_read_b64_tr_b16 a[156:157], v207 offset:53248
    ds_read_b64_tr_b16 a[158:159], v207 offset:54272
    v_cvt_pk_bf16_f32 v146, v188, v189
    v_fma_mix_f32 v190, v115, v174, v182 op_sel_hi:[1,0,0]
    v_mfma_f32_32x32x16_bf16 a[64:79], a[136:139], v[136:139], a[64:79]
    v_fma_mix_f32 v191, v115, v175, v183 op_sel:[1,0,0] op_sel_hi:[1,0,0]
    v_cvt_pk_bf16_f32 v147, v190, v191
    v_fma_mix_f32 v192, v116, v168, v176 op_sel_hi:[1,0,0]
    v_fma_mix_f32 v193, v116, v169, v177 op_sel:[1,0,0] op_sel_hi:[1,0,0]
    v_cvt_pk_bf16_f32 v148, v192, v193
    v_mfma_f32_32x32x16_bf16 a[80:95], a[136:139], v[140:143], a[80:95]
    v_fma_mix_f32 v194, v117, v170, v178 op_sel_hi:[1,0,0]
    v_fma_mix_f32 v195, v117, v171, v179 op_sel:[1,0,0] op_sel_hi:[1,0,0]
    v_cvt_pk_bf16_f32 v149, v194, v195
    v_fma_mix_f32 v196, v118, v172, v180 op_sel_hi:[1,0,0]
    v_mfma_f32_32x32x16_bf16 a[96:111], a[140:143], v[136:139], a[96:111]
    v_fma_mix_f32 v197, v118, v173, v181 op_sel:[1,0,0] op_sel_hi:[1,0,0]
    v_cvt_pk_bf16_f32 v150, v196, v197
    v_fma_mix_f32 v198, v119, v174, v182 op_sel_hi:[1,0,0]
    v_fma_mix_f32 v199, v119, v175, v183 op_sel:[1,0,0] op_sel_hi:[1,0,0]
    v_cvt_pk_bf16_f32 v151, v198, v199
    v_mfma_f32_32x32x16_bf16 a[112:127], a[140:143], v[140:143], a[112:127]
    s_waitcnt lgkmcnt(0)
    v_mfma_f32_32x32x16_bf16 a[0:15], a[144:147], v[144:147], a[0:15]
    s_waitcnt vmcnt(14)
    ds_read_b128 v[168:171], v234 offset:3968
    ds_read_b128 v[172:175], v234 offset:3984
    ds_read_b128 v[176:179], v234 offset:4000
    v_fma_mix_f32 v184, v120, v152, v160 op_sel_hi:[1,0,0]
    v_fma_mix_f32 v185, v120, v153, v161 op_sel:[1,0,0] op_sel_hi:[1,0,0]
    v_cvt_pk_bf16_f32 v136, v184, v185
    v_mfma_f32_32x32x16_bf16 a[16:31], a[144:147], v[148:151], a[16:31]
    ds_read_b128 v[180:183], v234 offset:4016
    ds_read_b64_tr_b16 a[128:129], v204 offset:57344
    ds_read_b64_tr_b16 a[130:131], v204 offset:58368
    v_fma_mix_f32 v186, v121, v154, v162 op_sel_hi:[1,0,0]
    v_fma_mix_f32 v187, v121, v155, v163 op_sel:[1,0,0] op_sel_hi:[1,0,0]
    v_mfma_f32_32x32x16_bf16 a[32:47], a[148:151], v[144:147], a[32:47]
    ds_read_b64_tr_b16 a[132:133], v205 offset:57344
    ds_read_b64_tr_b16 a[134:135], v205 offset:58368
    ds_read_b64_tr_b16 a[136:137], v206 offset:57344
    v_cvt_pk_bf16_f32 v137, v186, v187
    v_fma_mix_f32 v188, v122, v156, v164 op_sel_hi:[1,0,0]
    v_fma_mix_f32 v189, v122, v157, v165 op_sel:[1,0,0] op_sel_hi:[1,0,0]
    v_mfma_f32_32x32x16_bf16 a[48:63], a[148:151], v[148:151], a[48:63]
    ds_read_b64_tr_b16 a[138:139], v206 offset:58368
    ds_read_b64_tr_b16 a[140:141], v207 offset:57344
    ds_read_b64_tr_b16 a[142:143], v207 offset:58368
    v_cvt_pk_bf16_f32 v138, v188, v189
    v_fma_mix_f32 v190, v123, v158, v166 op_sel_hi:[1,0,0]
    v_mfma_f32_32x32x16_bf16 a[64:79], a[152:155], v[144:147], a[64:79]
    v_fma_mix_f32 v191, v123, v159, v167 op_sel:[1,0,0] op_sel_hi:[1,0,0]
    v_cvt_pk_bf16_f32 v139, v190, v191
    v_fma_mix_f32 v192, v124, v152, v160 op_sel_hi:[1,0,0]
    v_fma_mix_f32 v193, v124, v153, v161 op_sel:[1,0,0] op_sel_hi:[1,0,0]
    v_cvt_pk_bf16_f32 v140, v192, v193
    v_mfma_f32_32x32x16_bf16 a[80:95], a[152:155], v[148:151], a[80:95]
    v_fma_mix_f32 v194, v125, v154, v162 op_sel_hi:[1,0,0]
    v_fma_mix_f32 v195, v125, v155, v163 op_sel:[1,0,0] op_sel_hi:[1,0,0]
    v_cvt_pk_bf16_f32 v141, v194, v195
    v_fma_mix_f32 v196, v126, v156, v164 op_sel_hi:[1,0,0]
    v_mfma_f32_32x32x16_bf16 a[96:111], a[156:159], v[144:147], a[96:111]
    v_fma_mix_f32 v197, v126, v157, v165 op_sel:[1,0,0] op_sel_hi:[1,0,0]
    v_cvt_pk_bf16_f32 v142, v196, v197
    v_fma_mix_f32 v198, v127, v158, v166 op_sel_hi:[1,0,0]
    v_fma_mix_f32 v199, v127, v159, v167 op_sel:[1,0,0] op_sel_hi:[1,0,0]
    v_cvt_pk_bf16_f32 v143, v198, v199
    v_mfma_f32_32x32x16_bf16 a[112:127], a[156:159], v[148:151], a[112:127]
    s_waitcnt lgkmcnt(0)
    v_mfma_f32_32x32x16_bf16 a[0:15], a[128:131], v[136:139], a[0:15]
    s_waitcnt vmcnt(12)
    ds_read_b64_tr_b16 a[144:145], v204 offset:61440
    ds_read_b64_tr_b16 a[146:147], v204 offset:62464
    ds_read_b64_tr_b16 a[148:149], v205 offset:61440
    v_fma_mix_f32 v184, v128, v168, v176 op_sel_hi:[1,0,0]
    v_fma_mix_f32 v185, v128, v169, v177 op_sel:[1,0,0] op_sel_hi:[1,0,0]
    v_mfma_f32_32x32x16_bf16 a[16:31], a[128:131], v[140:143], a[16:31]
    ds_read_b64_tr_b16 a[150:151], v205 offset:62464
    ds_read_b64_tr_b16 a[152:153], v206 offset:61440
    ds_read_b64_tr_b16 a[154:155], v206 offset:62464
    v_cvt_pk_bf16_f32 v144, v184, v185
    v_fma_mix_f32 v186, v129, v170, v178 op_sel_hi:[1,0,0]
    v_fma_mix_f32 v187, v129, v171, v179 op_sel:[1,0,0] op_sel_hi:[1,0,0]
    v_mfma_f32_32x32x16_bf16 a[32:47], a[132:135], v[136:139], a[32:47]
    ds_read_b64_tr_b16 a[156:157], v207 offset:61440
    ds_read_b64_tr_b16 a[158:159], v207 offset:62464
    v_cvt_pk_bf16_f32 v145, v186, v187
    v_fma_mix_f32 v188, v130, v172, v180 op_sel_hi:[1,0,0]
    v_fma_mix_f32 v189, v130, v173, v181 op_sel:[1,0,0] op_sel_hi:[1,0,0]
    v_mfma_f32_32x32x16_bf16 a[48:63], a[132:135], v[140:143], a[48:63]
    v_cvt_pk_bf16_f32 v146, v188, v189
    v_fma_mix_f32 v190, v131, v174, v182 op_sel_hi:[1,0,0]
    v_fma_mix_f32 v191, v131, v175, v183 op_sel:[1,0,0] op_sel_hi:[1,0,0]
    v_cvt_pk_bf16_f32 v147, v190, v191
    v_mfma_f32_32x32x16_bf16 a[64:79], a[136:139], v[136:139], a[64:79]
    v_fma_mix_f32 v192, v132, v168, v176 op_sel_hi:[1,0,0]
    v_fma_mix_f32 v193, v132, v169, v177 op_sel:[1,0,0] op_sel_hi:[1,0,0]
    v_cvt_pk_bf16_f32 v148, v192, v193
    v_fma_mix_f32 v194, v133, v170, v178 op_sel_hi:[1,0,0]
    v_mfma_f32_32x32x16_bf16 a[80:95], a[136:139], v[140:143], a[80:95]
    v_fma_mix_f32 v195, v133, v171, v179 op_sel:[1,0,0] op_sel_hi:[1,0,0]
    v_cvt_pk_bf16_f32 v149, v194, v195
    v_fma_mix_f32 v196, v134, v172, v180 op_sel_hi:[1,0,0]
    v_fma_mix_f32 v197, v134, v173, v181 op_sel:[1,0,0] op_sel_hi:[1,0,0]
    v_mfma_f32_32x32x16_bf16 a[96:111], a[140:143], v[136:139], a[96:111]
    v_cvt_pk_bf16_f32 v150, v196, v197
    v_fma_mix_f32 v198, v135, v174, v182 op_sel_hi:[1,0,0]
    v_fma_mix_f32 v199, v135, v175, v183 op_sel:[1,0,0] op_sel_hi:[1,0,0]
    v_cvt_pk_bf16_f32 v151, v198, v199
    v_mfma_f32_32x32x16_bf16 a[112:127], a[140:143], v[140:143], a[112:127]
    s_waitcnt lgkmcnt(0)
    v_mfma_f32_32x32x16_bf16 a[0:15], a[144:147], v[144:147], a[0:15]
    v_mfma_f32_32x32x16_bf16 a[16:31], a[144:147], v[148:151], a[16:31]
    v_mfma_f32_32x32x16_bf16 a[32:47], a[148:151], v[144:147], a[32:47]
    v_mfma_f32_32x32x16_bf16 a[48:63], a[148:151], v[148:151], a[48:63]
    v_mfma_f32_32x32x16_bf16 a[64:79], a[152:155], v[144:147], a[64:79]
    v_mfma_f32_32x32x16_bf16 a[80:95], a[152:155], v[148:151], a[80:95]
    v_mfma_f32_32x32x16_bf16 a[96:111], a[156:159], v[144:147], a[96:111]
    v_mfma_f32_32x32x16_bf16 a[112:127], a[156:159], v[148:151], a[112:127]
    s_mov_b32 s3, 0x3e0293ee
    s_waitcnt vmcnt(8)
    s_barrier
    ds_read_b128 a[128:131], v216 offset:0
    ds_read_b128 a[132:135], v217 offset:0
    ds_read_b128 a[136:139], v218 offset:0
    ds_read_b128 a[140:143], v219 offset:0
    ds_read_b128 a[144:147], v220 offset:0
    ds_read_b128 a[148:151], v221 offset:0
    ds_read_b128 a[152:155], v222 offset:0
    ds_read_b128 a[156:159], v223 offset:0
    s_add_u32 m0, s33, 32768
    s_mov_b32 s39, 32768
    buffer_load_dwordx4 v228, s[8:11], s39 offen offset:0 lds
    buffer_load_dwordx4 v229, s[8:11], s39 offen offset:1024 lds
    buffer_load_dwordx4 v230, s[8:11], s39 offen offset:2048 lds
    buffer_load_dwordx4 v231, s[8:11], s39 offen offset:3072 lds
    v_accvgpr_read_b32 v72, a0
    v_accvgpr_read_b32 v73, a1
    v_accvgpr_read_b32 v74, a2
    v_accvgpr_read_b32 v75, a3
    v_accvgpr_read_b32 v76, a4
    v_accvgpr_read_b32 v77, a5
    v_accvgpr_read_b32 v78, a6
    v_accvgpr_read_b32 v79, a7
    v_accvgpr_read_b32 v80, a8
    v_accvgpr_read_b32 v81, a9
    v_accvgpr_read_b32 v82, a10
    v_accvgpr_read_b32 v83, a11
    v_accvgpr_read_b32 v84, a12
    v_accvgpr_read_b32 v85, a13
    v_accvgpr_read_b32 v86, a14
    v_accvgpr_read_b32 v87, a15
    v_mul_f32 v72, s3, v72
    v_mul_f32 v73, s3, v73
    v_mul_f32 v74, s3, v74
    v_mul_f32 v75, s3, v75
    v_mul_f32 v76, s3, v76
    v_mul_f32 v77, s3, v77
    v_mul_f32 v78, s3, v78
    v_mul_f32 v79, s3, v79
    v_mul_f32 v80, s3, v80
    v_mul_f32 v81, s3, v81
    v_mul_f32 v82, s3, v82
    v_mul_f32 v83, s3, v83
    v_mul_f32 v84, s3, v84
    v_mul_f32 v85, s3, v85
    v_mul_f32 v86, s3, v86
    v_mul_f32 v87, s3, v87
    v_cvt_pk_bf16_f32 v136, v72, v73
    v_cvt_pk_bf16_f32 v137, v74, v75
    v_cvt_pk_bf16_f32 v138, v76, v77
    v_cvt_pk_bf16_f32 v139, v78, v79
    v_cvt_pk_bf16_f32 v140, v80, v81
    v_cvt_pk_bf16_f32 v141, v82, v83
    v_cvt_pk_bf16_f32 v142, v84, v85
    v_cvt_pk_bf16_f32 v143, v86, v87
    v_accvgpr_read_b32 v88, a16
    v_accvgpr_read_b32 v89, a17
    v_accvgpr_read_b32 v90, a18
    v_accvgpr_read_b32 v91, a19
    v_accvgpr_read_b32 v92, a20
    v_accvgpr_read_b32 v93, a21
    v_accvgpr_read_b32 v94, a22
    v_accvgpr_read_b32 v95, a23
    v_accvgpr_read_b32 v96, a24
    v_accvgpr_read_b32 v97, a25
    v_accvgpr_read_b32 v98, a26
    v_accvgpr_read_b32 v99, a27
    v_accvgpr_read_b32 v100, a28
    v_accvgpr_read_b32 v101, a29
    v_accvgpr_read_b32 v102, a30
    v_accvgpr_read_b32 v103, a31
    v_mul_f32 v88, s3, v88
    v_mul_f32 v89, s3, v89
    v_mul_f32 v90, s3, v90
    v_mul_f32 v91, s3, v91
    v_mul_f32 v92, s3, v92
    v_mul_f32 v93, s3, v93
    v_mul_f32 v94, s3, v94
    v_mul_f32 v95, s3, v95
    v_mul_f32 v96, s3, v96
    v_mul_f32 v97, s3, v97
    v_mul_f32 v98, s3, v98
    v_mul_f32 v99, s3, v99
    v_mul_f32 v100, s3, v100
    v_mul_f32 v101, s3, v101
    v_mul_f32 v102, s3, v102
    v_mul_f32 v103, s3, v103
    v_cvt_pk_bf16_f32 v168, v88, v89
    v_cvt_pk_bf16_f32 v169, v90, v91
    v_cvt_pk_bf16_f32 v170, v92, v93
    v_cvt_pk_bf16_f32 v171, v94, v95
    v_cvt_pk_bf16_f32 v172, v96, v97
    v_cvt_pk_bf16_f32 v173, v98, v99
    v_cvt_pk_bf16_f32 v174, v100, v101
    v_cvt_pk_bf16_f32 v175, v102, v103
    s_add_u32 m0, s33, 81920
    s_mov_b32 s39, 16384
    buffer_load_dwordx4 v232, s[12:15], s39 offen offset:0 lds
    buffer_load_dwordx4 v232, s[12:15], s39 offen offset:1024 lds
    buffer_load_dwordx4 v232, s[12:15], s39 offen offset:2048 lds
    buffer_load_dwordx4 v232, s[12:15], s39 offen offset:3072 lds
    s_mov_b32 s80, s48
    s_and_b32 s81, s49, 0xffff
    s_mov_b32 s82, 4194304
    s_mov_b32 s83, 0x00020000
    s_mov_b32 s84, s50
    s_and_b32 s85, s51, 0xffff
    s_mov_b32 s86, 1835008
    s_mov_b32 s87, 0x00020000
    s_mov_b32 s88, s52
    s_and_b32 s89, s53, 0xffff
    s_mov_b32 s90, 1835008
    s_mov_b32 s91, 0x00020000
    s_mov_b32 s92, s54
    s_and_b32 s93, s55, 0xffff
    s_mov_b32 s94, 1835008
    s_mov_b32 s95, 0x00020000
    s_lshl_b32 s42, s2, 12
    s_lshl_b32 s39, s32, 10
    s_add_u32 s42, s42, s39
    v_lshrrev_b32 v236, 2, v235
    v_lshlrev_b32 v236, 6, v236
    buffer_load_dword v240, v236, s[92:95], s42 offen
    s_waitcnt lgkmcnt(0)
    v_mfma_f32_32x32x16_bf16 v[8:23], a[128:131], v[136:139], 0
    v_accvgpr_read_b32 v104, a32
    v_accvgpr_read_b32 v105, a33
    v_accvgpr_read_b32 v106, a34
    v_accvgpr_read_b32 v107, a35
    v_accvgpr_read_b32 v108, a36
    v_accvgpr_read_b32 v109, a37
    v_accvgpr_read_b32 v110, a38
    v_accvgpr_read_b32 v111, a39
    v_accvgpr_read_b32 v112, a40
    v_accvgpr_read_b32 v113, a41
    v_accvgpr_read_b32 v114, a42
    v_accvgpr_read_b32 v115, a43
    v_accvgpr_read_b32 v116, a44
    v_accvgpr_read_b32 v117, a45
    v_accvgpr_read_b32 v118, a46
    v_accvgpr_read_b32 v119, a47
    v_mul_f32 v104, s3, v104
    v_mul_f32 v105, s3, v105
    v_mul_f32 v106, s3, v106
    v_mul_f32 v107, s3, v107
    v_mul_f32 v108, s3, v108
    v_mfma_f32_32x32x16_bf16 v[24:39], a[128:131], v[168:171], 0
    v_mul_f32 v109, s3, v109
    v_mul_f32 v110, s3, v110
    v_mul_f32 v111, s3, v111
    v_mul_f32 v112, s3, v112
    v_mul_f32 v113, s3, v113
    v_mul_f32 v114, s3, v114
    v_mul_f32 v115, s3, v115
    v_mul_f32 v116, s3, v116
    v_mul_f32 v117, s3, v117
    v_mul_f32 v118, s3, v118
    v_mul_f32 v119, s3, v119
    v_cvt_pk_bf16_f32 v144, v104, v105
    v_cvt_pk_bf16_f32 v145, v106, v107
    v_cvt_pk_bf16_f32 v146, v108, v109
    v_cvt_pk_bf16_f32 v147, v110, v111
    v_cvt_pk_bf16_f32 v148, v112, v113
    v_cvt_pk_bf16_f32 v149, v114, v115
    v_cvt_pk_bf16_f32 v150, v116, v117
    v_cvt_pk_bf16_f32 v151, v118, v119
    v_accvgpr_read_b32 v120, a48
    v_accvgpr_read_b32 v121, a49
    v_mfma_f32_32x32x16_bf16 v[8:23], a[132:135], v[140:143], v[8:23]
    ds_read_b128 a[128:131], v216 offset:8192
    v_accvgpr_read_b32 v122, a50
    v_accvgpr_read_b32 v123, a51
    v_accvgpr_read_b32 v124, a52
    v_accvgpr_read_b32 v125, a53
    v_accvgpr_read_b32 v126, a54
    v_accvgpr_read_b32 v127, a55
    v_accvgpr_read_b32 v128, a56
    v_accvgpr_read_b32 v129, a57
    v_accvgpr_read_b32 v130, a58
    v_accvgpr_read_b32 v131, a59
    v_accvgpr_read_b32 v132, a60
    v_accvgpr_read_b32 v133, a61
    v_accvgpr_read_b32 v134, a62
    v_accvgpr_read_b32 v135, a63
    v_mul_f32 v120, s3, v120
    v_mul_f32 v121, s3, v121
    v_mul_f32 v122, s3, v122
    v_mfma_f32_32x32x16_bf16 v[24:39], a[132:135], v[172:175], v[24:39]
    v_mul_f32 v123, s3, v123
    v_mul_f32 v124, s3, v124
    v_mul_f32 v125, s3, v125
    v_mul_f32 v126, s3, v126
    v_mul_f32 v127, s3, v127
    v_mul_f32 v128, s3, v128
    v_mul_f32 v129, s3, v129
    v_mul_f32 v130, s3, v130
    v_mul_f32 v131, s3, v131
    v_mul_f32 v132, s3, v132
    v_mul_f32 v133, s3, v133
    v_mul_f32 v134, s3, v134
    v_mul_f32 v135, s3, v135
    v_cvt_pk_bf16_f32 v176, v120, v121
    v_cvt_pk_bf16_f32 v177, v122, v123
    v_cvt_pk_bf16_f32 v178, v124, v125
    v_cvt_pk_bf16_f32 v179, v126, v127
    v_cvt_pk_bf16_f32 v180, v128, v129
    v_cvt_pk_bf16_f32 v181, v130, v131
    v_cvt_pk_bf16_f32 v182, v132, v133
    v_cvt_pk_bf16_f32 v183, v134, v135
    v_mfma_f32_32x32x16_bf16 v[8:23], a[136:139], v[144:147], v[8:23]
    ds_read_b128 a[132:135], v217 offset:8192
    v_accvgpr_read_b32 v72, a64
    v_accvgpr_read_b32 v73, a65
    v_accvgpr_read_b32 v74, a66
    v_accvgpr_read_b32 v75, a67
    v_accvgpr_read_b32 v76, a68
    v_accvgpr_read_b32 v77, a69
    v_accvgpr_read_b32 v78, a70
    v_accvgpr_read_b32 v79, a71
    v_accvgpr_read_b32 v80, a72
    v_accvgpr_read_b32 v81, a73
    v_accvgpr_read_b32 v82, a74
    v_accvgpr_read_b32 v83, a75
    v_accvgpr_read_b32 v84, a76
    v_accvgpr_read_b32 v85, a77
    v_accvgpr_read_b32 v86, a78
    v_accvgpr_read_b32 v87, a79
    v_mul_f32 v72, s3, v72
    v_mul_f32 v73, s3, v73
    v_mfma_f32_32x32x16_bf16 v[24:39], a[136:139], v[176:179], v[24:39]
    v_mul_f32 v74, s3, v74
    v_mul_f32 v75, s3, v75
    v_mul_f32 v76, s3, v76
    v_mul_f32 v77, s3, v77
    v_mul_f32 v78, s3, v78
    v_mul_f32 v79, s3, v79
    v_mul_f32 v80, s3, v80
    v_mul_f32 v81, s3, v81
    v_mul_f32 v82, s3, v82
    v_mul_f32 v83, s3, v83
    v_mul_f32 v84, s3, v84
    v_mul_f32 v85, s3, v85
    v_mul_f32 v86, s3, v86
    v_mul_f32 v87, s3, v87
    v_cvt_pk_bf16_f32 v152, v72, v73
    v_cvt_pk_bf16_f32 v153, v74, v75
    v_cvt_pk_bf16_f32 v154, v76, v77
    v_cvt_pk_bf16_f32 v155, v78, v79
    v_cvt_pk_bf16_f32 v156, v80, v81
    v_cvt_pk_bf16_f32 v157, v82, v83
    v_cvt_pk_bf16_f32 v158, v84, v85
    v_cvt_pk_bf16_f32 v159, v86, v87
    v_mfma_f32_32x32x16_bf16 v[8:23], a[140:143], v[148:151], v[8:23]
    ds_read_b128 a[136:139], v218 offset:8192
    v_accvgpr_read_b32 v88, a80
    v_accvgpr_read_b32 v89, a81
    v_accvgpr_read_b32 v90, a82
    v_accvgpr_read_b32 v91, a83
    v_accvgpr_read_b32 v92, a84
    v_accvgpr_read_b32 v93, a85
    v_accvgpr_read_b32 v94, a86
    v_accvgpr_read_b32 v95, a87
    v_accvgpr_read_b32 v96, a88
    v_accvgpr_read_b32 v97, a89
    v_accvgpr_read_b32 v98, a90
    v_accvgpr_read_b32 v99, a91
    v_accvgpr_read_b32 v100, a92
    v_accvgpr_read_b32 v101, a93
    v_accvgpr_read_b32 v102, a94
    v_accvgpr_read_b32 v103, a95
    v_mul_f32 v88, s3, v88
    v_mul_f32 v89, s3, v89
    v_mfma_f32_32x32x16_bf16 v[24:39], a[140:143], v[180:183], v[24:39]
    v_mul_f32 v90, s3, v90
    v_mul_f32 v91, s3, v91
    v_mul_f32 v92, s3, v92
    v_mul_f32 v93, s3, v93
    v_mul_f32 v94, s3, v94
    v_mul_f32 v95, s3, v95
    v_mul_f32 v96, s3, v96
    v_mul_f32 v97, s3, v97
    v_mul_f32 v98, s3, v98
    v_mul_f32 v99, s3, v99
    v_mul_f32 v100, s3, v100
    v_mul_f32 v101, s3, v101
    v_mul_f32 v102, s3, v102
    v_mul_f32 v103, s3, v103
    v_cvt_pk_bf16_f32 v184, v88, v89
    v_cvt_pk_bf16_f32 v185, v90, v91
    v_cvt_pk_bf16_f32 v186, v92, v93
    v_cvt_pk_bf16_f32 v187, v94, v95
    v_cvt_pk_bf16_f32 v188, v96, v97
    v_cvt_pk_bf16_f32 v189, v98, v99
    v_cvt_pk_bf16_f32 v190, v100, v101
    v_cvt_pk_bf16_f32 v191, v102, v103
    v_mfma_f32_32x32x16_bf16 v[8:23], a[144:147], v[152:155], v[8:23]
    ds_read_b128 a[140:143], v219 offset:8192
    v_accvgpr_read_b32 v104, a96
    v_accvgpr_read_b32 v105, a97
    v_accvgpr_read_b32 v106, a98
    v_accvgpr_read_b32 v107, a99
    v_accvgpr_read_b32 v108, a100
    v_accvgpr_read_b32 v109, a101
    v_accvgpr_read_b32 v110, a102
    v_accvgpr_read_b32 v111, a103
    v_accvgpr_read_b32 v112, a104
    v_accvgpr_read_b32 v113, a105
    v_accvgpr_read_b32 v114, a106
    v_accvgpr_read_b32 v115, a107
    v_accvgpr_read_b32 v116, a108
    v_accvgpr_read_b32 v117, a109
    v_accvgpr_read_b32 v118, a110
    v_accvgpr_read_b32 v119, a111
    v_mul_f32 v104, s3, v104
    v_mul_f32 v105, s3, v105
    v_mfma_f32_32x32x16_bf16 v[24:39], a[144:147], v[184:187], v[24:39]
    v_mul_f32 v106, s3, v106
    v_mul_f32 v107, s3, v107
    v_mul_f32 v108, s3, v108
    v_mul_f32 v109, s3, v109
    v_mul_f32 v110, s3, v110
    v_mul_f32 v111, s3, v111
    v_mul_f32 v112, s3, v112
    v_mul_f32 v113, s3, v113
    v_mul_f32 v114, s3, v114
    v_mul_f32 v115, s3, v115
    v_mul_f32 v116, s3, v116
    v_mul_f32 v117, s3, v117
    v_mul_f32 v118, s3, v118
    v_mul_f32 v119, s3, v119
    v_cvt_pk_bf16_f32 v160, v104, v105
    v_cvt_pk_bf16_f32 v161, v106, v107
    v_cvt_pk_bf16_f32 v162, v108, v109
    v_cvt_pk_bf16_f32 v163, v110, v111
    v_cvt_pk_bf16_f32 v164, v112, v113
    v_cvt_pk_bf16_f32 v165, v114, v115
    v_cvt_pk_bf16_f32 v166, v116, v117
    v_cvt_pk_bf16_f32 v167, v118, v119
    v_mfma_f32_32x32x16_bf16 v[8:23], a[148:151], v[156:159], v[8:23]
    ds_read_b128 a[144:147], v220 offset:8192
    v_accvgpr_read_b32 v120, a112
    v_accvgpr_read_b32 v121, a113
    v_accvgpr_read_b32 v122, a114
    v_accvgpr_read_b32 v123, a115
    v_accvgpr_read_b32 v124, a116
    v_accvgpr_read_b32 v125, a117
    v_accvgpr_read_b32 v126, a118
    v_accvgpr_read_b32 v127, a119
    v_accvgpr_read_b32 v128, a120
    v_accvgpr_read_b32 v129, a121
    v_accvgpr_read_b32 v130, a122
    v_accvgpr_read_b32 v131, a123
    v_accvgpr_read_b32 v132, a124
    v_accvgpr_read_b32 v133, a125
    v_accvgpr_read_b32 v134, a126
    v_accvgpr_read_b32 v135, a127
    v_mul_f32 v120, s3, v120
    v_mul_f32 v121, s3, v121
    v_mfma_f32_32x32x16_bf16 v[24:39], a[148:151], v[188:191], v[24:39]
    v_mul_f32 v122, s3, v122
    v_mul_f32 v123, s3, v123
    v_mul_f32 v124, s3, v124
    v_mul_f32 v125, s3, v125
    v_mul_f32 v126, s3, v126
    v_mul_f32 v127, s3, v127
    v_mul_f32 v128, s3, v128
    v_mul_f32 v129, s3, v129
    v_mul_f32 v130, s3, v130
    v_mul_f32 v131, s3, v131
    v_mul_f32 v132, s3, v132
    v_mul_f32 v133, s3, v133
    v_mul_f32 v134, s3, v134
    v_mul_f32 v135, s3, v135
    v_cvt_pk_bf16_f32 v192, v120, v121
    v_cvt_pk_bf16_f32 v193, v122, v123
    v_cvt_pk_bf16_f32 v194, v124, v125
    v_cvt_pk_bf16_f32 v195, v126, v127
    v_cvt_pk_bf16_f32 v196, v128, v129
    v_cvt_pk_bf16_f32 v197, v130, v131
    v_cvt_pk_bf16_f32 v198, v132, v133
    v_cvt_pk_bf16_f32 v199, v134, v135
    v_mfma_f32_32x32x16_bf16 v[8:23], a[152:155], v[160:163], v[8:23]
    ds_read_b128 a[148:151], v221 offset:8192
    v_mfma_f32_32x32x16_bf16 v[24:39], a[152:155], v[192:195], v[24:39]
    v_mfma_f32_32x32x16_bf16 v[8:23], a[156:159], v[164:167], v[8:23]
    ds_read_b128 a[152:155], v222 offset:8192
    v_mfma_f32_32x32x16_bf16 v[24:39], a[156:159], v[196:199], v[24:39]
    ds_read_b128 a[156:159], v223 offset:8192
    s_nop 8
    v_max3_f32 v212, v8, v9, v10
    v_max3_f32 v212, v212, v11, v12
    v_max3_f32 v212, v212, v13, v14
    v_max3_f32 v212, v212, v15, v16
    v_max3_f32 v212, v212, v17, v18
    v_max3_f32 v212, v212, v19, v20
    v_max3_f32 v212, v212, v21, v22
    v_max_f32 v212, v212, v23
    v_mov_b32 v213, v212
    s_nop 1
    v_permlane32_swap_b32 v212, v213
    v_max_f32 v212, v212, v213
    v_add_f32 v212, 0x42c80000, v212
    v_sub_f32 v72, 0, v212
    v_mov_b32 v73, v72
    v_mov_b32 v74, v72
    v_mov_b32 v75, v72
    v_mov_b32 v76, v72
    v_mov_b32 v77, v72
    v_mov_b32 v78, v72
    v_mov_b32 v79, v72
    v_mov_b32 v80, v72
    v_mov_b32 v81, v72
    v_mov_b32 v82, v72
    v_mov_b32 v83, v72
    v_mov_b32 v84, v72
    v_mov_b32 v85, v72
    v_mov_b32 v86, v72
    v_mov_b32 v87, v72
    v_sub_f32 v8, v8, v212
    v_sub_f32 v9, v9, v212
    v_sub_f32 v10, v10, v212
    v_sub_f32 v11, v11, v212
    v_sub_f32 v12, v12, v212
    v_sub_f32 v13, v13, v212
    v_sub_f32 v14, v14, v212
    v_sub_f32 v15, v15, v212
    v_sub_f32 v16, v16, v212
    v_sub_f32 v17, v17, v212
    v_sub_f32 v18, v18, v212
    v_sub_f32 v19, v19, v212
    v_sub_f32 v20, v20, v212
    v_sub_f32 v21, v21, v212
    v_sub_f32 v22, v22, v212
    v_sub_f32 v23, v23, v212
    v_mov_b32 v210, 0
    v_max3_f32 v212, v24, v25, v26
    v_max3_f32 v212, v212, v27, v28
    v_max3_f32 v212, v212, v29, v30
    v_max3_f32 v212, v212, v31, v32
    v_max3_f32 v212, v212, v33, v34
    v_max3_f32 v212, v212, v35, v36
    v_max3_f32 v212, v212, v37, v38
    v_max_f32 v212, v212, v39
    v_mov_b32 v213, v212
    s_nop 1
    v_permlane32_swap_b32 v212, v213
    v_max_f32 v212, v212, v213
    v_add_f32 v212, 0x42c80000, v212
    v_sub_f32 v88, 0, v212
    v_mov_b32 v89, v88
    v_mov_b32 v90, v88
    v_mov_b32 v91, v88
    v_mov_b32 v92, v88
    v_mov_b32 v93, v88
    v_mov_b32 v94, v88
    v_mov_b32 v95, v88
    v_mov_b32 v96, v88
    v_mov_b32 v97, v88
    v_mov_b32 v98, v88
    v_mov_b32 v99, v88
    v_mov_b32 v100, v88
    v_mov_b32 v101, v88
    v_mov_b32 v102, v88
    v_mov_b32 v103, v88
    v_sub_f32 v24, v24, v212
    v_sub_f32 v25, v25, v212
    v_sub_f32 v26, v26, v212
    v_sub_f32 v27, v27, v212
    v_sub_f32 v28, v28, v212
    v_sub_f32 v29, v29, v212
    v_sub_f32 v30, v30, v212
    v_sub_f32 v31, v31, v212
    v_sub_f32 v32, v32, v212
    v_sub_f32 v33, v33, v212
    v_sub_f32 v34, v34, v212
    v_sub_f32 v35, v35, v212
    v_sub_f32 v36, v36, v212
    v_sub_f32 v37, v37, v212
    v_sub_f32 v38, v38, v212
    v_sub_f32 v39, v39, v212
    v_mov_b32 v211, 0
    s_mov_b32 s34, 49152
    s_mov_b32 s35, 32768
    s_mov_b32 s36, 8
    s_waitcnt lgkmcnt(0)
    v_mfma_f32_32x32x16_bf16 v[40:55], a[128:131], v[136:139], v[72:87]
    s_waitcnt vmcnt(9)
    s_barrier
    v_mfma_f32_32x32x16_bf16 v[56:71], a[128:131], v[168:171], v[88:103]
    v_exp_f32 v200, v8
    v_exp_f32 v201, v9
    v_exp_f32 v202, v10
    v_mfma_f32_32x32x16_bf16 v[40:55], a[132:135], v[140:143], v[40:55]
    ds_read_b128 a[128:131], v216 offset:16384
    v_add_f32 v208, v200, v201
    v_exp_f32 v203, v11
    v_cvt_pk_bf16_f32 v104, v200, v201
    v_exp_f32 v204, v12
    v_add_f32 v208, v208, v202
    s_add_u32 m0, s33, 49152
    v_mfma_f32_32x32x16_bf16 v[56:71], a[132:135], v[172:175], v[56:71]
    buffer_load_dwordx4 v228, s[8:11], s34 offen offset:0 lds
    v_exp_f32 v205, v13
    v_add_f32 v208, v208, v203
    v_cvt_pk_bf16_f32 v105, v202, v203
    v_exp_f32 v206, v14
    v_mfma_f32_32x32x16_bf16 v[40:55], a[136:139], v[144:147], v[40:55]
    ds_read_b128 a[132:135], v217 offset:16384
    v_add_f32 v208, v208, v204
    v_exp_f32 v207, v15
    v_add_f32 v208, v208, v205
    v_cvt_pk_bf16_f32 v106, v204, v205
    v_exp_f32 v200, v16
    v_add_f32 v208, v208, v206
    v_exp_f32 v201, v17
    v_mfma_f32_32x32x16_bf16 v[56:71], a[136:139], v[176:179], v[56:71]
    buffer_load_dwordx4 v229, s[8:11], s34 offen offset:1024 lds
    v_add_f32 v208, v208, v207
    v_cvt_pk_bf16_f32 v107, v206, v207
    v_exp_f32 v202, v18
    v_add_f32 v208, v208, v200
    v_mfma_f32_32x32x16_bf16 v[40:55], a[140:143], v[148:151], v[40:55]
    ds_read_b128 a[136:139], v218 offset:16384
    v_exp_f32 v203, v19
    v_add_f32 v208, v208, v201
    v_cvt_pk_bf16_f32 v108, v200, v201
    v_exp_f32 v204, v20
    v_add_f32 v208, v208, v202
    v_exp_f32 v205, v21
    v_add_f32 v208, v208, v203
    v_mfma_f32_32x32x16_bf16 v[56:71], a[140:143], v[180:183], v[56:71]
    buffer_load_dwordx4 v230, s[8:11], s34 offen offset:2048 lds
    v_cvt_pk_bf16_f32 v109, v202, v203
    v_exp_f32 v206, v22
    v_add_f32 v208, v208, v204
    v_exp_f32 v207, v23
    v_mfma_f32_32x32x16_bf16 v[40:55], a[144:147], v[152:155], v[40:55]
    ds_read_b128 a[140:143], v219 offset:16384
    v_add_f32 v208, v208, v205
    v_cvt_pk_bf16_f32 v110, v204, v205
    v_exp_f32 v200, v24
    v_add_f32 v208, v208, v206
    v_exp_f32 v201, v25
    v_add_f32 v208, v208, v207
    v_cvt_pk_bf16_f32 v111, v206, v207
    v_mfma_f32_32x32x16_bf16 v[56:71], a[144:147], v[184:187], v[56:71]
    buffer_load_dwordx4 v231, s[8:11], s34 offen offset:3072 lds
    v_exp_f32 v202, v26
    v_add_f32 v209, v200, v201
    v_exp_f32 v203, v27
    v_cvt_pk_bf16_f32 v112, v200, v201
    v_exp_f32 v204, v28
    v_mfma_f32_32x32x16_bf16 v[40:55], a[148:151], v[156:159], v[40:55]
    ds_read_b128 a[144:147], v220 offset:16384
    v_add_f32 v209, v209, v202
    v_exp_f32 v205, v29
    v_add_f32 v209, v209, v203
    v_cvt_pk_bf16_f32 v113, v202, v203
    v_exp_f32 v206, v30
    s_add_u32 s34, s34, 16384
    v_mfma_f32_32x32x16_bf16 v[56:71], a[148:151], v[188:191], v[56:71]
    v_add_f32 v209, v209, v204
    v_exp_f32 v207, v31
    v_add_f32 v209, v209, v205
    v_cvt_pk_bf16_f32 v114, v204, v205
    v_exp_f32 v200, v32
    v_add_f32 v209, v209, v206
    v_exp_f32 v201, v33
    v_mfma_f32_32x32x16_bf16 v[40:55], a[152:155], v[160:163], v[40:55]
    ds_read_b128 a[148:151], v221 offset:16384
    v_add_f32 v209, v209, v207
    v_cvt_pk_bf16_f32 v115, v206, v207
    v_exp_f32 v202, v34
    v_add_f32 v209, v209, v200
    v_exp_f32 v203, v35
    v_add_f32 v209, v209, v201
    v_cvt_pk_bf16_f32 v116, v200, v201
    v_mfma_f32_32x32x16_bf16 v[56:71], a[152:155], v[192:195], v[56:71]
    v_exp_f32 v204, v36
    v_add_f32 v209, v209, v202
    v_exp_f32 v205, v37
    v_add_f32 v209, v209, v203
    v_cvt_pk_bf16_f32 v117, v202, v203
    v_exp_f32 v206, v38
    v_add_f32 v209, v209, v204
    v_exp_f32 v207, v39
    v_mfma_f32_32x32x16_bf16 v[40:55], a[156:159], v[164:167], v[40:55]
    ds_read_b128 a[152:155], v222 offset:16384
    v_add_f32 v209, v209, v205
    v_cvt_pk_bf16_f32 v118, v204, v205
    v_add_f32 v209, v209, v206
    v_add_f32 v209, v209, v207
    v_cvt_pk_bf16_f32 v119, v206, v207
    v_max_f32 v212, v208, v209
    v_cmp_lt_f32 vcc, s37, v212
    v_mfma_f32_32x32x16_bf16 v[56:71], a[156:159], v[196:199], v[56:71]
    ds_read_b128 a[156:159], v223 offset:16384
    s_waitcnt lgkmcnt(0)
    s_cbranch_vccnz attn_kernel_slow_1
attn_kernel_ret_2:
    v_add_f32 v210, v210, v208
    v_add_f32 v211, v211, v209
    v_mfma_f32_32x32x16_bf16 v[8:23], a[128:131], v[136:139], v[72:87]
    ds_read_b64_tr_b16 a[160:161], v224 offset:0
    ds_read_b64_tr_b16 a[162:163], v224 offset:2048
    v_exp_f32 v200, v40
    v_exp_f32 v201, v41
    v_mfma_f32_32x32x16_bf16 v[24:39], a[128:131], v[168:171], v[88:103]
    ds_read_b64_tr_b16 a[164:165], v225 offset:0
    ds_read_b64_tr_b16 a[166:167], v225 offset:2048
    v_exp_f32 v202, v42
    v_mfma_f32_32x32x16_bf16 v[8:23], a[132:135], v[140:143], v[8:23]
    ds_read_b64_tr_b16 a[168:169], v226 offset:0
    ds_read_b64_tr_b16 a[170:171], v226 offset:2048
    v_add_f32 v208, v200, v201
    v_exp_f32 v203, v43
    v_mfma_f32_32x32x16_bf16 v[24:39], a[132:135], v[172:175], v[24:39]
    ds_read_b64_tr_b16 a[172:173], v227 offset:0
    ds_read_b64_tr_b16 a[174:175], v227 offset:2048
    v_cvt_pk_bf16_f32 v120, v200, v201
    v_exp_f32 v204, v44
    v_mfma_f32_32x32x16_bf16 v[8:23], a[136:139], v[144:147], v[8:23]
    ds_read_b64_tr_b16 a[176:177], v224 offset:4096
    ds_read_b64_tr_b16 a[178:179], v224 offset:6144
    v_add_f32 v208, v208, v202
    v_exp_f32 v205, v45
    v_mfma_f32_32x32x16_bf16 v[24:39], a[136:139], v[176:179], v[24:39]
    ds_read_b64_tr_b16 a[180:181], v225 offset:4096
    ds_read_b64_tr_b16 a[182:183], v225 offset:6144
    v_add_f32 v208, v208, v203
    v_cvt_pk_bf16_f32 v121, v202, v203
    v_exp_f32 v206, v46
    v_mfma_f32_32x32x16_bf16 v[8:23], a[140:143], v[148:151], v[8:23]
    ds_read_b64_tr_b16 a[184:185], v226 offset:4096
    ds_read_b64_tr_b16 a[186:187], v226 offset:6144
    v_add_f32 v208, v208, v204
    v_exp_f32 v207, v47
    v_mfma_f32_32x32x16_bf16 v[24:39], a[140:143], v[180:183], v[24:39]
    ds_read_b64_tr_b16 a[188:189], v227 offset:4096
    ds_read_b64_tr_b16 a[190:191], v227 offset:6144
    v_add_f32 v208, v208, v205
    v_cvt_pk_bf16_f32 v122, v204, v205
    v_mfma_f32_32x32x16_bf16 v[8:23], a[144:147], v[152:155], v[8:23]
    v_exp_f32 v200, v48
    v_add_f32 v208, v208, v206
    v_exp_f32 v201, v49
    v_mfma_f32_32x32x16_bf16 v[24:39], a[144:147], v[184:187], v[24:39]
    v_add_f32 v208, v208, v207
    v_cvt_pk_bf16_f32 v123, v206, v207
    v_exp_f32 v202, v50
    v_add_f32 v208, v208, v200
    v_mfma_f32_32x32x16_bf16 v[8:23], a[148:151], v[156:159], v[8:23]
    v_exp_f32 v203, v51
    v_add_f32 v208, v208, v201
    v_cvt_pk_bf16_f32 v124, v200, v201
    v_mfma_f32_32x32x16_bf16 v[24:39], a[148:151], v[188:191], v[24:39]
    v_exp_f32 v204, v52
    v_add_f32 v208, v208, v202
    v_exp_f32 v205, v53
    v_mfma_f32_32x32x16_bf16 v[8:23], a[152:155], v[160:163], v[8:23]
    v_add_f32 v208, v208, v203
    v_cvt_pk_bf16_f32 v125, v202, v203
    v_exp_f32 v206, v54
    v_mfma_f32_32x32x16_bf16 v[24:39], a[152:155], v[192:195], v[24:39]
    v_add_f32 v208, v208, v204
    v_exp_f32 v207, v55
    v_add_f32 v208, v208, v205
    v_cvt_pk_bf16_f32 v126, v204, v205
    v_mfma_f32_32x32x16_bf16 v[8:23], a[156:159], v[164:167], v[8:23]
    v_exp_f32 v200, v56
    v_add_f32 v208, v208, v206
    v_exp_f32 v201, v57
    v_mfma_f32_32x32x16_bf16 v[24:39], a[156:159], v[196:199], v[24:39]
    s_waitcnt lgkmcnt(0)
    v_add_f32 v208, v208, v207
    v_cvt_pk_bf16_f32 v127, v206, v207
    v_exp_f32 v202, v58
    v_mfma_f32_32x32x16_bf16 a[0:15], a[160:163], v[104:107], 0
    v_add_f32 v209, v200, v201
    v_exp_f32 v203, v59
    v_cvt_pk_bf16_f32 v128, v200, v201
    v_mfma_f32_32x32x16_bf16 a[16:31], a[160:163], v[112:115], 0
    ds_read_b128 a[128:131], v216 offset:24576
    ds_read_b128 a[132:135], v217 offset:24576
    v_exp_f32 v204, v60
    v_add_f32 v209, v209, v202
    v_mfma_f32_32x32x16_bf16 a[32:47], a[164:167], v[104:107], 0
    ds_read_b128 a[136:139], v218 offset:24576
    ds_read_b128 a[140:143], v219 offset:24576
    v_exp_f32 v205, v61
    v_add_f32 v209, v209, v203
    v_cvt_pk_bf16_f32 v129, v202, v203
    v_mfma_f32_32x32x16_bf16 a[48:63], a[164:167], v[112:115], 0
    ds_read_b128 a[144:147], v220 offset:24576
    ds_read_b128 a[148:151], v221 offset:24576
    v_exp_f32 v206, v62
    v_add_f32 v209, v209, v204
    v_mfma_f32_32x32x16_bf16 a[64:79], a[168:171], v[104:107], 0
    ds_read_b128 a[152:155], v222 offset:24576
    ds_read_b128 a[156:159], v223 offset:24576
    v_exp_f32 v207, v63
    v_add_f32 v209, v209, v205
    v_mfma_f32_32x32x16_bf16 a[80:95], a[168:171], v[112:115], 0
    v_cvt_pk_bf16_f32 v130, v204, v205
    v_exp_f32 v200, v64
    v_add_f32 v209, v209, v206
    s_add_u32 m0, s33, 98304
    v_mfma_f32_32x32x16_bf16 a[96:111], a[172:175], v[104:107], 0
    buffer_load_dwordx4 v232, s[12:15], s35 offen offset:0 lds
    v_exp_f32 v201, v65
    v_mfma_f32_32x32x16_bf16 a[112:127], a[172:175], v[112:115], 0
    v_add_f32 v209, v209, v207
    v_cvt_pk_bf16_f32 v131, v206, v207
    v_exp_f32 v202, v66
    v_add_f32 v209, v209, v200
    v_mfma_f32_32x32x16_bf16 a[0:15], a[176:179], v[108:111], a[0:15]
    buffer_load_dwordx4 v232, s[12:15], s35 offen offset:1024 lds
    v_exp_f32 v203, v67
    v_add_f32 v209, v209, v201
    v_mfma_f32_32x32x16_bf16 a[16:31], a[176:179], v[116:119], a[16:31]
    v_cvt_pk_bf16_f32 v132, v200, v201
    v_exp_f32 v204, v68
    v_add_f32 v209, v209, v202
    v_mfma_f32_32x32x16_bf16 a[32:47], a[180:183], v[108:111], a[32:47]
    buffer_load_dwordx4 v232, s[12:15], s35 offen offset:2048 lds
    v_exp_f32 v205, v69
    v_add_f32 v209, v209, v203
    v_mfma_f32_32x32x16_bf16 a[48:63], a[180:183], v[116:119], a[48:63]
    v_cvt_pk_bf16_f32 v133, v202, v203
    v_exp_f32 v206, v70
    v_add_f32 v209, v209, v204
    v_mfma_f32_32x32x16_bf16 a[64:79], a[184:187], v[108:111], a[64:79]
    buffer_load_dwordx4 v232, s[12:15], s35 offen offset:3072 lds
    v_exp_f32 v207, v71
    v_add_f32 v209, v209, v205
    v_mfma_f32_32x32x16_bf16 a[80:95], a[184:187], v[116:119], a[80:95]
    v_cvt_pk_bf16_f32 v134, v204, v205
    v_add_f32 v209, v209, v206
    v_add_f32 v209, v209, v207
    v_cvt_pk_bf16_f32 v135, v206, v207
    s_add_u32 s35, s35, 16384
    v_mfma_f32_32x32x16_bf16 a[96:111], a[188:191], v[108:111], a[96:111]
    buffer_load_dword v240, v236, s[80:83], s42 offen
    v_max_f32 v212, v208, v209
    v_cmp_lt_f32 vcc, s37, v212
    v_mfma_f32_32x32x16_bf16 a[112:127], a[188:191], v[116:119], a[112:127]
    s_waitcnt lgkmcnt(0)
    s_cbranch_vccnz attn_kernel_slow_3
attn_kernel_ret_4:
    v_add_f32 v210, v210, v208
    v_add_f32 v211, v211, v209
    s_branch attn_ent
.p2align 6
attn_loop:
    v_mfma_f32_32x32x16_bf16 v[40:55], a[128:131], v[136:139], v[72:87]
    ds_read_b64_tr_b16 a[160:161], v224 offset:57344
    ds_read_b64_tr_b16 a[162:163], v224 offset:59392
    v_exp_f32 v200, v8
    v_exp_f32 v201, v9
    v_mfma_f32_32x32x16_bf16 v[56:71], a[128:131], v[168:171], v[88:103]
    ds_read_b64_tr_b16 a[164:165], v225 offset:57344
    ds_read_b64_tr_b16 a[166:167], v225 offset:59392
    v_exp_f32 v202, v10
    v_mfma_f32_32x32x16_bf16 v[40:55], a[132:135], v[140:143], v[40:55]
    ds_read_b64_tr_b16 a[168:169], v226 offset:57344
    ds_read_b64_tr_b16 a[170:171], v226 offset:59392
    v_add_f32 v208, v200, v201
    v_exp_f32 v203, v11
    v_cvt_pk_bf16_f32 v104, v200, v201
    v_mfma_f32_32x32x16_bf16 v[56:71], a[132:135], v[172:175], v[56:71]
    ds_read_b64_tr_b16 a[172:173], v227 offset:57344
    ds_read_b64_tr_b16 a[174:175], v227 offset:59392
    v_exp_f32 v204, v12
    v_add_f32 v208, v208, v202
    v_mfma_f32_32x32x16_bf16 v[40:55], a[136:139], v[144:147], v[40:55]
    ds_read_b64_tr_b16 a[176:177], v224 offset:61440
    ds_read_b64_tr_b16 a[178:179], v224 offset:63488
    v_exp_f32 v205, v13
    v_add_f32 v208, v208, v203
    v_mfma_f32_32x32x16_bf16 v[56:71], a[136:139], v[176:179], v[56:71]
    ds_read_b64_tr_b16 a[180:181], v225 offset:61440
    ds_read_b64_tr_b16 a[182:183], v225 offset:63488
    v_cvt_pk_bf16_f32 v105, v202, v203
    v_exp_f32 v206, v14
    v_mfma_f32_32x32x16_bf16 v[40:55], a[140:143], v[148:151], v[40:55]
    ds_read_b64_tr_b16 a[184:185], v226 offset:61440
    ds_read_b64_tr_b16 a[186:187], v226 offset:63488
    v_add_f32 v208, v208, v204
    v_exp_f32 v207, v15
    v_mfma_f32_32x32x16_bf16 v[56:71], a[140:143], v[180:183], v[56:71]
    ds_read_b64_tr_b16 a[188:189], v227 offset:61440
    ds_read_b64_tr_b16 a[190:191], v227 offset:63488
    v_add_f32 v208, v208, v205
    v_cvt_pk_bf16_f32 v106, v204, v205
    v_exp_f32 v200, v16
    v_mfma_f32_32x32x16_bf16 v[40:55], a[144:147], v[152:155], v[40:55]
    v_add_f32 v208, v208, v206
    v_exp_f32 v201, v17
    v_add_f32 v208, v208, v207
    v_mfma_f32_32x32x16_bf16 v[56:71], a[144:147], v[184:187], v[56:71]
    v_cvt_pk_bf16_f32 v107, v206, v207
    v_exp_f32 v202, v18
    v_add_f32 v208, v208, v200
    v_exp_f32 v203, v19
    v_mfma_f32_32x32x16_bf16 v[40:55], a[148:151], v[156:159], v[40:55]
    v_add_f32 v208, v208, v201
    v_cvt_pk_bf16_f32 v108, v200, v201
    v_exp_f32 v204, v20
    v_mfma_f32_32x32x16_bf16 v[56:71], a[148:151], v[188:191], v[56:71]
    v_add_f32 v208, v208, v202
    v_exp_f32 v205, v21
    v_add_f32 v208, v208, v203
    v_cvt_pk_bf16_f32 v109, v202, v203
    v_mfma_f32_32x32x16_bf16 v[40:55], a[152:155], v[160:163], v[40:55]
    v_exp_f32 v206, v22
    v_add_f32 v208, v208, v204
    v_exp_f32 v207, v23
    v_mfma_f32_32x32x16_bf16 v[56:71], a[152:155], v[192:195], v[56:71]
    v_add_f32 v208, v208, v205
    v_cvt_pk_bf16_f32 v110, v204, v205
    v_exp_f32 v200, v24
    v_mfma_f32_32x32x16_bf16 v[40:55], a[156:159], v[164:167], v[40:55]
    v_add_f32 v208, v208, v206
    v_exp_f32 v201, v25
    v_add_f32 v208, v208, v207
    v_cvt_pk_bf16_f32 v111, v206, v207
    v_mfma_f32_32x32x16_bf16 v[56:71], a[156:159], v[196:199], v[56:71]
    s_waitcnt vmcnt(10) lgkmcnt(0)
    s_barrier
    v_mfma_f32_32x32x16_bf16 a[0:15], a[160:163], v[120:123], a[0:15]
    v_exp_f32 v202, v26
    v_add_f32 v209, v200, v201
    v_mfma_f32_32x32x16_bf16 a[16:31], a[160:163], v[128:131], a[16:31]
    ds_read_b128 a[128:131], v216 offset:16384
    ds_read_b128 a[132:135], v217 offset:16384
    v_exp_f32 v203, v27
    v_cvt_pk_bf16_f32 v112, v200, v201
    v_mfma_f32_32x32x16_bf16 a[32:47], a[164:167], v[120:123], a[32:47]
    ds_read_b128 a[136:139], v218 offset:16384
    ds_read_b128 a[140:143], v219 offset:16384
    v_exp_f32 v204, v28
    v_add_f32 v209, v209, v202
    v_mfma_f32_32x32x16_bf16 a[48:63], a[164:167], v[128:131], a[48:63]
    ds_read_b128 a[144:147], v220 offset:16384
    ds_read_b128 a[148:151], v221 offset:16384
    v_exp_f32 v205, v29
    v_add_f32 v209, v209, v203
    v_mfma_f32_32x32x16_bf16 a[64:79], a[168:171], v[120:123], a[64:79]
    ds_read_b128 a[152:155], v222 offset:16384
    ds_read_b128 a[156:159], v223 offset:16384
    v_cvt_pk_bf16_f32 v113, v202, v203
    v_exp_f32 v206, v30
    v_mfma_f32_32x32x16_bf16 a[80:95], a[168:171], v[128:131], a[80:95]
    v_add_f32 v209, v209, v204
    v_exp_f32 v207, v31
    v_add_f32 v209, v209, v205
    s_add_u32 m0, s33, 49152
    v_mfma_f32_32x32x16_bf16 a[96:111], a[172:175], v[120:123], a[96:111]
    buffer_load_dwordx4 v228, s[8:11], s34 offen offset:0 lds
    v_cvt_pk_bf16_f32 v114, v204, v205
    v_exp_f32 v200, v32
    v_mfma_f32_32x32x16_bf16 a[112:127], a[172:175], v[128:131], a[112:127]
    v_add_f32 v209, v209, v206
    v_exp_f32 v201, v33
    v_add_f32 v209, v209, v207
    v_cvt_pk_bf16_f32 v115, v206, v207
    v_mfma_f32_32x32x16_bf16 a[0:15], a[176:179], v[124:127], a[0:15]
    buffer_load_dwordx4 v229, s[8:11], s34 offen offset:1024 lds
    v_exp_f32 v202, v34
    v_add_f32 v209, v209, v200
    v_mfma_f32_32x32x16_bf16 a[16:31], a[176:179], v[132:135], a[16:31]
    v_exp_f32 v203, v35
    v_add_f32 v209, v209, v201
    v_cvt_pk_bf16_f32 v116, v200, v201
    v_mfma_f32_32x32x16_bf16 a[32:47], a[180:183], v[124:127], a[32:47]
    buffer_load_dwordx4 v230, s[8:11], s34 offen offset:2048 lds
    v_exp_f32 v204, v36
    v_add_f32 v209, v209, v202
    v_mfma_f32_32x32x16_bf16 a[48:63], a[180:183], v[132:135], a[48:63]
    v_exp_f32 v205, v37
    v_add_f32 v209, v209, v203
    v_cvt_pk_bf16_f32 v117, v202, v203
    v_exp_f32 v206, v38
    v_mfma_f32_32x32x16_bf16 a[64:79], a[184:187], v[124:127], a[64:79]
    buffer_load_dwordx4 v231, s[8:11], s34 offen offset:3072 lds
    v_add_f32 v209, v209, v204
    v_exp_f32 v207, v39
    v_mfma_f32_32x32x16_bf16 a[80:95], a[184:187], v[132:135], a[80:95]
    v_add_f32 v209, v209, v205
    v_cvt_pk_bf16_f32 v118, v204, v205
    v_add_f32 v209, v209, v206
    s_add_u32 s34, s34, 16384
    v_mfma_f32_32x32x16_bf16 a[96:111], a[188:191], v[124:127], a[96:111]
    v_add_f32 v209, v209, v207
    v_cvt_pk_bf16_f32 v119, v206, v207
    v_max_f32 v212, v208, v209
    v_cmp_lt_f32 vcc, s37, v212
    v_mfma_f32_32x32x16_bf16 a[112:127], a[188:191], v[132:135], a[112:127]
    s_waitcnt lgkmcnt(0)
    s_cbranch_vccnz attn_kernel_slow_5
attn_kernel_ret_6:
    v_add_f32 v210, v210, v208
    v_add_f32 v211, v211, v209
    v_mfma_f32_32x32x16_bf16 v[8:23], a[128:131], v[136:139], v[72:87]
    ds_read_b64_tr_b16 a[160:161], v224 offset:0
    ds_read_b64_tr_b16 a[162:163], v224 offset:2048
    v_exp_f32 v200, v40
    v_exp_f32 v201, v41
    v_mfma_f32_32x32x16_bf16 v[24:39], a[128:131], v[168:171], v[88:103]
    ds_read_b64_tr_b16 a[164:165], v225 offset:0
    ds_read_b64_tr_b16 a[166:167], v225 offset:2048
    v_exp_f32 v202, v42
    v_mfma_f32_32x32x16_bf16 v[8:23], a[132:135], v[140:143], v[8:23]
    ds_read_b64_tr_b16 a[168:169], v226 offset:0
    ds_read_b64_tr_b16 a[170:171], v226 offset:2048
    v_add_f32 v208, v200, v201
    v_exp_f32 v203, v43
    v_mfma_f32_32x32x16_bf16 v[24:39], a[132:135], v[172:175], v[24:39]
    ds_read_b64_tr_b16 a[172:173], v227 offset:0
    ds_read_b64_tr_b16 a[174:175], v227 offset:2048
    v_cvt_pk_bf16_f32 v120, v200, v201
    v_exp_f32 v204, v44
    v_mfma_f32_32x32x16_bf16 v[8:23], a[136:139], v[144:147], v[8:23]
    ds_read_b64_tr_b16 a[176:177], v224 offset:4096
    ds_read_b64_tr_b16 a[178:179], v224 offset:6144
    v_add_f32 v208, v208, v202
    v_exp_f32 v205, v45
    v_mfma_f32_32x32x16_bf16 v[24:39], a[136:139], v[176:179], v[24:39]
    ds_read_b64_tr_b16 a[180:181], v225 offset:4096
    ds_read_b64_tr_b16 a[182:183], v225 offset:6144
    v_add_f32 v208, v208, v203
    v_cvt_pk_bf16_f32 v121, v202, v203
    v_exp_f32 v206, v46
    v_mfma_f32_32x32x16_bf16 v[8:23], a[140:143], v[148:151], v[8:23]
    ds_read_b64_tr_b16 a[184:185], v226 offset:4096
    ds_read_b64_tr_b16 a[186:187], v226 offset:6144
    v_add_f32 v208, v208, v204
    v_exp_f32 v207, v47
    v_mfma_f32_32x32x16_bf16 v[24:39], a[140:143], v[180:183], v[24:39]
    ds_read_b64_tr_b16 a[188:189], v227 offset:4096
    ds_read_b64_tr_b16 a[190:191], v227 offset:6144
    v_add_f32 v208, v208, v205
    v_cvt_pk_bf16_f32 v122, v204, v205
    v_mfma_f32_32x32x16_bf16 v[8:23], a[144:147], v[152:155], v[8:23]
    v_exp_f32 v200, v48
    v_add_f32 v208, v208, v206
    v_exp_f32 v201, v49
    v_mfma_f32_32x32x16_bf16 v[24:39], a[144:147], v[184:187], v[24:39]
    v_add_f32 v208, v208, v207
    v_cvt_pk_bf16_f32 v123, v206, v207
    v_exp_f32 v202, v50
    v_add_f32 v208, v208, v200
    v_mfma_f32_32x32x16_bf16 v[8:23], a[148:151], v[156:159], v[8:23]
    v_exp_f32 v203, v51
    v_add_f32 v208, v208, v201
    v_cvt_pk_bf16_f32 v124, v200, v201
    v_mfma_f32_32x32x16_bf16 v[24:39], a[148:151], v[188:191], v[24:39]
    v_exp_f32 v204, v52
    v_add_f32 v208, v208, v202
    v_exp_f32 v205, v53
    v_mfma_f32_32x32x16_bf16 v[8:23], a[152:155], v[160:163], v[8:23]
    v_add_f32 v208, v208, v203
    v_cvt_pk_bf16_f32 v125, v202, v203
    v_exp_f32 v206, v54
    v_mfma_f32_32x32x16_bf16 v[24:39], a[152:155], v[192:195], v[24:39]
    v_add_f32 v208, v208, v204
    v_exp_f32 v207, v55
    v_add_f32 v208, v208, v205
    v_cvt_pk_bf16_f32 v126, v204, v205
    v_mfma_f32_32x32x16_bf16 v[8:23], a[156:159], v[164:167], v[8:23]
    v_exp_f32 v200, v56
    v_add_f32 v208, v208, v206
    v_exp_f32 v201, v57
    v_mfma_f32_32x32x16_bf16 v[24:39], a[156:159], v[196:199], v[24:39]
    s_waitcnt lgkmcnt(0)
    v_add_f32 v208, v208, v207
    v_cvt_pk_bf16_f32 v127, v206, v207
    v_exp_f32 v202, v58
    v_mfma_f32_32x32x16_bf16 a[0:15], a[160:163], v[104:107], a[0:15]
    v_add_f32 v209, v200, v201
    v_exp_f32 v203, v59
    v_cvt_pk_bf16_f32 v128, v200, v201
    v_mfma_f32_32x32x16_bf16 a[16:31], a[160:163], v[112:115], a[16:31]
    ds_read_b128 a[128:131], v216 offset:24576
    ds_read_b128 a[132:135], v217 offset:24576
    v_exp_f32 v204, v60
    v_add_f32 v209, v209, v202
    v_mfma_f32_32x32x16_bf16 a[32:47], a[164:167], v[104:107], a[32:47]
    ds_read_b128 a[136:139], v218 offset:24576
    ds_read_b128 a[140:143], v219 offset:24576
    v_exp_f32 v205, v61
    v_add_f32 v209, v209, v203
    v_cvt_pk_bf16_f32 v129, v202, v203
    v_mfma_f32_32x32x16_bf16 a[48:63], a[164:167], v[112:115], a[48:63]
    ds_read_b128 a[144:147], v220 offset:24576
    ds_read_b128 a[148:151], v221 offset:24576
    v_exp_f32 v206, v62
    v_add_f32 v209, v209, v204
    v_mfma_f32_32x32x16_bf16 a[64:79], a[168:171], v[104:107], a[64:79]
    ds_read_b128 a[152:155], v222 offset:24576
    ds_read_b128 a[156:159], v223 offset:24576
    v_exp_f32 v207, v63
    v_add_f32 v209, v209, v205
    v_mfma_f32_32x32x16_bf16 a[80:95], a[168:171], v[112:115], a[80:95]
    v_cvt_pk_bf16_f32 v130, v204, v205
    v_exp_f32 v200, v64
    v_add_f32 v209, v209, v206
    s_add_u32 m0, s33, 98304
    v_mfma_f32_32x32x16_bf16 a[96:111], a[172:175], v[104:107], a[96:111]
    buffer_load_dwordx4 v232, s[12:15], s35 offen offset:0 lds
    v_exp_f32 v201, v65
    v_mfma_f32_32x32x16_bf16 a[112:127], a[172:175], v[112:115], a[112:127]
    v_add_f32 v209, v209, v207
    v_cvt_pk_bf16_f32 v131, v206, v207
    v_exp_f32 v202, v66
    v_add_f32 v209, v209, v200
    v_mfma_f32_32x32x16_bf16 a[0:15], a[176:179], v[108:111], a[0:15]
    buffer_load_dwordx4 v232, s[12:15], s35 offen offset:1024 lds
    v_exp_f32 v203, v67
    v_add_f32 v209, v209, v201
    v_mfma_f32_32x32x16_bf16 a[16:31], a[176:179], v[116:119], a[16:31]
    v_cvt_pk_bf16_f32 v132, v200, v201
    v_exp_f32 v204, v68
    v_add_f32 v209, v209, v202
    v_mfma_f32_32x32x16_bf16 a[32:47], a[180:183], v[108:111], a[32:47]
    buffer_load_dwordx4 v232, s[12:15], s35 offen offset:2048 lds
    v_exp_f32 v205, v69
    v_add_f32 v209, v209, v203
    v_mfma_f32_32x32x16_bf16 a[48:63], a[180:183], v[116:119], a[48:63]
    v_cvt_pk_bf16_f32 v133, v202, v203
    v_exp_f32 v206, v70
    v_add_f32 v209, v209, v204
    v_mfma_f32_32x32x16_bf16 a[64:79], a[184:187], v[108:111], a[64:79]
    buffer_load_dwordx4 v232, s[12:15], s35 offen offset:3072 lds
    v_exp_f32 v207, v71
    v_add_f32 v209, v209, v205
    v_mfma_f32_32x32x16_bf16 a[80:95], a[184:187], v[116:119], a[80:95]
    v_cvt_pk_bf16_f32 v134, v204, v205
    v_add_f32 v209, v209, v206
    v_add_f32 v209, v209, v207
    v_cvt_pk_bf16_f32 v135, v206, v207
    s_add_u32 s35, s35, 16384
    v_mfma_f32_32x32x16_bf16 a[96:111], a[188:191], v[108:111], a[96:111]
    buffer_load_dword v240, v236, s[80:83], s42 offen
    v_max_f32 v212, v208, v209
    v_cmp_lt_f32 vcc, s37, v212
    v_mfma_f32_32x32x16_bf16 a[112:127], a[188:191], v[116:119], a[112:127]
    s_waitcnt lgkmcnt(0)
    s_cbranch_vccnz attn_kernel_slow_7
attn_kernel_ret_8:
    v_add_f32 v210, v210, v208
    v_add_f32 v211, v211, v209
attn_ent:
    v_mfma_f32_32x32x16_bf16 v[40:55], a[128:131], v[136:139], v[72:87]
    ds_read_b64_tr_b16 a[160:161], v224 offset:8192
    ds_read_b64_tr_b16 a[162:163], v224 offset:10240
    v_exp_f32 v200, v8
    v_exp_f32 v201, v9
    v_mfma_f32_32x32x16_bf16 v[56:71], a[128:131], v[168:171], v[88:103]
    ds_read_b64_tr_b16 a[164:165], v225 offset:8192
    ds_read_b64_tr_b16 a[166:167], v225 offset:10240
    v_exp_f32 v202, v10
    v_mfma_f32_32x32x16_bf16 v[40:55], a[132:135], v[140:143], v[40:55]
    ds_read_b64_tr_b16 a[168:169], v226 offset:8192
    ds_read_b64_tr_b16 a[170:171], v226 offset:10240
    v_add_f32 v208, v200, v201
    v_exp_f32 v203, v11
    v_cvt_pk_bf16_f32 v104, v200, v201
    v_mfma_f32_32x32x16_bf16 v[56:71], a[132:135], v[172:175], v[56:71]
    ds_read_b64_tr_b16 a[172:173], v227 offset:8192
    ds_read_b64_tr_b16 a[174:175], v227 offset:10240
    v_exp_f32 v204, v12
    v_add_f32 v208, v208, v202
    v_mfma_f32_32x32x16_bf16 v[40:55], a[136:139], v[144:147], v[40:55]
    ds_read_b64_tr_b16 a[176:177], v224 offset:12288
    ds_read_b64_tr_b16 a[178:179], v224 offset:14336
    v_exp_f32 v205, v13
    v_add_f32 v208, v208, v203
    v_mfma_f32_32x32x16_bf16 v[56:71], a[136:139], v[176:179], v[56:71]
    ds_read_b64_tr_b16 a[180:181], v225 offset:12288
    ds_read_b64_tr_b16 a[182:183], v225 offset:14336
    v_cvt_pk_bf16_f32 v105, v202, v203
    v_exp_f32 v206, v14
    v_mfma_f32_32x32x16_bf16 v[40:55], a[140:143], v[148:151], v[40:55]
    ds_read_b64_tr_b16 a[184:185], v226 offset:12288
    ds_read_b64_tr_b16 a[186:187], v226 offset:14336
    v_add_f32 v208, v208, v204
    v_exp_f32 v207, v15
    v_mfma_f32_32x32x16_bf16 v[56:71], a[140:143], v[180:183], v[56:71]
    ds_read_b64_tr_b16 a[188:189], v227 offset:12288
    ds_read_b64_tr_b16 a[190:191], v227 offset:14336
    v_add_f32 v208, v208, v205
    v_cvt_pk_bf16_f32 v106, v204, v205
    v_exp_f32 v200, v16
    v_mfma_f32_32x32x16_bf16 v[40:55], a[144:147], v[152:155], v[40:55]
    v_add_f32 v208, v208, v206
    v_exp_f32 v201, v17
    v_add_f32 v208, v208, v207
    v_mfma_f32_32x32x16_bf16 v[56:71], a[144:147], v[184:187], v[56:71]
    v_cvt_pk_bf16_f32 v107, v206, v207
    v_exp_f32 v202, v18
    v_add_f32 v208, v208, v200
    v_exp_f32 v203, v19
    v_mfma_f32_32x32x16_bf16 v[40:55], a[148:151], v[156:159], v[40:55]
    v_add_f32 v208, v208, v201
    v_cvt_pk_bf16_f32 v108, v200, v201
    v_exp_f32 v204, v20
    v_mfma_f32_32x32x16_bf16 v[56:71], a[148:151], v[188:191], v[56:71]
    v_add_f32 v208, v208, v202
    v_exp_f32 v205, v21
    v_add_f32 v208, v208, v203
    v_cvt_pk_bf16_f32 v109, v202, v203
    v_mfma_f32_32x32x16_bf16 v[40:55], a[152:155], v[160:163], v[40:55]
    v_exp_f32 v206, v22
    v_add_f32 v208, v208, v204
    v_exp_f32 v207, v23
    v_mfma_f32_32x32x16_bf16 v[56:71], a[152:155], v[192:195], v[56:71]
    v_add_f32 v208, v208, v205
    v_cvt_pk_bf16_f32 v110, v204, v205
    v_exp_f32 v200, v24
    v_mfma_f32_32x32x16_bf16 v[40:55], a[156:159], v[164:167], v[40:55]
    v_add_f32 v208, v208, v206
    v_exp_f32 v201, v25
    v_add_f32 v208, v208, v207
    v_cvt_pk_bf16_f32 v111, v206, v207
    v_mfma_f32_32x32x16_bf16 v[56:71], a[156:159], v[196:199], v[56:71]
    s_waitcnt vmcnt(10) lgkmcnt(0)
    s_barrier
    v_mfma_f32_32x32x16_bf16 a[0:15], a[160:163], v[120:123], a[0:15]
    v_exp_f32 v202, v26
    v_add_f32 v209, v200, v201
    v_mfma_f32_32x32x16_bf16 a[16:31], a[160:163], v[128:131], a[16:31]
    ds_read_b128 a[128:131], v216 offset:32768
    ds_read_b128 a[132:135], v217 offset:32768
    v_exp_f32 v203, v27
    v_cvt_pk_bf16_f32 v112, v200, v201
    v_mfma_f32_32x32x16_bf16 a[32:47], a[164:167], v[120:123], a[32:47]
    ds_read_b128 a[136:139], v218 offset:32768
    ds_read_b128 a[140:143], v219 offset:32768
    v_exp_f32 v204, v28
    v_add_f32 v209, v209, v202
    v_mfma_f32_32x32x16_bf16 a[48:63], a[164:167], v[128:131], a[48:63]
    ds_read_b128 a[144:147], v220 offset:32768
    ds_read_b128 a[148:151], v221 offset:32768
    v_exp_f32 v205, v29
    v_add_f32 v209, v209, v203
    v_mfma_f32_32x32x16_bf16 a[64:79], a[168:171], v[120:123], a[64:79]
    ds_read_b128 a[152:155], v222 offset:32768
    ds_read_b128 a[156:159], v223 offset:32768
    v_cvt_pk_bf16_f32 v113, v202, v203
    v_exp_f32 v206, v30
    v_mfma_f32_32x32x16_bf16 a[80:95], a[168:171], v[128:131], a[80:95]
    v_add_f32 v209, v209, v204
    v_exp_f32 v207, v31
    v_add_f32 v209, v209, v205
    s_add_u32 m0, s33, 0
    v_mfma_f32_32x32x16_bf16 a[96:111], a[172:175], v[120:123], a[96:111]
    buffer_load_dwordx4 v228, s[8:11], s34 offen offset:0 lds
    v_cvt_pk_bf16_f32 v114, v204, v205
    v_exp_f32 v200, v32
    v_mfma_f32_32x32x16_bf16 a[112:127], a[172:175], v[128:131], a[112:127]
    v_add_f32 v209, v209, v206
    v_exp_f32 v201, v33
    v_add_f32 v209, v209, v207
    v_cvt_pk_bf16_f32 v115, v206, v207
    v_mfma_f32_32x32x16_bf16 a[0:15], a[176:179], v[124:127], a[0:15]
    buffer_load_dwordx4 v229, s[8:11], s34 offen offset:1024 lds
    v_exp_f32 v202, v34
    v_add_f32 v209, v209, v200
    v_mfma_f32_32x32x16_bf16 a[16:31], a[176:179], v[132:135], a[16:31]
    v_exp_f32 v203, v35
    v_add_f32 v209, v209, v201
    v_cvt_pk_bf16_f32 v116, v200, v201
    v_mfma_f32_32x32x16_bf16 a[32:47], a[180:183], v[124:127], a[32:47]
    buffer_load_dwordx4 v230, s[8:11], s34 offen offset:2048 lds
    v_exp_f32 v204, v36
    v_add_f32 v209, v209, v202
    v_mfma_f32_32x32x16_bf16 a[48:63], a[180:183], v[132:135], a[48:63]
    v_exp_f32 v205, v37
    v_add_f32 v209, v209, v203
    v_cvt_pk_bf16_f32 v117, v202, v203
    v_exp_f32 v206, v38
    v_mfma_f32_32x32x16_bf16 a[64:79], a[184:187], v[124:127], a[64:79]
    buffer_load_dwordx4 v231, s[8:11], s34 offen offset:3072 lds
    v_add_f32 v209, v209, v204
    v_exp_f32 v207, v39
    v_mfma_f32_32x32x16_bf16 a[80:95], a[184:187], v[132:135], a[80:95]
    v_add_f32 v209, v209, v205
    v_cvt_pk_bf16_f32 v118, v204, v205
    v_add_f32 v209, v209, v206
    s_add_u32 s34, s34, 16384
    v_mfma_f32_32x32x16_bf16 a[96:111], a[188:191], v[124:127], a[96:111]
    v_add_f32 v209, v209, v207
    v_cvt_pk_bf16_f32 v119, v206, v207
    v_max_f32 v212, v208, v209
    v_cmp_lt_f32 vcc, s37, v212
    v_mfma_f32_32x32x16_bf16 a[112:127], a[188:191], v[132:135], a[112:127]
    s_waitcnt lgkmcnt(0)
    s_cbranch_vccnz attn_kernel_slow_9
attn_kernel_ret_10:
    v_add_f32 v210, v210, v208
    v_add_f32 v211, v211, v209
    v_mfma_f32_32x32x16_bf16 v[8:23], a[128:131], v[136:139], v[72:87]
    ds_read_b64_tr_b16 a[160:161], v224 offset:16384
    ds_read_b64_tr_b16 a[162:163], v224 offset:18432
    v_exp_f32 v200, v40
    v_exp_f32 v201, v41
    v_mfma_f32_32x32x16_bf16 v[24:39], a[128:131], v[168:171], v[88:103]
    ds_read_b64_tr_b16 a[164:165], v225 offset:16384
    ds_read_b64_tr_b16 a[166:167], v225 offset:18432
    v_exp_f32 v202, v42
    v_mfma_f32_32x32x16_bf16 v[8:23], a[132:135], v[140:143], v[8:23]
    ds_read_b64_tr_b16 a[168:169], v226 offset:16384
    ds_read_b64_tr_b16 a[170:171], v226 offset:18432
    v_add_f32 v208, v200, v201
    v_exp_f32 v203, v43
    v_mfma_f32_32x32x16_bf16 v[24:39], a[132:135], v[172:175], v[24:39]
    ds_read_b64_tr_b16 a[172:173], v227 offset:16384
    ds_read_b64_tr_b16 a[174:175], v227 offset:18432
    v_cvt_pk_bf16_f32 v120, v200, v201
    v_exp_f32 v204, v44
    v_mfma_f32_32x32x16_bf16 v[8:23], a[136:139], v[144:147], v[8:23]
    ds_read_b64_tr_b16 a[176:177], v224 offset:20480
    ds_read_b64_tr_b16 a[178:179], v224 offset:22528
    v_add_f32 v208, v208, v202
    v_exp_f32 v205, v45
    v_mfma_f32_32x32x16_bf16 v[24:39], a[136:139], v[176:179], v[24:39]
    ds_read_b64_tr_b16 a[180:181], v225 offset:20480
    ds_read_b64_tr_b16 a[182:183], v225 offset:22528
    v_add_f32 v208, v208, v203
    v_cvt_pk_bf16_f32 v121, v202, v203
    v_exp_f32 v206, v46
    v_mfma_f32_32x32x16_bf16 v[8:23], a[140:143], v[148:151], v[8:23]
    ds_read_b64_tr_b16 a[184:185], v226 offset:20480
    ds_read_b64_tr_b16 a[186:187], v226 offset:22528
    v_add_f32 v208, v208, v204
    v_exp_f32 v207, v47
    v_mfma_f32_32x32x16_bf16 v[24:39], a[140:143], v[180:183], v[24:39]
    ds_read_b64_tr_b16 a[188:189], v227 offset:20480
    ds_read_b64_tr_b16 a[190:191], v227 offset:22528
    v_add_f32 v208, v208, v205
    v_cvt_pk_bf16_f32 v122, v204, v205
    v_mfma_f32_32x32x16_bf16 v[8:23], a[144:147], v[152:155], v[8:23]
    v_exp_f32 v200, v48
    v_add_f32 v208, v208, v206
    v_exp_f32 v201, v49
    v_mfma_f32_32x32x16_bf16 v[24:39], a[144:147], v[184:187], v[24:39]
    v_add_f32 v208, v208, v207
    v_cvt_pk_bf16_f32 v123, v206, v207
    v_exp_f32 v202, v50
    v_add_f32 v208, v208, v200
    v_mfma_f32_32x32x16_bf16 v[8:23], a[148:151], v[156:159], v[8:23]
    v_exp_f32 v203, v51
    v_add_f32 v208, v208, v201
    v_cvt_pk_bf16_f32 v124, v200, v201
    v_mfma_f32_32x32x16_bf16 v[24:39], a[148:151], v[188:191], v[24:39]
    v_exp_f32 v204, v52
    v_add_f32 v208, v208, v202
    v_exp_f32 v205, v53
    v_mfma_f32_32x32x16_bf16 v[8:23], a[152:155], v[160:163], v[8:23]
    v_add_f32 v208, v208, v203
    v_cvt_pk_bf16_f32 v125, v202, v203
    v_exp_f32 v206, v54
    v_mfma_f32_32x32x16_bf16 v[24:39], a[152:155], v[192:195], v[24:39]
    v_add_f32 v208, v208, v204
    v_exp_f32 v207, v55
    v_add_f32 v208, v208, v205
    v_cvt_pk_bf16_f32 v126, v204, v205
    v_mfma_f32_32x32x16_bf16 v[8:23], a[156:159], v[164:167], v[8:23]
    v_exp_f32 v200, v56
    v_add_f32 v208, v208, v206
    v_exp_f32 v201, v57
    v_mfma_f32_32x32x16_bf16 v[24:39], a[156:159], v[196:199], v[24:39]
    s_waitcnt lgkmcnt(0)
    v_add_f32 v208, v208, v207
    v_cvt_pk_bf16_f32 v127, v206, v207
    v_exp_f32 v202, v58
    v_mfma_f32_32x32x16_bf16 a[0:15], a[160:163], v[104:107], a[0:15]
    v_add_f32 v209, v200, v201
    v_exp_f32 v203, v59
    v_cvt_pk_bf16_f32 v128, v200, v201
    v_mfma_f32_32x32x16_bf16 a[16:31], a[160:163], v[112:115], a[16:31]
    ds_read_b128 a[128:131], v216 offset:40960
    ds_read_b128 a[132:135], v217 offset:40960
    v_exp_f32 v204, v60
    v_add_f32 v209, v209, v202
    v_mfma_f32_32x32x16_bf16 a[32:47], a[164:167], v[104:107], a[32:47]
    ds_read_b128 a[136:139], v218 offset:40960
    ds_read_b128 a[140:143], v219 offset:40960
    v_exp_f32 v205, v61
    v_add_f32 v209, v209, v203
    v_cvt_pk_bf16_f32 v129, v202, v203
    v_mfma_f32_32x32x16_bf16 a[48:63], a[164:167], v[112:115], a[48:63]
    ds_read_b128 a[144:147], v220 offset:40960
    ds_read_b128 a[148:151], v221 offset:40960
    v_exp_f32 v206, v62
    v_add_f32 v209, v209, v204
    v_mfma_f32_32x32x16_bf16 a[64:79], a[168:171], v[104:107], a[64:79]
    ds_read_b128 a[152:155], v222 offset:40960
    ds_read_b128 a[156:159], v223 offset:40960
    v_exp_f32 v207, v63
    v_add_f32 v209, v209, v205
    v_mfma_f32_32x32x16_bf16 a[80:95], a[168:171], v[112:115], a[80:95]
    v_cvt_pk_bf16_f32 v130, v204, v205
    v_exp_f32 v200, v64
    v_add_f32 v209, v209, v206
    s_add_u32 m0, s33, 114688
    v_mfma_f32_32x32x16_bf16 a[96:111], a[172:175], v[104:107], a[96:111]
    buffer_load_dwordx4 v232, s[12:15], s35 offen offset:0 lds
    v_exp_f32 v201, v65
    v_mfma_f32_32x32x16_bf16 a[112:127], a[172:175], v[112:115], a[112:127]
    v_add_f32 v209, v209, v207
    v_cvt_pk_bf16_f32 v131, v206, v207
    v_exp_f32 v202, v66
    v_add_f32 v209, v209, v200
    v_mfma_f32_32x32x16_bf16 a[0:15], a[176:179], v[108:111], a[0:15]
    buffer_load_dwordx4 v232, s[12:15], s35 offen offset:1024 lds
    v_exp_f32 v203, v67
    v_add_f32 v209, v209, v201
    v_mfma_f32_32x32x16_bf16 a[16:31], a[176:179], v[116:119], a[16:31]
    v_cvt_pk_bf16_f32 v132, v200, v201
    v_exp_f32 v204, v68
    v_add_f32 v209, v209, v202
    v_mfma_f32_32x32x16_bf16 a[32:47], a[180:183], v[108:111], a[32:47]
    buffer_load_dwordx4 v232, s[12:15], s35 offen offset:2048 lds
    v_exp_f32 v205, v69
    v_add_f32 v209, v209, v203
    v_mfma_f32_32x32x16_bf16 a[48:63], a[180:183], v[116:119], a[48:63]
    v_cvt_pk_bf16_f32 v133, v202, v203
    v_exp_f32 v206, v70
    v_add_f32 v209, v209, v204
    v_mfma_f32_32x32x16_bf16 a[64:79], a[184:187], v[108:111], a[64:79]
    buffer_load_dwordx4 v232, s[12:15], s35 offen offset:3072 lds
    v_exp_f32 v207, v71
    v_add_f32 v209, v209, v205
    v_mfma_f32_32x32x16_bf16 a[80:95], a[184:187], v[116:119], a[80:95]
    v_cvt_pk_bf16_f32 v134, v204, v205
    v_add_f32 v209, v209, v206
    v_add_f32 v209, v209, v207
    v_cvt_pk_bf16_f32 v135, v206, v207
    s_add_u32 s35, s35, 16384
    v_mfma_f32_32x32x16_bf16 a[96:111], a[188:191], v[108:111], a[96:111]
    buffer_load_dword v240, v236, s[84:87], s42 offen
    v_max_f32 v212, v208, v209
    v_cmp_lt_f32 vcc, s37, v212
    v_mfma_f32_32x32x16_bf16 a[112:127], a[188:191], v[116:119], a[112:127]
    s_waitcnt lgkmcnt(0)
    s_cbranch_vccnz attn_kernel_slow_11
attn_kernel_ret_12:
    v_add_f32 v210, v210, v208
    v_add_f32 v211, v211, v209
    v_mfma_f32_32x32x16_bf16 v[40:55], a[128:131], v[136:139], v[72:87]
    ds_read_b64_tr_b16 a[160:161], v224 offset:24576
    ds_read_b64_tr_b16 a[162:163], v224 offset:26624
    v_exp_f32 v200, v8
    v_exp_f32 v201, v9
    v_mfma_f32_32x32x16_bf16 v[56:71], a[128:131], v[168:171], v[88:103]
    ds_read_b64_tr_b16 a[164:165], v225 offset:24576
    ds_read_b64_tr_b16 a[166:167], v225 offset:26624
    v_exp_f32 v202, v10
    v_mfma_f32_32x32x16_bf16 v[40:55], a[132:135], v[140:143], v[40:55]
    ds_read_b64_tr_b16 a[168:169], v226 offset:24576
    ds_read_b64_tr_b16 a[170:171], v226 offset:26624
    v_add_f32 v208, v200, v201
    v_exp_f32 v203, v11
    v_cvt_pk_bf16_f32 v104, v200, v201
    v_mfma_f32_32x32x16_bf16 v[56:71], a[132:135], v[172:175], v[56:71]
    ds_read_b64_tr_b16 a[172:173], v227 offset:24576
    ds_read_b64_tr_b16 a[174:175], v227 offset:26624
    v_exp_f32 v204, v12
    v_add_f32 v208, v208, v202
    v_mfma_f32_32x32x16_bf16 v[40:55], a[136:139], v[144:147], v[40:55]
    ds_read_b64_tr_b16 a[176:177], v224 offset:28672
    ds_read_b64_tr_b16 a[178:179], v224 offset:30720
    v_exp_f32 v205, v13
    v_add_f32 v208, v208, v203
    v_mfma_f32_32x32x16_bf16 v[56:71], a[136:139], v[176:179], v[56:71]
    ds_read_b64_tr_b16 a[180:181], v225 offset:28672
    ds_read_b64_tr_b16 a[182:183], v225 offset:30720
    v_cvt_pk_bf16_f32 v105, v202, v203
    v_exp_f32 v206, v14
    v_mfma_f32_32x32x16_bf16 v[40:55], a[140:143], v[148:151], v[40:55]
    ds_read_b64_tr_b16 a[184:185], v226 offset:28672
    ds_read_b64_tr_b16 a[186:187], v226 offset:30720
    v_add_f32 v208, v208, v204
    v_exp_f32 v207, v15
    v_mfma_f32_32x32x16_bf16 v[56:71], a[140:143], v[180:183], v[56:71]
    ds_read_b64_tr_b16 a[188:189], v227 offset:28672
    ds_read_b64_tr_b16 a[190:191], v227 offset:30720
    v_add_f32 v208, v208, v205
    v_cvt_pk_bf16_f32 v106, v204, v205
    v_exp_f32 v200, v16
    v_mfma_f32_32x32x16_bf16 v[40:55], a[144:147], v[152:155], v[40:55]
    v_add_f32 v208, v208, v206
    v_exp_f32 v201, v17
    v_add_f32 v208, v208, v207
    v_mfma_f32_32x32x16_bf16 v[56:71], a[144:147], v[184:187], v[56:71]
    v_cvt_pk_bf16_f32 v107, v206, v207
    v_exp_f32 v202, v18
    v_add_f32 v208, v208, v200
    v_exp_f32 v203, v19
    v_mfma_f32_32x32x16_bf16 v[40:55], a[148:151], v[156:159], v[40:55]
    v_add_f32 v208, v208, v201
    v_cvt_pk_bf16_f32 v108, v200, v201
    v_exp_f32 v204, v20
    v_mfma_f32_32x32x16_bf16 v[56:71], a[148:151], v[188:191], v[56:71]
    v_add_f32 v208, v208, v202
    v_exp_f32 v205, v21
    v_add_f32 v208, v208, v203
    v_cvt_pk_bf16_f32 v109, v202, v203
    v_mfma_f32_32x32x16_bf16 v[40:55], a[152:155], v[160:163], v[40:55]
    v_exp_f32 v206, v22
    v_add_f32 v208, v208, v204
    v_exp_f32 v207, v23
    v_mfma_f32_32x32x16_bf16 v[56:71], a[152:155], v[192:195], v[56:71]
    v_add_f32 v208, v208, v205
    v_cvt_pk_bf16_f32 v110, v204, v205
    v_exp_f32 v200, v24
    v_mfma_f32_32x32x16_bf16 v[40:55], a[156:159], v[164:167], v[40:55]
    v_add_f32 v208, v208, v206
    v_exp_f32 v201, v25
    v_add_f32 v208, v208, v207
    v_cvt_pk_bf16_f32 v111, v206, v207
    v_mfma_f32_32x32x16_bf16 v[56:71], a[156:159], v[196:199], v[56:71]
    s_waitcnt vmcnt(10) lgkmcnt(0)
    s_barrier
    v_mfma_f32_32x32x16_bf16 a[0:15], a[160:163], v[120:123], a[0:15]
    v_exp_f32 v202, v26
    v_add_f32 v209, v200, v201
    v_mfma_f32_32x32x16_bf16 a[16:31], a[160:163], v[128:131], a[16:31]
    ds_read_b128 a[128:131], v216 offset:49152
    ds_read_b128 a[132:135], v217 offset:49152
    v_exp_f32 v203, v27
    v_cvt_pk_bf16_f32 v112, v200, v201
    v_mfma_f32_32x32x16_bf16 a[32:47], a[164:167], v[120:123], a[32:47]
    ds_read_b128 a[136:139], v218 offset:49152
    ds_read_b128 a[140:143], v219 offset:49152
    v_exp_f32 v204, v28
    v_add_f32 v209, v209, v202
    v_mfma_f32_32x32x16_bf16 a[48:63], a[164:167], v[128:131], a[48:63]
    ds_read_b128 a[144:147], v220 offset:49152
    ds_read_b128 a[148:151], v221 offset:49152
    v_exp_f32 v205, v29
    v_add_f32 v209, v209, v203
    v_mfma_f32_32x32x16_bf16 a[64:79], a[168:171], v[120:123], a[64:79]
    ds_read_b128 a[152:155], v222 offset:49152
    ds_read_b128 a[156:159], v223 offset:49152
    v_cvt_pk_bf16_f32 v113, v202, v203
    v_exp_f32 v206, v30
    v_mfma_f32_32x32x16_bf16 a[80:95], a[168:171], v[128:131], a[80:95]
    v_add_f32 v209, v209, v204
    v_exp_f32 v207, v31
    v_add_f32 v209, v209, v205
    s_add_u32 m0, s33, 16384
    v_mfma_f32_32x32x16_bf16 a[96:111], a[172:175], v[120:123], a[96:111]
    buffer_load_dwordx4 v228, s[8:11], s34 offen offset:0 lds
    v_cvt_pk_bf16_f32 v114, v204, v205
    v_exp_f32 v200, v32
    v_mfma_f32_32x32x16_bf16 a[112:127], a[172:175], v[128:131], a[112:127]
    v_add_f32 v209, v209, v206
    v_exp_f32 v201, v33
    v_add_f32 v209, v209, v207
    v_cvt_pk_bf16_f32 v115, v206, v207
    v_mfma_f32_32x32x16_bf16 a[0:15], a[176:179], v[124:127], a[0:15]
    buffer_load_dwordx4 v229, s[8:11], s34 offen offset:1024 lds
    v_exp_f32 v202, v34
    v_add_f32 v209, v209, v200
    v_mfma_f32_32x32x16_bf16 a[16:31], a[176:179], v[132:135], a[16:31]
    v_exp_f32 v203, v35
    v_add_f32 v209, v209, v201
    v_cvt_pk_bf16_f32 v116, v200, v201
    v_mfma_f32_32x32x16_bf16 a[32:47], a[180:183], v[124:127], a[32:47]
    buffer_load_dwordx4 v230, s[8:11], s34 offen offset:2048 lds
    v_exp_f32 v204, v36
    v_add_f32 v209, v209, v202
    v_mfma_f32_32x32x16_bf16 a[48:63], a[180:183], v[132:135], a[48:63]
    v_exp_f32 v205, v37
    v_add_f32 v209, v209, v203
    v_cvt_pk_bf16_f32 v117, v202, v203
    v_exp_f32 v206, v38
    v_mfma_f32_32x32x16_bf16 a[64:79], a[184:187], v[124:127], a[64:79]
    buffer_load_dwordx4 v231, s[8:11], s34 offen offset:3072 lds
    v_add_f32 v209, v209, v204
    v_exp_f32 v207, v39
    v_mfma_f32_32x32x16_bf16 a[80:95], a[184:187], v[132:135], a[80:95]
    v_add_f32 v209, v209, v205
    v_cvt_pk_bf16_f32 v118, v204, v205
    v_add_f32 v209, v209, v206
    s_add_u32 s34, s34, 16384
    v_mfma_f32_32x32x16_bf16 a[96:111], a[188:191], v[124:127], a[96:111]
    v_add_f32 v209, v209, v207
    v_cvt_pk_bf16_f32 v119, v206, v207
    v_max_f32 v212, v208, v209
    v_cmp_lt_f32 vcc, s37, v212
    v_mfma_f32_32x32x16_bf16 a[112:127], a[188:191], v[132:135], a[112:127]
    s_waitcnt lgkmcnt(0)
    s_cbranch_vccnz attn_kernel_slow_13
attn_kernel_ret_14:
    v_add_f32 v210, v210, v208
    v_add_f32 v211, v211, v209
    v_mfma_f32_32x32x16_bf16 v[8:23], a[128:131], v[136:139], v[72:87]
    ds_read_b64_tr_b16 a[160:161], v224 offset:32768
    ds_read_b64_tr_b16 a[162:163], v224 offset:34816
    v_exp_f32 v200, v40
    v_exp_f32 v201, v41
    v_mfma_f32_32x32x16_bf16 v[24:39], a[128:131], v[168:171], v[88:103]
    ds_read_b64_tr_b16 a[164:165], v225 offset:32768
    ds_read_b64_tr_b16 a[166:167], v225 offset:34816
    v_exp_f32 v202, v42
    v_mfma_f32_32x32x16_bf16 v[8:23], a[132:135], v[140:143], v[8:23]
    ds_read_b64_tr_b16 a[168:169], v226 offset:32768
    ds_read_b64_tr_b16 a[170:171], v226 offset:34816
    v_add_f32 v208, v200, v201
    v_exp_f32 v203, v43
    v_mfma_f32_32x32x16_bf16 v[24:39], a[132:135], v[172:175], v[24:39]
    ds_read_b64_tr_b16 a[172:173], v227 offset:32768
    ds_read_b64_tr_b16 a[174:175], v227 offset:34816
    v_cvt_pk_bf16_f32 v120, v200, v201
    v_exp_f32 v204, v44
    v_mfma_f32_32x32x16_bf16 v[8:23], a[136:139], v[144:147], v[8:23]
    ds_read_b64_tr_b16 a[176:177], v224 offset:36864
    ds_read_b64_tr_b16 a[178:179], v224 offset:38912
    v_add_f32 v208, v208, v202
    v_exp_f32 v205, v45
    v_mfma_f32_32x32x16_bf16 v[24:39], a[136:139], v[176:179], v[24:39]
    ds_read_b64_tr_b16 a[180:181], v225 offset:36864
    ds_read_b64_tr_b16 a[182:183], v225 offset:38912
    v_add_f32 v208, v208, v203
    v_cvt_pk_bf16_f32 v121, v202, v203
    v_exp_f32 v206, v46
    v_mfma_f32_32x32x16_bf16 v[8:23], a[140:143], v[148:151], v[8:23]
    ds_read_b64_tr_b16 a[184:185], v226 offset:36864
    ds_read_b64_tr_b16 a[186:187], v226 offset:38912
    v_add_f32 v208, v208, v204
    v_exp_f32 v207, v47
    v_mfma_f32_32x32x16_bf16 v[24:39], a[140:143], v[180:183], v[24:39]
    ds_read_b64_tr_b16 a[188:189], v227 offset:36864
    ds_read_b64_tr_b16 a[190:191], v227 offset:38912
    v_add_f32 v208, v208, v205
    v_cvt_pk_bf16_f32 v122, v204, v205
    v_mfma_f32_32x32x16_bf16 v[8:23], a[144:147], v[152:155], v[8:23]
    v_exp_f32 v200, v48
    v_add_f32 v208, v208, v206
    v_exp_f32 v201, v49
    v_mfma_f32_32x32x16_bf16 v[24:39], a[144:147], v[184:187], v[24:39]
    v_add_f32 v208, v208, v207
    v_cvt_pk_bf16_f32 v123, v206, v207
    v_exp_f32 v202, v50
    v_add_f32 v208, v208, v200
    v_mfma_f32_32x32x16_bf16 v[8:23], a[148:151], v[156:159], v[8:23]
    v_exp_f32 v203, v51
    v_add_f32 v208, v208, v201
    v_cvt_pk_bf16_f32 v124, v200, v201
    v_mfma_f32_32x32x16_bf16 v[24:39], a[148:151], v[188:191], v[24:39]
    v_exp_f32 v204, v52
    v_add_f32 v208, v208, v202
    v_exp_f32 v205, v53
    v_mfma_f32_32x32x16_bf16 v[8:23], a[152:155], v[160:163], v[8:23]
    v_add_f32 v208, v208, v203
    v_cvt_pk_bf16_f32 v125, v202, v203
    v_exp_f32 v206, v54
    v_mfma_f32_32x32x16_bf16 v[24:39], a[152:155], v[192:195], v[24:39]
    v_add_f32 v208, v208, v204
    v_exp_f32 v207, v55
    v_add_f32 v208, v208, v205
    v_cvt_pk_bf16_f32 v126, v204, v205
    v_mfma_f32_32x32x16_bf16 v[8:23], a[156:159], v[164:167], v[8:23]
    v_exp_f32 v200, v56
    v_add_f32 v208, v208, v206
    v_exp_f32 v201, v57
    v_mfma_f32_32x32x16_bf16 v[24:39], a[156:159], v[196:199], v[24:39]
    s_waitcnt lgkmcnt(0)
    v_add_f32 v208, v208, v207
    v_cvt_pk_bf16_f32 v127, v206, v207
    v_exp_f32 v202, v58
    v_mfma_f32_32x32x16_bf16 a[0:15], a[160:163], v[104:107], a[0:15]
    v_add_f32 v209, v200, v201
    v_exp_f32 v203, v59
    v_cvt_pk_bf16_f32 v128, v200, v201
    v_mfma_f32_32x32x16_bf16 a[16:31], a[160:163], v[112:115], a[16:31]
    ds_read_b128 a[128:131], v216 offset:57344
    ds_read_b128 a[132:135], v217 offset:57344
    v_exp_f32 v204, v60
    v_add_f32 v209, v209, v202
    v_mfma_f32_32x32x16_bf16 a[32:47], a[164:167], v[104:107], a[32:47]
    ds_read_b128 a[136:139], v218 offset:57344
    ds_read_b128 a[140:143], v219 offset:57344
    v_exp_f32 v205, v61
    v_add_f32 v209, v209, v203
    v_cvt_pk_bf16_f32 v129, v202, v203
    v_mfma_f32_32x32x16_bf16 a[48:63], a[164:167], v[112:115], a[48:63]
    ds_read_b128 a[144:147], v220 offset:57344
    ds_read_b128 a[148:151], v221 offset:57344
    v_exp_f32 v206, v62
    v_add_f32 v209, v209, v204
    v_mfma_f32_32x32x16_bf16 a[64:79], a[168:171], v[104:107], a[64:79]
    ds_read_b128 a[152:155], v222 offset:57344
    ds_read_b128 a[156:159], v223 offset:57344
    v_exp_f32 v207, v63
    v_add_f32 v209, v209, v205
    v_mfma_f32_32x32x16_bf16 a[80:95], a[168:171], v[112:115], a[80:95]
    v_cvt_pk_bf16_f32 v130, v204, v205
    v_exp_f32 v200, v64
    v_add_f32 v209, v209, v206
    s_add_u32 m0, s33, 65536
    v_mfma_f32_32x32x16_bf16 a[96:111], a[172:175], v[104:107], a[96:111]
    buffer_load_dwordx4 v232, s[12:15], s35 offen offset:0 lds
    v_exp_f32 v201, v65
    v_mfma_f32_32x32x16_bf16 a[112:127], a[172:175], v[112:115], a[112:127]
    v_add_f32 v209, v209, v207
    v_cvt_pk_bf16_f32 v131, v206, v207
    v_exp_f32 v202, v66
    v_add_f32 v209, v209, v200
    v_mfma_f32_32x32x16_bf16 a[0:15], a[176:179], v[108:111], a[0:15]
    buffer_load_dwordx4 v232, s[12:15], s35 offen offset:1024 lds
    v_exp_f32 v203, v67
    v_add_f32 v209, v209, v201
    v_mfma_f32_32x32x16_bf16 a[16:31], a[176:179], v[116:119], a[16:31]
    v_cvt_pk_bf16_f32 v132, v200, v201
    v_exp_f32 v204, v68
    v_add_f32 v209, v209, v202
    v_mfma_f32_32x32x16_bf16 a[32:47], a[180:183], v[108:111], a[32:47]
    buffer_load_dwordx4 v232, s[12:15], s35 offen offset:2048 lds
    v_exp_f32 v205, v69
    v_add_f32 v209, v209, v203
    v_mfma_f32_32x32x16_bf16 a[48:63], a[180:183], v[116:119], a[48:63]
    v_cvt_pk_bf16_f32 v133, v202, v203
    v_exp_f32 v206, v70
    v_add_f32 v209, v209, v204
    v_mfma_f32_32x32x16_bf16 a[64:79], a[184:187], v[108:111], a[64:79]
    buffer_load_dwordx4 v232, s[12:15], s35 offen offset:3072 lds
    v_exp_f32 v207, v71
    v_add_f32 v209, v209, v205
    v_mfma_f32_32x32x16_bf16 a[80:95], a[184:187], v[116:119], a[80:95]
    v_cvt_pk_bf16_f32 v134, v204, v205
    v_add_f32 v209, v209, v206
    v_add_f32 v209, v209, v207
    v_cvt_pk_bf16_f32 v135, v206, v207
    s_add_u32 s35, s35, 16384
    v_mfma_f32_32x32x16_bf16 a[96:111], a[188:191], v[108:111], a[96:111]
    buffer_load_dword v240, v236, s[88:91], s42 offen
    v_max_f32 v212, v208, v209
    v_cmp_lt_f32 vcc, s37, v212
    v_mfma_f32_32x32x16_bf16 a[112:127], a[188:191], v[116:119], a[112:127]
    s_waitcnt lgkmcnt(0)
    s_cbranch_vccnz attn_kernel_slow_15
attn_kernel_ret_16:
    v_add_f32 v210, v210, v208
    v_add_f32 v211, v211, v209
    v_mfma_f32_32x32x16_bf16 v[40:55], a[128:131], v[136:139], v[72:87]
    ds_read_b64_tr_b16 a[160:161], v224 offset:40960
    ds_read_b64_tr_b16 a[162:163], v224 offset:43008
    v_exp_f32 v200, v8
    v_exp_f32 v201, v9
    v_mfma_f32_32x32x16_bf16 v[56:71], a[128:131], v[168:171], v[88:103]
    ds_read_b64_tr_b16 a[164:165], v225 offset:40960
    ds_read_b64_tr_b16 a[166:167], v225 offset:43008
    v_exp_f32 v202, v10
    v_mfma_f32_32x32x16_bf16 v[40:55], a[132:135], v[140:143], v[40:55]
    ds_read_b64_tr_b16 a[168:169], v226 offset:40960
    ds_read_b64_tr_b16 a[170:171], v226 offset:43008
    v_add_f32 v208, v200, v201
    v_exp_f32 v203, v11
    v_cvt_pk_bf16_f32 v104, v200, v201
    v_mfma_f32_32x32x16_bf16 v[56:71], a[132:135], v[172:175], v[56:71]
    ds_read_b64_tr_b16 a[172:173], v227 offset:40960
    ds_read_b64_tr_b16 a[174:175], v227 offset:43008
    v_exp_f32 v204, v12
    v_add_f32 v208, v208, v202
    v_mfma_f32_32x32x16_bf16 v[40:55], a[136:139], v[144:147], v[40:55]
    ds_read_b64_tr_b16 a[176:177], v224 offset:45056
    ds_read_b64_tr_b16 a[178:179], v224 offset:47104
    v_exp_f32 v205, v13
    v_add_f32 v208, v208, v203
    v_mfma_f32_32x32x16_bf16 v[56:71], a[136:139], v[176:179], v[56:71]
    ds_read_b64_tr_b16 a[180:181], v225 offset:45056
    ds_read_b64_tr_b16 a[182:183], v225 offset:47104
    v_cvt_pk_bf16_f32 v105, v202, v203
    v_exp_f32 v206, v14
    v_mfma_f32_32x32x16_bf16 v[40:55], a[140:143], v[148:151], v[40:55]
    ds_read_b64_tr_b16 a[184:185], v226 offset:45056
    ds_read_b64_tr_b16 a[186:187], v226 offset:47104
    v_add_f32 v208, v208, v204
    v_exp_f32 v207, v15
    v_add_f32 v208, v208, v205
    v_mfma_f32_32x32x16_bf16 v[56:71], a[140:143], v[180:183], v[56:71]
    ds_read_b64_tr_b16 a[188:189], v227 offset:45056
    ds_read_b64_tr_b16 a[190:191], v227 offset:47104
    v_cvt_pk_bf16_f32 v106, v204, v205
    v_exp_f32 v200, v16
    v_mfma_f32_32x32x16_bf16 v[40:55], a[144:147], v[152:155], v[40:55]
    v_add_f32 v208, v208, v206
    v_exp_f32 v201, v17
    v_add_f32 v208, v208, v207
    v_cvt_pk_bf16_f32 v107, v206, v207
    v_mfma_f32_32x32x16_bf16 v[56:71], a[144:147], v[184:187], v[56:71]
    v_exp_f32 v202, v18
    v_add_f32 v208, v208, v200
    v_exp_f32 v203, v19
    v_mfma_f32_32x32x16_bf16 v[40:55], a[148:151], v[156:159], v[40:55]
    v_add_f32 v208, v208, v201
    v_cvt_pk_bf16_f32 v108, v200, v201
    v_exp_f32 v204, v20
    v_add_f32 v208, v208, v202
    v_mfma_f32_32x32x16_bf16 v[56:71], a[148:151], v[188:191], v[56:71]
    v_exp_f32 v205, v21
    v_add_f32 v208, v208, v203
    v_cvt_pk_bf16_f32 v109, v202, v203
    v_mfma_f32_32x32x16_bf16 v[40:55], a[152:155], v[160:163], v[40:55]
    v_exp_f32 v206, v22
    v_add_f32 v208, v208, v204
    v_exp_f32 v207, v23
    v_mfma_f32_32x32x16_bf16 v[56:71], a[152:155], v[192:195], v[56:71]
    v_add_f32 v208, v208, v205
    v_cvt_pk_bf16_f32 v110, v204, v205
    v_exp_f32 v200, v24
    v_add_f32 v208, v208, v206
    v_mfma_f32_32x32x16_bf16 v[40:55], a[156:159], v[164:167], v[40:55]
    v_exp_f32 v201, v25
    v_add_f32 v208, v208, v207
    v_cvt_pk_bf16_f32 v111, v206, v207
    v_exp_f32 v202, v26
    v_mfma_f32_32x32x16_bf16 v[56:71], a[156:159], v[196:199], v[56:71]
    s_waitcnt vmcnt(10) lgkmcnt(0)
    s_barrier
    v_mfma_f32_32x32x16_bf16 a[0:15], a[160:163], v[120:123], a[0:15]
    s_cmp_le_u32 s36, 4
    s_cbranch_scc1 attn_copy
attn_copy_ret:
    v_mfma_f32_32x32x16_bf16 a[16:31], a[160:163], v[128:131], a[16:31]
    ds_read_b128 a[128:131], v216 offset:0
    ds_read_b128 a[132:135], v217 offset:0
    v_add_f32 v209, v200, v201
    v_exp_f32 v203, v27
    v_mfma_f32_32x32x16_bf16 a[32:47], a[164:167], v[120:123], a[32:47]
    ds_read_b128 a[136:139], v218 offset:0
    ds_read_b128 a[140:143], v219 offset:0
    v_cvt_pk_bf16_f32 v112, v200, v201
    v_exp_f32 v204, v28
    v_mfma_f32_32x32x16_bf16 a[48:63], a[164:167], v[128:131], a[48:63]
    ds_read_b128 a[144:147], v220 offset:0
    ds_read_b128 a[148:151], v221 offset:0
    v_add_f32 v209, v209, v202
    v_exp_f32 v205, v29
    v_add_f32 v209, v209, v203
    v_mfma_f32_32x32x16_bf16 a[64:79], a[168:171], v[120:123], a[64:79]
    ds_read_b128 a[152:155], v222 offset:0
    ds_read_b128 a[156:159], v223 offset:0
    v_cvt_pk_bf16_f32 v113, v202, v203
    v_exp_f32 v206, v30
    v_mfma_f32_32x32x16_bf16 a[80:95], a[168:171], v[128:131], a[80:95]
    v_add_f32 v209, v209, v204
    v_exp_f32 v207, v31
    v_add_f32 v209, v209, v205
    s_add_u32 m0, s33, 32768
    v_mfma_f32_32x32x16_bf16 a[96:111], a[172:175], v[120:123], a[96:111]
    buffer_load_dwordx4 v228, s[8:11], s34 offen offset:0 lds
    v_cvt_pk_bf16_f32 v114, v204, v205
    v_exp_f32 v200, v32
    v_mfma_f32_32x32x16_bf16 a[112:127], a[172:175], v[128:131], a[112:127]
    v_add_f32 v209, v209, v206
    v_exp_f32 v201, v33
    v_add_f32 v209, v209, v207
    v_cvt_pk_bf16_f32 v115, v206, v207
    v_mfma_f32_32x32x16_bf16 a[0:15], a[176:179], v[124:127], a[0:15]
    buffer_load_dwordx4 v229, s[8:11], s34 offen offset:1024 lds
    v_exp_f32 v202, v34
    v_mfma_f32_32x32x16_bf16 a[16:31], a[176:179], v[132:135], a[16:31]
    v_add_f32 v209, v209, v200
    v_exp_f32 v203, v35
    v_add_f32 v209, v209, v201
    v_cvt_pk_bf16_f32 v116, v200, v201
    v_mfma_f32_32x32x16_bf16 a[32:47], a[180:183], v[124:127], a[32:47]
    buffer_load_dwordx4 v230, s[8:11], s34 offen offset:2048 lds
    v_exp_f32 v204, v36
    v_add_f32 v209, v209, v202
    v_mfma_f32_32x32x16_bf16 a[48:63], a[180:183], v[132:135], a[48:63]
    v_exp_f32 v205, v37
    v_add_f32 v209, v209, v203
    v_cvt_pk_bf16_f32 v117, v202, v203
    v_exp_f32 v206, v38
    v_mfma_f32_32x32x16_bf16 a[64:79], a[184:187], v[124:127], a[64:79]
    buffer_load_dwordx4 v231, s[8:11], s34 offen offset:3072 lds
    v_add_f32 v209, v209, v204
    v_mfma_f32_32x32x16_bf16 a[80:95], a[184:187], v[132:135], a[80:95]
    v_exp_f32 v207, v39
    v_add_f32 v209, v209, v205
    v_cvt_pk_bf16_f32 v118, v204, v205
    v_add_f32 v209, v209, v206
    s_add_u32 s34, s34, 16384
    v_mfma_f32_32x32x16_bf16 a[96:111], a[188:191], v[124:127], a[96:111]
    v_add_f32 v209, v209, v207
    v_cvt_pk_bf16_f32 v119, v206, v207
    v_max_f32 v212, v208, v209
    v_cmp_lt_f32 vcc, s37, v212
    v_mfma_f32_32x32x16_bf16 a[112:127], a[188:191], v[132:135], a[112:127]
    s_waitcnt lgkmcnt(0)
    s_cbranch_vccnz attn_kernel_slow_17
attn_kernel_ret_18:
    v_add_f32 v210, v210, v208
    v_add_f32 v211, v211, v209
    s_sub_u32 s36, s36, 1
    s_cmp_eq_u32 s36, 0
    s_cbranch_scc1 attn_tail
    v_mfma_f32_32x32x16_bf16 v[8:23], a[128:131], v[136:139], v[72:87]
    ds_read_b64_tr_b16 a[160:161], v224 offset:49152
    ds_read_b64_tr_b16 a[162:163], v224 offset:51200
    v_exp_f32 v200, v40
    v_exp_f32 v201, v41
    v_mfma_f32_32x32x16_bf16 v[24:39], a[128:131], v[168:171], v[88:103]
    ds_read_b64_tr_b16 a[164:165], v225 offset:49152
    ds_read_b64_tr_b16 a[166:167], v225 offset:51200
    v_exp_f32 v202, v42
    v_mfma_f32_32x32x16_bf16 v[8:23], a[132:135], v[140:143], v[8:23]
    ds_read_b64_tr_b16 a[168:169], v226 offset:49152
    ds_read_b64_tr_b16 a[170:171], v226 offset:51200
    v_add_f32 v208, v200, v201
    v_exp_f32 v203, v43
    v_mfma_f32_32x32x16_bf16 v[24:39], a[132:135], v[172:175], v[24:39]
    ds_read_b64_tr_b16 a[172:173], v227 offset:49152
    ds_read_b64_tr_b16 a[174:175], v227 offset:51200
    v_cvt_pk_bf16_f32 v120, v200, v201
    v_exp_f32 v204, v44
    v_mfma_f32_32x32x16_bf16 v[8:23], a[136:139], v[144:147], v[8:23]
    ds_read_b64_tr_b16 a[176:177], v224 offset:53248
    ds_read_b64_tr_b16 a[178:179], v224 offset:55296
    v_add_f32 v208, v208, v202
    v_exp_f32 v205, v45
    v_mfma_f32_32x32x16_bf16 v[24:39], a[136:139], v[176:179], v[24:39]
    ds_read_b64_tr_b16 a[180:181], v225 offset:53248
    ds_read_b64_tr_b16 a[182:183], v225 offset:55296
    v_add_f32 v208, v208, v203
    v_cvt_pk_bf16_f32 v121, v202, v203
    v_exp_f32 v206, v46
    v_mfma_f32_32x32x16_bf16 v[8:23], a[140:143], v[148:151], v[8:23]
    ds_read_b64_tr_b16 a[184:185], v226 offset:53248
    ds_read_b64_tr_b16 a[186:187], v226 offset:55296
    v_add_f32 v208, v208, v204
    v_exp_f32 v207, v47
    v_mfma_f32_32x32x16_bf16 v[24:39], a[140:143], v[180:183], v[24:39]
    ds_read_b64_tr_b16 a[188:189], v227 offset:53248
    ds_read_b64_tr_b16 a[190:191], v227 offset:55296
    v_add_f32 v208, v208, v205
    v_cvt_pk_bf16_f32 v122, v204, v205
    v_mfma_f32_32x32x16_bf16 v[8:23], a[144:147], v[152:155], v[8:23]
    v_exp_f32 v200, v48
    v_add_f32 v208, v208, v206
    v_exp_f32 v201, v49
    v_mfma_f32_32x32x16_bf16 v[24:39], a[144:147], v[184:187], v[24:39]
    v_add_f32 v208, v208, v207
    v_cvt_pk_bf16_f32 v123, v206, v207
    v_exp_f32 v202, v50
    v_add_f32 v208, v208, v200
    v_mfma_f32_32x32x16_bf16 v[8:23], a[148:151], v[156:159], v[8:23]
    v_exp_f32 v203, v51
    v_add_f32 v208, v208, v201
    v_cvt_pk_bf16_f32 v124, v200, v201
    v_mfma_f32_32x32x16_bf16 v[24:39], a[148:151], v[188:191], v[24:39]
    v_exp_f32 v204, v52
    v_add_f32 v208, v208, v202
    v_exp_f32 v205, v53
    v_mfma_f32_32x32x16_bf16 v[8:23], a[152:155], v[160:163], v[8:23]
    v_add_f32 v208, v208, v203
    v_cvt_pk_bf16_f32 v125, v202, v203
    v_exp_f32 v206, v54
    v_add_f32 v208, v208, v204
    v_mfma_f32_32x32x16_bf16 v[24:39], a[152:155], v[192:195], v[24:39]
    v_exp_f32 v207, v55
    v_add_f32 v208, v208, v205
    v_cvt_pk_bf16_f32 v126, v204, v205
    v_mfma_f32_32x32x16_bf16 v[8:23], a[156:159], v[164:167], v[8:23]
    v_exp_f32 v200, v56
    v_add_f32 v208, v208, v206
    v_exp_f32 v201, v57
    v_mfma_f32_32x32x16_bf16 v[24:39], a[156:159], v[196:199], v[24:39]
    s_waitcnt lgkmcnt(0)
    v_add_f32 v208, v208, v207
    v_cvt_pk_bf16_f32 v127, v206, v207
    v_exp_f32 v202, v58
    v_add_f32 v209, v200, v201
    v_mfma_f32_32x32x16_bf16 a[0:15], a[160:163], v[104:107], a[0:15]
    v_exp_f32 v203, v59
    v_cvt_pk_bf16_f32 v128, v200, v201
    v_exp_f32 v204, v60
    v_mfma_f32_32x32x16_bf16 a[16:31], a[160:163], v[112:115], a[16:31]
    ds_read_b128 a[128:131], v216 offset:8192
    ds_read_b128 a[132:135], v217 offset:8192
    v_add_f32 v209, v209, v202
    v_exp_f32 v205, v61
    v_mfma_f32_32x32x16_bf16 a[32:47], a[164:167], v[104:107], a[32:47]
    ds_read_b128 a[136:139], v218 offset:8192
    ds_read_b128 a[140:143], v219 offset:8192
    v_add_f32 v209, v209, v203
    v_cvt_pk_bf16_f32 v129, v202, v203
    v_mfma_f32_32x32x16_bf16 a[48:63], a[164:167], v[112:115], a[48:63]
    ds_read_b128 a[144:147], v220 offset:8192
    ds_read_b128 a[148:151], v221 offset:8192
    v_exp_f32 v206, v62
    v_add_f32 v209, v209, v204
    v_mfma_f32_32x32x16_bf16 a[64:79], a[168:171], v[104:107], a[64:79]
    ds_read_b128 a[152:155], v222 offset:8192
    ds_read_b128 a[156:159], v223 offset:8192
    v_exp_f32 v207, v63
    v_add_f32 v209, v209, v205
    v_cvt_pk_bf16_f32 v130, v204, v205
    v_mfma_f32_32x32x16_bf16 a[80:95], a[168:171], v[112:115], a[80:95]
    v_exp_f32 v200, v64
    v_add_f32 v209, v209, v206
    s_add_u32 m0, s33, 81920
    v_mfma_f32_32x32x16_bf16 a[96:111], a[172:175], v[104:107], a[96:111]
    buffer_load_dwordx4 v232, s[12:15], s35 offen offset:0 lds
    v_exp_f32 v201, v65
    v_add_f32 v209, v209, v207
    v_mfma_f32_32x32x16_bf16 a[112:127], a[172:175], v[112:115], a[112:127]
    v_cvt_pk_bf16_f32 v131, v206, v207
    v_exp_f32 v202, v66
    v_add_f32 v209, v209, v200
    v_mfma_f32_32x32x16_bf16 a[0:15], a[176:179], v[108:111], a[0:15]
    buffer_load_dwordx4 v232, s[12:15], s35 offen offset:1024 lds
    v_exp_f32 v203, v67
    v_add_f32 v209, v209, v201
    v_mfma_f32_32x32x16_bf16 a[16:31], a[176:179], v[116:119], a[16:31]
    v_cvt_pk_bf16_f32 v132, v200, v201
    v_exp_f32 v204, v68
    v_add_f32 v209, v209, v202
    v_mfma_f32_32x32x16_bf16 a[32:47], a[180:183], v[108:111], a[32:47]
    buffer_load_dwordx4 v232, s[12:15], s35 offen offset:2048 lds
    v_exp_f32 v205, v69
    v_add_f32 v209, v209, v203
    v_cvt_pk_bf16_f32 v133, v202, v203
    v_mfma_f32_32x32x16_bf16 a[48:63], a[180:183], v[116:119], a[48:63]
    v_exp_f32 v206, v70
    v_add_f32 v209, v209, v204
    v_exp_f32 v207, v71
    v_mfma_f32_32x32x16_bf16 a[64:79], a[184:187], v[108:111], a[64:79]
    buffer_load_dwordx4 v232, s[12:15], s35 offen offset:3072 lds
    v_add_f32 v209, v209, v205
    v_cvt_pk_bf16_f32 v134, v204, v205
    v_mfma_f32_32x32x16_bf16 a[80:95], a[184:187], v[116:119], a[80:95]
    v_add_f32 v209, v209, v206
    v_add_f32 v209, v209, v207
    v_cvt_pk_bf16_f32 v135, v206, v207
    v_max_f32 v212, v208, v209
    s_add_u32 s35, s35, 16384
    v_mfma_f32_32x32x16_bf16 a[96:111], a[188:191], v[108:111], a[96:111]
    buffer_load_dword v240, v236, s[92:95], s42 offen
    v_cmp_lt_f32 vcc, s37, v212
    s_add_u32 s42, s42, 0x100000
    v_mfma_f32_32x32x16_bf16 a[112:127], a[188:191], v[116:119], a[112:127]
    s_waitcnt lgkmcnt(0)
    s_cbranch_vccnz attn_kernel_slow_19
attn_kernel_ret_20:
    v_add_f32 v210, v210, v208
    v_add_f32 v211, v211, v209
    s_branch attn_loop
attn_tail:
    s_mov_b32 s39, 28672
    buffer_load_dwordx4 v[244:247], v233, s[20:23], s39 offen sc1
    ds_read_b64_tr_b16 a[160:161], v224 offset:49152
    ds_read_b64_tr_b16 a[162:163], v224 offset:51200
    ds_read_b64_tr_b16 a[164:165], v225 offset:49152
    ds_read_b64_tr_b16 a[166:167], v225 offset:51200
    ds_read_b64_tr_b16 a[168:169], v226 offset:49152
    ds_read_b64_tr_b16 a[170:171], v226 offset:51200
    ds_read_b64_tr_b16 a[172:173], v227 offset:49152
    ds_read_b64_tr_b16 a[174:175], v227 offset:51200
    ds_read_b64_tr_b16 a[176:177], v224 offset:53248
    ds_read_b64_tr_b16 a[178:179], v224 offset:55296
    ds_read_b64_tr_b16 a[180:181], v225 offset:53248
    ds_read_b64_tr_b16 a[182:183], v225 offset:55296
    ds_read_b64_tr_b16 a[184:185], v226 offset:53248
    ds_read_b64_tr_b16 a[186:187], v226 offset:55296
    ds_read_b64_tr_b16 a[188:189], v227 offset:53248
    ds_read_b64_tr_b16 a[190:191], v227 offset:55296
    s_waitcnt lgkmcnt(0)
    v_mfma_f32_32x32x16_bf16 a[0:15], a[160:163], v[104:107], a[0:15]
    v_exp_f32 v200, v40
    v_exp_f32 v201, v41
    v_exp_f32 v202, v42
    v_add_f32 v208, v200, v201
    v_mfma_f32_32x32x16_bf16 a[16:31], a[160:163], v[112:115], a[16:31]
    v_exp_f32 v203, v43
    v_cvt_pk_bf16_f32 v120, v200, v201
    v_exp_f32 v204, v44
    v_add_f32 v208, v208, v202
    v_exp_f32 v205, v45
    v_mfma_f32_32x32x16_bf16 a[32:47], a[164:167], v[104:107], a[32:47]
    v_add_f32 v208, v208, v203
    v_cvt_pk_bf16_f32 v121, v202, v203
    v_exp_f32 v206, v46
    v_add_f32 v208, v208, v204
    v_exp_f32 v207, v47
    v_add_f32 v208, v208, v205
    v_mfma_f32_32x32x16_bf16 a[48:63], a[164:167], v[112:115], a[48:63]
    v_cvt_pk_bf16_f32 v122, v204, v205
    v_exp_f32 v200, v48
    v_add_f32 v208, v208, v206
    v_exp_f32 v201, v49
    v_add_f32 v208, v208, v207
    v_mfma_f32_32x32x16_bf16 a[64:79], a[168:171], v[104:107], a[64:79]
    v_cvt_pk_bf16_f32 v123, v206, v207
    v_exp_f32 v202, v50
    v_add_f32 v208, v208, v200
    v_exp_f32 v203, v51
    v_add_f32 v208, v208, v201
    v_cvt_pk_bf16_f32 v124, v200, v201
    v_mfma_f32_32x32x16_bf16 a[80:95], a[168:171], v[112:115], a[80:95]
    v_exp_f32 v204, v52
    v_add_f32 v208, v208, v202
    v_exp_f32 v205, v53
    v_add_f32 v208, v208, v203
    v_cvt_pk_bf16_f32 v125, v202, v203
    v_mfma_f32_32x32x16_bf16 a[96:111], a[172:175], v[104:107], a[96:111]
    v_exp_f32 v206, v54
    v_add_f32 v208, v208, v204
    v_exp_f32 v207, v55
    v_add_f32 v208, v208, v205
    v_cvt_pk_bf16_f32 v126, v204, v205
    v_mfma_f32_32x32x16_bf16 a[112:127], a[172:175], v[112:115], a[112:127]
    v_exp_f32 v200, v56
    v_add_f32 v208, v208, v206
    v_exp_f32 v201, v57
    v_add_f32 v208, v208, v207
    v_cvt_pk_bf16_f32 v127, v206, v207
    v_exp_f32 v202, v58
    v_mfma_f32_32x32x16_bf16 a[0:15], a[176:179], v[108:111], a[0:15]
    v_add_f32 v209, v200, v201
    v_exp_f32 v203, v59
    v_cvt_pk_bf16_f32 v128, v200, v201
    v_exp_f32 v204, v60
    v_add_f32 v209, v209, v202
    v_mfma_f32_32x32x16_bf16 a[16:31], a[176:179], v[116:119], a[16:31]
    v_exp_f32 v205, v61
    v_add_f32 v209, v209, v203
    v_cvt_pk_bf16_f32 v129, v202, v203
    v_exp_f32 v206, v62
    v_add_f32 v209, v209, v204
    v_mfma_f32_32x32x16_bf16 a[32:47], a[180:183], v[108:111], a[32:47]
    v_exp_f32 v207, v63
    v_add_f32 v209, v209, v205
    v_cvt_pk_bf16_f32 v130, v204, v205
    v_exp_f32 v200, v64
    v_add_f32 v209, v209, v206
    v_exp_f32 v201, v65
    v_mfma_f32_32x32x16_bf16 a[48:63], a[180:183], v[116:119], a[48:63]
    v_add_f32 v209, v209, v207
    v_cvt_pk_bf16_f32 v131, v206, v207
    v_exp_f32 v202, v66
    v_add_f32 v209, v209, v200
    v_exp_f32 v203, v67
    v_mfma_f32_32x32x16_bf16 a[64:79], a[184:187], v[108:111], a[64:79]
    v_add_f32 v209, v209, v201
    v_cvt_pk_bf16_f32 v132, v200, v201
    v_exp_f32 v204, v68
    v_add_f32 v209, v209, v202
    v_exp_f32 v205, v69
    v_mfma_f32_32x32x16_bf16 a[80:95], a[184:187], v[116:119], a[80:95]
    v_add_f32 v209, v209, v203
    v_cvt_pk_bf16_f32 v133, v202, v203
    v_exp_f32 v206, v70
    v_add_f32 v209, v209, v204
    v_exp_f32 v207, v71
    v_add_f32 v209, v209, v205
    v_mfma_f32_32x32x16_bf16 a[96:111], a[188:191], v[108:111], a[96:111]
    v_cvt_pk_bf16_f32 v134, v204, v205
    v_add_f32 v209, v209, v206
    v_add_f32 v209, v209, v207
    v_cvt_pk_bf16_f32 v135, v206, v207
    v_max_f32 v212, v208, v209
    v_cmp_lt_f32 vcc, s37, v212
    v_mfma_f32_32x32x16_bf16 a[112:127], a[188:191], v[116:119], a[112:127]
    s_cbranch_vccnz attn_kernel_slow_21
attn_kernel_ret_22:
    v_add_f32 v210, v210, v208
    v_add_f32 v211, v211, v209
    ds_read_b64_tr_b16 a[160:161], v224 offset:57344
    ds_read_b64_tr_b16 a[162:163], v224 offset:59392
    ds_read_b64_tr_b16 a[164:165], v225 offset:57344
    ds_read_b64_tr_b16 a[166:167], v225 offset:59392
    ds_read_b64_tr_b16 a[168:169], v226 offset:57344
    ds_read_b64_tr_b16 a[170:171], v226 offset:59392
    ds_read_b64_tr_b16 a[172:173], v227 offset:57344
    ds_read_b64_tr_b16 a[174:175], v227 offset:59392
    ds_read_b64_tr_b16 a[176:177], v224 offset:61440
    ds_read_b64_tr_b16 a[178:179], v224 offset:63488
    ds_read_b64_tr_b16 a[180:181], v225 offset:61440
    ds_read_b64_tr_b16 a[182:183], v225 offset:63488
    ds_read_b64_tr_b16 a[184:185], v226 offset:61440
    ds_read_b64_tr_b16 a[186:187], v226 offset:63488
    ds_read_b64_tr_b16 a[188:189], v227 offset:61440
    ds_read_b64_tr_b16 a[190:191], v227 offset:63488
    s_waitcnt lgkmcnt(0)
    v_mfma_f32_32x32x16_bf16 a[0:15], a[160:163], v[120:123], a[0:15]
    v_mfma_f32_32x32x16_bf16 a[16:31], a[160:163], v[128:131], a[16:31]
    v_mfma_f32_32x32x16_bf16 a[32:47], a[164:167], v[120:123], a[32:47]
    v_mfma_f32_32x32x16_bf16 a[48:63], a[164:167], v[128:131], a[48:63]
    v_mfma_f32_32x32x16_bf16 a[64:79], a[168:171], v[120:123], a[64:79]
    v_mfma_f32_32x32x16_bf16 a[80:95], a[168:171], v[128:131], a[80:95]
    v_mfma_f32_32x32x16_bf16 a[96:111], a[172:175], v[120:123], a[96:111]
    v_mfma_f32_32x32x16_bf16 a[112:127], a[172:175], v[128:131], a[112:127]
    v_mfma_f32_32x32x16_bf16 a[0:15], a[176:179], v[124:127], a[0:15]
    v_mfma_f32_32x32x16_bf16 a[16:31], a[176:179], v[132:135], a[16:31]
    v_mfma_f32_32x32x16_bf16 a[32:47], a[180:183], v[124:127], a[32:47]
    v_mfma_f32_32x32x16_bf16 a[48:63], a[180:183], v[132:135], a[48:63]
    v_mfma_f32_32x32x16_bf16 a[64:79], a[184:187], v[124:127], a[64:79]
    v_mfma_f32_32x32x16_bf16 a[80:95], a[184:187], v[132:135], a[80:95]
    v_mfma_f32_32x32x16_bf16 a[96:111], a[188:191], v[124:127], a[96:111]
    v_mfma_f32_32x32x16_bf16 a[112:127], a[188:191], v[132:135], a[112:127]
    s_barrier
    v_mov_b32 v212, v210
    s_nop 1
    v_permlane32_swap_b32 v210, v212
    v_add_f32 v210, v210, v212
    v_rcp_f32 v210, v210
    v_mov_b32 v212, v211
    s_nop 1
    v_permlane32_swap_b32 v211, v212
    v_add_f32 v211, v211, v212
    v_rcp_f32 v211, v211
    s_add_u32 s39, s41, 0
    s_add_u32 s40, s41, 4096
    v_accvgpr_read_b32 v8, a0
    v_accvgpr_read_b32 v9, a1
    v_accvgpr_read_b32 v10, a2
    v_accvgpr_read_b32 v11, a3
    v_accvgpr_read_b32 v12, a4
    v_accvgpr_read_b32 v13, a5
    v_accvgpr_read_b32 v14, a6
    v_accvgpr_read_b32 v15, a7
    v_mul_f32 v8, v8, v210
    v_mul_f32 v9, v9, v210
    v_mul_f32 v10, v10, v210
    v_mul_f32 v11, v11, v210
    v_mul_f32 v12, v12, v210
    v_mul_f32 v13, v13, v210
    v_mul_f32 v14, v14, v210
    v_mul_f32 v15, v15, v210
    v_cvt_pk_bf16_f32 v16, v8, v9
    v_cvt_pk_bf16_f32 v17, v10, v11
    v_cvt_pk_bf16_f32 v18, v12, v13
    v_cvt_pk_bf16_f32 v19, v14, v15
    buffer_store_dwordx4 v[16:19], v233, s[20:23], s39 offen offset:0 sc1
    v_accvgpr_read_b32 v24, a8
    v_accvgpr_read_b32 v25, a9
    v_accvgpr_read_b32 v26, a10
    v_accvgpr_read_b32 v27, a11
    v_accvgpr_read_b32 v28, a12
    v_accvgpr_read_b32 v29, a13
    v_accvgpr_read_b32 v30, a14
    v_accvgpr_read_b32 v31, a15
    v_mul_f32 v24, v24, v210
    v_mul_f32 v25, v25, v210
    v_mul_f32 v26, v26, v210
    v_mul_f32 v27, v27, v210
    v_mul_f32 v28, v28, v210
    v_mul_f32 v29, v29, v210
    v_mul_f32 v30, v30, v210
    v_mul_f32 v31, v31, v210
    v_cvt_pk_bf16_f32 v32, v24, v25
    v_cvt_pk_bf16_f32 v33, v26, v27
    v_cvt_pk_bf16_f32 v34, v28, v29
    v_cvt_pk_bf16_f32 v35, v30, v31
    buffer_store_dwordx4 v[32:35], v233, s[20:23], s39 offen offset:1024 sc1
    v_accvgpr_read_b32 v40, a32
    v_accvgpr_read_b32 v41, a33
    v_accvgpr_read_b32 v42, a34
    v_accvgpr_read_b32 v43, a35
    v_accvgpr_read_b32 v44, a36
    v_accvgpr_read_b32 v45, a37
    v_accvgpr_read_b32 v46, a38
    v_accvgpr_read_b32 v47, a39
    v_mul_f32 v40, v40, v210
    v_mul_f32 v41, v41, v210
    v_mul_f32 v42, v42, v210
    v_mul_f32 v43, v43, v210
    v_mul_f32 v44, v44, v210
    v_mul_f32 v45, v45, v210
    v_mul_f32 v46, v46, v210
    v_mul_f32 v47, v47, v210
    v_cvt_pk_bf16_f32 v48, v40, v41
    v_cvt_pk_bf16_f32 v49, v42, v43
    v_cvt_pk_bf16_f32 v50, v44, v45
    v_cvt_pk_bf16_f32 v51, v46, v47
    buffer_store_dwordx4 v[48:51], v233, s[20:23], s39 offen offset:2048 sc1
    v_accvgpr_read_b32 v56, a40
    v_accvgpr_read_b32 v57, a41
    v_accvgpr_read_b32 v58, a42
    v_accvgpr_read_b32 v59, a43
    v_accvgpr_read_b32 v60, a44
    v_accvgpr_read_b32 v61, a45
    v_accvgpr_read_b32 v62, a46
    v_accvgpr_read_b32 v63, a47
    v_mul_f32 v56, v56, v210
    v_mul_f32 v57, v57, v210
    v_mul_f32 v58, v58, v210
    v_mul_f32 v59, v59, v210
    v_mul_f32 v60, v60, v210
    v_mul_f32 v61, v61, v210
    v_mul_f32 v62, v62, v210
    v_mul_f32 v63, v63, v210
    v_cvt_pk_bf16_f32 v64, v56, v57
    v_cvt_pk_bf16_f32 v65, v58, v59
    v_cvt_pk_bf16_f32 v66, v60, v61
    v_cvt_pk_bf16_f32 v67, v62, v63
    buffer_store_dwordx4 v[64:67], v233, s[20:23], s39 offen offset:3072 sc1
    v_accvgpr_read_b32 v8, a64
    v_accvgpr_read_b32 v9, a65
    v_accvgpr_read_b32 v10, a66
    v_accvgpr_read_b32 v11, a67
    v_accvgpr_read_b32 v12, a68
    v_accvgpr_read_b32 v13, a69
    v_accvgpr_read_b32 v14, a70
    v_accvgpr_read_b32 v15, a71
    v_mul_f32 v8, v8, v210
    v_mul_f32 v9, v9, v210
    v_mul_f32 v10, v10, v210
    v_mul_f32 v11, v11, v210
    v_mul_f32 v12, v12, v210
    v_mul_f32 v13, v13, v210
    v_mul_f32 v14, v14, v210
    v_mul_f32 v15, v15, v210
    v_cvt_pk_bf16_f32 v16, v8, v9
    v_cvt_pk_bf16_f32 v17, v10, v11
    v_cvt_pk_bf16_f32 v18, v12, v13
    v_cvt_pk_bf16_f32 v19, v14, v15
    buffer_store_dwordx4 v[16:19], v233, s[20:23], s40 offen offset:0 sc1
    v_accvgpr_read_b32 v24, a72
    v_accvgpr_read_b32 v25, a73
    v_accvgpr_read_b32 v26, a74
    v_accvgpr_read_b32 v27, a75
    v_accvgpr_read_b32 v28, a76
    v_accvgpr_read_b32 v29, a77
    v_accvgpr_read_b32 v30, a78
    v_accvgpr_read_b32 v31, a79
    v_mul_f32 v24, v24, v210
    v_mul_f32 v25, v25, v210
    v_mul_f32 v26, v26, v210
    v_mul_f32 v27, v27, v210
    v_mul_f32 v28, v28, v210
    v_mul_f32 v29, v29, v210
    v_mul_f32 v30, v30, v210
    v_mul_f32 v31, v31, v210
    v_cvt_pk_bf16_f32 v32, v24, v25
    v_cvt_pk_bf16_f32 v33, v26, v27
    v_cvt_pk_bf16_f32 v34, v28, v29
    v_cvt_pk_bf16_f32 v35, v30, v31
    buffer_store_dwordx4 v[32:35], v233, s[20:23], s40 offen offset:1024 sc1
    v_accvgpr_read_b32 v40, a96
    v_accvgpr_read_b32 v41, a97
    v_accvgpr_read_b32 v42, a98
    v_accvgpr_read_b32 v43, a99
    v_accvgpr_read_b32 v44, a100
    v_accvgpr_read_b32 v45, a101
    v_accvgpr_read_b32 v46, a102
    v_accvgpr_read_b32 v47, a103
    v_mul_f32 v40, v40, v210
    v_mul_f32 v41, v41, v210
    v_mul_f32 v42, v42, v210
    v_mul_f32 v43, v43, v210
    v_mul_f32 v44, v44, v210
    v_mul_f32 v45, v45, v210
    v_mul_f32 v46, v46, v210
    v_mul_f32 v47, v47, v210
    v_cvt_pk_bf16_f32 v48, v40, v41
    v_cvt_pk_bf16_f32 v49, v42, v43
    v_cvt_pk_bf16_f32 v50, v44, v45
    v_cvt_pk_bf16_f32 v51, v46, v47
    buffer_store_dwordx4 v[48:51], v233, s[20:23], s40 offen offset:2048 sc1
    v_accvgpr_read_b32 v56, a104
    v_accvgpr_read_b32 v57, a105
    v_accvgpr_read_b32 v58, a106
    v_accvgpr_read_b32 v59, a107
    v_accvgpr_read_b32 v60, a108
    v_accvgpr_read_b32 v61, a109
    v_accvgpr_read_b32 v62, a110
    v_accvgpr_read_b32 v63, a111
    v_mul_f32 v56, v56, v210
    v_mul_f32 v57, v57, v210
    v_mul_f32 v58, v58, v210
    v_mul_f32 v59, v59, v210
    v_mul_f32 v60, v60, v210
    v_mul_f32 v61, v61, v210
    v_mul_f32 v62, v62, v210
    v_mul_f32 v63, v63, v210
    v_cvt_pk_bf16_f32 v64, v56, v57
    v_cvt_pk_bf16_f32 v65, v58, v59
    v_cvt_pk_bf16_f32 v66, v60, v61
    v_cvt_pk_bf16_f32 v67, v62, v63
    buffer_store_dwordx4 v[64:67], v233, s[20:23], s40 offen offset:3072 sc1
    s_add_u32 s39, s41, 262144
    s_add_u32 s40, s41, 266240
    v_accvgpr_read_b32 v8, a16
    v_accvgpr_read_b32 v9, a17
    v_accvgpr_read_b32 v10, a18
    v_accvgpr_read_b32 v11, a19
    v_accvgpr_read_b32 v12, a20
    v_accvgpr_read_b32 v13, a21
    v_accvgpr_read_b32 v14, a22
    v_accvgpr_read_b32 v15, a23
    v_mul_f32 v8, v8, v211
    v_mul_f32 v9, v9, v211
    v_mul_f32 v10, v10, v211
    v_mul_f32 v11, v11, v211
    v_mul_f32 v12, v12, v211
    v_mul_f32 v13, v13, v211
    v_mul_f32 v14, v14, v211
    v_mul_f32 v15, v15, v211
    v_cvt_pk_bf16_f32 v16, v8, v9
    v_cvt_pk_bf16_f32 v17, v10, v11
    v_cvt_pk_bf16_f32 v18, v12, v13
    v_cvt_pk_bf16_f32 v19, v14, v15
    buffer_store_dwordx4 v[16:19], v233, s[20:23], s39 offen offset:0 sc1
    v_accvgpr_read_b32 v24, a24
    v_accvgpr_read_b32 v25, a25
    v_accvgpr_read_b32 v26, a26
    v_accvgpr_read_b32 v27, a27
    v_accvgpr_read_b32 v28, a28
    v_accvgpr_read_b32 v29, a29
    v_accvgpr_read_b32 v30, a30
    v_accvgpr_read_b32 v31, a31
    v_mul_f32 v24, v24, v211
    v_mul_f32 v25, v25, v211
    v_mul_f32 v26, v26, v211
    v_mul_f32 v27, v27, v211
    v_mul_f32 v28, v28, v211
    v_mul_f32 v29, v29, v211
    v_mul_f32 v30, v30, v211
    v_mul_f32 v31, v31, v211
    v_cvt_pk_bf16_f32 v32, v24, v25
    v_cvt_pk_bf16_f32 v33, v26, v27
    v_cvt_pk_bf16_f32 v34, v28, v29
    v_cvt_pk_bf16_f32 v35, v30, v31
    buffer_store_dwordx4 v[32:35], v233, s[20:23], s39 offen offset:1024 sc1
    v_accvgpr_read_b32 v40, a48
    v_accvgpr_read_b32 v41, a49
    v_accvgpr_read_b32 v42, a50
    v_accvgpr_read_b32 v43, a51
    v_accvgpr_read_b32 v44, a52
    v_accvgpr_read_b32 v45, a53
    v_accvgpr_read_b32 v46, a54
    v_accvgpr_read_b32 v47, a55
    v_mul_f32 v40, v40, v211
    v_mul_f32 v41, v41, v211
    v_mul_f32 v42, v42, v211
    v_mul_f32 v43, v43, v211
    v_mul_f32 v44, v44, v211
    v_mul_f32 v45, v45, v211
    v_mul_f32 v46, v46, v211
    v_mul_f32 v47, v47, v211
    v_cvt_pk_bf16_f32 v48, v40, v41
    v_cvt_pk_bf16_f32 v49, v42, v43
    v_cvt_pk_bf16_f32 v50, v44, v45
    v_cvt_pk_bf16_f32 v51, v46, v47
    buffer_store_dwordx4 v[48:51], v233, s[20:23], s39 offen offset:2048 sc1
    v_accvgpr_read_b32 v56, a56
    v_accvgpr_read_b32 v57, a57
    v_accvgpr_read_b32 v58, a58
    v_accvgpr_read_b32 v59, a59
    v_accvgpr_read_b32 v60, a60
    v_accvgpr_read_b32 v61, a61
    v_accvgpr_read_b32 v62, a62
    v_accvgpr_read_b32 v63, a63
    v_mul_f32 v56, v56, v211
    v_mul_f32 v57, v57, v211
    v_mul_f32 v58, v58, v211
    v_mul_f32 v59, v59, v211
    v_mul_f32 v60, v60, v211
    v_mul_f32 v61, v61, v211
    v_mul_f32 v62, v62, v211
    v_mul_f32 v63, v63, v211
    v_cvt_pk_bf16_f32 v64, v56, v57
    v_cvt_pk_bf16_f32 v65, v58, v59
    v_cvt_pk_bf16_f32 v66, v60, v61
    v_cvt_pk_bf16_f32 v67, v62, v63
    buffer_store_dwordx4 v[64:67], v233, s[20:23], s39 offen offset:3072 sc1
    v_accvgpr_read_b32 v8, a80
    v_accvgpr_read_b32 v9, a81
    v_accvgpr_read_b32 v10, a82
    v_accvgpr_read_b32 v11, a83
    v_accvgpr_read_b32 v12, a84
    v_accvgpr_read_b32 v13, a85
    v_accvgpr_read_b32 v14, a86
    v_accvgpr_read_b32 v15, a87
    v_mul_f32 v8, v8, v211
    v_mul_f32 v9, v9, v211
    v_mul_f32 v10, v10, v211
    v_mul_f32 v11, v11, v211
    v_mul_f32 v12, v12, v211
    v_mul_f32 v13, v13, v211
    v_mul_f32 v14, v14, v211
    v_mul_f32 v15, v15, v211
    v_cvt_pk_bf16_f32 v16, v8, v9
    v_cvt_pk_bf16_f32 v17, v10, v11
    v_cvt_pk_bf16_f32 v18, v12, v13
    v_cvt_pk_bf16_f32 v19, v14, v15
    buffer_store_dwordx4 v[16:19], v233, s[20:23], s40 offen offset:0 sc1
    v_accvgpr_read_b32 v24, a88
    v_accvgpr_read_b32 v25, a89
    v_accvgpr_read_b32 v26, a90
    v_accvgpr_read_b32 v27, a91
    v_accvgpr_read_b32 v28, a92
    v_accvgpr_read_b32 v29, a93
    v_accvgpr_read_b32 v30, a94
    v_accvgpr_read_b32 v31, a95
    v_mul_f32 v24, v24, v211
    v_mul_f32 v25, v25, v211
    v_mul_f32 v26, v26, v211
    v_mul_f32 v27, v27, v211
    v_mul_f32 v28, v28, v211
    v_mul_f32 v29, v29, v211
    v_mul_f32 v30, v30, v211
    v_mul_f32 v31, v31, v211
    v_cvt_pk_bf16_f32 v32, v24, v25
    v_cvt_pk_bf16_f32 v33, v26, v27
    v_cvt_pk_bf16_f32 v34, v28, v29
    v_cvt_pk_bf16_f32 v35, v30, v31
    buffer_store_dwordx4 v[32:35], v233, s[20:23], s40 offen offset:1024 sc1
    v_accvgpr_read_b32 v40, a112
    v_accvgpr_read_b32 v41, a113
    v_accvgpr_read_b32 v42, a114
    v_accvgpr_read_b32 v43, a115
    v_accvgpr_read_b32 v44, a116
    v_accvgpr_read_b32 v45, a117
    v_accvgpr_read_b32 v46, a118
    v_accvgpr_read_b32 v47, a119
    v_mul_f32 v40, v40, v211
    v_mul_f32 v41, v41, v211
    v_mul_f32 v42, v42, v211
    v_mul_f32 v43, v43, v211
    v_mul_f32 v44, v44, v211
    v_mul_f32 v45, v45, v211
    v_mul_f32 v46, v46, v211
    v_mul_f32 v47, v47, v211
    v_cvt_pk_bf16_f32 v48, v40, v41
    v_cvt_pk_bf16_f32 v49, v42, v43
    v_cvt_pk_bf16_f32 v50, v44, v45
    v_cvt_pk_bf16_f32 v51, v46, v47
    buffer_store_dwordx4 v[48:51], v233, s[20:23], s40 offen offset:2048 sc1
    v_accvgpr_read_b32 v56, a120
    v_accvgpr_read_b32 v57, a121
    v_accvgpr_read_b32 v58, a122
    v_accvgpr_read_b32 v59, a123
    v_accvgpr_read_b32 v60, a124
    v_accvgpr_read_b32 v61, a125
    v_accvgpr_read_b32 v62, a126
    v_accvgpr_read_b32 v63, a127
    v_mul_f32 v56, v56, v211
    v_mul_f32 v57, v57, v211
    v_mul_f32 v58, v58, v211
    v_mul_f32 v59, v59, v211
    v_mul_f32 v60, v60, v211
    v_mul_f32 v61, v61, v211
    v_mul_f32 v62, v62, v211
    v_mul_f32 v63, v63, v211
    v_cvt_pk_bf16_f32 v64, v56, v57
    v_cvt_pk_bf16_f32 v65, v58, v59
    v_cvt_pk_bf16_f32 v66, v60, v61
    v_cvt_pk_bf16_f32 v67, v62, v63
    buffer_store_dwordx4 v[64:67], v233, s[20:23], s40 offen offset:3072 sc1
    s_mov_b32 s12, s26
    s_and_b32 s13, s27, 0xffff
    s_mov_b32 s14, 67108864
    s_mov_b32 s15, 0x00020000
    s_lshl_b32 s46, s29, 2
    s_add_u32 s46, s46, s32
    s_lshl_b32 s46, s46, 7
    s_lshl_b32 s3, s28, 2
    s_add_u32 s46, s46, s3
    s_add_u32 s46, s46, 24576
    s_waitcnt vmcnt(16)
    s_mov_b32 s48, 0x40000
attn_fc:
    v_min_u32 v244, v244, v245
    v_min3_u32 v244, v244, v246, v247
    v_cmp_eq_u32 vcc, 0, v244
    s_nop 0
    s_cbranch_vccz attn_fc_go
    s_sleep 2
    s_mov_b32 s39, 28672
    buffer_load_dwordx4 v[244:247], v233, s[20:23], s39 offen sc1
    s_waitcnt vmcnt(0)
    s_sub_u32 s48, s48, 1
    s_cmp_lg_u32 s48, 0
    s_cbranch_scc1 attn_fc
attn_fc_go:
    s_and_b32 s50, s2, 3
    s_mul_i32 s50, s50, 28
    s_lshr_b32 s3, s2, 3
    s_add_u32 s50, s50, s3
    s_lshr_b32 s51, s50, 3
    s_cmp_ge_u32 s3, 28
    s_cselect_b32 s51, 14, s51
    s_and_b32 s50, s50, 7
    s_bfe_u32 s3, s2, 0x10002
    s_lshl_b32 s3, s3, 3
    s_add_u32 s50, s50, s3
    s_waitcnt vmcnt(0)
    v_mov_b32 v244, 0
    v_mov_b32 v245, 1
    s_mov_b64 exec, 1
    buffer_store_dword v245, v244, s[12:15], s46 offen sc1
    s_mov_b64 exec, -1
    v_mbcnt_lo_u32_b32 v252, -1, 0
    v_mbcnt_hi_u32_b32 v252, -1, v252
    v_lshrrev_b32 v253, 3, v252
    v_lshlrev_b32 v251, 1, v253
    v_and_b32 v251, 4, v251
    v_and_b32 v252, 7, v252
    v_xor_b32 v251, v251, v252
    v_lshlrev_b32 v251, 4, v251
    v_lshl_add_u32 v251, v253, 7, v251
    s_lshl_b32 s49, s32, 15
    s_and_b32 s55, s2, 1
    s_lshl_b32 s55, s55, 2
    s_lshr_b32 s47, s2, 6
    s_add_u32 s55, s55, s47
    s_lshl_b32 s55, s55, 19
    s_mul_i32 s47, s32, 131072
    s_add_u32 s55, s55, s47
    s_add_u32 s55, s55, 33554432
    s_add_u32 m0, s49, 0
    s_nop 0
    buffer_load_dwordx4 v251, s[12:15], s55 offen sc1 lds
    buffer_load_dwordx4 v251, s[12:15], s55 offen offset:1024 sc1 lds
    s_add_u32 s55, s55, 2048
    s_add_u32 m0, s49, 2048
    s_nop 0
    buffer_load_dwordx4 v251, s[12:15], s55 offen sc1 lds
    buffer_load_dwordx4 v251, s[12:15], s55 offen offset:1024 sc1 lds
    s_add_u32 s55, s55, 2048
    s_add_u32 m0, s49, 4096
    s_nop 0
    buffer_load_dwordx4 v251, s[12:15], s55 offen sc1 lds
    buffer_load_dwordx4 v251, s[12:15], s55 offen offset:1024 sc1 lds
    s_add_u32 s55, s55, 2048
    s_add_u32 m0, s49, 6144
    s_nop 0
    buffer_load_dwordx4 v251, s[12:15], s55 offen sc1 lds
    buffer_load_dwordx4 v251, s[12:15], s55 offen offset:1024 sc1 lds
    s_add_u32 s55, s55, 2048
    s_add_u32 m0, s49, 8192
    s_nop 0
    buffer_load_dwordx4 v251, s[12:15], s55 offen sc1 lds
    buffer_load_dwordx4 v251, s[12:15], s55 offen offset:1024 sc1 lds
    s_add_u32 s55, s55, 2048
    s_add_u32 m0, s49, 10240
    s_nop 0
    buffer_load_dwordx4 v251, s[12:15], s55 offen sc1 lds
    buffer_load_dwordx4 v251, s[12:15], s55 offen offset:1024 sc1 lds
    s_add_u32 s55, s55, 2048
    s_add_u32 m0, s49, 12288
    s_nop 0
    buffer_load_dwordx4 v251, s[12:15], s55 offen sc1 lds
    buffer_load_dwordx4 v251, s[12:15], s55 offen offset:1024 sc1 lds
    s_add_u32 s55, s55, 2048
    s_add_u32 m0, s49, 14336
    s_nop 0
    buffer_load_dwordx4 v251, s[12:15], s55 offen sc1 lds
    buffer_load_dwordx4 v251, s[12:15], s55 offen offset:1024 sc1 lds
    s_add_u32 s55, s55, 2048
    s_add_u32 m0, s49, 16384
    s_nop 0
    buffer_load_dwordx4 v251, s[12:15], s55 offen sc1 lds
    buffer_load_dwordx4 v251, s[12:15], s55 offen offset:1024 sc1 lds
    s_add_u32 s55, s55, 2048
    s_add_u32 m0, s49, 18432
    s_nop 0
    buffer_load_dwordx4 v251, s[12:15], s55 offen sc1 lds
    buffer_load_dwordx4 v251, s[12:15], s55 offen offset:1024 sc1 lds
    s_add_u32 s55, s55, 2048
    s_add_u32 m0, s49, 20480
    s_nop 0
    buffer_load_dwordx4 v251, s[12:15], s55 offen sc1 lds
    buffer_load_dwordx4 v251, s[12:15], s55 offen offset:1024 sc1 lds
    s_add_u32 s55, s55, 2048
    s_add_u32 m0, s49, 22528
    s_nop 0
    buffer_load_dwordx4 v251, s[12:15], s55 offen sc1 lds
    buffer_load_dwordx4 v251, s[12:15], s55 offen offset:1024 sc1 lds
    s_add_u32 s55, s55, 2048
    s_add_u32 m0, s49, 24576
    s_nop 0
    buffer_load_dwordx4 v251, s[12:15], s55 offen sc1 lds
    buffer_load_dwordx4 v251, s[12:15], s55 offen offset:1024 sc1 lds
    s_add_u32 s55, s55, 2048
    s_add_u32 m0, s49, 26624
    s_nop 0
    buffer_load_dwordx4 v251, s[12:15], s55 offen sc1 lds
    buffer_load_dwordx4 v251, s[12:15], s55 offen offset:1024 sc1 lds
    s_add_u32 s55, s55, 2048
    s_add_u32 m0, s49, 28672
    s_nop 0
    buffer_load_dwordx4 v251, s[12:15], s55 offen sc1 lds
    buffer_load_dwordx4 v251, s[12:15], s55 offen offset:1024 sc1 lds
    s_add_u32 s55, s55, 2048
    s_bfe_u32 s28, s2, 0x20001
    s_lshl_b32 s28, s28, 3
    s_bfe_u32 s30, s2, 0x30003
    s_add_u32 s28, s28, s30
    s_and_b32 s29, s2, 1
    s_lshl_b32 s29, s29, 2
    s_lshr_b32 s30, s2, 6
    s_add_u32 s29, s29, s30
    v_mbcnt_lo_u32_b32 v2, -1, 0
    v_mbcnt_hi_u32_b32 v2, -1, v2
    v_lshlrev_b32 v216, 4, v2
    s_mul_i32 s33, s28, 524288
    s_mul_i32 s35, s32, 65536
    s_add_u32 s33, s33, s35
    s_add_u32 s33, s33, 4194304
    s_add_u32 s39, s33, 262144
    s_lshr_b32 s40, s32, 1
    s_and_b32 s47, s32, 1
    s_lshl_b32 s41, s29, 6
    s_lshl_b32 s42, s40, 5
    s_add_u32 s41, s41, s42
    s_lshl_b32 s42, s28, 6
    s_lshl_b32 s43, s47, 5
    s_add_u32 s42, s42, s43
    v_lshrrev_b32 v4, 5, v2
    v_and_b32 v5, 31, v2
    v_add_u32 v6, s42, v5
    v_lshlrev_b32 v6, 10, v6
    v_lshl_add_u32 v6, v4, 4, v6
    s_lshl_b32 s43, s41, 1
    v_add_u32 v6, s43, v6
    s_lshl_b32 s43, s42, 10
    s_lshl_b32 s44, s41, 6
    s_add_u32 s43, s43, s44
    s_add_u32 s43, s43, 20971520
    v_lshlrev_b32 v7, 5, v4
    s_lshl_b32 s44, s41, 2
    s_add_u32 s44, s44, 4096
    s_mov_b32 s16, s60
    s_and_b32 s17, s61, 0xffff
    s_mov_b32 s18, 2097152
    s_mov_b32 s19, 0x00020000
    buffer_load_dwordx4 v[220:223], v7, s[12:15], s44 offen offset:0
    buffer_load_dwordx4 v[224:227], v7, s[12:15], s44 offen offset:16
    buffer_load_dwordx4 v[236:239], v6, s[16:19], 0 offen offset:0
    buffer_load_dwordx4 v[228:231], v7, s[12:15], s44 offen offset:64
    buffer_load_dwordx4 v[232:235], v7, s[12:15], s44 offen offset:80
    buffer_load_dwordx4 v[240:243], v6, s[16:19], 0 offen offset:32
    v_bfe_u32 v3, v2, 2, 2
    v_lshl_add_u32 v1, v4, 3, v3
    v_lshlrev_b32 v1, 7, v1
    v_bfe_u32 v218, v2, 4, 1
    v_lshl_add_u32 v1, v218, 5, v1
    v_and_b32 v218, 1, v2
    v_lshl_add_u32 v1, v218, 4, v1
    v_bfe_u32 v218, v2, 1, 1
    v_lshl_add_u32 v1, v218, 3, v1
    v_add_u32 v1, s49, v1
    v_lshrrev_b32 v3, 1, v3
    v_lshl_add_u32 v218, v3, 6, v1
    v_xor_b32 v3, 1, v3
    v_lshl_add_u32 v219, v3, 6, v1
    v_mov_b32 v8, 0
    v_mov_b32 v9, 0
    v_mov_b32 v10, 0
    v_mov_b32 v11, 0
    v_mov_b32 v12, 0
    v_mov_b32 v13, 0
    v_mov_b32 v14, 0
    v_mov_b32 v15, 0
    v_mov_b32 v16, 0
    v_mov_b32 v17, 0
    v_mov_b32 v18, 0
    v_mov_b32 v19, 0
    v_mov_b32 v20, 0
    v_mov_b32 v21, 0
    v_mov_b32 v22, 0
    v_mov_b32 v23, 0
    v_mov_b32 v24, 0
    v_mov_b32 v25, 0
    v_mov_b32 v26, 0
    v_mov_b32 v27, 0
    v_mov_b32 v28, 0
    v_mov_b32 v29, 0
    v_mov_b32 v30, 0
    v_mov_b32 v31, 0
    v_mov_b32 v32, 0
    v_mov_b32 v33, 0
    v_mov_b32 v34, 0
    v_mov_b32 v35, 0
    v_mov_b32 v36, 0
    v_mov_b32 v37, 0
    v_mov_b32 v38, 0
    v_mov_b32 v39, 0
    v_mov_b32 v40, 0
    v_mov_b32 v41, 0
    v_mov_b32 v42, 0
    v_mov_b32 v43, 0
    v_mov_b32 v44, 0
    v_mov_b32 v45, 0
    v_mov_b32 v46, 0
    v_mov_b32 v47, 0
    v_mov_b32 v48, 0
    v_mov_b32 v49, 0
    v_mov_b32 v50, 0
    v_mov_b32 v51, 0
    v_mov_b32 v52, 0
    v_mov_b32 v53, 0
    v_mov_b32 v54, 0
    v_mov_b32 v55, 0
    v_mov_b32 v56, 0
    v_mov_b32 v57, 0
    v_mov_b32 v58, 0
    v_mov_b32 v59, 0
    v_mov_b32 v60, 0
    v_mov_b32 v61, 0
    v_mov_b32 v62, 0
    v_mov_b32 v63, 0
    v_mov_b32 v64, 0
    v_mov_b32 v65, 0
    v_mov_b32 v66, 0
    v_mov_b32 v67, 0
    v_mov_b32 v68, 0
    v_mov_b32 v69, 0
    v_mov_b32 v70, 0
    v_mov_b32 v71, 0
    s_mov_b32 s38, 3
    s_lshl_b32 s45, s28, 7
    s_add_u32 s45, s45, 24576
    s_cmp_lg_u32 s32, 0
    s_cbranch_scc1 pa_go
    v_min_u32 v246, 31, v2
    v_lshlrev_b32 v246, 2, v246
    s_mov_b32 s48, 0x40000
pa_poll:
    buffer_load_dword v247, v246, s[12:15], s45 offen sc1
    s_waitcnt vmcnt(0)
    v_cmp_eq_u32 vcc, 0, v247
    s_nop 0
    s_cbranch_vccz pa_go
    s_sleep 2
    s_sub_u32 s48, s48, 1
    s_cmp_lg_u32 s48, 0
    s_cbranch_scc1 pa_poll
pa_go:
    s_waitcnt vmcnt(0)
    s_barrier
    buffer_load_dwordx4 v[72:75], v216, s[12:15], s33 offen offset:0 sc1
    buffer_load_dwordx4 v[76:79], v216, s[12:15], s39 offen offset:0 sc1
    buffer_load_dwordx4 v[80:83], v216, s[12:15], s33 offen offset:1024 sc1
    buffer_load_dwordx4 v[84:87], v216, s[12:15], s39 offen offset:1024 sc1
    s_add_u32 s33, s33, 2048
    s_add_u32 s39, s39, 2048
    buffer_load_dwordx4 v[88:91], v216, s[12:15], s33 offen offset:0 sc1
    buffer_load_dwordx4 v[92:95], v216, s[12:15], s39 offen offset:0 sc1
    buffer_load_dwordx4 v[96:99], v216, s[12:15], s33 offen offset:1024 sc1
    buffer_load_dwordx4 v[100:103], v216, s[12:15], s39 offen offset:1024 sc1
    s_add_u32 s33, s33, 2048
    s_add_u32 s39, s39, 2048
    buffer_load_dwordx4 v[104:107], v216, s[12:15], s33 offen offset:0 sc1
    buffer_load_dwordx4 v[108:111], v216, s[12:15], s39 offen offset:0 sc1
    buffer_load_dwordx4 v[112:115], v216, s[12:15], s33 offen offset:1024 sc1
    buffer_load_dwordx4 v[116:119], v216, s[12:15], s39 offen offset:1024 sc1
    s_add_u32 s33, s33, 2048
    s_add_u32 s39, s39, 2048
    buffer_load_dwordx4 v[120:123], v216, s[12:15], s33 offen offset:0 sc1
    buffer_load_dwordx4 v[124:127], v216, s[12:15], s39 offen offset:0 sc1
    buffer_load_dwordx4 v[128:131], v216, s[12:15], s33 offen offset:1024 sc1
    buffer_load_dwordx4 v[132:135], v216, s[12:15], s39 offen offset:1024 sc1
    s_add_u32 s33, s33, 2048
    s_add_u32 s39, s39, 2048
    buffer_load_dwordx4 v[136:139], v216, s[12:15], s33 offen offset:0 sc1
    buffer_load_dwordx4 v[140:143], v216, s[12:15], s39 offen offset:0 sc1
    buffer_load_dwordx4 v[144:147], v216, s[12:15], s33 offen offset:1024 sc1
    buffer_load_dwordx4 v[148:151], v216, s[12:15], s39 offen offset:1024 sc1
    s_add_u32 s33, s33, 2048
    s_add_u32 s39, s39, 2048
    buffer_load_dwordx4 v[152:155], v216, s[12:15], s33 offen offset:0 sc1
    buffer_load_dwordx4 v[156:159], v216, s[12:15], s39 offen offset:0 sc1
    buffer_load_dwordx4 v[160:163], v216, s[12:15], s33 offen offset:1024 sc1
    buffer_load_dwordx4 v[164:167], v216, s[12:15], s39 offen offset:1024 sc1
    s_add_u32 s33, s33, 2048
    s_add_u32 s39, s39, 2048
    buffer_load_dwordx4 v[168:171], v216, s[12:15], s33 offen offset:0 sc1
    buffer_load_dwordx4 v[172:175], v216, s[12:15], s39 offen offset:0 sc1
    buffer_load_dwordx4 v[176:179], v216, s[12:15], s33 offen offset:1024 sc1
    buffer_load_dwordx4 v[180:183], v216, s[12:15], s39 offen offset:1024 sc1
    s_add_u32 s33, s33, 2048
    s_add_u32 s39, s39, 2048
    buffer_load_dwordx4 v[184:187], v216, s[12:15], s33 offen offset:0 sc1
    buffer_load_dwordx4 v[188:191], v216, s[12:15], s39 offen offset:0 sc1
    s_waitcnt vmcnt(28)
    ds_read_b64_tr_b16 v[200:201], v218 offset:0
    ds_read_b64_tr_b16 v[202:203], v218 offset:512
    ds_read_b64_tr_b16 v[204:205], v219 offset:0
    ds_read_b64_tr_b16 v[206:207], v219 offset:512
    s_waitcnt lgkmcnt(0)
    v_mfma_f32_32x32x16_bf16 v[8:23], v[200:203], v[72:75], v[8:23]
    s_waitcnt vmcnt(26)
    ds_read_b64_tr_b16 v[208:209], v218 offset:2048
    ds_read_b64_tr_b16 v[210:211], v218 offset:2560
    ds_read_b64_tr_b16 v[212:213], v219 offset:2048
    ds_read_b64_tr_b16 v[214:215], v219 offset:2560
    s_add_u32 m0, s49, 30720
    v_mfma_f32_32x32x16_bf16 v[24:39], v[200:203], v[76:79], v[24:39]
    buffer_load_dwordx4 v[192:195], v216, s[12:15], s33 offen offset:1024 sc1
    buffer_load_dwordx4 v251, s[12:15], s55 offen sc1 lds
    v_mfma_f32_32x32x16_bf16 v[40:55], v[204:207], v[72:75], v[40:55]
    buffer_load_dwordx4 v251, s[12:15], s55 offen offset:1024 sc1 lds
    buffer_load_dwordx4 v[196:199], v216, s[12:15], s39 offen offset:1024 sc1
    s_add_u32 s55, s55, 2048
    s_add_u32 s33, s33, 2048
    s_add_u32 s39, s39, 2048
    v_mfma_f32_32x32x16_bf16 v[56:71], v[204:207], v[76:79], v[56:71]
    s_waitcnt lgkmcnt(0)
    v_mfma_f32_32x32x16_bf16 v[8:23], v[208:211], v[80:83], v[8:23]
    s_waitcnt vmcnt(28)
    ds_read_b64_tr_b16 v[200:201], v218 offset:4096
    ds_read_b64_tr_b16 v[202:203], v218 offset:4608
    ds_read_b64_tr_b16 v[204:205], v219 offset:4096
    ds_read_b64_tr_b16 v[206:207], v219 offset:4608
    s_add_u32 m0, s49, 0
    v_mfma_f32_32x32x16_bf16 v[24:39], v[208:211], v[84:87], v[24:39]
    buffer_load_dwordx4 v[72:75], v216, s[12:15], s33 offen offset:0 sc1
    buffer_load_dwordx4 v251, s[12:15], s55 offen sc1 lds
    v_mfma_f32_32x32x16_bf16 v[40:55], v[212:215], v[80:83], v[40:55]
    buffer_load_dwordx4 v251, s[12:15], s55 offen offset:1024 sc1 lds
    buffer_load_dwordx4 v[76:79], v216, s[12:15], s39 offen offset:0 sc1
    s_add_u32 s55, s55, 2048
    v_mfma_f32_32x32x16_bf16 v[56:71], v[212:215], v[84:87], v[56:71]
    s_waitcnt lgkmcnt(0)
    v_mfma_f32_32x32x16_bf16 v[8:23], v[200:203], v[88:91], v[8:23]
    s_waitcnt vmcnt(30)
    ds_read_b64_tr_b16 v[208:209], v218 offset:6144
    ds_read_b64_tr_b16 v[210:211], v218 offset:6656
    ds_read_b64_tr_b16 v[212:213], v219 offset:6144
    ds_read_b64_tr_b16 v[214:215], v219 offset:6656
    s_add_u32 m0, s49, 2048
    v_mfma_f32_32x32x16_bf16 v[24:39], v[200:203], v[92:95], v[24:39]
    buffer_load_dwordx4 v[80:83], v216, s[12:15], s33 offen offset:1024 sc1
    buffer_load_dwordx4 v251, s[12:15], s55 offen sc1 lds
    v_mfma_f32_32x32x16_bf16 v[40:55], v[204:207], v[88:91], v[40:55]
    buffer_load_dwordx4 v251, s[12:15], s55 offen offset:1024 sc1 lds
    buffer_load_dwordx4 v[84:87], v216, s[12:15], s39 offen offset:1024 sc1
    s_add_u32 s55, s55, 2048
    s_add_u32 s33, s33, 2048
    s_add_u32 s39, s39, 2048
    v_mfma_f32_32x32x16_bf16 v[56:71], v[204:207], v[92:95], v[56:71]
    s_waitcnt lgkmcnt(0)
    v_mfma_f32_32x32x16_bf16 v[8:23], v[208:211], v[96:99], v[8:23]
    s_waitcnt vmcnt(32)
    ds_read_b64_tr_b16 v[200:201], v218 offset:8192
    ds_read_b64_tr_b16 v[202:203], v218 offset:8704
    ds_read_b64_tr_b16 v[204:205], v219 offset:8192
    ds_read_b64_tr_b16 v[206:207], v219 offset:8704
    s_add_u32 m0, s49, 4096
    v_mfma_f32_32x32x16_bf16 v[24:39], v[208:211], v[100:103], v[24:39]
    buffer_load_dwordx4 v[88:91], v216, s[12:15], s33 offen offset:0 sc1
    buffer_load_dwordx4 v251, s[12:15], s55 offen sc1 lds
    v_mfma_f32_32x32x16_bf16 v[40:55], v[212:215], v[96:99], v[40:55]
    buffer_load_dwordx4 v251, s[12:15], s55 offen offset:1024 sc1 lds
    buffer_load_dwordx4 v[92:95], v216, s[12:15], s39 offen offset:0 sc1
    s_add_u32 s55, s55, 2048
    v_mfma_f32_32x32x16_bf16 v[56:71], v[212:215], v[100:103], v[56:71]
    s_waitcnt lgkmcnt(0)
    v_mfma_f32_32x32x16_bf16 v[8:23], v[200:203], v[104:107], v[8:23]
    s_waitcnt vmcnt(34)
    ds_read_b64_tr_b16 v[208:209], v218 offset:10240
    ds_read_b64_tr_b16 v[210:211], v218 offset:10752
    ds_read_b64_tr_b16 v[212:213], v219 offset:10240
    ds_read_b64_tr_b16 v[214:215], v219 offset:10752
    s_add_u32 m0, s49, 6144
    v_mfma_f32_32x32x16_bf16 v[24:39], v[200:203], v[108:111], v[24:39]
    buffer_load_dwordx4 v[96:99], v216, s[12:15], s33 offen offset:1024 sc1
    buffer_load_dwordx4 v251, s[12:15], s55 offen sc1 lds
    v_mfma_f32_32x32x16_bf16 v[40:55], v[204:207], v[104:107], v[40:55]
    buffer_load_dwordx4 v251, s[12:15], s55 offen offset:1024 sc1 lds
    buffer_load_dwordx4 v[100:103], v216, s[12:15], s39 offen offset:1024 sc1
    s_add_u32 s55, s55, 2048
    s_add_u32 s33, s33, 2048
    s_add_u32 s39, s39, 2048
    v_mfma_f32_32x32x16_bf16 v[56:71], v[204:207], v[108:111], v[56:71]
    s_waitcnt lgkmcnt(0)
    v_mfma_f32_32x32x16_bf16 v[8:23], v[208:211], v[112:115], v[8:23]
    s_waitcnt vmcnt(36)
    ds_read_b64_tr_b16 v[200:201], v218 offset:12288
    ds_read_b64_tr_b16 v[202:203], v218 offset:12800
    ds_read_b64_tr_b16 v[204:205], v219 offset:12288
    ds_read_b64_tr_b16 v[206:207], v219 offset:12800
    s_add_u32 m0, s49, 8192
    v_mfma_f32_32x32x16_bf16 v[24:39], v[208:211], v[116:119], v[24:39]
    buffer_load_dwordx4 v[104:107], v216, s[12:15], s33 offen offset:0 sc1
    buffer_load_dwordx4 v251, s[12:15], s55 offen sc1 lds
    v_mfma_f32_32x32x16_bf16 v[40:55], v[212:215], v[112:115], v[40:55]
    buffer_load_dwordx4 v251, s[12:15], s55 offen offset:1024 sc1 lds
    buffer_load_dwordx4 v[108:111], v216, s[12:15], s39 offen offset:0 sc1
    s_add_u32 s55, s55, 2048
    v_mfma_f32_32x32x16_bf16 v[56:71], v[212:215], v[116:119], v[56:71]
    s_waitcnt lgkmcnt(0)
    v_mfma_f32_32x32x16_bf16 v[8:23], v[200:203], v[120:123], v[8:23]
    s_waitcnt vmcnt(38)
    ds_read_b64_tr_b16 v[208:209], v218 offset:14336
    ds_read_b64_tr_b16 v[210:211], v218 offset:14848
    ds_read_b64_tr_b16 v[212:213], v219 offset:14336
    ds_read_b64_tr_b16 v[214:215], v219 offset:14848
    s_add_u32 m0, s49, 10240
    v_mfma_f32_32x32x16_bf16 v[24:39], v[200:203], v[124:127], v[24:39]
    buffer_load_dwordx4 v[112:115], v216, s[12:15], s33 offen offset:1024 sc1
    buffer_load_dwordx4 v251, s[12:15], s55 offen sc1 lds
    v_mfma_f32_32x32x16_bf16 v[40:55], v[204:207], v[120:123], v[40:55]
    buffer_load_dwordx4 v251, s[12:15], s55 offen offset:1024 sc1 lds
    buffer_load_dwordx4 v[116:119], v216, s[12:15], s39 offen offset:1024 sc1
    s_add_u32 s55, s55, 2048
    s_add_u32 s33, s33, 2048
    s_add_u32 s39, s39, 2048
    v_mfma_f32_32x32x16_bf16 v[56:71], v[204:207], v[124:127], v[56:71]
    s_waitcnt lgkmcnt(0)
    v_mfma_f32_32x32x16_bf16 v[8:23], v[208:211], v[128:131], v[8:23]
    s_waitcnt vmcnt(40)
    ds_read_b64_tr_b16 v[200:201], v218 offset:16384
    ds_read_b64_tr_b16 v[202:203], v218 offset:16896
    ds_read_b64_tr_b16 v[204:205], v219 offset:16384
    ds_read_b64_tr_b16 v[206:207], v219 offset:16896
    s_add_u32 m0, s49, 12288
    v_mfma_f32_32x32x16_bf16 v[24:39], v[208:211], v[132:135], v[24:39]
    buffer_load_dwordx4 v[120:123], v216, s[12:15], s33 offen offset:0 sc1
    buffer_load_dwordx4 v251, s[12:15], s55 offen sc1 lds
    v_mfma_f32_32x32x16_bf16 v[40:55], v[212:215], v[128:131], v[40:55]
    buffer_load_dwordx4 v251, s[12:15], s55 offen offset:1024 sc1 lds
    buffer_load_dwordx4 v[124:127], v216, s[12:15], s39 offen offset:0 sc1
    s_add_u32 s55, s55, 2048
    v_mfma_f32_32x32x16_bf16 v[56:71], v[212:215], v[132:135], v[56:71]
    s_waitcnt lgkmcnt(0)
    v_mfma_f32_32x32x16_bf16 v[8:23], v[200:203], v[136:139], v[8:23]
    s_waitcnt vmcnt(42)
    ds_read_b64_tr_b16 v[208:209], v218 offset:18432
    ds_read_b64_tr_b16 v[210:211], v218 offset:18944
    ds_read_b64_tr_b16 v[212:213], v219 offset:18432
    ds_read_b64_tr_b16 v[214:215], v219 offset:18944
    s_add_u32 m0, s49, 14336
    v_mfma_f32_32x32x16_bf16 v[24:39], v[200:203], v[140:143], v[24:39]
    buffer_load_dwordx4 v[128:131], v216, s[12:15], s33 offen offset:1024 sc1
    buffer_load_dwordx4 v251, s[12:15], s55 offen sc1 lds
    v_mfma_f32_32x32x16_bf16 v[40:55], v[204:207], v[136:139], v[40:55]
    buffer_load_dwordx4 v251, s[12:15], s55 offen offset:1024 sc1 lds
    buffer_load_dwordx4 v[132:135], v216, s[12:15], s39 offen offset:1024 sc1
    s_add_u32 s55, s55, 2048
    s_add_u32 s33, s33, 2048
    s_add_u32 s39, s39, 2048
    v_mfma_f32_32x32x16_bf16 v[56:71], v[204:207], v[140:143], v[56:71]
    s_waitcnt lgkmcnt(0)
    v_mfma_f32_32x32x16_bf16 v[8:23], v[208:211], v[144:147], v[8:23]
    s_waitcnt vmcnt(44)
    ds_read_b64_tr_b16 v[200:201], v218 offset:20480
    ds_read_b64_tr_b16 v[202:203], v218 offset:20992
    ds_read_b64_tr_b16 v[204:205], v219 offset:20480
    ds_read_b64_tr_b16 v[206:207], v219 offset:20992
    s_add_u32 m0, s49, 16384
    v_mfma_f32_32x32x16_bf16 v[24:39], v[208:211], v[148:151], v[24:39]
    buffer_load_dwordx4 v[136:139], v216, s[12:15], s33 offen offset:0 sc1
    buffer_load_dwordx4 v251, s[12:15], s55 offen sc1 lds
    v_mfma_f32_32x32x16_bf16 v[40:55], v[212:215], v[144:147], v[40:55]
    buffer_load_dwordx4 v251, s[12:15], s55 offen offset:1024 sc1 lds
    buffer_load_dwordx4 v[140:143], v216, s[12:15], s39 offen offset:0 sc1
    s_add_u32 s55, s55, 2048
    v_mfma_f32_32x32x16_bf16 v[56:71], v[212:215], v[148:151], v[56:71]
    s_waitcnt lgkmcnt(0)
    v_mfma_f32_32x32x16_bf16 v[8:23], v[200:203], v[152:155], v[8:23]
    s_waitcnt vmcnt(46)
    ds_read_b64_tr_b16 v[208:209], v218 offset:22528
    ds_read_b64_tr_b16 v[210:211], v218 offset:23040
    ds_read_b64_tr_b16 v[212:213], v219 offset:22528
    ds_read_b64_tr_b16 v[214:215], v219 offset:23040
    s_add_u32 m0, s49, 18432
    v_mfma_f32_32x32x16_bf16 v[24:39], v[200:203], v[156:159], v[24:39]
    buffer_load_dwordx4 v[144:147], v216, s[12:15], s33 offen offset:1024 sc1
    buffer_load_dwordx4 v251, s[12:15], s55 offen sc1 lds
    v_mfma_f32_32x32x16_bf16 v[40:55], v[204:207], v[152:155], v[40:55]
    buffer_load_dwordx4 v251, s[12:15], s55 offen offset:1024 sc1 lds
    buffer_load_dwordx4 v[148:151], v216, s[12:15], s39 offen offset:1024 sc1
    s_add_u32 s55, s55, 2048
    s_add_u32 s33, s33, 2048
    s_add_u32 s39, s39, 2048
    v_mfma_f32_32x32x16_bf16 v[56:71], v[204:207], v[156:159], v[56:71]
    s_waitcnt lgkmcnt(0)
    v_mfma_f32_32x32x16_bf16 v[8:23], v[208:211], v[160:163], v[8:23]
    s_waitcnt vmcnt(48)
    ds_read_b64_tr_b16 v[200:201], v218 offset:24576
    ds_read_b64_tr_b16 v[202:203], v218 offset:25088
    ds_read_b64_tr_b16 v[204:205], v219 offset:24576
    ds_read_b64_tr_b16 v[206:207], v219 offset:25088
    s_add_u32 m0, s49, 20480
    v_mfma_f32_32x32x16_bf16 v[24:39], v[208:211], v[164:167], v[24:39]
    buffer_load_dwordx4 v[152:155], v216, s[12:15], s33 offen offset:0 sc1
    buffer_load_dwordx4 v251, s[12:15], s55 offen sc1 lds
    v_mfma_f32_32x32x16_bf16 v[40:55], v[212:215], v[160:163], v[40:55]
    buffer_load_dwordx4 v251, s[12:15], s55 offen offset:1024 sc1 lds
    buffer_load_dwordx4 v[156:159], v216, s[12:15], s39 offen offset:0 sc1
    s_add_u32 s55, s55, 2048
    v_mfma_f32_32x32x16_bf16 v[56:71], v[212:215], v[164:167], v[56:71]
    s_waitcnt lgkmcnt(0)
    v_mfma_f32_32x32x16_bf16 v[8:23], v[200:203], v[168:171], v[8:23]
    s_waitcnt vmcnt(50)
    ds_read_b64_tr_b16 v[208:209], v218 offset:26624
    ds_read_b64_tr_b16 v[210:211], v218 offset:27136
    ds_read_b64_tr_b16 v[212:213], v219 offset:26624
    ds_read_b64_tr_b16 v[214:215], v219 offset:27136
    s_add_u32 m0, s49, 22528
    v_mfma_f32_32x32x16_bf16 v[24:39], v[200:203], v[172:175], v[24:39]
    buffer_load_dwordx4 v[160:163], v216, s[12:15], s33 offen offset:1024 sc1
    buffer_load_dwordx4 v251, s[12:15], s55 offen sc1 lds
    v_mfma_f32_32x32x16_bf16 v[40:55], v[204:207], v[168:171], v[40:55]
    buffer_load_dwordx4 v251, s[12:15], s55 offen offset:1024 sc1 lds
    buffer_load_dwordx4 v[164:167], v216, s[12:15], s39 offen offset:1024 sc1
    s_add_u32 s55, s55, 2048
    s_add_u32 s33, s33, 2048
    s_add_u32 s39, s39, 2048
    v_mfma_f32_32x32x16_bf16 v[56:71], v[204:207], v[172:175], v[56:71]
    s_waitcnt lgkmcnt(0)
    v_mfma_f32_32x32x16_bf16 v[8:23], v[208:211], v[176:179], v[8:23]
    s_waitcnt vmcnt(52)
    ds_read_b64_tr_b16 v[200:201], v218 offset:28672
    ds_read_b64_tr_b16 v[202:203], v218 offset:29184
    ds_read_b64_tr_b16 v[204:205], v219 offset:28672
    ds_read_b64_tr_b16 v[206:207], v219 offset:29184
    s_add_u32 m0, s49, 24576
    v_mfma_f32_32x32x16_bf16 v[24:39], v[208:211], v[180:183], v[24:39]
    buffer_load_dwordx4 v[168:171], v216, s[12:15], s33 offen offset:0 sc1
    buffer_load_dwordx4 v251, s[12:15], s55 offen sc1 lds
    v_mfma_f32_32x32x16_bf16 v[40:55], v[212:215], v[176:179], v[40:55]
    buffer_load_dwordx4 v251, s[12:15], s55 offen offset:1024 sc1 lds
    buffer_load_dwordx4 v[172:175], v216, s[12:15], s39 offen offset:0 sc1
    s_add_u32 s55, s55, 2048
    v_mfma_f32_32x32x16_bf16 v[56:71], v[212:215], v[180:183], v[56:71]
    s_waitcnt lgkmcnt(0)
    v_mfma_f32_32x32x16_bf16 v[8:23], v[200:203], v[184:187], v[8:23]
    s_waitcnt vmcnt(52)
    ds_read_b64_tr_b16 v[208:209], v218 offset:30720
    ds_read_b64_tr_b16 v[210:211], v218 offset:31232
    ds_read_b64_tr_b16 v[212:213], v219 offset:30720
    ds_read_b64_tr_b16 v[214:215], v219 offset:31232
    s_add_u32 m0, s49, 26624
    v_mfma_f32_32x32x16_bf16 v[24:39], v[200:203], v[188:191], v[24:39]
    buffer_load_dwordx4 v[176:179], v216, s[12:15], s33 offen offset:1024 sc1
    buffer_load_dwordx4 v251, s[12:15], s55 offen sc1 lds
    v_mfma_f32_32x32x16_bf16 v[40:55], v[204:207], v[184:187], v[40:55]
    buffer_load_dwordx4 v251, s[12:15], s55 offen offset:1024 sc1 lds
    buffer_load_dwordx4 v[180:183], v216, s[12:15], s39 offen offset:1024 sc1
    s_add_u32 s55, s55, 2048
    s_add_u32 s33, s33, 2048
    s_add_u32 s39, s39, 2048
    v_mfma_f32_32x32x16_bf16 v[56:71], v[204:207], v[188:191], v[56:71]
    s_waitcnt lgkmcnt(0)
    v_mfma_f32_32x32x16_bf16 v[8:23], v[208:211], v[192:195], v[8:23]
    s_waitcnt vmcnt(52)
    ds_read_b64_tr_b16 v[200:201], v218 offset:0
    ds_read_b64_tr_b16 v[202:203], v218 offset:512
    ds_read_b64_tr_b16 v[204:205], v219 offset:0
    ds_read_b64_tr_b16 v[206:207], v219 offset:512
    s_add_u32 m0, s49, 28672
    v_mfma_f32_32x32x16_bf16 v[24:39], v[208:211], v[196:199], v[24:39]
    buffer_load_dwordx4 v[184:187], v216, s[12:15], s33 offen offset:0 sc1
    buffer_load_dwordx4 v251, s[12:15], s55 offen sc1 lds
    v_mfma_f32_32x32x16_bf16 v[40:55], v[212:215], v[192:195], v[40:55]
    buffer_load_dwordx4 v251, s[12:15], s55 offen offset:1024 sc1 lds
    buffer_load_dwordx4 v[188:191], v216, s[12:15], s39 offen offset:0 sc1
    s_add_u32 s55, s55, 2048
    v_mfma_f32_32x32x16_bf16 v[56:71], v[212:215], v[196:199], v[56:71]
    s_waitcnt lgkmcnt(0)
    s_mov_b32 s38, 2
pa_loop:
    v_mfma_f32_32x32x16_bf16 v[8:23], v[200:203], v[72:75], v[8:23]
    s_waitcnt vmcnt(52)
    ds_read_b64_tr_b16 v[208:209], v218 offset:2048
    ds_read_b64_tr_b16 v[210:211], v218 offset:2560
    ds_read_b64_tr_b16 v[212:213], v219 offset:2048
    ds_read_b64_tr_b16 v[214:215], v219 offset:2560
    s_add_u32 m0, s49, 30720
    v_mfma_f32_32x32x16_bf16 v[24:39], v[200:203], v[76:79], v[24:39]
    buffer_load_dwordx4 v[192:195], v216, s[12:15], s33 offen offset:1024 sc1
    buffer_load_dwordx4 v251, s[12:15], s55 offen sc1 lds
    v_mfma_f32_32x32x16_bf16 v[40:55], v[204:207], v[72:75], v[40:55]
    buffer_load_dwordx4 v251, s[12:15], s55 offen offset:1024 sc1 lds
    buffer_load_dwordx4 v[196:199], v216, s[12:15], s39 offen offset:1024 sc1
    s_add_u32 s55, s55, 2048
    s_add_u32 s33, s33, 2048
    s_add_u32 s39, s39, 2048
    v_mfma_f32_32x32x16_bf16 v[56:71], v[204:207], v[76:79], v[56:71]
    s_waitcnt lgkmcnt(0)
    v_mfma_f32_32x32x16_bf16 v[8:23], v[208:211], v[80:83], v[8:23]
    s_waitcnt vmcnt(52)
    ds_read_b64_tr_b16 v[200:201], v218 offset:4096
    ds_read_b64_tr_b16 v[202:203], v218 offset:4608
    ds_read_b64_tr_b16 v[204:205], v219 offset:4096
    ds_read_b64_tr_b16 v[206:207], v219 offset:4608
    s_add_u32 m0, s49, 0
    v_mfma_f32_32x32x16_bf16 v[24:39], v[208:211], v[84:87], v[24:39]
    buffer_load_dwordx4 v[72:75], v216, s[12:15], s33 offen offset:0 sc1
    buffer_load_dwordx4 v251, s[12:15], s55 offen sc1 lds
    v_mfma_f32_32x32x16_bf16 v[40:55], v[212:215], v[80:83], v[40:55]
    buffer_load_dwordx4 v251, s[12:15], s55 offen offset:1024 sc1 lds
    buffer_load_dwordx4 v[76:79], v216, s[12:15], s39 offen offset:0 sc1
    s_add_u32 s55, s55, 2048
    v_mfma_f32_32x32x16_bf16 v[56:71], v[212:215], v[84:87], v[56:71]
    s_waitcnt lgkmcnt(0)
    v_mfma_f32_32x32x16_bf16 v[8:23], v[200:203], v[88:91], v[8:23]
    s_waitcnt vmcnt(52)
    ds_read_b64_tr_b16 v[208:209], v218 offset:6144
    ds_read_b64_tr_b16 v[210:211], v218 offset:6656
    ds_read_b64_tr_b16 v[212:213], v219 offset:6144
    ds_read_b64_tr_b16 v[214:215], v219 offset:6656
    s_add_u32 m0, s49, 2048
    v_mfma_f32_32x32x16_bf16 v[24:39], v[200:203], v[92:95], v[24:39]
    buffer_load_dwordx4 v[80:83], v216, s[12:15], s33 offen offset:1024 sc1
    buffer_load_dwordx4 v251, s[12:15], s55 offen sc1 lds
    v_mfma_f32_32x32x16_bf16 v[40:55], v[204:207], v[88:91], v[40:55]
    buffer_load_dwordx4 v251, s[12:15], s55 offen offset:1024 sc1 lds
    buffer_load_dwordx4 v[84:87], v216, s[12:15], s39 offen offset:1024 sc1
    s_add_u32 s55, s55, 2048
    s_add_u32 s33, s33, 2048
    s_add_u32 s39, s39, 2048
    v_mfma_f32_32x32x16_bf16 v[56:71], v[204:207], v[92:95], v[56:71]
    s_waitcnt lgkmcnt(0)
    v_mfma_f32_32x32x16_bf16 v[8:23], v[208:211], v[96:99], v[8:23]
    s_waitcnt vmcnt(52)
    ds_read_b64_tr_b16 v[200:201], v218 offset:8192
    ds_read_b64_tr_b16 v[202:203], v218 offset:8704
    ds_read_b64_tr_b16 v[204:205], v219 offset:8192
    ds_read_b64_tr_b16 v[206:207], v219 offset:8704
    s_add_u32 m0, s49, 4096
    v_mfma_f32_32x32x16_bf16 v[24:39], v[208:211], v[100:103], v[24:39]
    buffer_load_dwordx4 v[88:91], v216, s[12:15], s33 offen offset:0 sc1
    buffer_load_dwordx4 v251, s[12:15], s55 offen sc1 lds
    v_mfma_f32_32x32x16_bf16 v[40:55], v[212:215], v[96:99], v[40:55]
    buffer_load_dwordx4 v251, s[12:15], s55 offen offset:1024 sc1 lds
    buffer_load_dwordx4 v[92:95], v216, s[12:15], s39 offen offset:0 sc1
    s_add_u32 s55, s55, 2048
    v_mfma_f32_32x32x16_bf16 v[56:71], v[212:215], v[100:103], v[56:71]
    s_waitcnt lgkmcnt(0)
    v_mfma_f32_32x32x16_bf16 v[8:23], v[200:203], v[104:107], v[8:23]
    s_waitcnt vmcnt(52)
    ds_read_b64_tr_b16 v[208:209], v218 offset:10240
    ds_read_b64_tr_b16 v[210:211], v218 offset:10752
    ds_read_b64_tr_b16 v[212:213], v219 offset:10240
    ds_read_b64_tr_b16 v[214:215], v219 offset:10752
    s_add_u32 m0, s49, 6144
    v_mfma_f32_32x32x16_bf16 v[24:39], v[200:203], v[108:111], v[24:39]
    buffer_load_dwordx4 v[96:99], v216, s[12:15], s33 offen offset:1024 sc1
    buffer_load_dwordx4 v251, s[12:15], s55 offen sc1 lds
    v_mfma_f32_32x32x16_bf16 v[40:55], v[204:207], v[104:107], v[40:55]
    buffer_load_dwordx4 v251, s[12:15], s55 offen offset:1024 sc1 lds
    buffer_load_dwordx4 v[100:103], v216, s[12:15], s39 offen offset:1024 sc1
    s_add_u32 s55, s55, 2048
    s_add_u32 s33, s33, 2048
    s_add_u32 s39, s39, 2048
    v_mfma_f32_32x32x16_bf16 v[56:71], v[204:207], v[108:111], v[56:71]
    s_waitcnt lgkmcnt(0)
    v_mfma_f32_32x32x16_bf16 v[8:23], v[208:211], v[112:115], v[8:23]
    s_waitcnt vmcnt(52)
    ds_read_b64_tr_b16 v[200:201], v218 offset:12288
    ds_read_b64_tr_b16 v[202:203], v218 offset:12800
    ds_read_b64_tr_b16 v[204:205], v219 offset:12288
    ds_read_b64_tr_b16 v[206:207], v219 offset:12800
    s_add_u32 m0, s49, 8192
    v_mfma_f32_32x32x16_bf16 v[24:39], v[208:211], v[116:119], v[24:39]
    buffer_load_dwordx4 v[104:107], v216, s[12:15], s33 offen offset:0 sc1
    buffer_load_dwordx4 v251, s[12:15], s55 offen sc1 lds
    v_mfma_f32_32x32x16_bf16 v[40:55], v[212:215], v[112:115], v[40:55]
    buffer_load_dwordx4 v251, s[12:15], s55 offen offset:1024 sc1 lds
    buffer_load_dwordx4 v[108:111], v216, s[12:15], s39 offen offset:0 sc1
    s_add_u32 s55, s55, 2048
    v_mfma_f32_32x32x16_bf16 v[56:71], v[212:215], v[116:119], v[56:71]
    s_waitcnt lgkmcnt(0)
    v_mfma_f32_32x32x16_bf16 v[8:23], v[200:203], v[120:123], v[8:23]
    s_waitcnt vmcnt(52)
    ds_read_b64_tr_b16 v[208:209], v218 offset:14336
    ds_read_b64_tr_b16 v[210:211], v218 offset:14848
    ds_read_b64_tr_b16 v[212:213], v219 offset:14336
    ds_read_b64_tr_b16 v[214:215], v219 offset:14848
    s_add_u32 m0, s49, 10240
    v_mfma_f32_32x32x16_bf16 v[24:39], v[200:203], v[124:127], v[24:39]
    buffer_load_dwordx4 v[112:115], v216, s[12:15], s33 offen offset:1024 sc1
    buffer_load_dwordx4 v251, s[12:15], s55 offen sc1 lds
    v_mfma_f32_32x32x16_bf16 v[40:55], v[204:207], v[120:123], v[40:55]
    buffer_load_dwordx4 v251, s[12:15], s55 offen offset:1024 sc1 lds
    buffer_load_dwordx4 v[116:119], v216, s[12:15], s39 offen offset:1024 sc1
    s_add_u32 s55, s55, 2048
    s_add_u32 s33, s33, 2048
    s_add_u32 s39, s39, 2048
    v_mfma_f32_32x32x16_bf16 v[56:71], v[204:207], v[124:127], v[56:71]
    s_waitcnt lgkmcnt(0)
    v_mfma_f32_32x32x16_bf16 v[8:23], v[208:211], v[128:131], v[8:23]
    s_waitcnt vmcnt(52)
    ds_read_b64_tr_b16 v[200:201], v218 offset:16384
    ds_read_b64_tr_b16 v[202:203], v218 offset:16896
    ds_read_b64_tr_b16 v[204:205], v219 offset:16384
    ds_read_b64_tr_b16 v[206:207], v219 offset:16896
    s_add_u32 m0, s49, 12288
    v_mfma_f32_32x32x16_bf16 v[24:39], v[208:211], v[132:135], v[24:39]
    buffer_load_dwordx4 v[120:123], v216, s[12:15], s33 offen offset:0 sc1
    buffer_load_dwordx4 v251, s[12:15], s55 offen sc1 lds
    v_mfma_f32_32x32x16_bf16 v[40:55], v[212:215], v[128:131], v[40:55]
    buffer_load_dwordx4 v251, s[12:15], s55 offen offset:1024 sc1 lds
    buffer_load_dwordx4 v[124:127], v216, s[12:15], s39 offen offset:0 sc1
    s_add_u32 s55, s55, 2048
    v_mfma_f32_32x32x16_bf16 v[56:71], v[212:215], v[132:135], v[56:71]
    s_waitcnt lgkmcnt(0)
    v_mfma_f32_32x32x16_bf16 v[8:23], v[200:203], v[136:139], v[8:23]
    s_waitcnt vmcnt(52)
    ds_read_b64_tr_b16 v[208:209], v218 offset:18432
    ds_read_b64_tr_b16 v[210:211], v218 offset:18944
    ds_read_b64_tr_b16 v[212:213], v219 offset:18432
    ds_read_b64_tr_b16 v[214:215], v219 offset:18944
    s_add_u32 m0, s49, 14336
    v_mfma_f32_32x32x16_bf16 v[24:39], v[200:203], v[140:143], v[24:39]
    buffer_load_dwordx4 v[128:131], v216, s[12:15], s33 offen offset:1024 sc1
    buffer_load_dwordx4 v251, s[12:15], s55 offen sc1 lds
    v_mfma_f32_32x32x16_bf16 v[40:55], v[204:207], v[136:139], v[40:55]
    buffer_load_dwordx4 v251, s[12:15], s55 offen offset:1024 sc1 lds
    buffer_load_dwordx4 v[132:135], v216, s[12:15], s39 offen offset:1024 sc1
    s_add_u32 s55, s55, 2048
    s_add_u32 s33, s33, 2048
    s_add_u32 s39, s39, 2048
    v_mfma_f32_32x32x16_bf16 v[56:71], v[204:207], v[140:143], v[56:71]
    s_waitcnt lgkmcnt(0)
    v_mfma_f32_32x32x16_bf16 v[8:23], v[208:211], v[144:147], v[8:23]
    s_waitcnt vmcnt(52)
    ds_read_b64_tr_b16 v[200:201], v218 offset:20480
    ds_read_b64_tr_b16 v[202:203], v218 offset:20992
    ds_read_b64_tr_b16 v[204:205], v219 offset:20480
    ds_read_b64_tr_b16 v[206:207], v219 offset:20992
    s_add_u32 m0, s49, 16384
    v_mfma_f32_32x32x16_bf16 v[24:39], v[208:211], v[148:151], v[24:39]
    buffer_load_dwordx4 v[136:139], v216, s[12:15], s33 offen offset:0 sc1
    buffer_load_dwordx4 v251, s[12:15], s55 offen sc1 lds
    v_mfma_f32_32x32x16_bf16 v[40:55], v[212:215], v[144:147], v[40:55]
    buffer_load_dwordx4 v251, s[12:15], s55 offen offset:1024 sc1 lds
    buffer_load_dwordx4 v[140:143], v216, s[12:15], s39 offen offset:0 sc1
    s_add_u32 s55, s55, 2048
    v_mfma_f32_32x32x16_bf16 v[56:71], v[212:215], v[148:151], v[56:71]
    s_waitcnt lgkmcnt(0)
    v_mfma_f32_32x32x16_bf16 v[8:23], v[200:203], v[152:155], v[8:23]
    s_waitcnt vmcnt(52)
    ds_read_b64_tr_b16 v[208:209], v218 offset:22528
    ds_read_b64_tr_b16 v[210:211], v218 offset:23040
    ds_read_b64_tr_b16 v[212:213], v219 offset:22528
    ds_read_b64_tr_b16 v[214:215], v219 offset:23040
    s_add_u32 m0, s49, 18432
    v_mfma_f32_32x32x16_bf16 v[24:39], v[200:203], v[156:159], v[24:39]
    buffer_load_dwordx4 v[144:147], v216, s[12:15], s33 offen offset:1024 sc1
    buffer_load_dwordx4 v251, s[12:15], s55 offen sc1 lds
    v_mfma_f32_32x32x16_bf16 v[40:55], v[204:207], v[152:155], v[40:55]
    buffer_load_dwordx4 v251, s[12:15], s55 offen offset:1024 sc1 lds
    buffer_load_dwordx4 v[148:151], v216, s[12:15], s39 offen offset:1024 sc1
    s_add_u32 s55, s55, 2048
    s_add_u32 s33, s33, 2048
    s_add_u32 s39, s39, 2048
    v_mfma_f32_32x32x16_bf16 v[56:71], v[204:207], v[156:159], v[56:71]
    s_waitcnt lgkmcnt(0)
    v_mfma_f32_32x32x16_bf16 v[8:23], v[208:211], v[160:163], v[8:23]
    s_waitcnt vmcnt(52)
    ds_read_b64_tr_b16 v[200:201], v218 offset:24576
    ds_read_b64_tr_b16 v[202:203], v218 offset:25088
    ds_read_b64_tr_b16 v[204:205], v219 offset:24576
    ds_read_b64_tr_b16 v[206:207], v219 offset:25088
    s_add_u32 m0, s49, 20480
    v_mfma_f32_32x32x16_bf16 v[24:39], v[208:211], v[164:167], v[24:39]
    buffer_load_dwordx4 v[152:155], v216, s[12:15], s33 offen offset:0 sc1
    buffer_load_dwordx4 v251, s[12:15], s55 offen sc1 lds
    v_mfma_f32_32x32x16_bf16 v[40:55], v[212:215], v[160:163], v[40:55]
    buffer_load_dwordx4 v251, s[12:15], s55 offen offset:1024 sc1 lds
    buffer_load_dwordx4 v[156:159], v216, s[12:15], s39 offen offset:0 sc1
    s_add_u32 s55, s55, 2048
    v_mfma_f32_32x32x16_bf16 v[56:71], v[212:215], v[164:167], v[56:71]
    s_waitcnt lgkmcnt(0)
    v_mfma_f32_32x32x16_bf16 v[8:23], v[200:203], v[168:171], v[8:23]
    s_waitcnt vmcnt(52)
    ds_read_b64_tr_b16 v[208:209], v218 offset:26624
    ds_read_b64_tr_b16 v[210:211], v218 offset:27136
    ds_read_b64_tr_b16 v[212:213], v219 offset:26624
    ds_read_b64_tr_b16 v[214:215], v219 offset:27136
    s_add_u32 m0, s49, 22528
    v_mfma_f32_32x32x16_bf16 v[24:39], v[200:203], v[172:175], v[24:39]
    buffer_load_dwordx4 v[160:163], v216, s[12:15], s33 offen offset:1024 sc1
    buffer_load_dwordx4 v251, s[12:15], s55 offen sc1 lds
    v_mfma_f32_32x32x16_bf16 v[40:55], v[204:207], v[168:171], v[40:55]
    buffer_load_dwordx4 v251, s[12:15], s55 offen offset:1024 sc1 lds
    buffer_load_dwordx4 v[164:167], v216, s[12:15], s39 offen offset:1024 sc1
    s_add_u32 s55, s55, 2048
    s_add_u32 s33, s33, 2048
    s_add_u32 s39, s39, 2048
    v_mfma_f32_32x32x16_bf16 v[56:71], v[204:207], v[172:175], v[56:71]
    s_waitcnt lgkmcnt(0)
    v_mfma_f32_32x32x16_bf16 v[8:23], v[208:211], v[176:179], v[8:23]
    s_waitcnt vmcnt(52)
    ds_read_b64_tr_b16 v[200:201], v218 offset:28672
    ds_read_b64_tr_b16 v[202:203], v218 offset:29184
    ds_read_b64_tr_b16 v[204:205], v219 offset:28672
    ds_read_b64_tr_b16 v[206:207], v219 offset:29184
    s_add_u32 m0, s49, 24576
    v_mfma_f32_32x32x16_bf16 v[24:39], v[208:211], v[180:183], v[24:39]
    buffer_load_dwordx4 v[168:171], v216, s[12:15], s33 offen offset:0 sc1
    buffer_load_dwordx4 v251, s[12:15], s55 offen sc1 lds
    v_mfma_f32_32x32x16_bf16 v[40:55], v[212:215], v[176:179], v[40:55]
    buffer_load_dwordx4 v251, s[12:15], s55 offen offset:1024 sc1 lds
    buffer_load_dwordx4 v[172:175], v216, s[12:15], s39 offen offset:0 sc1
    s_add_u32 s55, s55, 2048
    v_mfma_f32_32x32x16_bf16 v[56:71], v[212:215], v[180:183], v[56:71]
    s_waitcnt lgkmcnt(0)
    v_mfma_f32_32x32x16_bf16 v[8:23], v[200:203], v[184:187], v[8:23]
    s_waitcnt vmcnt(52)
    ds_read_b64_tr_b16 v[208:209], v218 offset:30720
    ds_read_b64_tr_b16 v[210:211], v218 offset:31232
    ds_read_b64_tr_b16 v[212:213], v219 offset:30720
    ds_read_b64_tr_b16 v[214:215], v219 offset:31232
    s_add_u32 m0, s49, 26624
    v_mfma_f32_32x32x16_bf16 v[24:39], v[200:203], v[188:191], v[24:39]
    buffer_load_dwordx4 v[176:179], v216, s[12:15], s33 offen offset:1024 sc1
    buffer_load_dwordx4 v251, s[12:15], s55 offen sc1 lds
    v_mfma_f32_32x32x16_bf16 v[40:55], v[204:207], v[184:187], v[40:55]
    buffer_load_dwordx4 v251, s[12:15], s55 offen offset:1024 sc1 lds
    buffer_load_dwordx4 v[180:183], v216, s[12:15], s39 offen offset:1024 sc1
    s_add_u32 s55, s55, 2048
    s_add_u32 s33, s33, 2048
    s_add_u32 s39, s39, 2048
    v_mfma_f32_32x32x16_bf16 v[56:71], v[204:207], v[188:191], v[56:71]
    s_waitcnt lgkmcnt(0)
    v_mfma_f32_32x32x16_bf16 v[8:23], v[208:211], v[192:195], v[8:23]
    s_waitcnt vmcnt(52)
    ds_read_b64_tr_b16 v[200:201], v218 offset:0
    ds_read_b64_tr_b16 v[202:203], v218 offset:512
    ds_read_b64_tr_b16 v[204:205], v219 offset:0
    ds_read_b64_tr_b16 v[206:207], v219 offset:512
    s_add_u32 m0, s49, 28672
    v_mfma_f32_32x32x16_bf16 v[24:39], v[208:211], v[196:199], v[24:39]
    buffer_load_dwordx4 v[184:187], v216, s[12:15], s33 offen offset:0 sc1
    buffer_load_dwordx4 v251, s[12:15], s55 offen sc1 lds
    v_mfma_f32_32x32x16_bf16 v[40:55], v[212:215], v[192:195], v[40:55]
    buffer_load_dwordx4 v251, s[12:15], s55 offen offset:1024 sc1 lds
    buffer_load_dwordx4 v[188:191], v216, s[12:15], s39 offen offset:0 sc1
    s_add_u32 s55, s55, 2048
    v_mfma_f32_32x32x16_bf16 v[56:71], v[212:215], v[196:199], v[56:71]
    s_waitcnt lgkmcnt(0)
    s_sub_u32 s38, s38, 1
    s_cmp_lg_u32 s38, 0
    s_cbranch_scc1 pa_loop
    v_mfma_f32_32x32x16_bf16 v[8:23], v[200:203], v[72:75], v[8:23]
    s_waitcnt vmcnt(52)
    ds_read_b64_tr_b16 v[208:209], v218 offset:2048
    ds_read_b64_tr_b16 v[210:211], v218 offset:2560
    ds_read_b64_tr_b16 v[212:213], v219 offset:2048
    ds_read_b64_tr_b16 v[214:215], v219 offset:2560
    s_add_u32 m0, s49, 30720
    v_mfma_f32_32x32x16_bf16 v[24:39], v[200:203], v[76:79], v[24:39]
    buffer_load_dwordx4 v[192:195], v216, s[12:15], s33 offen offset:1024 sc1
    buffer_load_dwordx4 v251, s[12:15], s55 offen sc1 lds
    v_mfma_f32_32x32x16_bf16 v[40:55], v[204:207], v[72:75], v[40:55]
    buffer_load_dwordx4 v251, s[12:15], s55 offen offset:1024 sc1 lds
    buffer_load_dwordx4 v[196:199], v216, s[12:15], s39 offen offset:1024 sc1
    s_add_u32 s55, s55, 2048
    s_add_u32 s33, s33, 2048
    s_add_u32 s39, s39, 2048
    v_mfma_f32_32x32x16_bf16 v[56:71], v[204:207], v[76:79], v[56:71]
    s_waitcnt lgkmcnt(0)
    v_mfma_f32_32x32x16_bf16 v[8:23], v[208:211], v[80:83], v[8:23]
    s_waitcnt vmcnt(52)
    ds_read_b64_tr_b16 v[200:201], v218 offset:4096
    ds_read_b64_tr_b16 v[202:203], v218 offset:4608
    ds_read_b64_tr_b16 v[204:205], v219 offset:4096
    ds_read_b64_tr_b16 v[206:207], v219 offset:4608
    v_mfma_f32_32x32x16_bf16 v[24:39], v[208:211], v[84:87], v[24:39]
    v_mbcnt_lo_u32_b32 v251, -1, 0
    v_mbcnt_hi_u32_b32 v251, -1, v251
    v_lshrrev_b32 v252, 4, v251
    v_and_b32 v253, 15, v251
    v_lshlrev_b32 v250, 2, v252
    v_xor_b32 v250, v250, v253
    v_lshlrev_b32 v250, 4, v250
    v_mul_u32_u24 v252, 3584, v252
    v_add_u32 v250, v250, v252
    s_and_b32 s54, s32, 1
    s_cmp_eq_u32 s54, 0
    s_cselect_b32 s24, s56, s58
    s_cselect_b32 s25, s57, s59
    s_and_b32 s25, s25, 0xffff
    s_mov_b32 s26, 1835008
    s_mov_b32 s27, 0x00020000
    s_lshr_b32 s54, s32, 1
    s_mul_i32 s54, s54, 229376
    s_lshl_b32 s53, s51, 8
    s_add_u32 s54, s54, s53
    s_lshl_b32 s53, s32, 15
    v_mfma_f32_32x32x16_bf16 v[40:55], v[212:215], v[80:83], v[40:55]
    v_mfma_f32_32x32x16_bf16 v[56:71], v[212:215], v[84:87], v[56:71]
    s_waitcnt lgkmcnt(0)
    v_mfma_f32_32x32x16_bf16 v[8:23], v[200:203], v[88:91], v[8:23]
    s_waitcnt vmcnt(48)
    ds_read_b64_tr_b16 v[208:209], v218 offset:6144
    ds_read_b64_tr_b16 v[210:211], v218 offset:6656
    ds_read_b64_tr_b16 v[212:213], v219 offset:6144
    ds_read_b64_tr_b16 v[214:215], v219 offset:6656
    v_mfma_f32_32x32x16_bf16 v[24:39], v[200:203], v[92:95], v[24:39]
    s_add_u32 m0, s53, 0
    s_add_u32 s52, s54, 0
    buffer_load_dwordx4 v250, s[24:27], s52 offen lds
    v_mfma_f32_32x32x16_bf16 v[40:55], v[204:207], v[88:91], v[40:55]
    s_add_u32 m0, s53, 1024
    s_add_u32 s52, s54, 14336
    buffer_load_dwordx4 v250, s[24:27], s52 offen lds
    v_mfma_f32_32x32x16_bf16 v[56:71], v[204:207], v[92:95], v[56:71]
    s_waitcnt lgkmcnt(0)
    v_mfma_f32_32x32x16_bf16 v[8:23], v[208:211], v[96:99], v[8:23]
    s_waitcnt vmcnt(46)
    ds_read_b64_tr_b16 v[200:201], v218 offset:8192
    ds_read_b64_tr_b16 v[202:203], v218 offset:8704
    ds_read_b64_tr_b16 v[204:205], v219 offset:8192
    ds_read_b64_tr_b16 v[206:207], v219 offset:8704
    v_mfma_f32_32x32x16_bf16 v[24:39], v[208:211], v[100:103], v[24:39]
    s_add_u32 m0, s53, 2048
    s_add_u32 s52, s54, 28672
    buffer_load_dwordx4 v250, s[24:27], s52 offen lds
    v_mfma_f32_32x32x16_bf16 v[40:55], v[212:215], v[96:99], v[40:55]
    s_add_u32 m0, s53, 3072
    s_add_u32 s52, s54, 43008
    buffer_load_dwordx4 v250, s[24:27], s52 offen lds
    v_mfma_f32_32x32x16_bf16 v[56:71], v[212:215], v[100:103], v[56:71]
    s_waitcnt lgkmcnt(0)
    v_mfma_f32_32x32x16_bf16 v[8:23], v[200:203], v[104:107], v[8:23]
    s_waitcnt vmcnt(44)
    ds_read_b64_tr_b16 v[208:209], v218 offset:10240
    ds_read_b64_tr_b16 v[210:211], v218 offset:10752
    ds_read_b64_tr_b16 v[212:213], v219 offset:10240
    ds_read_b64_tr_b16 v[214:215], v219 offset:10752
    v_mfma_f32_32x32x16_bf16 v[24:39], v[200:203], v[108:111], v[24:39]
    s_add_u32 m0, s53, 4096
    s_add_u32 s52, s54, 57344
    buffer_load_dwordx4 v250, s[24:27], s52 offen lds
    v_mfma_f32_32x32x16_bf16 v[40:55], v[204:207], v[104:107], v[40:55]
    s_add_u32 m0, s53, 5120
    s_add_u32 s52, s54, 71680
    buffer_load_dwordx4 v250, s[24:27], s52 offen lds
    v_mfma_f32_32x32x16_bf16 v[56:71], v[204:207], v[108:111], v[56:71]
    s_waitcnt lgkmcnt(0)
    v_mfma_f32_32x32x16_bf16 v[8:23], v[208:211], v[112:115], v[8:23]
    s_waitcnt vmcnt(42)
    ds_read_b64_tr_b16 v[200:201], v218 offset:12288
    ds_read_b64_tr_b16 v[202:203], v218 offset:12800
    ds_read_b64_tr_b16 v[204:205], v219 offset:12288
    ds_read_b64_tr_b16 v[206:207], v219 offset:12800
    v_mfma_f32_32x32x16_bf16 v[24:39], v[208:211], v[116:119], v[24:39]
    s_add_u32 m0, s53, 6144
    s_add_u32 s52, s54, 86016
    buffer_load_dwordx4 v250, s[24:27], s52 offen lds
    v_mfma_f32_32x32x16_bf16 v[40:55], v[212:215], v[112:115], v[40:55]
    s_add_u32 m0, s53, 7168
    s_add_u32 s52, s54, 100352
    buffer_load_dwordx4 v250, s[24:27], s52 offen lds
    v_mfma_f32_32x32x16_bf16 v[56:71], v[212:215], v[116:119], v[56:71]
    s_waitcnt lgkmcnt(0)
    v_mfma_f32_32x32x16_bf16 v[8:23], v[200:203], v[120:123], v[8:23]
    s_waitcnt vmcnt(40)
    ds_read_b64_tr_b16 v[208:209], v218 offset:14336
    ds_read_b64_tr_b16 v[210:211], v218 offset:14848
    ds_read_b64_tr_b16 v[212:213], v219 offset:14336
    ds_read_b64_tr_b16 v[214:215], v219 offset:14848
    v_mfma_f32_32x32x16_bf16 v[24:39], v[200:203], v[124:127], v[24:39]
    s_add_u32 m0, s53, 8192
    s_add_u32 s52, s54, 114688
    buffer_load_dwordx4 v250, s[24:27], s52 offen lds
    v_mfma_f32_32x32x16_bf16 v[40:55], v[204:207], v[120:123], v[40:55]
    s_add_u32 m0, s53, 9216
    s_add_u32 s52, s54, 129024
    buffer_load_dwordx4 v250, s[24:27], s52 offen lds
    v_mfma_f32_32x32x16_bf16 v[56:71], v[204:207], v[124:127], v[56:71]
    s_waitcnt lgkmcnt(0)
    v_mfma_f32_32x32x16_bf16 v[8:23], v[208:211], v[128:131], v[8:23]
    s_waitcnt vmcnt(38)
    ds_read_b64_tr_b16 v[200:201], v218 offset:16384
    ds_read_b64_tr_b16 v[202:203], v218 offset:16896
    ds_read_b64_tr_b16 v[204:205], v219 offset:16384
    ds_read_b64_tr_b16 v[206:207], v219 offset:16896
    v_mfma_f32_32x32x16_bf16 v[24:39], v[208:211], v[132:135], v[24:39]
    s_add_u32 m0, s53, 10240
    s_add_u32 s52, s54, 143360
    buffer_load_dwordx4 v250, s[24:27], s52 offen lds
    v_mfma_f32_32x32x16_bf16 v[40:55], v[212:215], v[128:131], v[40:55]
    s_add_u32 m0, s53, 11264
    s_add_u32 s52, s54, 157696
    buffer_load_dwordx4 v250, s[24:27], s52 offen lds
    v_mfma_f32_32x32x16_bf16 v[56:71], v[212:215], v[132:135], v[56:71]
    s_waitcnt lgkmcnt(0)
    v_mfma_f32_32x32x16_bf16 v[8:23], v[200:203], v[136:139], v[8:23]
    s_waitcnt vmcnt(36)
    ds_read_b64_tr_b16 v[208:209], v218 offset:18432
    ds_read_b64_tr_b16 v[210:211], v218 offset:18944
    ds_read_b64_tr_b16 v[212:213], v219 offset:18432
    ds_read_b64_tr_b16 v[214:215], v219 offset:18944
    v_mfma_f32_32x32x16_bf16 v[24:39], v[200:203], v[140:143], v[24:39]
    s_add_u32 m0, s53, 12288
    s_add_u32 s52, s54, 172032
    buffer_load_dwordx4 v250, s[24:27], s52 offen lds
    v_mfma_f32_32x32x16_bf16 v[40:55], v[204:207], v[136:139], v[40:55]
    s_add_u32 m0, s53, 13312
    s_add_u32 s52, s54, 186368
    buffer_load_dwordx4 v250, s[24:27], s52 offen lds
    v_mfma_f32_32x32x16_bf16 v[56:71], v[204:207], v[140:143], v[56:71]
    s_waitcnt lgkmcnt(0)
    v_mfma_f32_32x32x16_bf16 v[8:23], v[208:211], v[144:147], v[8:23]
    s_waitcnt vmcnt(34)
    ds_read_b64_tr_b16 v[200:201], v218 offset:20480
    ds_read_b64_tr_b16 v[202:203], v218 offset:20992
    ds_read_b64_tr_b16 v[204:205], v219 offset:20480
    ds_read_b64_tr_b16 v[206:207], v219 offset:20992
    v_mfma_f32_32x32x16_bf16 v[24:39], v[208:211], v[148:151], v[24:39]
    s_add_u32 m0, s53, 14336
    s_add_u32 s52, s54, 200704
    buffer_load_dwordx4 v250, s[24:27], s52 offen lds
    v_mfma_f32_32x32x16_bf16 v[40:55], v[212:215], v[144:147], v[40:55]
    s_add_u32 m0, s53, 15360
    s_add_u32 s52, s54, 215040
    buffer_load_dwordx4 v250, s[24:27], s52 offen lds
    v_mfma_f32_32x32x16_bf16 v[56:71], v[212:215], v[148:151], v[56:71]
    s_waitcnt lgkmcnt(0)
    v_mfma_f32_32x32x16_bf16 v[8:23], v[200:203], v[152:155], v[8:23]
    s_waitcnt vmcnt(32)
    ds_read_b64_tr_b16 v[208:209], v218 offset:22528
    ds_read_b64_tr_b16 v[210:211], v218 offset:23040
    ds_read_b64_tr_b16 v[212:213], v219 offset:22528
    ds_read_b64_tr_b16 v[214:215], v219 offset:23040
    v_mfma_f32_32x32x16_bf16 v[24:39], v[200:203], v[156:159], v[24:39]
    v_mfma_f32_32x32x16_bf16 v[40:55], v[204:207], v[152:155], v[40:55]
    v_mfma_f32_32x32x16_bf16 v[56:71], v[204:207], v[156:159], v[56:71]
    s_waitcnt lgkmcnt(0)
    v_mfma_f32_32x32x16_bf16 v[8:23], v[208:211], v[160:163], v[8:23]
    s_waitcnt vmcnt(28)
    ds_read_b64_tr_b16 v[200:201], v218 offset:24576
    ds_read_b64_tr_b16 v[202:203], v218 offset:25088
    ds_read_b64_tr_b16 v[204:205], v219 offset:24576
    ds_read_b64_tr_b16 v[206:207], v219 offset:25088
    v_mfma_f32_32x32x16_bf16 v[24:39], v[208:211], v[164:167], v[24:39]
    v_mfma_f32_32x32x16_bf16 v[40:55], v[212:215], v[160:163], v[40:55]
    v_mfma_f32_32x32x16_bf16 v[56:71], v[212:215], v[164:167], v[56:71]
    s_waitcnt lgkmcnt(0)
    v_mfma_f32_32x32x16_bf16 v[8:23], v[200:203], v[168:171], v[8:23]
    s_waitcnt vmcnt(24)
    ds_read_b64_tr_b16 v[208:209], v218 offset:26624
    ds_read_b64_tr_b16 v[210:211], v218 offset:27136
    ds_read_b64_tr_b16 v[212:213], v219 offset:26624
    ds_read_b64_tr_b16 v[214:215], v219 offset:27136
    v_mfma_f32_32x32x16_bf16 v[24:39], v[200:203], v[172:175], v[24:39]
    v_mfma_f32_32x32x16_bf16 v[40:55], v[204:207], v[168:171], v[40:55]
    v_mfma_f32_32x32x16_bf16 v[56:71], v[204:207], v[172:175], v[56:71]
    s_waitcnt lgkmcnt(0)
    v_mfma_f32_32x32x16_bf16 v[8:23], v[208:211], v[176:179], v[8:23]
    s_waitcnt vmcnt(20)
    ds_read_b64_tr_b16 v[200:201], v218 offset:28672
    ds_read_b64_tr_b16 v[202:203], v218 offset:29184
    ds_read_b64_tr_b16 v[204:205], v219 offset:28672
    ds_read_b64_tr_b16 v[206:207], v219 offset:29184
    v_mfma_f32_32x32x16_bf16 v[24:39], v[208:211], v[180:183], v[24:39]
    v_mfma_f32_32x32x16_bf16 v[40:55], v[212:215], v[176:179], v[40:55]
    v_mfma_f32_32x32x16_bf16 v[56:71], v[212:215], v[180:183], v[56:71]
    s_waitcnt lgkmcnt(0)
    v_mfma_f32_32x32x16_bf16 v[8:23], v[200:203], v[184:187], v[8:23]
    s_waitcnt vmcnt(16)
    ds_read_b64_tr_b16 v[208:209], v218 offset:30720
    ds_read_b64_tr_b16 v[210:211], v218 offset:31232
    ds_read_b64_tr_b16 v[212:213], v219 offset:30720
    ds_read_b64_tr_b16 v[214:215], v219 offset:31232
    v_mfma_f32_32x32x16_bf16 v[24:39], v[200:203], v[188:191], v[24:39]
    v_mfma_f32_32x32x16_bf16 v[40:55], v[204:207], v[184:187], v[40:55]
    v_mfma_f32_32x32x16_bf16 v[56:71], v[204:207], v[188:191], v[56:71]
    s_waitcnt lgkmcnt(0)
    v_mfma_f32_32x32x16_bf16 v[8:23], v[208:211], v[192:195], v[8:23]
    v_mfma_f32_32x32x16_bf16 v[24:39], v[208:211], v[196:199], v[24:39]
    v_mfma_f32_32x32x16_bf16 v[40:55], v[212:215], v[192:195], v[40:55]
    v_mfma_f32_32x32x16_bf16 v[56:71], v[212:215], v[196:199], v[56:71]
    v_add_u32 v3, s49, v216
    s_nop 7
    ds_write_b128 v3, v[8:11] offset:16384
    ds_write_b128 v3, v[12:15] offset:17408
    ds_write_b128 v3, v[16:19] offset:18432
    ds_write_b128 v3, v[20:23] offset:19456
    ds_write_b128 v3, v[24:27] offset:20480
    ds_write_b128 v3, v[28:31] offset:21504
    ds_write_b128 v3, v[32:35] offset:22528
    ds_write_b128 v3, v[36:39] offset:23552
    ds_write_b128 v3, v[40:43] offset:24576
    ds_write_b128 v3, v[44:47] offset:25600
    ds_write_b128 v3, v[48:51] offset:26624
    ds_write_b128 v3, v[52:55] offset:27648
    ds_write_b128 v3, v[56:59] offset:28672
    ds_write_b128 v3, v[60:63] offset:29696
    ds_write_b128 v3, v[64:67] offset:30720
    ds_write_b128 v3, v[68:71] offset:31744
    s_waitcnt lgkmcnt(0)
    s_barrier
    s_lshl_b32 s35, s32, 12
    v_add_u32 v3, s35, v216
    v_add_u32 v1, 0x10000, v3
    ds_read_b128 v[72:75], v3 offset:16384
    ds_read_b128 v[76:79], v3 offset:17408
    ds_read_b128 v[80:83], v3 offset:18432
    ds_read_b128 v[84:87], v3 offset:19456
    ds_read_b128 v[88:91], v3 offset:49152
    ds_read_b128 v[92:95], v3 offset:50176
    ds_read_b128 v[96:99], v3 offset:51200
    ds_read_b128 v[100:103], v3 offset:52224
    ds_read_b128 v[104:107], v1 offset:16384
    ds_read_b128 v[108:111], v1 offset:17408
    ds_read_b128 v[112:115], v1 offset:18432
    ds_read_b128 v[116:119], v1 offset:19456
    ds_read_b128 v[120:123], v1 offset:49152
    ds_read_b128 v[124:127], v1 offset:50176
    ds_read_b128 v[128:131], v1 offset:51200
    ds_read_b128 v[132:135], v1 offset:52224
    s_waitcnt lgkmcnt(8)
    v_add_f32 v72, v72, v88
    v_add_f32 v73, v73, v89
    v_add_f32 v74, v74, v90
    v_add_f32 v75, v75, v91
    v_add_f32 v76, v76, v92
    v_add_f32 v77, v77, v93
    v_add_f32 v78, v78, v94
    v_add_f32 v79, v79, v95
    v_add_f32 v80, v80, v96
    v_add_f32 v81, v81, v97
    v_add_f32 v82, v82, v98
    v_add_f32 v83, v83, v99
    v_add_f32 v84, v84, v100
    v_add_f32 v85, v85, v101
    v_add_f32 v86, v86, v102
    v_add_f32 v87, v87, v103
    s_waitcnt lgkmcnt(4)
    v_add_f32 v72, v72, v104
    v_add_f32 v73, v73, v105
    v_add_f32 v74, v74, v106
    v_add_f32 v75, v75, v107
    v_add_f32 v76, v76, v108
    v_add_f32 v77, v77, v109
    v_add_f32 v78, v78, v110
    v_add_f32 v79, v79, v111
    v_add_f32 v80, v80, v112
    v_add_f32 v81, v81, v113
    v_add_f32 v82, v82, v114
    v_add_f32 v83, v83, v115
    v_add_f32 v84, v84, v116
    v_add_f32 v85, v85, v117
    v_add_f32 v86, v86, v118
    v_add_f32 v87, v87, v119
    s_waitcnt lgkmcnt(0)
    v_add_f32 v72, v72, v120
    v_add_f32 v73, v73, v121
    v_add_f32 v74, v74, v122
    v_add_f32 v75, v75, v123
    v_add_f32 v76, v76, v124
    v_add_f32 v77, v77, v125
    v_add_f32 v78, v78, v126
    v_add_f32 v79, v79, v127
    v_add_f32 v80, v80, v128
    v_add_f32 v81, v81, v129
    v_add_f32 v82, v82, v130
    v_add_f32 v83, v83, v131
    v_add_f32 v84, v84, v132
    v_add_f32 v85, v85, v133
    v_add_f32 v86, v86, v134
    v_add_f32 v87, v87, v135
    s_barrier
    v_cvt_pk_bf16_f32 v72, 0, v72
    v_cvt_pk_bf16_f32 v73, 0, v73
    v_cvt_pk_bf16_f32 v74, 0, v74
    v_cvt_pk_bf16_f32 v75, 0, v75
    v_cvt_pk_bf16_f32 v76, 0, v76
    v_cvt_pk_bf16_f32 v77, 0, v77
    v_cvt_pk_bf16_f32 v78, 0, v78
    v_cvt_pk_bf16_f32 v79, 0, v79
    v_cvt_pk_bf16_f32 v80, 0, v80
    v_cvt_pk_bf16_f32 v81, 0, v81
    v_cvt_pk_bf16_f32 v82, 0, v82
    v_cvt_pk_bf16_f32 v83, 0, v83
    v_cvt_pk_bf16_f32 v84, 0, v84
    v_cvt_pk_bf16_f32 v85, 0, v85
    v_cvt_pk_bf16_f32 v86, 0, v86
    v_cvt_pk_bf16_f32 v87, 0, v87
    v_mul_f32 v72, v72, v220
    v_mul_f32 v73, v73, v221
    v_mul_f32 v74, v74, v222
    v_mul_f32 v75, v75, v223
    v_mul_f32 v76, v76, v224
    v_mul_f32 v77, v77, v225
    v_mul_f32 v78, v78, v226
    v_mul_f32 v79, v79, v227
    v_mul_f32 v80, v80, v228
    v_mul_f32 v81, v81, v229
    v_mul_f32 v82, v82, v230
    v_mul_f32 v83, v83, v231
    v_mul_f32 v84, v84, v232
    v_mul_f32 v85, v85, v233
    v_mul_f32 v86, v86, v234
    v_mul_f32 v87, v87, v235
    v_cvt_pk_bf16_f32 v72, 0, v72
    v_cvt_pk_bf16_f32 v73, 0, v73
    v_cvt_pk_bf16_f32 v74, 0, v74
    v_cvt_pk_bf16_f32 v75, 0, v75
    v_cvt_pk_bf16_f32 v76, 0, v76
    v_cvt_pk_bf16_f32 v77, 0, v77
    v_cvt_pk_bf16_f32 v78, 0, v78
    v_cvt_pk_bf16_f32 v79, 0, v79
    v_cvt_pk_bf16_f32 v80, 0, v80
    v_cvt_pk_bf16_f32 v81, 0, v81
    v_cvt_pk_bf16_f32 v82, 0, v82
    v_cvt_pk_bf16_f32 v83, 0, v83
    v_cvt_pk_bf16_f32 v84, 0, v84
    v_cvt_pk_bf16_f32 v85, 0, v85
    v_cvt_pk_bf16_f32 v86, 0, v86
    v_cvt_pk_bf16_f32 v87, 0, v87
    v_lshlrev_b32 v88, 16, v236
    v_and_b32 v89, 0xffff0000, v236
    v_lshlrev_b32 v90, 16, v237
    v_and_b32 v91, 0xffff0000, v237
    v_lshlrev_b32 v92, 16, v238
    v_and_b32 v93, 0xffff0000, v238
    v_lshlrev_b32 v94, 16, v239
    v_and_b32 v95, 0xffff0000, v239
    v_lshlrev_b32 v96, 16, v240
    v_and_b32 v97, 0xffff0000, v240
    v_lshlrev_b32 v98, 16, v241
    v_and_b32 v99, 0xffff0000, v241
    v_lshlrev_b32 v100, 16, v242
    v_and_b32 v101, 0xffff0000, v242
    v_lshlrev_b32 v102, 16, v243
    v_and_b32 v103, 0xffff0000, v243
    v_add_f32 v72, v72, v88
    v_add_f32 v73, v73, v89
    v_add_f32 v74, v74, v90
    v_add_f32 v75, v75, v91
    v_add_f32 v76, v76, v92
    v_add_f32 v77, v77, v93
    v_add_f32 v78, v78, v94
    v_add_f32 v79, v79, v95
    v_add_f32 v80, v80, v96
    v_add_f32 v81, v81, v97
    v_add_f32 v82, v82, v98
    v_add_f32 v83, v83, v99
    v_add_f32 v84, v84, v100
    v_add_f32 v85, v85, v101
    v_add_f32 v86, v86, v102
    v_add_f32 v87, v87, v103
    v_cvt_pk_bf16_f32 v104, v72, v73
    v_cvt_pk_bf16_f32 v105, v74, v75
    v_cvt_pk_bf16_f32 v106, v76, v77
    v_cvt_pk_bf16_f32 v107, v78, v79
    v_cvt_pk_bf16_f32 v108, v80, v81
    v_cvt_pk_bf16_f32 v109, v82, v83
    v_cvt_pk_bf16_f32 v110, v84, v85
    v_cvt_pk_bf16_f32 v111, v86, v87
    buffer_store_dwordx4 v[104:107], v216, s[12:15], s43 offen offset:0 sc1
    buffer_store_dwordx4 v[108:111], v216, s[12:15], s43 offen offset:1024 sc1
    v_accvgpr_write_b32 a64, v104
    v_accvgpr_write_b32 a65, v105
    v_accvgpr_write_b32 a66, v106
    v_accvgpr_write_b32 a67, v107
    v_accvgpr_write_b32 a68, v108
    v_accvgpr_write_b32 a69, v109
    v_accvgpr_write_b32 a70, v110
    v_accvgpr_write_b32 a71, v111
    v_lshlrev_b32 v72, 16, v104
    v_and_b32 v73, 0xffff0000, v104
    v_lshlrev_b32 v74, 16, v105
    v_and_b32 v75, 0xffff0000, v105
    v_lshlrev_b32 v76, 16, v106
    v_and_b32 v77, 0xffff0000, v106
    v_lshlrev_b32 v78, 16, v107
    v_and_b32 v79, 0xffff0000, v107
    v_lshlrev_b32 v80, 16, v108
    v_and_b32 v81, 0xffff0000, v108
    v_lshlrev_b32 v82, 16, v109
    v_and_b32 v83, 0xffff0000, v109
    v_lshlrev_b32 v84, 16, v110
    v_and_b32 v85, 0xffff0000, v110
    v_lshlrev_b32 v86, 16, v111
    v_and_b32 v87, 0xffff0000, v111
    v_add_f32 v88, v72, v73
    v_mul_f32 v89, v72, v72
    v_fmac_f32 v89, v73, v73
    v_add_f32 v88, v88, v74
    v_fmac_f32 v89, v74, v74
    v_add_f32 v88, v88, v75
    v_fmac_f32 v89, v75, v75
    v_add_f32 v88, v88, v76
    v_fmac_f32 v89, v76, v76
    v_add_f32 v88, v88, v77
    v_fmac_f32 v89, v77, v77
    v_add_f32 v88, v88, v78
    v_fmac_f32 v89, v78, v78
    v_add_f32 v88, v88, v79
    v_fmac_f32 v89, v79, v79
    v_add_f32 v88, v88, v80
    v_fmac_f32 v89, v80, v80
    v_add_f32 v88, v88, v81
    v_fmac_f32 v89, v81, v81
    v_add_f32 v88, v88, v82
    v_fmac_f32 v89, v82, v82
    v_add_f32 v88, v88, v83
    v_fmac_f32 v89, v83, v83
    v_add_f32 v88, v88, v84
    v_fmac_f32 v89, v84, v84
    v_add_f32 v88, v88, v85
    v_fmac_f32 v89, v85, v85
    v_add_f32 v88, v88, v86
    v_fmac_f32 v89, v86, v86
    v_add_f32 v88, v88, v87
    v_fmac_f32 v89, v87, v87
    v_mov_b32 v90, v88
    v_mov_b32 v91, v89
    s_nop 0
    v_permlane32_swap_b32 v88, v90
    v_permlane32_swap_b32 v89, v91
    v_add_f32 v88, v88, v90
    v_add_f32 v89, v89, v91
    s_lshl_b32 s45, s42, 7
    s_lshl_b32 s46, s41, 3
    s_add_u32 s45, s45, s46
    s_add_u32 s45, s45, 23068672
    v_lshlrev_b32 v3, 3, v5
    s_mov_b64 exec, 0xffffffff
    buffer_store_dwordx2 v[88:89], v3, s[12:15], s45 offen sc1
    s_mov_b64 exec, -1
    s_lshr_b32 s46, s28, 1
    s_lshl_b32 s46, s46, 8
    s_and_b32 s45, s28, 1
    s_lshl_b32 s45, s45, 5
    s_add_u32 s46, s46, s45
    s_lshl_b32 s45, s29, 2
    s_add_u32 s46, s46, s45
    s_add_u32 s46, s46, 16384
    s_cmp_ge_u32 s51, 14
    s_cbranch_scc1 tail_skipb
    v_mbcnt_lo_u32_b32 v235, -1, 0
    v_mbcnt_hi_u32_b32 v235, -1, v235
    v_lshlrev_b32 v232, 4, v235
    v_lshrrev_b32 v239, 4, v235
    v_and_b32 v240, 15, v235
    v_lshlrev_b32 v241, 2, v239
    v_xor_b32 v241, v241, v240
    v_lshlrev_b32 v241, 4, v241
    v_mul_u32_u24 v242, 3584, v239
    v_add_u32 v233, v242, v241
    s_lshl_b32 s38, s32, 12
    s_lshl_b32 s3, s50, 2
    s_add_u32 s3, s3, s32
    s_lshl_b32 s35, s3, 15
    s_add_u32 s35, s35, 20971520
    s_mul_i32 s37, s3, 114688
    s_lshl_b32 s33, s51, 13
    s_add_u32 s37, s37, s33
    s_add_u32 s37, s37, 25165824
    s_mul_i32 s36, s32, 57344
    s_lshl_b32 s33, s51, 8
    s_add_u32 s36, s36, s33
    v_and_b32 v243, 31, v235
    v_lshrrev_b32 v242, 5, v235
    v_lshlrev_b32 v244, 3, v243
    v_lshl_add_u32 v244, v242, 11, v244
    s_lshl_b32 s39, s3, 12
    s_add_u32 s39, s39, 23068672
    s_waitcnt vmcnt(0)
    s_barrier
    s_cmp_lg_u32 s32, 0
    s_cbranch_scc1 attn_kernel_nosig_23
    v_mov_b32 v252, 0
    v_mov_b32 v253, 1
    s_mov_b64 exec, 1
    buffer_store_dword v253, v252, s[12:15], s46 offen sc1
    s_mov_b64 exec, -1
attn_kernel_nosig_23:
    s_mov_b32 s8, s56
    s_and_b32 s9, s57, 0xffff
    s_mov_b32 s10, 1835008
    s_mov_b32 s11, 0x00020000
    s_mov_b32 s20, s58
    s_and_b32 s21, s59, 0xffff
    s_mov_b32 s22, 1835008
    s_mov_b32 s23, 0x00020000
    s_lshl_b32 s33, s32, 10
    s_add_u32 m0, s33, 131072
    s_add_u32 s33, s33, 8192
    buffer_load_dwordx4 v232, s[12:15], s33 offen lds
    s_add_u32 m0, s38, 16384
    s_add_u32 s33, s36, 458752
    buffer_load_dwordx4 v233, s[8:11], s33 offen offset:0 lds
    s_add_u32 s33, s36, 472064
    buffer_load_dwordx4 v233, s[8:11], s33 offen offset:1024 lds
    s_add_u32 s33, s36, 485376
    buffer_load_dwordx4 v233, s[8:11], s33 offen offset:2048 lds
    s_add_u32 s33, s36, 498688
    buffer_load_dwordx4 v233, s[8:11], s33 offen offset:3072 lds
    s_add_u32 m0, s38, 49152
    s_add_u32 s33, s36, 458752
    buffer_load_dwordx4 v233, s[20:23], s33 offen offset:0 lds
    s_add_u32 s33, s36, 472064
    buffer_load_dwordx4 v233, s[20:23], s33 offen offset:1024 lds
    s_add_u32 s33, s36, 485376
    buffer_load_dwordx4 v233, s[20:23], s33 offen offset:2048 lds
    s_add_u32 s33, s36, 498688
    buffer_load_dwordx4 v233, s[20:23], s33 offen offset:3072 lds
    s_add_u32 m0, s38, 81920
    s_add_u32 s33, s36, 688128
    buffer_load_dwordx4 v233, s[8:11], s33 offen offset:0 lds
    s_add_u32 s33, s36, 701440
    buffer_load_dwordx4 v233, s[8:11], s33 offen offset:1024 lds
    s_add_u32 s33, s36, 714752
    buffer_load_dwordx4 v233, s[8:11], s33 offen offset:2048 lds
    s_add_u32 s33, s36, 728064
    buffer_load_dwordx4 v233, s[8:11], s33 offen offset:3072 lds
    s_add_u32 m0, s38, 114688
    s_add_u32 s33, s36, 688128
    buffer_load_dwordx4 v233, s[20:23], s33 offen offset:0 lds
    s_add_u32 s33, s36, 701440
    buffer_load_dwordx4 v233, s[20:23], s33 offen offset:1024 lds
    s_add_u32 s33, s36, 714752
    buffer_load_dwordx4 v233, s[20:23], s33 offen offset:2048 lds
    s_add_u32 s33, s36, 728064
    buffer_load_dwordx4 v233, s[20:23], s33 offen offset:3072 lds
    v_lshrrev_b32 v245, 2, v240
    v_and_b32 v246, 1, v239
    v_lshlrev_b32 v246, 5, v246
    v_and_b32 v247, 1, v235
    v_lshl_add_u32 v246, v247, 4, v246
    v_bfe_u32 v247, v235, 1, 1
    v_lshl_add_u32 v246, v247, 3, v246
    v_lshl_add_u32 v246, v245, 8, v246
    v_lshl_add_u32 v246, v242, 11, v246
    v_xor_b32 v247, 0, v245
    v_lshl_add_u32 v224, v247, 6, v246
    v_add_u32 v228, 0x10000, v224
    v_xor_b32 v247, 1, v245
    v_lshl_add_u32 v225, v247, 6, v246
    v_add_u32 v229, 0x10000, v225
    v_xor_b32 v247, 2, v245
    v_lshl_add_u32 v226, v247, 6, v246
    v_add_u32 v230, 0x10000, v226
    v_xor_b32 v247, 3, v245
    v_lshl_add_u32 v227, v247, 6, v246
    v_add_u32 v231, 0x10000, v227
    v_lshlrev_b32 v234, 6, v242
    v_add_u32 v234, 131072, v234
    s_lshl_b32 s45, s50, 8
    s_add_u32 s45, s45, 16384
    s_cmp_lg_u32 s32, 0
    s_cbranch_scc1 pb_go
    v_min_u32 v248, 15, v235
    v_lshlrev_b32 v248, 2, v248
    s_mov_b32 s48, 0x40000
pb_poll:
    buffer_load_dword v249, v248, s[12:15], s45 offen sc1
    s_waitcnt vmcnt(0)
    v_cmp_eq_u32 vcc, 0, v249
    s_nop 0
    s_cbranch_vccz pb_go
    s_sleep 2
    s_sub_u32 s48, s48, 1
    s_cmp_lg_u32 s48, 0
    s_cbranch_scc1 pb_poll
pb_go:
    s_waitcnt vmcnt(0)
    s_barrier
    buffer_load_dwordx2 v[184:185], v244, s[12:15], s39 offen offset:0 sc1
    buffer_load_dwordx2 v[186:187], v244, s[12:15], s39 offen offset:256 sc1
    buffer_load_dwordx2 v[188:189], v244, s[12:15], s39 offen offset:512 sc1
    buffer_load_dwordx2 v[190:191], v244, s[12:15], s39 offen offset:768 sc1
    buffer_load_dwordx2 v[192:193], v244, s[12:15], s39 offen offset:1024 sc1
    buffer_load_dwordx2 v[194:195], v244, s[12:15], s39 offen offset:1280 sc1
    buffer_load_dwordx2 v[196:197], v244, s[12:15], s39 offen offset:1536 sc1
    buffer_load_dwordx2 v[198:199], v244, s[12:15], s39 offen offset:1792 sc1
    s_add_u32 s34, s35, 0
    buffer_load_dwordx4 v[128:131], v232, s[12:15], s34 offen offset:0 sc1
    buffer_load_dwordx4 v[132:135], v232, s[12:15], s34 offen offset:1024 sc1
    buffer_load_dwordx4 v[136:139], v232, s[12:15], s34 offen offset:2048 sc1
    buffer_load_dwordx4 v[140:143], v232, s[12:15], s34 offen offset:3072 sc1
    s_add_u32 s34, s35, 4096
    buffer_load_dwordx4 v[144:147], v232, s[12:15], s34 offen offset:0 sc1
    buffer_load_dwordx4 v[148:151], v232, s[12:15], s34 offen offset:1024 sc1
    buffer_load_dwordx4 v[152:155], v232, s[12:15], s34 offen offset:2048 sc1
    buffer_load_dwordx4 v[156:159], v232, s[12:15], s34 offen offset:3072 sc1
    s_add_u32 s34, s35, 8192
    buffer_load_dwordx4 v[160:163], v232, s[12:15], s34 offen offset:0 sc1
    buffer_load_dwordx4 v[164:167], v232, s[12:15], s34 offen offset:1024 sc1
    buffer_load_dwordx4 v[168:171], v232, s[12:15], s34 offen offset:2048 sc1
    buffer_load_dwordx4 v[172:175], v232, s[12:15], s34 offen offset:3072 sc1
    s_waitcnt vmcnt(12)
    s_mov_b32 s3, 0x3b000000
    v_add_f32 v184, v184, v186
    v_add_f32 v185, v185, v187
    v_add_f32 v184, v184, v188
    v_add_f32 v185, v185, v189
    v_add_f32 v184, v184, v190
    v_add_f32 v185, v185, v191
    v_add_f32 v184, v184, v192
    v_add_f32 v185, v185, v193
    v_add_f32 v184, v184, v194
    v_add_f32 v185, v185, v195
    v_add_f32 v184, v184, v196
    v_add_f32 v185, v185, v197
    v_add_f32 v184, v184, v198
    v_add_f32 v185, v185, v199
    v_mov_b32 v186, v184
    v_mov_b32 v187, v185
    s_nop 0
    v_permlane32_swap_b32 v184, v186
    v_permlane32_swap_b32 v185, v187
    v_add_f32 v184, v184, v186
    v_add_f32 v185, v185, v187
    v_mul_f32 v184, s3, v184
    v_mul_f32 v185, s3, v185
    v_fma_f32 v185, -v184, v184, v185
    v_max_f32 v185, 0, v185
    v_cvt_pk_bf16_f32 v184, 0, v184
    v_cvt_pk_bf16_f32 v185, 0, v185
    v_add_f32 v185, 0x3727c5ac, v185
    v_cvt_pk_bf16_f32 v185, 0, v185
    v_sqrt_f32 v185, v185
    s_nop 0
    v_cvt_pk_bf16_f32 v185, 0, v185
    v_rcp_f32 v236, v185
    s_nop 0
    v_mul_f32 v237, v184, v236
    v_sub_f32 v237, 0, v237
    s_barrier
    ds_read_b128 v[184:187], v234 offset:0
    ds_read_b128 v[188:191], v234 offset:16
    ds_read_b128 v[192:195], v234 offset:32
    ds_read_b128 v[196:199], v234 offset:48
    ds_read_b64_tr_b16 a[0:1], v224 offset:0
    ds_read_b64_tr_b16 a[2:3], v224 offset:1024
    ds_read_b64_tr_b16 a[4:5], v225 offset:0
    ds_read_b64_tr_b16 a[6:7], v225 offset:1024
    ds_read_b64_tr_b16 a[8:9], v226 offset:0
    ds_read_b64_tr_b16 a[10:11], v226 offset:1024
    ds_read_b64_tr_b16 a[12:13], v227 offset:0
    ds_read_b64_tr_b16 a[14:15], v227 offset:1024
    ds_read_b64_tr_b16 a[16:17], v224 offset:32768
    ds_read_b64_tr_b16 a[18:19], v224 offset:33792
    ds_read_b64_tr_b16 a[20:21], v225 offset:32768
    ds_read_b64_tr_b16 a[22:23], v225 offset:33792
    ds_read_b64_tr_b16 a[24:25], v226 offset:32768
    ds_read_b64_tr_b16 a[26:27], v226 offset:33792
    ds_read_b64_tr_b16 a[28:29], v227 offset:32768
    ds_read_b64_tr_b16 a[30:31], v227 offset:33792
    ds_read_b128 v[200:203], v234 offset:128
    ds_read_b128 v[204:207], v234 offset:144
    ds_read_b128 v[208:211], v234 offset:160
    ds_read_b128 v[212:215], v234 offset:176
    s_waitcnt vmcnt(11) lgkmcnt(15)
    v_lshlrev_b32 v216, 16, v128
    v_and_b32 v217, 0xffff0000, v128
    v_fma_f32 v216, v216, v236, v237
    v_fma_f32 v217, v217, v236, v237
    v_fma_f32 v216, v216, v184, v192
    v_fma_f32 v217, v217, v185, v193
    v_cvt_pk_bf16_f32 v176, v216, v217
    v_lshlrev_b32 v218, 16, v129
    v_and_b32 v219, 0xffff0000, v129
    v_fma_f32 v218, v218, v236, v237
    v_fma_f32 v219, v219, v236, v237
    v_fma_f32 v218, v218, v186, v194
    v_fma_f32 v219, v219, v187, v195
    v_cvt_pk_bf16_f32 v177, v218, v219
    v_lshlrev_b32 v220, 16, v130
    v_and_b32 v221, 0xffff0000, v130
    v_fma_f32 v220, v220, v236, v237
    v_fma_f32 v221, v221, v236, v237
    v_fma_f32 v220, v220, v188, v196
    v_fma_f32 v221, v221, v189, v197
    v_cvt_pk_bf16_f32 v178, v220, v221
    v_lshlrev_b32 v222, 16, v131
    v_and_b32 v223, 0xffff0000, v131
    v_fma_f32 v222, v222, v236, v237
    v_fma_f32 v223, v223, v236, v237
    v_fma_f32 v222, v222, v190, v198
    v_fma_f32 v223, v223, v191, v199
    v_cvt_pk_bf16_f32 v179, v222, v223
    s_waitcnt lgkmcnt(4)
    s_nop 0
    v_mfma_f32_32x32x16_bf16 v[0:15], a[0:3], v[176:179], 0
    s_waitcnt vmcnt(10) lgkmcnt(0)
    ds_read_b128 v[184:187], v234 offset:256
    ds_read_b128 v[188:191], v234 offset:272
    ds_read_b128 v[192:195], v234 offset:288
    ds_read_b128 v[196:199], v234 offset:304
    v_lshlrev_b32 v216, 16, v132
    v_and_b32 v217, 0xffff0000, v132
    v_fma_f32 v216, v216, v236, v237
    v_mfma_f32_32x32x16_bf16 v[16:31], a[4:7], v[176:179], 0
    ds_read_b64_tr_b16 a[32:33], v224 offset:4096
    ds_read_b64_tr_b16 a[34:35], v224 offset:5120
    ds_read_b64_tr_b16 a[36:37], v225 offset:4096
    ds_read_b64_tr_b16 a[38:39], v225 offset:5120
    v_fma_f32 v217, v217, v236, v237
    v_fma_f32 v216, v216, v200, v208
    v_fma_f32 v217, v217, v201, v209
    v_cvt_pk_bf16_f32 v180, v216, v217
    v_mfma_f32_32x32x16_bf16 v[32:47], a[8:11], v[176:179], 0
    ds_read_b64_tr_b16 a[40:41], v226 offset:4096
    ds_read_b64_tr_b16 a[42:43], v226 offset:5120
    ds_read_b64_tr_b16 a[44:45], v227 offset:4096
    ds_read_b64_tr_b16 a[46:47], v227 offset:5120
    v_lshlrev_b32 v218, 16, v133
    v_and_b32 v219, 0xffff0000, v133
    v_fma_f32 v218, v218, v236, v237
    v_mfma_f32_32x32x16_bf16 v[48:63], a[12:15], v[176:179], 0
    ds_read_b64_tr_b16 a[48:49], v224 offset:36864
    ds_read_b64_tr_b16 a[50:51], v224 offset:37888
    ds_read_b64_tr_b16 a[52:53], v225 offset:36864
    ds_read_b64_tr_b16 a[54:55], v225 offset:37888
    v_fma_f32 v219, v219, v236, v237
    v_fma_f32 v218, v218, v202, v210
    v_fma_f32 v219, v219, v203, v211
    v_cvt_pk_bf16_f32 v181, v218, v219
    v_mfma_f32_32x32x16_bf16 v[64:79], a[16:19], v[176:179], 0
    ds_read_b64_tr_b16 a[56:57], v226 offset:36864
    ds_read_b64_tr_b16 a[58:59], v226 offset:37888
    ds_read_b64_tr_b16 a[60:61], v227 offset:36864
    ds_read_b64_tr_b16 a[62:63], v227 offset:37888
    v_lshlrev_b32 v220, 16, v134
    v_and_b32 v221, 0xffff0000, v134
    v_fma_f32 v220, v220, v236, v237
    v_mfma_f32_32x32x16_bf16 v[80:95], a[20:23], v[176:179], 0
    v_fma_f32 v221, v221, v236, v237
    v_fma_f32 v220, v220, v204, v212
    v_fma_f32 v221, v221, v205, v213
    v_cvt_pk_bf16_f32 v182, v220, v221
    v_lshlrev_b32 v222, 16, v135
    v_and_b32 v223, 0xffff0000, v135
    s_add_u32 s34, s35, 12288
    v_mfma_f32_32x32x16_bf16 v[96:111], a[24:27], v[176:179], 0
    buffer_load_dwordx4 v[128:131], v232, s[12:15], s34 offen offset:0 sc1
    v_fma_f32 v222, v222, v236, v237
    v_fma_f32 v223, v223, v236, v237
    v_fma_f32 v222, v222, v206, v214
    v_fma_f32 v223, v223, v207, v215
    v_cvt_pk_bf16_f32 v183, v222, v223
    v_mfma_f32_32x32x16_bf16 v[112:127], a[28:31], v[176:179], 0
    s_waitcnt lgkmcnt(0)
    v_mfma_f32_32x32x16_bf16 v[0:15], a[32:35], v[180:183], v[0:15]
    s_waitcnt vmcnt(10)
    ds_read_b128 v[200:203], v234 offset:384
    ds_read_b128 v[204:207], v234 offset:400
    ds_read_b128 v[208:211], v234 offset:416
    ds_read_b128 v[212:215], v234 offset:432
    v_lshlrev_b32 v216, 16, v136
    v_and_b32 v217, 0xffff0000, v136
    v_fma_f32 v216, v216, v236, v237
    v_mfma_f32_32x32x16_bf16 v[16:31], a[36:39], v[180:183], v[16:31]
    ds_read_b64_tr_b16 a[0:1], v224 offset:8192
    ds_read_b64_tr_b16 a[2:3], v224 offset:9216
    ds_read_b64_tr_b16 a[4:5], v225 offset:8192
    ds_read_b64_tr_b16 a[6:7], v225 offset:9216
    v_fma_f32 v217, v217, v236, v237
    v_fma_f32 v216, v216, v184, v192
    v_fma_f32 v217, v217, v185, v193
    v_cvt_pk_bf16_f32 v176, v216, v217
    v_mfma_f32_32x32x16_bf16 v[32:47], a[40:43], v[180:183], v[32:47]
    ds_read_b64_tr_b16 a[8:9], v226 offset:8192
    ds_read_b64_tr_b16 a[10:11], v226 offset:9216
    ds_read_b64_tr_b16 a[12:13], v227 offset:8192
    ds_read_b64_tr_b16 a[14:15], v227 offset:9216
    v_lshlrev_b32 v218, 16, v137
    v_and_b32 v219, 0xffff0000, v137
    v_fma_f32 v218, v218, v236, v237
    v_mfma_f32_32x32x16_bf16 v[48:63], a[44:47], v[180:183], v[48:63]
    ds_read_b64_tr_b16 a[16:17], v224 offset:40960
    ds_read_b64_tr_b16 a[18:19], v224 offset:41984
    ds_read_b64_tr_b16 a[20:21], v225 offset:40960
    ds_read_b64_tr_b16 a[22:23], v225 offset:41984
    v_fma_f32 v219, v219, v236, v237
    v_fma_f32 v218, v218, v186, v194
    v_fma_f32 v219, v219, v187, v195
    v_mfma_f32_32x32x16_bf16 v[64:79], a[48:51], v[180:183], v[64:79]
    ds_read_b64_tr_b16 a[24:25], v226 offset:40960
    ds_read_b64_tr_b16 a[26:27], v226 offset:41984
    ds_read_b64_tr_b16 a[28:29], v227 offset:40960
    ds_read_b64_tr_b16 a[30:31], v227 offset:41984
    v_cvt_pk_bf16_f32 v177, v218, v219
    v_lshlrev_b32 v220, 16, v138
    v_and_b32 v221, 0xffff0000, v138
    v_fma_f32 v220, v220, v236, v237
    v_mfma_f32_32x32x16_bf16 v[80:95], a[52:55], v[180:183], v[80:95]
    v_fma_f32 v221, v221, v236, v237
    v_fma_f32 v220, v220, v188, v196
    v_fma_f32 v221, v221, v189, v197
    v_cvt_pk_bf16_f32 v178, v220, v221
    v_lshlrev_b32 v222, 16, v139
    v_and_b32 v223, 0xffff0000, v139
    v_mfma_f32_32x32x16_bf16 v[96:111], a[56:59], v[180:183], v[96:111]
    buffer_load_dwordx4 v[132:135], v232, s[12:15], s34 offen offset:1024 sc1
    v_fma_f32 v222, v222, v236, v237
    v_fma_f32 v223, v223, v236, v237
    v_fma_f32 v222, v222, v190, v198
    v_fma_f32 v223, v223, v191, v199
    v_cvt_pk_bf16_f32 v179, v222, v223
    v_mfma_f32_32x32x16_bf16 v[112:127], a[60:63], v[180:183], v[112:127]
    s_waitcnt lgkmcnt(0)
    v_mfma_f32_32x32x16_bf16 v[0:15], a[0:3], v[176:179], v[0:15]
    s_waitcnt vmcnt(10)
    ds_read_b128 v[184:187], v234 offset:512
    ds_read_b128 v[188:191], v234 offset:528
    ds_read_b128 v[192:195], v234 offset:544
    ds_read_b128 v[196:199], v234 offset:560
    v_lshlrev_b32 v216, 16, v140
    v_and_b32 v217, 0xffff0000, v140
    v_fma_f32 v216, v216, v236, v237
    v_mfma_f32_32x32x16_bf16 v[16:31], a[4:7], v[176:179], v[16:31]
    ds_read_b64_tr_b16 a[32:33], v224 offset:12288
    ds_read_b64_tr_b16 a[34:35], v224 offset:13312
    ds_read_b64_tr_b16 a[36:37], v225 offset:12288
    ds_read_b64_tr_b16 a[38:39], v225 offset:13312
    v_fma_f32 v217, v217, v236, v237
    v_fma_f32 v216, v216, v200, v208
    v_fma_f32 v217, v217, v201, v209
    v_cvt_pk_bf16_f32 v180, v216, v217
    v_mfma_f32_32x32x16_bf16 v[32:47], a[8:11], v[176:179], v[32:47]
    ds_read_b64_tr_b16 a[40:41], v226 offset:12288
    ds_read_b64_tr_b16 a[42:43], v226 offset:13312
    ds_read_b64_tr_b16 a[44:45], v227 offset:12288
    ds_read_b64_tr_b16 a[46:47], v227 offset:13312
    v_lshlrev_b32 v218, 16, v141
    v_and_b32 v219, 0xffff0000, v141
    v_fma_f32 v218, v218, v236, v237
    v_mfma_f32_32x32x16_bf16 v[48:63], a[12:15], v[176:179], v[48:63]
    ds_read_b64_tr_b16 a[48:49], v224 offset:45056
    ds_read_b64_tr_b16 a[50:51], v224 offset:46080
    ds_read_b64_tr_b16 a[52:53], v225 offset:45056
    ds_read_b64_tr_b16 a[54:55], v225 offset:46080
    v_fma_f32 v219, v219, v236, v237
    v_fma_f32 v218, v218, v202, v210
    v_fma_f32 v219, v219, v203, v211
    v_mfma_f32_32x32x16_bf16 v[64:79], a[16:19], v[176:179], v[64:79]
    ds_read_b64_tr_b16 a[56:57], v226 offset:45056
    ds_read_b64_tr_b16 a[58:59], v226 offset:46080
    ds_read_b64_tr_b16 a[60:61], v227 offset:45056
    ds_read_b64_tr_b16 a[62:63], v227 offset:46080
    v_cvt_pk_bf16_f32 v181, v218, v219
    v_lshlrev_b32 v220, 16, v142
    v_and_b32 v221, 0xffff0000, v142
    v_fma_f32 v220, v220, v236, v237
    v_mfma_f32_32x32x16_bf16 v[80:95], a[20:23], v[176:179], v[80:95]
    v_fma_f32 v221, v221, v236, v237
    v_fma_f32 v220, v220, v204, v212
    v_fma_f32 v221, v221, v205, v213
    v_cvt_pk_bf16_f32 v182, v220, v221
    v_lshlrev_b32 v222, 16, v143
    v_and_b32 v223, 0xffff0000, v143
    v_mfma_f32_32x32x16_bf16 v[96:111], a[24:27], v[176:179], v[96:111]
    buffer_load_dwordx4 v[136:139], v232, s[12:15], s34 offen offset:2048 sc1
    v_fma_f32 v222, v222, v236, v237
    v_fma_f32 v223, v223, v236, v237
    v_fma_f32 v222, v222, v206, v214
    v_fma_f32 v223, v223, v207, v215
    v_cvt_pk_bf16_f32 v183, v222, v223
    v_mfma_f32_32x32x16_bf16 v[112:127], a[28:31], v[176:179], v[112:127]
    s_waitcnt lgkmcnt(0)
    v_mfma_f32_32x32x16_bf16 v[0:15], a[32:35], v[180:183], v[0:15]
    s_waitcnt vmcnt(10)
    s_barrier
    v_lshlrev_b32 v216, 16, v144
    v_and_b32 v217, 0xffff0000, v144
    v_mfma_f32_32x32x16_bf16 v[16:31], a[36:39], v[180:183], v[16:31]
    ds_read_b128 v[200:203], v234 offset:640
    ds_read_b128 v[204:207], v234 offset:656
    ds_read_b128 v[208:211], v234 offset:672
    ds_read_b128 v[212:215], v234 offset:688
    v_fma_f32 v216, v216, v236, v237
    v_fma_f32 v217, v217, v236, v237
    v_fma_f32 v216, v216, v184, v192
    v_fma_f32 v217, v217, v185, v193
    v_mfma_f32_32x32x16_bf16 v[32:47], a[40:43], v[180:183], v[32:47]
    ds_read_b64_tr_b16 a[0:1], v228 offset:0
    ds_read_b64_tr_b16 a[2:3], v228 offset:1024
    ds_read_b64_tr_b16 a[4:5], v229 offset:0
    ds_read_b64_tr_b16 a[6:7], v229 offset:1024
    v_cvt_pk_bf16_f32 v176, v216, v217
    v_lshlrev_b32 v218, 16, v145
    v_and_b32 v219, 0xffff0000, v145
    v_fma_f32 v218, v218, v236, v237
    v_mfma_f32_32x32x16_bf16 v[48:63], a[44:47], v[180:183], v[48:63]
    ds_read_b64_tr_b16 a[8:9], v230 offset:0
    ds_read_b64_tr_b16 a[10:11], v230 offset:1024
    ds_read_b64_tr_b16 a[12:13], v231 offset:0
    ds_read_b64_tr_b16 a[14:15], v231 offset:1024
    v_fma_f32 v219, v219, v236, v237
    v_fma_f32 v218, v218, v186, v194
    v_fma_f32 v219, v219, v187, v195
    v_cvt_pk_bf16_f32 v177, v218, v219
    v_mfma_f32_32x32x16_bf16 v[64:79], a[48:51], v[180:183], v[64:79]
    ds_read_b64_tr_b16 a[16:17], v228 offset:32768
    ds_read_b64_tr_b16 a[18:19], v228 offset:33792
    ds_read_b64_tr_b16 a[20:21], v229 offset:32768
    ds_read_b64_tr_b16 a[22:23], v229 offset:33792
    v_lshlrev_b32 v220, 16, v146
    v_and_b32 v221, 0xffff0000, v146
    v_fma_f32 v220, v220, v236, v237
    v_fma_f32 v221, v221, v236, v237
    v_mfma_f32_32x32x16_bf16 v[80:95], a[52:55], v[180:183], v[80:95]
    ds_read_b64_tr_b16 a[24:25], v230 offset:32768
    ds_read_b64_tr_b16 a[26:27], v230 offset:33792
    ds_read_b64_tr_b16 a[28:29], v231 offset:32768
    ds_read_b64_tr_b16 a[30:31], v231 offset:33792
    v_fma_f32 v220, v220, v188, v196
    v_fma_f32 v221, v221, v189, v197
    v_cvt_pk_bf16_f32 v178, v220, v221
    v_lshlrev_b32 v222, 16, v147
    v_mfma_f32_32x32x16_bf16 v[96:111], a[56:59], v[180:183], v[96:111]
    buffer_load_dwordx4 v[140:143], v232, s[12:15], s34 offen offset:3072 sc1
    v_and_b32 v223, 0xffff0000, v147
    v_fma_f32 v222, v222, v236, v237
    v_fma_f32 v223, v223, v236, v237
    v_fma_f32 v222, v222, v190, v198
    v_fma_f32 v223, v223, v191, v199
    v_cvt_pk_bf16_f32 v179, v222, v223
    v_mfma_f32_32x32x16_bf16 v[112:127], a[60:63], v[180:183], v[112:127]
    s_waitcnt lgkmcnt(0)
    v_mfma_f32_32x32x16_bf16 v[0:15], a[0:3], v[176:179], v[0:15]
    s_waitcnt vmcnt(10)
    ds_read_b128 v[184:187], v234 offset:768
    ds_read_b128 v[188:191], v234 offset:784
    ds_read_b128 v[192:195], v234 offset:800
    ds_read_b128 v[196:199], v234 offset:816
    v_lshlrev_b32 v216, 16, v148
    v_and_b32 v217, 0xffff0000, v148
    v_fma_f32 v216, v216, v236, v237
    v_fma_f32 v217, v217, v236, v237
    v_fma_f32 v216, v216, v200, v208
    v_fma_f32 v217, v217, v201, v209
    v_mfma_f32_32x32x16_bf16 v[16:31], a[4:7], v[176:179], v[16:31]
    ds_read_b64_tr_b16 a[32:33], v228 offset:4096
    ds_read_b64_tr_b16 a[34:35], v228 offset:5120
    ds_read_b64_tr_b16 a[36:37], v229 offset:4096
    ds_read_b64_tr_b16 a[38:39], v229 offset:5120
    v_cvt_pk_bf16_f32 v180, v216, v217
    v_lshlrev_b32 v218, 16, v149
    v_and_b32 v219, 0xffff0000, v149
    v_fma_f32 v218, v218, v236, v237
    v_fma_f32 v219, v219, v236, v237
    v_fma_f32 v218, v218, v202, v210
    v_mfma_f32_32x32x16_bf16 v[32:47], a[8:11], v[176:179], v[32:47]
    ds_read_b64_tr_b16 a[40:41], v230 offset:4096
    ds_read_b64_tr_b16 a[42:43], v230 offset:5120
    ds_read_b64_tr_b16 a[44:45], v231 offset:4096
    ds_read_b64_tr_b16 a[46:47], v231 offset:5120
    v_fma_f32 v219, v219, v203, v211
    v_cvt_pk_bf16_f32 v181, v218, v219
    v_lshlrev_b32 v220, 16, v150
    s_add_u32 m0, s38, 0
    s_add_u32 s33, s36, 917504
    v_mfma_f32_32x32x16_bf16 v[48:63], a[12:15], v[176:179], v[48:63]
    buffer_load_dwordx4 v233, s[8:11], s33 offen offset:0 lds
    ds_read_b64_tr_b16 a[48:49], v228 offset:36864
    ds_read_b64_tr_b16 a[50:51], v228 offset:37888
    ds_read_b64_tr_b16 a[52:53], v229 offset:36864
    ds_read_b64_tr_b16 a[54:55], v229 offset:37888
    s_add_u32 s33, s36, 930816
    v_mfma_f32_32x32x16_bf16 v[64:79], a[16:19], v[176:179], v[64:79]
    buffer_load_dwordx4 v233, s[8:11], s33 offen offset:1024 lds
    ds_read_b64_tr_b16 a[56:57], v230 offset:36864
    ds_read_b64_tr_b16 a[58:59], v230 offset:37888
    ds_read_b64_tr_b16 a[60:61], v231 offset:36864
    ds_read_b64_tr_b16 a[62:63], v231 offset:37888
    v_and_b32 v221, 0xffff0000, v150
    s_add_u32 s33, s36, 944128
    v_mfma_f32_32x32x16_bf16 v[80:95], a[20:23], v[176:179], v[80:95]
    buffer_load_dwordx4 v233, s[8:11], s33 offen offset:2048 lds
    v_fma_f32 v220, v220, v236, v237
    v_fma_f32 v221, v221, v236, v237
    v_fma_f32 v220, v220, v204, v212
    v_fma_f32 v221, v221, v205, v213
    v_cvt_pk_bf16_f32 v182, v220, v221
    v_lshlrev_b32 v222, 16, v151
    v_and_b32 v223, 0xffff0000, v151
    s_add_u32 s33, s36, 957440
    v_mfma_f32_32x32x16_bf16 v[96:111], a[24:27], v[176:179], v[96:111]
    buffer_load_dwordx4 v233, s[8:11], s33 offen offset:3072 lds
    v_fma_f32 v222, v222, v236, v237
    v_fma_f32 v223, v223, v236, v237
    v_fma_f32 v222, v222, v206, v214
    v_fma_f32 v223, v223, v207, v215
    v_cvt_pk_bf16_f32 v183, v222, v223
    s_add_u32 m0, s38, 32768
    s_add_u32 s33, s36, 917504
    v_mfma_f32_32x32x16_bf16 v[112:127], a[28:31], v[176:179], v[112:127]
    s_waitcnt lgkmcnt(0)
    buffer_load_dwordx4 v233, s[20:23], s33 offen offset:0 lds
    v_mfma_f32_32x32x16_bf16 v[0:15], a[32:35], v[180:183], v[0:15]
    s_waitcnt vmcnt(14)
    ds_read_b128 v[200:203], v234 offset:896
    ds_read_b128 v[204:207], v234 offset:912
    ds_read_b128 v[208:211], v234 offset:928
    ds_read_b128 v[212:215], v234 offset:944
    v_lshlrev_b32 v216, 16, v152
    v_and_b32 v217, 0xffff0000, v152
    v_fma_f32 v216, v216, v236, v237
    v_fma_f32 v217, v217, v236, v237
    v_fma_f32 v216, v216, v184, v192
    v_mfma_f32_32x32x16_bf16 v[16:31], a[36:39], v[180:183], v[16:31]
    ds_read_b64_tr_b16 a[0:1], v228 offset:8192
    ds_read_b64_tr_b16 a[2:3], v228 offset:9216
    ds_read_b64_tr_b16 a[4:5], v229 offset:8192
    ds_read_b64_tr_b16 a[6:7], v229 offset:9216
    v_fma_f32 v217, v217, v185, v193
    v_cvt_pk_bf16_f32 v176, v216, v217
    v_lshlrev_b32 v218, 16, v153
    v_and_b32 v219, 0xffff0000, v153
    v_fma_f32 v218, v218, v236, v237
    v_mfma_f32_32x32x16_bf16 v[32:47], a[40:43], v[180:183], v[32:47]
    ds_read_b64_tr_b16 a[8:9], v230 offset:8192
    ds_read_b64_tr_b16 a[10:11], v230 offset:9216
    ds_read_b64_tr_b16 a[12:13], v231 offset:8192
    ds_read_b64_tr_b16 a[14:15], v231 offset:9216
    v_fma_f32 v219, v219, v236, v237
    v_fma_f32 v218, v218, v186, v194
    v_fma_f32 v219, v219, v187, v195
    v_cvt_pk_bf16_f32 v177, v218, v219
    s_add_u32 s33, s36, 930816
    v_mfma_f32_32x32x16_bf16 v[48:63], a[44:47], v[180:183], v[48:63]
    buffer_load_dwordx4 v233, s[20:23], s33 offen offset:1024 lds
    ds_read_b64_tr_b16 a[16:17], v228 offset:40960
    ds_read_b64_tr_b16 a[18:19], v228 offset:41984
    ds_read_b64_tr_b16 a[20:21], v229 offset:40960
    ds_read_b64_tr_b16 a[22:23], v229 offset:41984
    v_lshlrev_b32 v220, 16, v154
    s_add_u32 s33, s36, 944128
    v_mfma_f32_32x32x16_bf16 v[64:79], a[48:51], v[180:183], v[64:79]
    buffer_load_dwordx4 v233, s[20:23], s33 offen offset:2048 lds
    ds_read_b64_tr_b16 a[24:25], v230 offset:40960
    ds_read_b64_tr_b16 a[26:27], v230 offset:41984
    ds_read_b64_tr_b16 a[28:29], v231 offset:40960
    ds_read_b64_tr_b16 a[30:31], v231 offset:41984
    s_add_u32 s33, s36, 957440
    v_mfma_f32_32x32x16_bf16 v[80:95], a[52:55], v[180:183], v[80:95]
    buffer_load_dwordx4 v233, s[20:23], s33 offen offset:3072 lds
    v_and_b32 v221, 0xffff0000, v154
    v_fma_f32 v220, v220, v236, v237
    v_fma_f32 v221, v221, v236, v237
    v_fma_f32 v220, v220, v188, v196
    v_fma_f32 v221, v221, v189, v197
    v_cvt_pk_bf16_f32 v178, v220, v221
    s_add_u32 s34, s35, 16384
    v_mfma_f32_32x32x16_bf16 v[96:111], a[56:59], v[180:183], v[96:111]
    buffer_load_dwordx4 v[144:147], v232, s[12:15], s34 offen offset:0 sc1
    v_lshlrev_b32 v222, 16, v155
    v_and_b32 v223, 0xffff0000, v155
    v_fma_f32 v222, v222, v236, v237
    v_fma_f32 v223, v223, v236, v237
    v_fma_f32 v222, v222, v190, v198
    v_fma_f32 v223, v223, v191, v199
    v_cvt_pk_bf16_f32 v179, v222, v223
    v_mfma_f32_32x32x16_bf16 v[112:127], a[60:63], v[180:183], v[112:127]
    s_waitcnt lgkmcnt(0)
    buffer_load_dwordx4 v[148:151], v232, s[12:15], s34 offen offset:1024 sc1
    v_mfma_f32_32x32x16_bf16 v[0:15], a[0:3], v[176:179], v[0:15]
    s_waitcnt vmcnt(18)
    ds_read_b128 v[184:187], v234 offset:1024
    ds_read_b128 v[188:191], v234 offset:1040
    ds_read_b128 v[192:195], v234 offset:1056
    ds_read_b128 v[196:199], v234 offset:1072
    v_lshlrev_b32 v216, 16, v156
    v_and_b32 v217, 0xffff0000, v156
    v_fma_f32 v216, v216, v236, v237
    v_mfma_f32_32x32x16_bf16 v[16:31], a[4:7], v[176:179], v[16:31]
    ds_read_b64_tr_b16 a[32:33], v228 offset:12288
    ds_read_b64_tr_b16 a[34:35], v228 offset:13312
    ds_read_b64_tr_b16 a[36:37], v229 offset:12288
    ds_read_b64_tr_b16 a[38:39], v229 offset:13312
    v_fma_f32 v217, v217, v236, v237
    v_fma_f32 v216, v216, v200, v208
    v_fma_f32 v217, v217, v201, v209
    v_cvt_pk_bf16_f32 v180, v216, v217
    v_mfma_f32_32x32x16_bf16 v[32:47], a[8:11], v[176:179], v[32:47]
    ds_read_b64_tr_b16 a[40:41], v230 offset:12288
    ds_read_b64_tr_b16 a[42:43], v230 offset:13312
    ds_read_b64_tr_b16 a[44:45], v231 offset:12288
    ds_read_b64_tr_b16 a[46:47], v231 offset:13312
    v_lshlrev_b32 v218, 16, v157
    v_and_b32 v219, 0xffff0000, v157
    v_fma_f32 v218, v218, v236, v237
    v_mfma_f32_32x32x16_bf16 v[48:63], a[12:15], v[176:179], v[48:63]
    ds_read_b64_tr_b16 a[48:49], v228 offset:45056
    ds_read_b64_tr_b16 a[50:51], v228 offset:46080
    ds_read_b64_tr_b16 a[52:53], v229 offset:45056
    ds_read_b64_tr_b16 a[54:55], v229 offset:46080
    v_fma_f32 v219, v219, v236, v237
    v_fma_f32 v218, v218, v202, v210
    v_fma_f32 v219, v219, v203, v211
    v_mfma_f32_32x32x16_bf16 v[64:79], a[16:19], v[176:179], v[64:79]
    ds_read_b64_tr_b16 a[56:57], v230 offset:45056
    ds_read_b64_tr_b16 a[58:59], v230 offset:46080
    ds_read_b64_tr_b16 a[60:61], v231 offset:45056
    ds_read_b64_tr_b16 a[62:63], v231 offset:46080
    v_cvt_pk_bf16_f32 v181, v218, v219
    v_lshlrev_b32 v220, 16, v158
    v_and_b32 v221, 0xffff0000, v158
    v_fma_f32 v220, v220, v236, v237
    v_mfma_f32_32x32x16_bf16 v[80:95], a[20:23], v[176:179], v[80:95]
    v_fma_f32 v221, v221, v236, v237
    v_fma_f32 v220, v220, v204, v212
    v_fma_f32 v221, v221, v205, v213
    v_cvt_pk_bf16_f32 v182, v220, v221
    v_lshlrev_b32 v222, 16, v159
    v_and_b32 v223, 0xffff0000, v159
    v_mfma_f32_32x32x16_bf16 v[96:111], a[24:27], v[176:179], v[96:111]
    buffer_load_dwordx4 v[152:155], v232, s[12:15], s34 offen offset:2048 sc1
    v_fma_f32 v222, v222, v236, v237
    v_fma_f32 v223, v223, v236, v237
    v_fma_f32 v222, v222, v206, v214
    v_fma_f32 v223, v223, v207, v215
    v_cvt_pk_bf16_f32 v183, v222, v223
    v_mfma_f32_32x32x16_bf16 v[112:127], a[28:31], v[176:179], v[112:127]
    s_waitcnt lgkmcnt(0)
    v_mfma_f32_32x32x16_bf16 v[0:15], a[32:35], v[180:183], v[0:15]
    s_waitcnt vmcnt(18)
    s_barrier
    v_lshlrev_b32 v216, 16, v160
    v_and_b32 v217, 0xffff0000, v160
    v_mfma_f32_32x32x16_bf16 v[16:31], a[36:39], v[180:183], v[16:31]
    ds_read_b128 v[200:203], v234 offset:1152
    ds_read_b128 v[204:207], v234 offset:1168
    ds_read_b128 v[208:211], v234 offset:1184
    ds_read_b128 v[212:215], v234 offset:1200
    v_fma_f32 v216, v216, v236, v237
    v_fma_f32 v217, v217, v236, v237
    v_fma_f32 v216, v216, v184, v192
    v_fma_f32 v217, v217, v185, v193
    v_mfma_f32_32x32x16_bf16 v[32:47], a[40:43], v[180:183], v[32:47]
    ds_read_b64_tr_b16 a[0:1], v224 offset:16384
    ds_read_b64_tr_b16 a[2:3], v224 offset:17408
    ds_read_b64_tr_b16 a[4:5], v225 offset:16384
    ds_read_b64_tr_b16 a[6:7], v225 offset:17408
    v_cvt_pk_bf16_f32 v176, v216, v217
    v_lshlrev_b32 v218, 16, v161
    v_and_b32 v219, 0xffff0000, v161
    v_fma_f32 v218, v218, v236, v237
    v_mfma_f32_32x32x16_bf16 v[48:63], a[44:47], v[180:183], v[48:63]
    ds_read_b64_tr_b16 a[8:9], v226 offset:16384
    ds_read_b64_tr_b16 a[10:11], v226 offset:17408
    ds_read_b64_tr_b16 a[12:13], v227 offset:16384
    ds_read_b64_tr_b16 a[14:15], v227 offset:17408
    v_fma_f32 v219, v219, v236, v237
    v_fma_f32 v218, v218, v186, v194
    v_fma_f32 v219, v219, v187, v195
    v_cvt_pk_bf16_f32 v177, v218, v219
    v_mfma_f32_32x32x16_bf16 v[64:79], a[48:51], v[180:183], v[64:79]
    ds_read_b64_tr_b16 a[16:17], v224 offset:49152
    ds_read_b64_tr_b16 a[18:19], v224 offset:50176
    ds_read_b64_tr_b16 a[20:21], v225 offset:49152
    ds_read_b64_tr_b16 a[22:23], v225 offset:50176
    v_lshlrev_b32 v220, 16, v162
    v_and_b32 v221, 0xffff0000, v162
    v_fma_f32 v220, v220, v236, v237
    v_fma_f32 v221, v221, v236, v237
    v_mfma_f32_32x32x16_bf16 v[80:95], a[52:55], v[180:183], v[80:95]
    ds_read_b64_tr_b16 a[24:25], v226 offset:49152
    ds_read_b64_tr_b16 a[26:27], v226 offset:50176
    ds_read_b64_tr_b16 a[28:29], v227 offset:49152
    ds_read_b64_tr_b16 a[30:31], v227 offset:50176
    v_fma_f32 v220, v220, v188, v196
    v_fma_f32 v221, v221, v189, v197
    v_cvt_pk_bf16_f32 v178, v220, v221
    v_lshlrev_b32 v222, 16, v163
    v_mfma_f32_32x32x16_bf16 v[96:111], a[56:59], v[180:183], v[96:111]
    buffer_load_dwordx4 v[156:159], v232, s[12:15], s34 offen offset:3072 sc1
    v_and_b32 v223, 0xffff0000, v163
    v_fma_f32 v222, v222, v236, v237
    v_fma_f32 v223, v223, v236, v237
    v_fma_f32 v222, v222, v190, v198
    v_fma_f32 v223, v223, v191, v199
    v_cvt_pk_bf16_f32 v179, v222, v223
    v_mfma_f32_32x32x16_bf16 v[112:127], a[60:63], v[180:183], v[112:127]
    s_waitcnt lgkmcnt(0)
    v_mfma_f32_32x32x16_bf16 v[0:15], a[0:3], v[176:179], v[0:15]
    s_waitcnt vmcnt(18)
    ds_read_b128 v[184:187], v234 offset:1280
    ds_read_b128 v[188:191], v234 offset:1296
    ds_read_b128 v[192:195], v234 offset:1312
    ds_read_b128 v[196:199], v234 offset:1328
    v_lshlrev_b32 v216, 16, v164
    v_and_b32 v217, 0xffff0000, v164
    v_fma_f32 v216, v216, v236, v237
    v_fma_f32 v217, v217, v236, v237
    v_fma_f32 v216, v216, v200, v208
    v_fma_f32 v217, v217, v201, v209
    v_mfma_f32_32x32x16_bf16 v[16:31], a[4:7], v[176:179], v[16:31]
    ds_read_b64_tr_b16 a[32:33], v224 offset:20480
    ds_read_b64_tr_b16 a[34:35], v224 offset:21504
    ds_read_b64_tr_b16 a[36:37], v225 offset:20480
    ds_read_b64_tr_b16 a[38:39], v225 offset:21504
    v_cvt_pk_bf16_f32 v180, v216, v217
    v_lshlrev_b32 v218, 16, v165
    v_and_b32 v219, 0xffff0000, v165
    v_fma_f32 v218, v218, v236, v237
    v_fma_f32 v219, v219, v236, v237
    v_fma_f32 v218, v218, v202, v210
    v_mfma_f32_32x32x16_bf16 v[32:47], a[8:11], v[176:179], v[32:47]
    ds_read_b64_tr_b16 a[40:41], v226 offset:20480
    ds_read_b64_tr_b16 a[42:43], v226 offset:21504
    ds_read_b64_tr_b16 a[44:45], v227 offset:20480
    ds_read_b64_tr_b16 a[46:47], v227 offset:21504
    v_fma_f32 v219, v219, v203, v211
    v_cvt_pk_bf16_f32 v181, v218, v219
    v_lshlrev_b32 v220, 16, v166
    s_add_u32 m0, s38, 65536
    s_add_u32 s33, s36, 1146880
    v_mfma_f32_32x32x16_bf16 v[48:63], a[12:15], v[176:179], v[48:63]
    buffer_load_dwordx4 v233, s[8:11], s33 offen offset:0 lds
    ds_read_b64_tr_b16 a[48:49], v224 offset:53248
    ds_read_b64_tr_b16 a[50:51], v224 offset:54272
    ds_read_b64_tr_b16 a[52:53], v225 offset:53248
    ds_read_b64_tr_b16 a[54:55], v225 offset:54272
    s_add_u32 s33, s36, 1160192
    v_mfma_f32_32x32x16_bf16 v[64:79], a[16:19], v[176:179], v[64:79]
    buffer_load_dwordx4 v233, s[8:11], s33 offen offset:1024 lds
    ds_read_b64_tr_b16 a[56:57], v226 offset:53248
    ds_read_b64_tr_b16 a[58:59], v226 offset:54272
    ds_read_b64_tr_b16 a[60:61], v227 offset:53248
    ds_read_b64_tr_b16 a[62:63], v227 offset:54272
    v_and_b32 v221, 0xffff0000, v166
    s_add_u32 s33, s36, 1173504
    v_mfma_f32_32x32x16_bf16 v[80:95], a[20:23], v[176:179], v[80:95]
    buffer_load_dwordx4 v233, s[8:11], s33 offen offset:2048 lds
    v_fma_f32 v220, v220, v236, v237
    v_fma_f32 v221, v221, v236, v237
    v_fma_f32 v220, v220, v204, v212
    v_fma_f32 v221, v221, v205, v213
    v_cvt_pk_bf16_f32 v182, v220, v221
    v_lshlrev_b32 v222, 16, v167
    v_and_b32 v223, 0xffff0000, v167
    s_add_u32 s33, s36, 1186816
    v_mfma_f32_32x32x16_bf16 v[96:111], a[24:27], v[176:179], v[96:111]
    buffer_load_dwordx4 v233, s[8:11], s33 offen offset:3072 lds
    v_fma_f32 v222, v222, v236, v237
    v_fma_f32 v223, v223, v236, v237
    v_fma_f32 v222, v222, v206, v214
    v_fma_f32 v223, v223, v207, v215
    v_cvt_pk_bf16_f32 v183, v222, v223
    s_add_u32 m0, s38, 98304
    s_add_u32 s33, s36, 1146880
    v_mfma_f32_32x32x16_bf16 v[112:127], a[28:31], v[176:179], v[112:127]
    s_waitcnt lgkmcnt(0)
    buffer_load_dwordx4 v233, s[20:23], s33 offen offset:0 lds
    v_mfma_f32_32x32x16_bf16 v[0:15], a[32:35], v[180:183], v[0:15]
    s_waitcnt vmcnt(22)
    ds_read_b128 v[200:203], v234 offset:1408
    ds_read_b128 v[204:207], v234 offset:1424
    ds_read_b128 v[208:211], v234 offset:1440
    ds_read_b128 v[212:215], v234 offset:1456
    v_lshlrev_b32 v216, 16, v168
    v_and_b32 v217, 0xffff0000, v168
    v_fma_f32 v216, v216, v236, v237
    v_fma_f32 v217, v217, v236, v237
    v_fma_f32 v216, v216, v184, v192
    v_mfma_f32_32x32x16_bf16 v[16:31], a[36:39], v[180:183], v[16:31]
    ds_read_b64_tr_b16 a[0:1], v224 offset:24576
    ds_read_b64_tr_b16 a[2:3], v224 offset:25600
    ds_read_b64_tr_b16 a[4:5], v225 offset:24576
    ds_read_b64_tr_b16 a[6:7], v225 offset:25600
    v_fma_f32 v217, v217, v185, v193
    v_cvt_pk_bf16_f32 v176, v216, v217
    v_lshlrev_b32 v218, 16, v169
    v_and_b32 v219, 0xffff0000, v169
    v_fma_f32 v218, v218, v236, v237
    v_mfma_f32_32x32x16_bf16 v[32:47], a[40:43], v[180:183], v[32:47]
    ds_read_b64_tr_b16 a[8:9], v226 offset:24576
    ds_read_b64_tr_b16 a[10:11], v226 offset:25600
    ds_read_b64_tr_b16 a[12:13], v227 offset:24576
    ds_read_b64_tr_b16 a[14:15], v227 offset:25600
    v_fma_f32 v219, v219, v236, v237
    v_fma_f32 v218, v218, v186, v194
    v_fma_f32 v219, v219, v187, v195
    v_cvt_pk_bf16_f32 v177, v218, v219
    s_add_u32 s33, s36, 1160192
    v_mfma_f32_32x32x16_bf16 v[48:63], a[44:47], v[180:183], v[48:63]
    buffer_load_dwordx4 v233, s[20:23], s33 offen offset:1024 lds
    ds_read_b64_tr_b16 a[16:17], v224 offset:57344
    ds_read_b64_tr_b16 a[18:19], v224 offset:58368
    ds_read_b64_tr_b16 a[20:21], v225 offset:57344
    ds_read_b64_tr_b16 a[22:23], v225 offset:58368
    v_lshlrev_b32 v220, 16, v170
    s_add_u32 s33, s36, 1173504
    v_mfma_f32_32x32x16_bf16 v[64:79], a[48:51], v[180:183], v[64:79]
    buffer_load_dwordx4 v233, s[20:23], s33 offen offset:2048 lds
    ds_read_b64_tr_b16 a[24:25], v226 offset:57344
    ds_read_b64_tr_b16 a[26:27], v226 offset:58368
    ds_read_b64_tr_b16 a[28:29], v227 offset:57344
    ds_read_b64_tr_b16 a[30:31], v227 offset:58368
    s_add_u32 s33, s36, 1186816
    v_mfma_f32_32x32x16_bf16 v[80:95], a[52:55], v[180:183], v[80:95]
    buffer_load_dwordx4 v233, s[20:23], s33 offen offset:3072 lds
    v_and_b32 v221, 0xffff0000, v170
    v_fma_f32 v220, v220, v236, v237
    v_fma_f32 v221, v221, v236, v237
    v_fma_f32 v220, v220, v188, v196
    v_fma_f32 v221, v221, v189, v197
    v_cvt_pk_bf16_f32 v178, v220, v221
    s_add_u32 s34, s35, 20480
    v_mfma_f32_32x32x16_bf16 v[96:111], a[56:59], v[180:183], v[96:111]
    buffer_load_dwordx4 v[160:163], v232, s[12:15], s34 offen offset:0 sc1
    v_lshlrev_b32 v222, 16, v171
    v_and_b32 v223, 0xffff0000, v171
    v_fma_f32 v222, v222, v236, v237
    v_fma_f32 v223, v223, v236, v237
    v_fma_f32 v222, v222, v190, v198
    v_fma_f32 v223, v223, v191, v199
    v_cvt_pk_bf16_f32 v179, v222, v223
    v_mfma_f32_32x32x16_bf16 v[112:127], a[60:63], v[180:183], v[112:127]
    s_waitcnt lgkmcnt(0)
    buffer_load_dwordx4 v[164:167], v232, s[12:15], s34 offen offset:1024 sc1
    v_mfma_f32_32x32x16_bf16 v[0:15], a[0:3], v[176:179], v[0:15]
    s_waitcnt vmcnt(26)
    ds_read_b128 v[184:187], v234 offset:1536
    ds_read_b128 v[188:191], v234 offset:1552
    ds_read_b128 v[192:195], v234 offset:1568
    ds_read_b128 v[196:199], v234 offset:1584
    v_lshlrev_b32 v216, 16, v172
    v_and_b32 v217, 0xffff0000, v172
    v_fma_f32 v216, v216, v236, v237
    v_mfma_f32_32x32x16_bf16 v[16:31], a[4:7], v[176:179], v[16:31]
    ds_read_b64_tr_b16 a[32:33], v224 offset:28672
    ds_read_b64_tr_b16 a[34:35], v224 offset:29696
    ds_read_b64_tr_b16 a[36:37], v225 offset:28672
    ds_read_b64_tr_b16 a[38:39], v225 offset:29696
    v_fma_f32 v217, v217, v236, v237
    v_fma_f32 v216, v216, v200, v208
    v_fma_f32 v217, v217, v201, v209
    v_cvt_pk_bf16_f32 v180, v216, v217
    v_mfma_f32_32x32x16_bf16 v[32:47], a[8:11], v[176:179], v[32:47]
    ds_read_b64_tr_b16 a[40:41], v226 offset:28672
    ds_read_b64_tr_b16 a[42:43], v226 offset:29696
    ds_read_b64_tr_b16 a[44:45], v227 offset:28672
    ds_read_b64_tr_b16 a[46:47], v227 offset:29696
    v_lshlrev_b32 v218, 16, v173
    v_and_b32 v219, 0xffff0000, v173
    v_fma_f32 v218, v218, v236, v237
    v_mfma_f32_32x32x16_bf16 v[48:63], a[12:15], v[176:179], v[48:63]
    ds_read_b64_tr_b16 a[48:49], v224 offset:61440
    ds_read_b64_tr_b16 a[50:51], v224 offset:62464
    ds_read_b64_tr_b16 a[52:53], v225 offset:61440
    ds_read_b64_tr_b16 a[54:55], v225 offset:62464
    v_fma_f32 v219, v219, v236, v237
    v_fma_f32 v218, v218, v202, v210
    v_fma_f32 v219, v219, v203, v211
    v_mfma_f32_32x32x16_bf16 v[64:79], a[16:19], v[176:179], v[64:79]
    ds_read_b64_tr_b16 a[56:57], v226 offset:61440
    ds_read_b64_tr_b16 a[58:59], v226 offset:62464
    ds_read_b64_tr_b16 a[60:61], v227 offset:61440
    ds_read_b64_tr_b16 a[62:63], v227 offset:62464
    v_cvt_pk_bf16_f32 v181, v218, v219
    v_lshlrev_b32 v220, 16, v174
    v_and_b32 v221, 0xffff0000, v174
    v_fma_f32 v220, v220, v236, v237
    v_mfma_f32_32x32x16_bf16 v[80:95], a[20:23], v[176:179], v[80:95]
    v_fma_f32 v221, v221, v236, v237
    v_fma_f32 v220, v220, v204, v212
    v_fma_f32 v221, v221, v205, v213
    v_cvt_pk_bf16_f32 v182, v220, v221
    v_lshlrev_b32 v222, 16, v175
    v_and_b32 v223, 0xffff0000, v175
    v_mfma_f32_32x32x16_bf16 v[96:111], a[24:27], v[176:179], v[96:111]
    buffer_load_dwordx4 v[168:171], v232, s[12:15], s34 offen offset:2048 sc1
    v_fma_f32 v222, v222, v236, v237
    v_fma_f32 v223, v223, v236, v237
    v_fma_f32 v222, v222, v206, v214
    v_fma_f32 v223, v223, v207, v215
    v_cvt_pk_bf16_f32 v183, v222, v223
    v_mfma_f32_32x32x16_bf16 v[112:127], a[28:31], v[176:179], v[112:127]
    s_waitcnt lgkmcnt(0)
    v_mfma_f32_32x32x16_bf16 v[0:15], a[32:35], v[180:183], v[0:15]
    s_waitcnt vmcnt(26)
    s_barrier
    v_lshlrev_b32 v216, 16, v128
    v_and_b32 v217, 0xffff0000, v128
    v_mfma_f32_32x32x16_bf16 v[16:31], a[36:39], v[180:183], v[16:31]
    ds_read_b128 v[200:203], v234 offset:1664
    ds_read_b128 v[204:207], v234 offset:1680
    ds_read_b128 v[208:211], v234 offset:1696
    ds_read_b128 v[212:215], v234 offset:1712
    v_fma_f32 v216, v216, v236, v237
    v_fma_f32 v217, v217, v236, v237
    v_fma_f32 v216, v216, v184, v192
    v_fma_f32 v217, v217, v185, v193
    v_mfma_f32_32x32x16_bf16 v[32:47], a[40:43], v[180:183], v[32:47]
    ds_read_b64_tr_b16 a[0:1], v228 offset:16384
    ds_read_b64_tr_b16 a[2:3], v228 offset:17408
    ds_read_b64_tr_b16 a[4:5], v229 offset:16384
    ds_read_b64_tr_b16 a[6:7], v229 offset:17408
    v_cvt_pk_bf16_f32 v176, v216, v217
    v_lshlrev_b32 v218, 16, v129
    v_and_b32 v219, 0xffff0000, v129
    v_fma_f32 v218, v218, v236, v237
    v_mfma_f32_32x32x16_bf16 v[48:63], a[44:47], v[180:183], v[48:63]
    ds_read_b64_tr_b16 a[8:9], v230 offset:16384
    ds_read_b64_tr_b16 a[10:11], v230 offset:17408
    ds_read_b64_tr_b16 a[12:13], v231 offset:16384
    ds_read_b64_tr_b16 a[14:15], v231 offset:17408
    v_fma_f32 v219, v219, v236, v237
    v_fma_f32 v218, v218, v186, v194
    v_fma_f32 v219, v219, v187, v195
    v_cvt_pk_bf16_f32 v177, v218, v219
    v_mfma_f32_32x32x16_bf16 v[64:79], a[48:51], v[180:183], v[64:79]
    ds_read_b64_tr_b16 a[16:17], v228 offset:49152
    ds_read_b64_tr_b16 a[18:19], v228 offset:50176
    ds_read_b64_tr_b16 a[20:21], v229 offset:49152
    ds_read_b64_tr_b16 a[22:23], v229 offset:50176
    v_lshlrev_b32 v220, 16, v130
    v_and_b32 v221, 0xffff0000, v130
    v_fma_f32 v220, v220, v236, v237
    v_fma_f32 v221, v221, v236, v237
    v_mfma_f32_32x32x16_bf16 v[80:95], a[52:55], v[180:183], v[80:95]
    ds_read_b64_tr_b16 a[24:25], v230 offset:49152
    ds_read_b64_tr_b16 a[26:27], v230 offset:50176
    ds_read_b64_tr_b16 a[28:29], v231 offset:49152
    ds_read_b64_tr_b16 a[30:31], v231 offset:50176
    v_fma_f32 v220, v220, v188, v196
    v_fma_f32 v221, v221, v189, v197
    v_cvt_pk_bf16_f32 v178, v220, v221
    v_lshlrev_b32 v222, 16, v131
    v_mfma_f32_32x32x16_bf16 v[96:111], a[56:59], v[180:183], v[96:111]
    buffer_load_dwordx4 v[172:175], v232, s[12:15], s34 offen offset:3072 sc1
    v_and_b32 v223, 0xffff0000, v131
    v_fma_f32 v222, v222, v236, v237
    v_fma_f32 v223, v223, v236, v237
    v_fma_f32 v222, v222, v190, v198
    v_fma_f32 v223, v223, v191, v199
    v_cvt_pk_bf16_f32 v179, v222, v223
    v_mfma_f32_32x32x16_bf16 v[112:127], a[60:63], v[180:183], v[112:127]
    s_waitcnt lgkmcnt(0)
    v_mfma_f32_32x32x16_bf16 v[0:15], a[0:3], v[176:179], v[0:15]
    s_waitcnt vmcnt(26)
    ds_read_b128 v[184:187], v234 offset:1792
    ds_read_b128 v[188:191], v234 offset:1808
    ds_read_b128 v[192:195], v234 offset:1824
    ds_read_b128 v[196:199], v234 offset:1840
    v_lshlrev_b32 v216, 16, v132
    v_and_b32 v217, 0xffff0000, v132
    v_fma_f32 v216, v216, v236, v237
    v_fma_f32 v217, v217, v236, v237
    v_fma_f32 v216, v216, v200, v208
    v_fma_f32 v217, v217, v201, v209
    v_mfma_f32_32x32x16_bf16 v[16:31], a[4:7], v[176:179], v[16:31]
    ds_read_b64_tr_b16 a[32:33], v228 offset:20480
    ds_read_b64_tr_b16 a[34:35], v228 offset:21504
    ds_read_b64_tr_b16 a[36:37], v229 offset:20480
    ds_read_b64_tr_b16 a[38:39], v229 offset:21504
    v_cvt_pk_bf16_f32 v180, v216, v217
    v_lshlrev_b32 v218, 16, v133
    v_and_b32 v219, 0xffff0000, v133
    v_fma_f32 v218, v218, v236, v237
    v_fma_f32 v219, v219, v236, v237
    v_fma_f32 v218, v218, v202, v210
    v_mfma_f32_32x32x16_bf16 v[32:47], a[8:11], v[176:179], v[32:47]
    ds_read_b64_tr_b16 a[40:41], v230 offset:20480
    ds_read_b64_tr_b16 a[42:43], v230 offset:21504
    ds_read_b64_tr_b16 a[44:45], v231 offset:20480
    ds_read_b64_tr_b16 a[46:47], v231 offset:21504
    v_fma_f32 v219, v219, v203, v211
    v_cvt_pk_bf16_f32 v181, v218, v219
    v_lshlrev_b32 v220, 16, v134
    s_add_u32 m0, s38, 16384
    s_add_u32 s33, s36, 1376256
    v_mfma_f32_32x32x16_bf16 v[48:63], a[12:15], v[176:179], v[48:63]
    buffer_load_dwordx4 v233, s[8:11], s33 offen offset:0 lds
    ds_read_b64_tr_b16 a[48:49], v228 offset:53248
    ds_read_b64_tr_b16 a[50:51], v228 offset:54272
    ds_read_b64_tr_b16 a[52:53], v229 offset:53248
    ds_read_b64_tr_b16 a[54:55], v229 offset:54272
    s_add_u32 s33, s36, 1389568
    v_mfma_f32_32x32x16_bf16 v[64:79], a[16:19], v[176:179], v[64:79]
    buffer_load_dwordx4 v233, s[8:11], s33 offen offset:1024 lds
    ds_read_b64_tr_b16 a[56:57], v230 offset:53248
    ds_read_b64_tr_b16 a[58:59], v230 offset:54272
    ds_read_b64_tr_b16 a[60:61], v231 offset:53248
    ds_read_b64_tr_b16 a[62:63], v231 offset:54272
    v_and_b32 v221, 0xffff0000, v134
    s_add_u32 s33, s36, 1402880
    v_mfma_f32_32x32x16_bf16 v[80:95], a[20:23], v[176:179], v[80:95]
    buffer_load_dwordx4 v233, s[8:11], s33 offen offset:2048 lds
    v_fma_f32 v220, v220, v236, v237
    v_fma_f32 v221, v221, v236, v237
    v_fma_f32 v220, v220, v204, v212
    v_fma_f32 v221, v221, v205, v213
    v_cvt_pk_bf16_f32 v182, v220, v221
    v_lshlrev_b32 v222, 16, v135
    v_and_b32 v223, 0xffff0000, v135
    s_add_u32 s33, s36, 1416192
    v_mfma_f32_32x32x16_bf16 v[96:111], a[24:27], v[176:179], v[96:111]
    buffer_load_dwordx4 v233, s[8:11], s33 offen offset:3072 lds
    v_fma_f32 v222, v222, v236, v237
    v_fma_f32 v223, v223, v236, v237
    v_fma_f32 v222, v222, v206, v214
    v_fma_f32 v223, v223, v207, v215
    v_cvt_pk_bf16_f32 v183, v222, v223
    s_add_u32 m0, s38, 49152
    s_add_u32 s33, s36, 1376256
    v_mfma_f32_32x32x16_bf16 v[112:127], a[28:31], v[176:179], v[112:127]
    s_waitcnt lgkmcnt(0)
    buffer_load_dwordx4 v233, s[20:23], s33 offen offset:0 lds
    v_mfma_f32_32x32x16_bf16 v[0:15], a[32:35], v[180:183], v[0:15]
    s_waitcnt vmcnt(30)
    ds_read_b128 v[200:203], v234 offset:1920
    ds_read_b128 v[204:207], v234 offset:1936
    ds_read_b128 v[208:211], v234 offset:1952
    ds_read_b128 v[212:215], v234 offset:1968
    v_lshlrev_b32 v216, 16, v136
    v_and_b32 v217, 0xffff0000, v136
    v_fma_f32 v216, v216, v236, v237
    v_fma_f32 v217, v217, v236, v237
    v_fma_f32 v216, v216, v184, v192
    v_mfma_f32_32x32x16_bf16 v[16:31], a[36:39], v[180:183], v[16:31]
    ds_read_b64_tr_b16 a[0:1], v228 offset:24576
    ds_read_b64_tr_b16 a[2:3], v228 offset:25600
    ds_read_b64_tr_b16 a[4:5], v229 offset:24576
    ds_read_b64_tr_b16 a[6:7], v229 offset:25600
    v_fma_f32 v217, v217, v185, v193
    v_cvt_pk_bf16_f32 v176, v216, v217
    v_lshlrev_b32 v218, 16, v137
    v_and_b32 v219, 0xffff0000, v137
    v_fma_f32 v218, v218, v236, v237
    v_mfma_f32_32x32x16_bf16 v[32:47], a[40:43], v[180:183], v[32:47]
    ds_read_b64_tr_b16 a[8:9], v230 offset:24576
    ds_read_b64_tr_b16 a[10:11], v230 offset:25600
    ds_read_b64_tr_b16 a[12:13], v231 offset:24576
    ds_read_b64_tr_b16 a[14:15], v231 offset:25600
    v_fma_f32 v219, v219, v236, v237
    v_fma_f32 v218, v218, v186, v194
    v_fma_f32 v219, v219, v187, v195
    v_cvt_pk_bf16_f32 v177, v218, v219
    s_add_u32 s33, s36, 1389568
    v_mfma_f32_32x32x16_bf16 v[48:63], a[44:47], v[180:183], v[48:63]
    buffer_load_dwordx4 v233, s[20:23], s33 offen offset:1024 lds
    ds_read_b64_tr_b16 a[16:17], v228 offset:57344
    ds_read_b64_tr_b16 a[18:19], v228 offset:58368
    ds_read_b64_tr_b16 a[20:21], v229 offset:57344
    ds_read_b64_tr_b16 a[22:23], v229 offset:58368
    v_lshlrev_b32 v220, 16, v138
    s_add_u32 s33, s36, 1402880
    v_mfma_f32_32x32x16_bf16 v[64:79], a[48:51], v[180:183], v[64:79]
    buffer_load_dwordx4 v233, s[20:23], s33 offen offset:2048 lds
    ds_read_b64_tr_b16 a[24:25], v230 offset:57344
    ds_read_b64_tr_b16 a[26:27], v230 offset:58368
    ds_read_b64_tr_b16 a[28:29], v231 offset:57344
    ds_read_b64_tr_b16 a[30:31], v231 offset:58368
    s_add_u32 s33, s36, 1416192
    v_mfma_f32_32x32x16_bf16 v[80:95], a[52:55], v[180:183], v[80:95]
    buffer_load_dwordx4 v233, s[20:23], s33 offen offset:3072 lds
    v_and_b32 v221, 0xffff0000, v138
    v_fma_f32 v220, v220, v236, v237
    v_fma_f32 v221, v221, v236, v237
    v_fma_f32 v220, v220, v188, v196
    v_fma_f32 v221, v221, v189, v197
    v_cvt_pk_bf16_f32 v178, v220, v221
    s_add_u32 s34, s35, 24576
    v_mfma_f32_32x32x16_bf16 v[96:111], a[56:59], v[180:183], v[96:111]
    buffer_load_dwordx4 v[128:131], v232, s[12:15], s34 offen offset:0 sc1
    v_lshlrev_b32 v222, 16, v139
    v_and_b32 v223, 0xffff0000, v139
    v_fma_f32 v222, v222, v236, v237
    v_fma_f32 v223, v223, v236, v237
    v_fma_f32 v222, v222, v190, v198
    v_fma_f32 v223, v223, v191, v199
    v_cvt_pk_bf16_f32 v179, v222, v223
    v_mfma_f32_32x32x16_bf16 v[112:127], a[60:63], v[180:183], v[112:127]
    s_waitcnt lgkmcnt(0)
    buffer_load_dwordx4 v[132:135], v232, s[12:15], s34 offen offset:1024 sc1
    v_mfma_f32_32x32x16_bf16 v[0:15], a[0:3], v[176:179], v[0:15]
    s_waitcnt vmcnt(34)
    ds_read_b128 v[184:187], v234 offset:2048
    ds_read_b128 v[188:191], v234 offset:2064
    ds_read_b128 v[192:195], v234 offset:2080
    ds_read_b128 v[196:199], v234 offset:2096
    v_lshlrev_b32 v216, 16, v140
    v_and_b32 v217, 0xffff0000, v140
    v_fma_f32 v216, v216, v236, v237
    v_mfma_f32_32x32x16_bf16 v[16:31], a[4:7], v[176:179], v[16:31]
    ds_read_b64_tr_b16 a[32:33], v228 offset:28672
    ds_read_b64_tr_b16 a[34:35], v228 offset:29696
    ds_read_b64_tr_b16 a[36:37], v229 offset:28672
    ds_read_b64_tr_b16 a[38:39], v229 offset:29696
    v_fma_f32 v217, v217, v236, v237
    v_fma_f32 v216, v216, v200, v208
    v_fma_f32 v217, v217, v201, v209
    v_cvt_pk_bf16_f32 v180, v216, v217
    v_mfma_f32_32x32x16_bf16 v[32:47], a[8:11], v[176:179], v[32:47]
    ds_read_b64_tr_b16 a[40:41], v230 offset:28672
    ds_read_b64_tr_b16 a[42:43], v230 offset:29696
    ds_read_b64_tr_b16 a[44:45], v231 offset:28672
    ds_read_b64_tr_b16 a[46:47], v231 offset:29696
    v_lshlrev_b32 v218, 16, v141
    v_and_b32 v219, 0xffff0000, v141
    v_fma_f32 v218, v218, v236, v237
    v_mfma_f32_32x32x16_bf16 v[48:63], a[12:15], v[176:179], v[48:63]
    ds_read_b64_tr_b16 a[48:49], v228 offset:61440
    ds_read_b64_tr_b16 a[50:51], v228 offset:62464
    ds_read_b64_tr_b16 a[52:53], v229 offset:61440
    ds_read_b64_tr_b16 a[54:55], v229 offset:62464
    v_fma_f32 v219, v219, v236, v237
    v_fma_f32 v218, v218, v202, v210
    v_fma_f32 v219, v219, v203, v211
    v_mfma_f32_32x32x16_bf16 v[64:79], a[16:19], v[176:179], v[64:79]
    ds_read_b64_tr_b16 a[56:57], v230 offset:61440
    ds_read_b64_tr_b16 a[58:59], v230 offset:62464
    ds_read_b64_tr_b16 a[60:61], v231 offset:61440
    ds_read_b64_tr_b16 a[62:63], v231 offset:62464
    v_cvt_pk_bf16_f32 v181, v218, v219
    v_lshlrev_b32 v220, 16, v142
    v_and_b32 v221, 0xffff0000, v142
    v_fma_f32 v220, v220, v236, v237
    v_mfma_f32_32x32x16_bf16 v[80:95], a[20:23], v[176:179], v[80:95]
    v_fma_f32 v221, v221, v236, v237
    v_fma_f32 v220, v220, v204, v212
    v_fma_f32 v221, v221, v205, v213
    v_cvt_pk_bf16_f32 v182, v220, v221
    v_lshlrev_b32 v222, 16, v143
    v_and_b32 v223, 0xffff0000, v143
    v_mfma_f32_32x32x16_bf16 v[96:111], a[24:27], v[176:179], v[96:111]
    buffer_load_dwordx4 v[136:139], v232, s[12:15], s34 offen offset:2048 sc1
    v_fma_f32 v222, v222, v236, v237
    v_fma_f32 v223, v223, v236, v237
    v_fma_f32 v222, v222, v206, v214
    v_fma_f32 v223, v223, v207, v215
    v_cvt_pk_bf16_f32 v183, v222, v223
    v_mfma_f32_32x32x16_bf16 v[112:127], a[28:31], v[176:179], v[112:127]
    s_waitcnt lgkmcnt(0)
    v_mfma_f32_32x32x16_bf16 v[0:15], a[32:35], v[180:183], v[0:15]
    s_waitcnt vmcnt(26)
    s_barrier
    v_lshlrev_b32 v216, 16, v144
    v_and_b32 v217, 0xffff0000, v144
    v_mfma_f32_32x32x16_bf16 v[16:31], a[36:39], v[180:183], v[16:31]
    ds_read_b128 v[200:203], v234 offset:2176
    ds_read_b128 v[204:207], v234 offset:2192
    ds_read_b128 v[208:211], v234 offset:2208
    ds_read_b128 v[212:215], v234 offset:2224
    v_fma_f32 v216, v216, v236, v237
    v_fma_f32 v217, v217, v236, v237
    v_fma_f32 v216, v216, v184, v192
    v_fma_f32 v217, v217, v185, v193
    v_mfma_f32_32x32x16_bf16 v[32:47], a[40:43], v[180:183], v[32:47]
    ds_read_b64_tr_b16 a[0:1], v224 offset:0
    ds_read_b64_tr_b16 a[2:3], v224 offset:1024
    ds_read_b64_tr_b16 a[4:5], v225 offset:0
    ds_read_b64_tr_b16 a[6:7], v225 offset:1024
    v_cvt_pk_bf16_f32 v176, v216, v217
    v_lshlrev_b32 v218, 16, v145
    v_and_b32 v219, 0xffff0000, v145
    v_fma_f32 v218, v218, v236, v237
    v_mfma_f32_32x32x16_bf16 v[48:63], a[44:47], v[180:183], v[48:63]
    ds_read_b64_tr_b16 a[8:9], v226 offset:0
    ds_read_b64_tr_b16 a[10:11], v226 offset:1024
    ds_read_b64_tr_b16 a[12:13], v227 offset:0
    ds_read_b64_tr_b16 a[14:15], v227 offset:1024
    v_fma_f32 v219, v219, v236, v237
    v_fma_f32 v218, v218, v186, v194
    v_fma_f32 v219, v219, v187, v195
    v_cvt_pk_bf16_f32 v177, v218, v219
    v_mfma_f32_32x32x16_bf16 v[64:79], a[48:51], v[180:183], v[64:79]
    ds_read_b64_tr_b16 a[16:17], v224 offset:32768
    ds_read_b64_tr_b16 a[18:19], v224 offset:33792
    ds_read_b64_tr_b16 a[20:21], v225 offset:32768
    ds_read_b64_tr_b16 a[22:23], v225 offset:33792
    v_lshlrev_b32 v220, 16, v146
    v_and_b32 v221, 0xffff0000, v146
    v_fma_f32 v220, v220, v236, v237
    v_fma_f32 v221, v221, v236, v237
    v_mfma_f32_32x32x16_bf16 v[80:95], a[52:55], v[180:183], v[80:95]
    ds_read_b64_tr_b16 a[24:25], v226 offset:32768
    ds_read_b64_tr_b16 a[26:27], v226 offset:33792
    ds_read_b64_tr_b16 a[28:29], v227 offset:32768
    ds_read_b64_tr_b16 a[30:31], v227 offset:33792
    v_fma_f32 v220, v220, v188, v196
    v_fma_f32 v221, v221, v189, v197
    v_cvt_pk_bf16_f32 v178, v220, v221
    v_lshlrev_b32 v222, 16, v147
    v_mfma_f32_32x32x16_bf16 v[96:111], a[56:59], v[180:183], v[96:111]
    buffer_load_dwordx4 v[140:143], v232, s[12:15], s34 offen offset:3072 sc1
    v_and_b32 v223, 0xffff0000, v147
    v_fma_f32 v222, v222, v236, v237
    v_fma_f32 v223, v223, v236, v237
    v_fma_f32 v222, v222, v190, v198
    v_fma_f32 v223, v223, v191, v199
    v_cvt_pk_bf16_f32 v179, v222, v223
    v_mfma_f32_32x32x16_bf16 v[112:127], a[60:63], v[180:183], v[112:127]
    s_waitcnt lgkmcnt(0)
    v_mfma_f32_32x32x16_bf16 v[0:15], a[0:3], v[176:179], v[0:15]
    s_waitcnt vmcnt(26)
    ds_read_b128 v[184:187], v234 offset:2304
    ds_read_b128 v[188:191], v234 offset:2320
    ds_read_b128 v[192:195], v234 offset:2336
    ds_read_b128 v[196:199], v234 offset:2352
    v_lshlrev_b32 v216, 16, v148
    v_and_b32 v217, 0xffff0000, v148
    v_fma_f32 v216, v216, v236, v237
    v_fma_f32 v217, v217, v236, v237
    v_fma_f32 v216, v216, v200, v208
    v_fma_f32 v217, v217, v201, v209
    v_mfma_f32_32x32x16_bf16 v[16:31], a[4:7], v[176:179], v[16:31]
    ds_read_b64_tr_b16 a[32:33], v224 offset:4096
    ds_read_b64_tr_b16 a[34:35], v224 offset:5120
    ds_read_b64_tr_b16 a[36:37], v225 offset:4096
    ds_read_b64_tr_b16 a[38:39], v225 offset:5120
    v_cvt_pk_bf16_f32 v180, v216, v217
    v_lshlrev_b32 v218, 16, v149
    v_and_b32 v219, 0xffff0000, v149
    v_fma_f32 v218, v218, v236, v237
    v_fma_f32 v219, v219, v236, v237
    v_fma_f32 v218, v218, v202, v210
    v_mfma_f32_32x32x16_bf16 v[32:47], a[8:11], v[176:179], v[32:47]
    ds_read_b64_tr_b16 a[40:41], v226 offset:4096
    ds_read_b64_tr_b16 a[42:43], v226 offset:5120
    ds_read_b64_tr_b16 a[44:45], v227 offset:4096
    ds_read_b64_tr_b16 a[46:47], v227 offset:5120
    v_fma_f32 v219, v219, v203, v211
    v_cvt_pk_bf16_f32 v181, v218, v219
    v_lshlrev_b32 v220, 16, v150
    s_add_u32 m0, s38, 81920
    s_add_u32 s33, s36, 1605632
    v_mfma_f32_32x32x16_bf16 v[48:63], a[12:15], v[176:179], v[48:63]
    buffer_load_dwordx4 v233, s[8:11], s33 offen offset:0 lds
    ds_read_b64_tr_b16 a[48:49], v224 offset:36864
    ds_read_b64_tr_b16 a[50:51], v224 offset:37888
    ds_read_b64_tr_b16 a[52:53], v225 offset:36864
    ds_read_b64_tr_b16 a[54:55], v225 offset:37888
    s_add_u32 s33, s36, 1618944
    v_mfma_f32_32x32x16_bf16 v[64:79], a[16:19], v[176:179], v[64:79]
    buffer_load_dwordx4 v233, s[8:11], s33 offen offset:1024 lds
    ds_read_b64_tr_b16 a[56:57], v226 offset:36864
    ds_read_b64_tr_b16 a[58:59], v226 offset:37888
    ds_read_b64_tr_b16 a[60:61], v227 offset:36864
    ds_read_b64_tr_b16 a[62:63], v227 offset:37888
    v_and_b32 v221, 0xffff0000, v150
    s_add_u32 s33, s36, 1632256
    v_mfma_f32_32x32x16_bf16 v[80:95], a[20:23], v[176:179], v[80:95]
    buffer_load_dwordx4 v233, s[8:11], s33 offen offset:2048 lds
    v_fma_f32 v220, v220, v236, v237
    v_fma_f32 v221, v221, v236, v237
    v_fma_f32 v220, v220, v204, v212
    v_fma_f32 v221, v221, v205, v213
    v_cvt_pk_bf16_f32 v182, v220, v221
    v_lshlrev_b32 v222, 16, v151
    v_and_b32 v223, 0xffff0000, v151
    s_add_u32 s33, s36, 1645568
    v_mfma_f32_32x32x16_bf16 v[96:111], a[24:27], v[176:179], v[96:111]
    buffer_load_dwordx4 v233, s[8:11], s33 offen offset:3072 lds
    v_fma_f32 v222, v222, v236, v237
    v_fma_f32 v223, v223, v236, v237
    v_fma_f32 v222, v222, v206, v214
    v_fma_f32 v223, v223, v207, v215
    v_cvt_pk_bf16_f32 v183, v222, v223
    s_add_u32 m0, s38, 114688
    s_add_u32 s33, s36, 1605632
    v_mfma_f32_32x32x16_bf16 v[112:127], a[28:31], v[176:179], v[112:127]
    s_waitcnt lgkmcnt(0)
    buffer_load_dwordx4 v233, s[20:23], s33 offen offset:0 lds
    v_mfma_f32_32x32x16_bf16 v[0:15], a[32:35], v[180:183], v[0:15]
    s_waitcnt vmcnt(30)
    ds_read_b128 v[200:203], v234 offset:2432
    ds_read_b128 v[204:207], v234 offset:2448
    ds_read_b128 v[208:211], v234 offset:2464
    ds_read_b128 v[212:215], v234 offset:2480
    v_lshlrev_b32 v216, 16, v152
    v_and_b32 v217, 0xffff0000, v152
    v_fma_f32 v216, v216, v236, v237
    v_fma_f32 v217, v217, v236, v237
    v_fma_f32 v216, v216, v184, v192
    v_mfma_f32_32x32x16_bf16 v[16:31], a[36:39], v[180:183], v[16:31]
    ds_read_b64_tr_b16 a[0:1], v224 offset:8192
    ds_read_b64_tr_b16 a[2:3], v224 offset:9216
    ds_read_b64_tr_b16 a[4:5], v225 offset:8192
    ds_read_b64_tr_b16 a[6:7], v225 offset:9216
    v_fma_f32 v217, v217, v185, v193
    v_cvt_pk_bf16_f32 v176, v216, v217
    v_lshlrev_b32 v218, 16, v153
    v_and_b32 v219, 0xffff0000, v153
    v_fma_f32 v218, v218, v236, v237
    v_mfma_f32_32x32x16_bf16 v[32:47], a[40:43], v[180:183], v[32:47]
    ds_read_b64_tr_b16 a[8:9], v226 offset:8192
    ds_read_b64_tr_b16 a[10:11], v226 offset:9216
    ds_read_b64_tr_b16 a[12:13], v227 offset:8192
    ds_read_b64_tr_b16 a[14:15], v227 offset:9216
    v_fma_f32 v219, v219, v236, v237
    v_fma_f32 v218, v218, v186, v194
    v_fma_f32 v219, v219, v187, v195
    v_cvt_pk_bf16_f32 v177, v218, v219
    s_add_u32 s33, s36, 1618944
    v_mfma_f32_32x32x16_bf16 v[48:63], a[44:47], v[180:183], v[48:63]
    buffer_load_dwordx4 v233, s[20:23], s33 offen offset:1024 lds
    ds_read_b64_tr_b16 a[16:17], v224 offset:40960
    ds_read_b64_tr_b16 a[18:19], v224 offset:41984
    ds_read_b64_tr_b16 a[20:21], v225 offset:40960
    ds_read_b64_tr_b16 a[22:23], v225 offset:41984
    v_lshlrev_b32 v220, 16, v154
    s_add_u32 s33, s36, 1632256
    v_mfma_f32_32x32x16_bf16 v[64:79], a[48:51], v[180:183], v[64:79]
    buffer_load_dwordx4 v233, s[20:23], s33 offen offset:2048 lds
    ds_read_b64_tr_b16 a[24:25], v226 offset:40960
    ds_read_b64_tr_b16 a[26:27], v226 offset:41984
    ds_read_b64_tr_b16 a[28:29], v227 offset:40960
    ds_read_b64_tr_b16 a[30:31], v227 offset:41984
    s_add_u32 s33, s36, 1645568
    v_mfma_f32_32x32x16_bf16 v[80:95], a[52:55], v[180:183], v[80:95]
    buffer_load_dwordx4 v233, s[20:23], s33 offen offset:3072 lds
    v_and_b32 v221, 0xffff0000, v154
    v_fma_f32 v220, v220, v236, v237
    v_fma_f32 v221, v221, v236, v237
    v_fma_f32 v220, v220, v188, v196
    v_fma_f32 v221, v221, v189, v197
    v_cvt_pk_bf16_f32 v178, v220, v221
    s_add_u32 s34, s35, 28672
    v_mfma_f32_32x32x16_bf16 v[96:111], a[56:59], v[180:183], v[96:111]
    buffer_load_dwordx4 v[144:147], v232, s[12:15], s34 offen offset:0 sc1
    v_lshlrev_b32 v222, 16, v155
    v_and_b32 v223, 0xffff0000, v155
    v_fma_f32 v222, v222, v236, v237
    v_fma_f32 v223, v223, v236, v237
    v_fma_f32 v222, v222, v190, v198
    v_fma_f32 v223, v223, v191, v199
    v_cvt_pk_bf16_f32 v179, v222, v223
    v_mfma_f32_32x32x16_bf16 v[112:127], a[60:63], v[180:183], v[112:127]
    s_waitcnt lgkmcnt(0)
    buffer_load_dwordx4 v[148:151], v232, s[12:15], s34 offen offset:1024 sc1
    v_mfma_f32_32x32x16_bf16 v[0:15], a[0:3], v[176:179], v[0:15]
    s_waitcnt vmcnt(34)
    ds_read_b128 v[184:187], v234 offset:2560
    ds_read_b128 v[188:191], v234 offset:2576
    ds_read_b128 v[192:195], v234 offset:2592
    ds_read_b128 v[196:199], v234 offset:2608
    v_lshlrev_b32 v216, 16, v156
    v_and_b32 v217, 0xffff0000, v156
    v_fma_f32 v216, v216, v236, v237
    v_mfma_f32_32x32x16_bf16 v[16:31], a[4:7], v[176:179], v[16:31]
    ds_read_b64_tr_b16 a[32:33], v224 offset:12288
    ds_read_b64_tr_b16 a[34:35], v224 offset:13312
    ds_read_b64_tr_b16 a[36:37], v225 offset:12288
    ds_read_b64_tr_b16 a[38:39], v225 offset:13312
    v_fma_f32 v217, v217, v236, v237
    v_fma_f32 v216, v216, v200, v208
    v_fma_f32 v217, v217, v201, v209
    v_cvt_pk_bf16_f32 v180, v216, v217
    v_mfma_f32_32x32x16_bf16 v[32:47], a[8:11], v[176:179], v[32:47]
    ds_read_b64_tr_b16 a[40:41], v226 offset:12288
    ds_read_b64_tr_b16 a[42:43], v226 offset:13312
    ds_read_b64_tr_b16 a[44:45], v227 offset:12288
    ds_read_b64_tr_b16 a[46:47], v227 offset:13312
    v_lshlrev_b32 v218, 16, v157
    v_and_b32 v219, 0xffff0000, v157
    v_fma_f32 v218, v218, v236, v237
    v_mfma_f32_32x32x16_bf16 v[48:63], a[12:15], v[176:179], v[48:63]
    ds_read_b64_tr_b16 a[48:49], v224 offset:45056
    ds_read_b64_tr_b16 a[50:51], v224 offset:46080
    ds_read_b64_tr_b16 a[52:53], v225 offset:45056
    ds_read_b64_tr_b16 a[54:55], v225 offset:46080
    v_fma_f32 v219, v219, v236, v237
    v_fma_f32 v218, v218, v202, v210
    v_fma_f32 v219, v219, v203, v211
    v_mfma_f32_32x32x16_bf16 v[64:79], a[16:19], v[176:179], v[64:79]
    ds_read_b64_tr_b16 a[56:57], v226 offset:45056
    ds_read_b64_tr_b16 a[58:59], v226 offset:46080
    ds_read_b64_tr_b16 a[60:61], v227 offset:45056
    ds_read_b64_tr_b16 a[62:63], v227 offset:46080
    v_cvt_pk_bf16_f32 v181, v218, v219
    v_lshlrev_b32 v220, 16, v158
    v_and_b32 v221, 0xffff0000, v158
    v_fma_f32 v220, v220, v236, v237
    v_mfma_f32_32x32x16_bf16 v[80:95], a[20:23], v[176:179], v[80:95]
    v_fma_f32 v221, v221, v236, v237
    v_fma_f32 v220, v220, v204, v212
    v_fma_f32 v221, v221, v205, v213
    v_cvt_pk_bf16_f32 v182, v220, v221
    v_lshlrev_b32 v222, 16, v159
    v_and_b32 v223, 0xffff0000, v159
    v_mfma_f32_32x32x16_bf16 v[96:111], a[24:27], v[176:179], v[96:111]
    buffer_load_dwordx4 v[152:155], v232, s[12:15], s34 offen offset:2048 sc1
    v_fma_f32 v222, v222, v236, v237
    v_fma_f32 v223, v223, v236, v237
    v_fma_f32 v222, v222, v206, v214
    v_fma_f32 v223, v223, v207, v215
    v_cvt_pk_bf16_f32 v183, v222, v223
    v_mfma_f32_32x32x16_bf16 v[112:127], a[28:31], v[176:179], v[112:127]
    s_waitcnt lgkmcnt(0)
    v_mfma_f32_32x32x16_bf16 v[0:15], a[32:35], v[180:183], v[0:15]
    s_waitcnt vmcnt(26)
    s_barrier
    v_lshlrev_b32 v216, 16, v160
    v_and_b32 v217, 0xffff0000, v160
    v_mfma_f32_32x32x16_bf16 v[16:31], a[36:39], v[180:183], v[16:31]
    ds_read_b128 v[200:203], v234 offset:2688
    ds_read_b128 v[204:207], v234 offset:2704
    ds_read_b128 v[208:211], v234 offset:2720
    ds_read_b128 v[212:215], v234 offset:2736
    v_fma_f32 v216, v216, v236, v237
    v_fma_f32 v217, v217, v236, v237
    v_fma_f32 v216, v216, v184, v192
    v_fma_f32 v217, v217, v185, v193
    v_mfma_f32_32x32x16_bf16 v[32:47], a[40:43], v[180:183], v[32:47]
    ds_read_b64_tr_b16 a[0:1], v228 offset:0
    ds_read_b64_tr_b16 a[2:3], v228 offset:1024
    ds_read_b64_tr_b16 a[4:5], v229 offset:0
    ds_read_b64_tr_b16 a[6:7], v229 offset:1024
    v_cvt_pk_bf16_f32 v176, v216, v217
    v_lshlrev_b32 v218, 16, v161
    v_and_b32 v219, 0xffff0000, v161
    v_fma_f32 v218, v218, v236, v237
    v_mfma_f32_32x32x16_bf16 v[48:63], a[44:47], v[180:183], v[48:63]
    ds_read_b64_tr_b16 a[8:9], v230 offset:0
    ds_read_b64_tr_b16 a[10:11], v230 offset:1024
    ds_read_b64_tr_b16 a[12:13], v231 offset:0
    ds_read_b64_tr_b16 a[14:15], v231 offset:1024
    v_fma_f32 v219, v219, v236, v237
    v_fma_f32 v218, v218, v186, v194
    v_fma_f32 v219, v219, v187, v195
    v_cvt_pk_bf16_f32 v177, v218, v219
    v_mfma_f32_32x32x16_bf16 v[64:79], a[48:51], v[180:183], v[64:79]
    ds_read_b64_tr_b16 a[16:17], v228 offset:32768
    ds_read_b64_tr_b16 a[18:19], v228 offset:33792
    ds_read_b64_tr_b16 a[20:21], v229 offset:32768
    ds_read_b64_tr_b16 a[22:23], v229 offset:33792
    v_lshlrev_b32 v220, 16, v162
    v_and_b32 v221, 0xffff0000, v162
    v_fma_f32 v220, v220, v236, v237
    v_fma_f32 v221, v221, v236, v237
    v_mfma_f32_32x32x16_bf16 v[80:95], a[52:55], v[180:183], v[80:95]
    ds_read_b64_tr_b16 a[24:25], v230 offset:32768
    ds_read_b64_tr_b16 a[26:27], v230 offset:33792
    ds_read_b64_tr_b16 a[28:29], v231 offset:32768
    ds_read_b64_tr_b16 a[30:31], v231 offset:33792
    v_fma_f32 v220, v220, v188, v196
    v_fma_f32 v221, v221, v189, v197
    v_cvt_pk_bf16_f32 v178, v220, v221
    v_lshlrev_b32 v222, 16, v163
    v_mfma_f32_32x32x16_bf16 v[96:111], a[56:59], v[180:183], v[96:111]
    buffer_load_dwordx4 v[156:159], v232, s[12:15], s34 offen offset:3072 sc1
    v_and_b32 v223, 0xffff0000, v163
    v_fma_f32 v222, v222, v236, v237
    v_fma_f32 v223, v223, v236, v237
    v_fma_f32 v222, v222, v190, v198
    v_fma_f32 v223, v223, v191, v199
    v_cvt_pk_bf16_f32 v179, v222, v223
    v_mfma_f32_32x32x16_bf16 v[112:127], a[60:63], v[180:183], v[112:127]
    s_waitcnt lgkmcnt(0)
    v_mfma_f32_32x32x16_bf16 v[0:15], a[0:3], v[176:179], v[0:15]
    s_waitcnt vmcnt(26)
    ds_read_b128 v[184:187], v234 offset:2816
    ds_read_b128 v[188:191], v234 offset:2832
    ds_read_b128 v[192:195], v234 offset:2848
    ds_read_b128 v[196:199], v234 offset:2864
    v_lshlrev_b32 v216, 16, v164
    v_and_b32 v217, 0xffff0000, v164
    v_fma_f32 v216, v216, v236, v237
    v_mfma_f32_32x32x16_bf16 v[16:31], a[4:7], v[176:179], v[16:31]
    ds_read_b64_tr_b16 a[32:33], v228 offset:4096
    ds_read_b64_tr_b16 a[34:35], v228 offset:5120
    ds_read_b64_tr_b16 a[36:37], v229 offset:4096
    ds_read_b64_tr_b16 a[38:39], v229 offset:5120
    v_fma_f32 v217, v217, v236, v237
    v_fma_f32 v216, v216, v200, v208
    v_fma_f32 v217, v217, v201, v209
    v_mfma_f32_32x32x16_bf16 v[32:47], a[8:11], v[176:179], v[32:47]
    ds_read_b64_tr_b16 a[40:41], v230 offset:4096
    ds_read_b64_tr_b16 a[42:43], v230 offset:5120
    ds_read_b64_tr_b16 a[44:45], v231 offset:4096
    ds_read_b64_tr_b16 a[46:47], v231 offset:5120
    v_cvt_pk_bf16_f32 v180, v216, v217
    v_lshlrev_b32 v218, 16, v165
    v_and_b32 v219, 0xffff0000, v165
    v_mfma_f32_32x32x16_bf16 v[48:63], a[12:15], v[176:179], v[48:63]
    ds_read_b64_tr_b16 a[48:49], v228 offset:36864
    ds_read_b64_tr_b16 a[50:51], v228 offset:37888
    ds_read_b64_tr_b16 a[52:53], v229 offset:36864
    ds_read_b64_tr_b16 a[54:55], v229 offset:37888
    v_fma_f32 v218, v218, v236, v237
    v_fma_f32 v219, v219, v236, v237
    v_fma_f32 v218, v218, v202, v210
    v_mfma_f32_32x32x16_bf16 v[64:79], a[16:19], v[176:179], v[64:79]
    ds_read_b64_tr_b16 a[56:57], v230 offset:36864
    ds_read_b64_tr_b16 a[58:59], v230 offset:37888
    ds_read_b64_tr_b16 a[60:61], v231 offset:36864
    ds_read_b64_tr_b16 a[62:63], v231 offset:37888
    v_fma_f32 v219, v219, v203, v211
    v_cvt_pk_bf16_f32 v181, v218, v219
    v_lshlrev_b32 v220, 16, v166
    v_and_b32 v221, 0xffff0000, v166
    v_mfma_f32_32x32x16_bf16 v[80:95], a[20:23], v[176:179], v[80:95]
    v_fma_f32 v220, v220, v236, v237
    v_fma_f32 v221, v221, v236, v237
    v_fma_f32 v220, v220, v204, v212
    v_fma_f32 v221, v221, v205, v213
    v_cvt_pk_bf16_f32 v182, v220, v221
    v_lshlrev_b32 v222, 16, v167
    v_mfma_f32_32x32x16_bf16 v[96:111], a[24:27], v[176:179], v[96:111]
    v_and_b32 v223, 0xffff0000, v167
    v_fma_f32 v222, v222, v236, v237
    v_fma_f32 v223, v223, v236, v237
    v_fma_f32 v222, v222, v206, v214
    v_fma_f32 v223, v223, v207, v215
    v_cvt_pk_bf16_f32 v183, v222, v223
    v_mfma_f32_32x32x16_bf16 v[112:127], a[28:31], v[176:179], v[112:127]
    s_waitcnt lgkmcnt(0)
    v_mfma_f32_32x32x16_bf16 v[0:15], a[32:35], v[180:183], v[0:15]
    s_waitcnt vmcnt(25)
    ds_read_b128 v[200:203], v234 offset:2944
    ds_read_b128 v[204:207], v234 offset:2960
    ds_read_b128 v[208:211], v234 offset:2976
    ds_read_b128 v[212:215], v234 offset:2992
    v_lshlrev_b32 v216, 16, v168
    v_and_b32 v217, 0xffff0000, v168
    v_fma_f32 v216, v216, v236, v237
    v_mfma_f32_32x32x16_bf16 v[16:31], a[36:39], v[180:183], v[16:31]
    ds_read_b64_tr_b16 a[0:1], v228 offset:8192
    ds_read_b64_tr_b16 a[2:3], v228 offset:9216
    ds_read_b64_tr_b16 a[4:5], v229 offset:8192
    ds_read_b64_tr_b16 a[6:7], v229 offset:9216
    v_fma_f32 v217, v217, v236, v237
    v_fma_f32 v216, v216, v184, v192
    v_fma_f32 v217, v217, v185, v193
    v_mfma_f32_32x32x16_bf16 v[32:47], a[40:43], v[180:183], v[32:47]
    ds_read_b64_tr_b16 a[8:9], v230 offset:8192
    ds_read_b64_tr_b16 a[10:11], v230 offset:9216
    ds_read_b64_tr_b16 a[12:13], v231 offset:8192
    ds_read_b64_tr_b16 a[14:15], v231 offset:9216
    v_cvt_pk_bf16_f32 v176, v216, v217
    v_lshlrev_b32 v218, 16, v169
    v_and_b32 v219, 0xffff0000, v169
    v_mfma_f32_32x32x16_bf16 v[48:63], a[44:47], v[180:183], v[48:63]
    ds_read_b64_tr_b16 a[16:17], v228 offset:40960
    ds_read_b64_tr_b16 a[18:19], v228 offset:41984
    ds_read_b64_tr_b16 a[20:21], v229 offset:40960
    ds_read_b64_tr_b16 a[22:23], v229 offset:41984
    v_fma_f32 v218, v218, v236, v237
    v_fma_f32 v219, v219, v236, v237
    v_fma_f32 v218, v218, v186, v194
    v_mfma_f32_32x32x16_bf16 v[64:79], a[48:51], v[180:183], v[64:79]
    ds_read_b64_tr_b16 a[24:25], v230 offset:40960
    ds_read_b64_tr_b16 a[26:27], v230 offset:41984
    ds_read_b64_tr_b16 a[28:29], v231 offset:40960
    ds_read_b64_tr_b16 a[30:31], v231 offset:41984
    v_fma_f32 v219, v219, v187, v195
    v_cvt_pk_bf16_f32 v177, v218, v219
    v_lshlrev_b32 v220, 16, v170
    v_and_b32 v221, 0xffff0000, v170
    v_mfma_f32_32x32x16_bf16 v[80:95], a[52:55], v[180:183], v[80:95]
    v_fma_f32 v220, v220, v236, v237
    v_fma_f32 v221, v221, v236, v237
    v_fma_f32 v220, v220, v188, v196
    v_fma_f32 v221, v221, v189, v197
    v_cvt_pk_bf16_f32 v178, v220, v221
    v_lshlrev_b32 v222, 16, v171
    v_mfma_f32_32x32x16_bf16 v[96:111], a[56:59], v[180:183], v[96:111]
    v_and_b32 v223, 0xffff0000, v171
    v_fma_f32 v222, v222, v236, v237
    v_fma_f32 v223, v223, v236, v237
    v_fma_f32 v222, v222, v190, v198
    v_fma_f32 v223, v223, v191, v199
    v_cvt_pk_bf16_f32 v179, v222, v223
    v_mfma_f32_32x32x16_bf16 v[112:127], a[60:63], v[180:183], v[112:127]
    s_waitcnt lgkmcnt(0)
    v_mfma_f32_32x32x16_bf16 v[0:15], a[0:3], v[176:179], v[0:15]
    s_waitcnt vmcnt(24)
    ds_read_b128 v[184:187], v234 offset:3072
    ds_read_b128 v[188:191], v234 offset:3088
    ds_read_b128 v[192:195], v234 offset:3104
    ds_read_b128 v[196:199], v234 offset:3120
    v_lshlrev_b32 v216, 16, v172
    v_and_b32 v217, 0xffff0000, v172
    v_fma_f32 v216, v216, v236, v237
    v_fma_f32 v217, v217, v236, v237
    v_mfma_f32_32x32x16_bf16 v[16:31], a[4:7], v[176:179], v[16:31]
    ds_read_b64_tr_b16 a[32:33], v228 offset:12288
    ds_read_b64_tr_b16 a[34:35], v228 offset:13312
    ds_read_b64_tr_b16 a[36:37], v229 offset:12288
    ds_read_b64_tr_b16 a[38:39], v229 offset:13312
    v_fma_f32 v216, v216, v200, v208
    v_fma_f32 v217, v217, v201, v209
    v_cvt_pk_bf16_f32 v180, v216, v217
    v_lshlrev_b32 v218, 16, v173
    v_mfma_f32_32x32x16_bf16 v[32:47], a[8:11], v[176:179], v[32:47]
    ds_read_b64_tr_b16 a[40:41], v230 offset:12288
    ds_read_b64_tr_b16 a[42:43], v230 offset:13312
    ds_read_b64_tr_b16 a[44:45], v231 offset:12288
    ds_read_b64_tr_b16 a[46:47], v231 offset:13312
    v_and_b32 v219, 0xffff0000, v173
    v_fma_f32 v218, v218, v236, v237
    v_fma_f32 v219, v219, v236, v237
    v_fma_f32 v218, v218, v202, v210
    v_mfma_f32_32x32x16_bf16 v[48:63], a[12:15], v[176:179], v[48:63]
    ds_read_b64_tr_b16 a[48:49], v228 offset:45056
    ds_read_b64_tr_b16 a[50:51], v228 offset:46080
    ds_read_b64_tr_b16 a[52:53], v229 offset:45056
    ds_read_b64_tr_b16 a[54:55], v229 offset:46080
    v_fma_f32 v219, v219, v203, v211
    v_cvt_pk_bf16_f32 v181, v218, v219
    v_lshlrev_b32 v220, 16, v174
    v_and_b32 v221, 0xffff0000, v174
    v_mfma_f32_32x32x16_bf16 v[64:79], a[16:19], v[176:179], v[64:79]
    ds_read_b64_tr_b16 a[56:57], v230 offset:45056
    ds_read_b64_tr_b16 a[58:59], v230 offset:46080
    ds_read_b64_tr_b16 a[60:61], v231 offset:45056
    ds_read_b64_tr_b16 a[62:63], v231 offset:46080
    v_fma_f32 v220, v220, v236, v237
    v_fma_f32 v221, v221, v236, v237
    v_fma_f32 v220, v220, v204, v212
    v_fma_f32 v221, v221, v205, v213
    v_mfma_f32_32x32x16_bf16 v[80:95], a[20:23], v[176:179], v[80:95]
    v_cvt_pk_bf16_f32 v182, v220, v221
    v_lshlrev_b32 v222, 16, v175
    v_and_b32 v223, 0xffff0000, v175
    v_fma_f32 v222, v222, v236, v237
    v_fma_f32 v223, v223, v236, v237
    v_fma_f32 v222, v222, v206, v214
    v_fma_f32 v223, v223, v207, v215
    v_cvt_pk_bf16_f32 v183, v222, v223
    v_mfma_f32_32x32x16_bf16 v[96:111], a[24:27], v[176:179], v[96:111]
    v_mbcnt_lo_u32_b32 v252, -1, 0
    v_mbcnt_hi_u32_b32 v252, -1, v252
    v_lshrrev_b32 v253, 3, v252
    v_lshlrev_b32 v251, 1, v253
    v_and_b32 v251, 4, v251
    v_and_b32 v252, 7, v252
    v_xor_b32 v251, v251, v252
    v_lshlrev_b32 v251, 4, v251
    v_lshl_add_u32 v251, v253, 7, v251
    s_lshl_b32 s49, s32, 15
    s_and_b32 s55, s2, 1
    s_lshl_b32 s55, s55, 2
    s_lshr_b32 s47, s2, 6
    s_add_u32 s55, s55, s47
    s_lshl_b32 s55, s55, 18
    s_mul_i32 s47, s32, 57344
    s_add_u32 s55, s55, s47
    s_add_u32 s55, s55, 37748736
    v_mfma_f32_32x32x16_bf16 v[112:127], a[28:31], v[176:179], v[112:127]
    s_waitcnt lgkmcnt(0)
    v_mfma_f32_32x32x16_bf16 v[0:15], a[32:35], v[180:183], v[0:15]
    s_waitcnt vmcnt(15)
    s_barrier
    v_lshlrev_b32 v216, 16, v128
    v_and_b32 v217, 0xffff0000, v128
    v_mfma_f32_32x32x16_bf16 v[16:31], a[36:39], v[180:183], v[16:31]
    ds_read_b128 v[200:203], v234 offset:3200
    ds_read_b128 v[204:207], v234 offset:3216
    ds_read_b128 v[208:211], v234 offset:3232
    ds_read_b128 v[212:215], v234 offset:3248
    v_fma_f32 v216, v216, v236, v237
    v_fma_f32 v217, v217, v236, v237
    v_fma_f32 v216, v216, v184, v192
    v_fma_f32 v217, v217, v185, v193
    v_mfma_f32_32x32x16_bf16 v[32:47], a[40:43], v[180:183], v[32:47]
    ds_read_b64_tr_b16 a[0:1], v224 offset:16384
    ds_read_b64_tr_b16 a[2:3], v224 offset:17408
    ds_read_b64_tr_b16 a[4:5], v225 offset:16384
    ds_read_b64_tr_b16 a[6:7], v225 offset:17408
    v_cvt_pk_bf16_f32 v176, v216, v217
    v_lshlrev_b32 v218, 16, v129
    v_and_b32 v219, 0xffff0000, v129
    v_mfma_f32_32x32x16_bf16 v[48:63], a[44:47], v[180:183], v[48:63]
    ds_read_b64_tr_b16 a[8:9], v226 offset:16384
    ds_read_b64_tr_b16 a[10:11], v226 offset:17408
    ds_read_b64_tr_b16 a[12:13], v227 offset:16384
    ds_read_b64_tr_b16 a[14:15], v227 offset:17408
    v_fma_f32 v218, v218, v236, v237
    v_fma_f32 v219, v219, v236, v237
    v_fma_f32 v218, v218, v186, v194
    v_fma_f32 v219, v219, v187, v195
    v_mfma_f32_32x32x16_bf16 v[64:79], a[48:51], v[180:183], v[64:79]
    ds_read_b64_tr_b16 a[16:17], v224 offset:49152
    ds_read_b64_tr_b16 a[18:19], v224 offset:50176
    ds_read_b64_tr_b16 a[20:21], v225 offset:49152
    ds_read_b64_tr_b16 a[22:23], v225 offset:50176
    v_cvt_pk_bf16_f32 v177, v218, v219
    v_lshlrev_b32 v220, 16, v130
    v_and_b32 v221, 0xffff0000, v130
    v_fma_f32 v220, v220, v236, v237
    v_mfma_f32_32x32x16_bf16 v[80:95], a[52:55], v[180:183], v[80:95]
    ds_read_b64_tr_b16 a[24:25], v226 offset:49152
    ds_read_b64_tr_b16 a[26:27], v226 offset:50176
    ds_read_b64_tr_b16 a[28:29], v227 offset:49152
    ds_read_b64_tr_b16 a[30:31], v227 offset:50176
    v_fma_f32 v221, v221, v236, v237
    v_fma_f32 v220, v220, v188, v196
    v_fma_f32 v221, v221, v189, v197
    v_cvt_pk_bf16_f32 v178, v220, v221
    v_mfma_f32_32x32x16_bf16 v[96:111], a[56:59], v[180:183], v[96:111]
    v_lshlrev_b32 v222, 16, v131
    v_and_b32 v223, 0xffff0000, v131
    v_fma_f32 v222, v222, v236, v237
    v_fma_f32 v223, v223, v236, v237
    v_fma_f32 v222, v222, v190, v198
    v_fma_f32 v223, v223, v191, v199
    v_cvt_pk_bf16_f32 v179, v222, v223
    v_mfma_f32_32x32x16_bf16 v[112:127], a[60:63], v[180:183], v[112:127]
    s_waitcnt lgkmcnt(0)
    v_mfma_f32_32x32x16_bf16 v[0:15], a[0:3], v[176:179], v[0:15]
    s_waitcnt vmcnt(14)
    ds_read_b128 v[184:187], v234 offset:3328
    ds_read_b128 v[188:191], v234 offset:3344
    ds_read_b128 v[192:195], v234 offset:3360
    ds_read_b128 v[196:199], v234 offset:3376
    v_lshlrev_b32 v216, 16, v132
    v_and_b32 v217, 0xffff0000, v132
    v_fma_f32 v216, v216, v236, v237
    v_fma_f32 v217, v217, v236, v237
    v_mfma_f32_32x32x16_bf16 v[16:31], a[4:7], v[176:179], v[16:31]
    ds_read_b64_tr_b16 a[32:33], v224 offset:20480
    ds_read_b64_tr_b16 a[34:35], v224 offset:21504
    ds_read_b64_tr_b16 a[36:37], v225 offset:20480
    ds_read_b64_tr_b16 a[38:39], v225 offset:21504
    v_fma_f32 v216, v216, v200, v208
    v_fma_f32 v217, v217, v201, v209
    v_cvt_pk_bf16_f32 v180, v216, v217
    v_mfma_f32_32x32x16_bf16 v[32:47], a[8:11], v[176:179], v[32:47]
    ds_read_b64_tr_b16 a[40:41], v226 offset:20480
    ds_read_b64_tr_b16 a[42:43], v226 offset:21504
    ds_read_b64_tr_b16 a[44:45], v227 offset:20480
    ds_read_b64_tr_b16 a[46:47], v227 offset:21504
    v_lshlrev_b32 v218, 16, v133
    v_and_b32 v219, 0xffff0000, v133
    v_fma_f32 v218, v218, v236, v237
    v_fma_f32 v219, v219, v236, v237
    v_mfma_f32_32x32x16_bf16 v[48:63], a[12:15], v[176:179], v[48:63]
    ds_read_b64_tr_b16 a[48:49], v224 offset:53248
    ds_read_b64_tr_b16 a[50:51], v224 offset:54272
    ds_read_b64_tr_b16 a[52:53], v225 offset:53248
    ds_read_b64_tr_b16 a[54:55], v225 offset:54272
    v_fma_f32 v218, v218, v202, v210
    v_fma_f32 v219, v219, v203, v211
    v_cvt_pk_bf16_f32 v181, v218, v219
    v_lshlrev_b32 v220, 16, v134
    v_mfma_f32_32x32x16_bf16 v[64:79], a[16:19], v[176:179], v[64:79]
    ds_read_b64_tr_b16 a[56:57], v226 offset:53248
    ds_read_b64_tr_b16 a[58:59], v226 offset:54272
    ds_read_b64_tr_b16 a[60:61], v227 offset:53248
    ds_read_b64_tr_b16 a[62:63], v227 offset:54272
    v_and_b32 v221, 0xffff0000, v134
    v_fma_f32 v220, v220, v236, v237
    v_fma_f32 v221, v221, v236, v237
    v_fma_f32 v220, v220, v204, v212
    v_mfma_f32_32x32x16_bf16 v[80:95], a[20:23], v[176:179], v[80:95]
    v_fma_f32 v221, v221, v205, v213
    v_cvt_pk_bf16_f32 v182, v220, v221
    v_lshlrev_b32 v222, 16, v135
    v_and_b32 v223, 0xffff0000, v135
    v_fma_f32 v222, v222, v236, v237
    v_fma_f32 v223, v223, v236, v237
    v_fma_f32 v222, v222, v206, v214
    v_mfma_f32_32x32x16_bf16 v[96:111], a[24:27], v[176:179], v[96:111]
    s_add_u32 m0, s49, 0
    s_nop 0
    buffer_load_dwordx4 v251, s[12:15], s55 offen sc1 lds
    buffer_load_dwordx4 v251, s[12:15], s55 offen offset:1024 sc1 lds
    s_add_u32 s55, s55, 2048
    v_fma_f32 v223, v223, v207, v215
    v_cvt_pk_bf16_f32 v183, v222, v223
    v_mfma_f32_32x32x16_bf16 v[112:127], a[28:31], v[176:179], v[112:127]
    s_waitcnt lgkmcnt(0)
    v_mfma_f32_32x32x16_bf16 v[0:15], a[32:35], v[180:183], v[0:15]
    s_waitcnt vmcnt(15)
    ds_read_b128 v[200:203], v234 offset:3456
    ds_read_b128 v[204:207], v234 offset:3472
    ds_read_b128 v[208:211], v234 offset:3488
    ds_read_b128 v[212:215], v234 offset:3504
    v_lshlrev_b32 v216, 16, v136
    v_and_b32 v217, 0xffff0000, v136
    v_fma_f32 v216, v216, v236, v237
    v_fma_f32 v217, v217, v236, v237
    v_mfma_f32_32x32x16_bf16 v[16:31], a[36:39], v[180:183], v[16:31]
    ds_read_b64_tr_b16 a[0:1], v224 offset:24576
    ds_read_b64_tr_b16 a[2:3], v224 offset:25600
    ds_read_b64_tr_b16 a[4:5], v225 offset:24576
    ds_read_b64_tr_b16 a[6:7], v225 offset:25600
    v_fma_f32 v216, v216, v184, v192
    v_fma_f32 v217, v217, v185, v193
    v_cvt_pk_bf16_f32 v176, v216, v217
    v_mfma_f32_32x32x16_bf16 v[32:47], a[40:43], v[180:183], v[32:47]
    ds_read_b64_tr_b16 a[8:9], v226 offset:24576
    ds_read_b64_tr_b16 a[10:11], v226 offset:25600
    ds_read_b64_tr_b16 a[12:13], v227 offset:24576
    ds_read_b64_tr_b16 a[14:15], v227 offset:25600
    v_lshlrev_b32 v218, 16, v137
    v_and_b32 v219, 0xffff0000, v137
    v_fma_f32 v218, v218, v236, v237
    v_fma_f32 v219, v219, v236, v237
    v_mfma_f32_32x32x16_bf16 v[48:63], a[44:47], v[180:183], v[48:63]
    ds_read_b64_tr_b16 a[16:17], v224 offset:57344
    ds_read_b64_tr_b16 a[18:19], v224 offset:58368
    ds_read_b64_tr_b16 a[20:21], v225 offset:57344
    ds_read_b64_tr_b16 a[22:23], v225 offset:58368
    v_fma_f32 v218, v218, v186, v194
    v_fma_f32 v219, v219, v187, v195
    v_cvt_pk_bf16_f32 v177, v218, v219
    v_lshlrev_b32 v220, 16, v138
    v_mfma_f32_32x32x16_bf16 v[64:79], a[48:51], v[180:183], v[64:79]
    ds_read_b64_tr_b16 a[24:25], v226 offset:57344
    ds_read_b64_tr_b16 a[26:27], v226 offset:58368
    ds_read_b64_tr_b16 a[28:29], v227 offset:57344
    ds_read_b64_tr_b16 a[30:31], v227 offset:58368
    v_and_b32 v221, 0xffff0000, v138
    v_fma_f32 v220, v220, v236, v237
    v_fma_f32 v221, v221, v236, v237
    v_fma_f32 v220, v220, v188, v196
    v_mfma_f32_32x32x16_bf16 v[80:95], a[52:55], v[180:183], v[80:95]
    v_fma_f32 v221, v221, v189, v197
    v_cvt_pk_bf16_f32 v178, v220, v221
    v_lshlrev_b32 v222, 16, v139
    v_and_b32 v223, 0xffff0000, v139
    v_fma_f32 v222, v222, v236, v237
    v_fma_f32 v223, v223, v236, v237
    v_fma_f32 v222, v222, v190, v198
    v_mfma_f32_32x32x16_bf16 v[96:111], a[56:59], v[180:183], v[96:111]
    s_add_u32 m0, s49, 2048
    s_nop 0
    buffer_load_dwordx4 v251, s[12:15], s55 offen sc1 lds
    buffer_load_dwordx4 v251, s[12:15], s55 offen offset:1024 sc1 lds
    s_add_u32 s55, s55, 2048
    v_fma_f32 v223, v223, v191, v199
    v_cvt_pk_bf16_f32 v179, v222, v223
    v_mfma_f32_32x32x16_bf16 v[112:127], a[60:63], v[180:183], v[112:127]
    s_waitcnt lgkmcnt(0)
    v_mfma_f32_32x32x16_bf16 v[0:15], a[0:3], v[176:179], v[0:15]
    s_waitcnt vmcnt(16)
    ds_read_b128 v[184:187], v234 offset:3584
    ds_read_b128 v[188:191], v234 offset:3600
    ds_read_b128 v[192:195], v234 offset:3616
    ds_read_b128 v[196:199], v234 offset:3632
    v_lshlrev_b32 v216, 16, v140
    v_and_b32 v217, 0xffff0000, v140
    v_fma_f32 v216, v216, v236, v237
    v_fma_f32 v217, v217, v236, v237
    v_mfma_f32_32x32x16_bf16 v[16:31], a[4:7], v[176:179], v[16:31]
    ds_read_b64_tr_b16 a[32:33], v224 offset:28672
    ds_read_b64_tr_b16 a[34:35], v224 offset:29696
    ds_read_b64_tr_b16 a[36:37], v225 offset:28672
    ds_read_b64_tr_b16 a[38:39], v225 offset:29696
    v_fma_f32 v216, v216, v200, v208
    v_fma_f32 v217, v217, v201, v209
    v_cvt_pk_bf16_f32 v180, v216, v217
    v_mfma_f32_32x32x16_bf16 v[32:47], a[8:11], v[176:179], v[32:47]
    ds_read_b64_tr_b16 a[40:41], v226 offset:28672
    ds_read_b64_tr_b16 a[42:43], v226 offset:29696
    ds_read_b64_tr_b16 a[44:45], v227 offset:28672
    ds_read_b64_tr_b16 a[46:47], v227 offset:29696
    v_lshlrev_b32 v218, 16, v141
    v_and_b32 v219, 0xffff0000, v141
    v_fma_f32 v218, v218, v236, v237
    v_fma_f32 v219, v219, v236, v237
    v_mfma_f32_32x32x16_bf16 v[48:63], a[12:15], v[176:179], v[48:63]
    ds_read_b64_tr_b16 a[48:49], v224 offset:61440
    ds_read_b64_tr_b16 a[50:51], v224 offset:62464
    ds_read_b64_tr_b16 a[52:53], v225 offset:61440
    ds_read_b64_tr_b16 a[54:55], v225 offset:62464
    v_fma_f32 v218, v218, v202, v210
    v_fma_f32 v219, v219, v203, v211
    v_cvt_pk_bf16_f32 v181, v218, v219
    v_lshlrev_b32 v220, 16, v142
    v_mfma_f32_32x32x16_bf16 v[64:79], a[16:19], v[176:179], v[64:79]
    ds_read_b64_tr_b16 a[56:57], v226 offset:61440
    ds_read_b64_tr_b16 a[58:59], v226 offset:62464
    ds_read_b64_tr_b16 a[60:61], v227 offset:61440
    ds_read_b64_tr_b16 a[62:63], v227 offset:62464
    v_and_b32 v221, 0xffff0000, v142
    v_fma_f32 v220, v220, v236, v237
    v_fma_f32 v221, v221, v236, v237
    v_fma_f32 v220, v220, v204, v212
    v_mfma_f32_32x32x16_bf16 v[80:95], a[20:23], v[176:179], v[80:95]
    v_fma_f32 v221, v221, v205, v213
    v_cvt_pk_bf16_f32 v182, v220, v221
    v_lshlrev_b32 v222, 16, v143
    v_and_b32 v223, 0xffff0000, v143
    v_fma_f32 v222, v222, v236, v237
    v_fma_f32 v223, v223, v236, v237
    v_fma_f32 v222, v222, v206, v214
    v_mfma_f32_32x32x16_bf16 v[96:111], a[24:27], v[176:179], v[96:111]
    s_add_u32 m0, s49, 4096
    s_nop 0
    buffer_load_dwordx4 v251, s[12:15], s55 offen sc1 lds
    buffer_load_dwordx4 v251, s[12:15], s55 offen offset:1024 sc1 lds
    s_add_u32 s55, s55, 2048
    v_fma_f32 v223, v223, v207, v215
    v_cvt_pk_bf16_f32 v183, v222, v223
    v_mfma_f32_32x32x16_bf16 v[112:127], a[28:31], v[176:179], v[112:127]
    s_waitcnt lgkmcnt(0)
    v_mfma_f32_32x32x16_bf16 v[0:15], a[32:35], v[180:183], v[0:15]
    s_waitcnt vmcnt(9)
    s_barrier
    v_lshlrev_b32 v216, 16, v144
    v_and_b32 v217, 0xffff0000, v144
    v_mfma_f32_32x32x16_bf16 v[16:31], a[36:39], v[180:183], v[16:31]
    ds_read_b128 v[200:203], v234 offset:3712
    ds_read_b128 v[204:207], v234 offset:3728
    ds_read_b128 v[208:211], v234 offset:3744
    ds_read_b128 v[212:215], v234 offset:3760
    v_fma_f32 v216, v216, v236, v237
    v_fma_f32 v217, v217, v236, v237
    v_fma_f32 v216, v216, v184, v192
    v_fma_f32 v217, v217, v185, v193
    v_cvt_pk_bf16_f32 v176, v216, v217
    v_mfma_f32_32x32x16_bf16 v[32:47], a[40:43], v[180:183], v[32:47]
    ds_read_b64_tr_b16 a[0:1], v228 offset:16384
    ds_read_b64_tr_b16 a[2:3], v228 offset:17408
    ds_read_b64_tr_b16 a[4:5], v229 offset:16384
    ds_read_b64_tr_b16 a[6:7], v229 offset:17408
    v_lshlrev_b32 v218, 16, v145
    v_and_b32 v219, 0xffff0000, v145
    v_fma_f32 v218, v218, v236, v237
    v_fma_f32 v219, v219, v236, v237
    v_fma_f32 v218, v218, v186, v194
    v_mfma_f32_32x32x16_bf16 v[48:63], a[44:47], v[180:183], v[48:63]
    ds_read_b64_tr_b16 a[8:9], v230 offset:16384
    ds_read_b64_tr_b16 a[10:11], v230 offset:17408
    ds_read_b64_tr_b16 a[12:13], v231 offset:16384
    ds_read_b64_tr_b16 a[14:15], v231 offset:17408
    v_fma_f32 v219, v219, v187, v195
    v_cvt_pk_bf16_f32 v177, v218, v219
    v_lshlrev_b32 v220, 16, v146
    v_and_b32 v221, 0xffff0000, v146
    v_mfma_f32_32x32x16_bf16 v[64:79], a[48:51], v[180:183], v[64:79]
    ds_read_b64_tr_b16 a[16:17], v228 offset:49152
    ds_read_b64_tr_b16 a[18:19], v228 offset:50176
    ds_read_b64_tr_b16 a[20:21], v229 offset:49152
    ds_read_b64_tr_b16 a[22:23], v229 offset:50176
    v_fma_f32 v220, v220, v236, v237
    v_fma_f32 v221, v221, v236, v237
    v_fma_f32 v220, v220, v188, v196
    v_fma_f32 v221, v221, v189, v197
    v_cvt_pk_bf16_f32 v178, v220, v221
    v_mfma_f32_32x32x16_bf16 v[80:95], a[52:55], v[180:183], v[80:95]
    ds_read_b64_tr_b16 a[24:25], v230 offset:49152
    ds_read_b64_tr_b16 a[26:27], v230 offset:50176
    ds_read_b64_tr_b16 a[28:29], v231 offset:49152
    ds_read_b64_tr_b16 a[30:31], v231 offset:50176
    v_lshlrev_b32 v222, 16, v147
    v_and_b32 v223, 0xffff0000, v147
    v_fma_f32 v222, v222, v236, v237
    v_fma_f32 v223, v223, v236, v237
    v_fma_f32 v222, v222, v190, v198
    v_mfma_f32_32x32x16_bf16 v[96:111], a[56:59], v[180:183], v[96:111]
    s_add_u32 m0, s49, 6144
    s_nop 0
    buffer_load_dwordx4 v251, s[12:15], s55 offen sc1 lds
    buffer_load_dwordx4 v251, s[12:15], s55 offen offset:1024 sc1 lds
    s_add_u32 s55, s55, 2048
    v_fma_f32 v223, v223, v191, v199
    v_cvt_pk_bf16_f32 v179, v222, v223
    v_mfma_f32_32x32x16_bf16 v[112:127], a[60:63], v[180:183], v[112:127]
    s_waitcnt lgkmcnt(0)
    v_mfma_f32_32x32x16_bf16 v[0:15], a[0:3], v[176:179], v[0:15]
    s_waitcnt vmcnt(10)
    ds_read_b128 v[184:187], v234 offset:3840
    ds_read_b128 v[188:191], v234 offset:3856
    ds_read_b128 v[192:195], v234 offset:3872
    ds_read_b128 v[196:199], v234 offset:3888
    v_lshlrev_b32 v216, 16, v148
    v_and_b32 v217, 0xffff0000, v148
    v_fma_f32 v216, v216, v236, v237
    v_fma_f32 v217, v217, v236, v237
    v_mfma_f32_32x32x16_bf16 v[16:31], a[4:7], v[176:179], v[16:31]
    ds_read_b64_tr_b16 a[32:33], v228 offset:20480
    ds_read_b64_tr_b16 a[34:35], v228 offset:21504
    ds_read_b64_tr_b16 a[36:37], v229 offset:20480
    ds_read_b64_tr_b16 a[38:39], v229 offset:21504
    v_fma_f32 v216, v216, v200, v208
    v_fma_f32 v217, v217, v201, v209
    v_cvt_pk_bf16_f32 v180, v216, v217
    v_mfma_f32_32x32x16_bf16 v[32:47], a[8:11], v[176:179], v[32:47]
    ds_read_b64_tr_b16 a[40:41], v230 offset:20480
    ds_read_b64_tr_b16 a[42:43], v230 offset:21504
    ds_read_b64_tr_b16 a[44:45], v231 offset:20480
    ds_read_b64_tr_b16 a[46:47], v231 offset:21504
    v_lshlrev_b32 v218, 16, v149
    v_and_b32 v219, 0xffff0000, v149
    v_fma_f32 v218, v218, v236, v237
    v_fma_f32 v219, v219, v236, v237
    v_mfma_f32_32x32x16_bf16 v[48:63], a[12:15], v[176:179], v[48:63]
    ds_read_b64_tr_b16 a[48:49], v228 offset:53248
    ds_read_b64_tr_b16 a[50:51], v228 offset:54272
    ds_read_b64_tr_b16 a[52:53], v229 offset:53248
    ds_read_b64_tr_b16 a[54:55], v229 offset:54272
    v_fma_f32 v218, v218, v202, v210
    v_fma_f32 v219, v219, v203, v211
    v_cvt_pk_bf16_f32 v181, v218, v219
    v_lshlrev_b32 v220, 16, v150
    v_mfma_f32_32x32x16_bf16 v[64:79], a[16:19], v[176:179], v[64:79]
    ds_read_b64_tr_b16 a[56:57], v230 offset:53248
    ds_read_b64_tr_b16 a[58:59], v230 offset:54272
    ds_read_b64_tr_b16 a[60:61], v231 offset:53248
    ds_read_b64_tr_b16 a[62:63], v231 offset:54272
    v_and_b32 v221, 0xffff0000, v150
    v_fma_f32 v220, v220, v236, v237
    v_fma_f32 v221, v221, v236, v237
    v_fma_f32 v220, v220, v204, v212
    v_mfma_f32_32x32x16_bf16 v[80:95], a[20:23], v[176:179], v[80:95]
    v_fma_f32 v221, v221, v205, v213
    v_cvt_pk_bf16_f32 v182, v220, v221
    v_lshlrev_b32 v222, 16, v151
    v_and_b32 v223, 0xffff0000, v151
    v_fma_f32 v222, v222, v236, v237
    v_fma_f32 v223, v223, v236, v237
    v_fma_f32 v222, v222, v206, v214
    v_mfma_f32_32x32x16_bf16 v[96:111], a[24:27], v[176:179], v[96:111]
    s_add_u32 m0, s49, 8192
    s_nop 0
    buffer_load_dwordx4 v251, s[12:15], s55 offen sc1 lds
    buffer_load_dwordx4 v251, s[12:15], s55 offen offset:1024 sc1 lds
    s_add_u32 s55, s55, 2048
    v_fma_f32 v223, v223, v207, v215
    v_cvt_pk_bf16_f32 v183, v222, v223
    v_mfma_f32_32x32x16_bf16 v[112:127], a[28:31], v[176:179], v[112:127]
    s_waitcnt lgkmcnt(0)
    v_mfma_f32_32x32x16_bf16 v[0:15], a[32:35], v[180:183], v[0:15]
    s_waitcnt vmcnt(11)
    ds_read_b128 v[200:203], v234 offset:3968
    ds_read_b128 v[204:207], v234 offset:3984
    ds_read_b128 v[208:211], v234 offset:4000
    ds_read_b128 v[212:215], v234 offset:4016
    v_lshlrev_b32 v216, 16, v152
    v_and_b32 v217, 0xffff0000, v152
    v_fma_f32 v216, v216, v236, v237
    v_fma_f32 v217, v217, v236, v237
    v_mfma_f32_32x32x16_bf16 v[16:31], a[36:39], v[180:183], v[16:31]
    ds_read_b64_tr_b16 a[0:1], v228 offset:24576
    ds_read_b64_tr_b16 a[2:3], v228 offset:25600
    ds_read_b64_tr_b16 a[4:5], v229 offset:24576
    ds_read_b64_tr_b16 a[6:7], v229 offset:25600
    v_fma_f32 v216, v216, v184, v192
    v_fma_f32 v217, v217, v185, v193
    v_cvt_pk_bf16_f32 v176, v216, v217
    v_mfma_f32_32x32x16_bf16 v[32:47], a[40:43], v[180:183], v[32:47]
    ds_read_b64_tr_b16 a[8:9], v230 offset:24576
    ds_read_b64_tr_b16 a[10:11], v230 offset:25600
    ds_read_b64_tr_b16 a[12:13], v231 offset:24576
    ds_read_b64_tr_b16 a[14:15], v231 offset:25600
    v_lshlrev_b32 v218, 16, v153
    v_and_b32 v219, 0xffff0000, v153
    v_fma_f32 v218, v218, v236, v237
    v_fma_f32 v219, v219, v236, v237
    v_mfma_f32_32x32x16_bf16 v[48:63], a[44:47], v[180:183], v[48:63]
    ds_read_b64_tr_b16 a[16:17], v228 offset:57344
    ds_read_b64_tr_b16 a[18:19], v228 offset:58368
    ds_read_b64_tr_b16 a[20:21], v229 offset:57344
    ds_read_b64_tr_b16 a[22:23], v229 offset:58368
    v_fma_f32 v218, v218, v186, v194
    v_fma_f32 v219, v219, v187, v195
    v_cvt_pk_bf16_f32 v177, v218, v219
    v_lshlrev_b32 v220, 16, v154
    v_mfma_f32_32x32x16_bf16 v[64:79], a[48:51], v[180:183], v[64:79]
    ds_read_b64_tr_b16 a[24:25], v230 offset:57344
    ds_read_b64_tr_b16 a[26:27], v230 offset:58368
    ds_read_b64_tr_b16 a[28:29], v231 offset:57344
    ds_read_b64_tr_b16 a[30:31], v231 offset:58368
    v_and_b32 v221, 0xffff0000, v154
    v_fma_f32 v220, v220, v236, v237
    v_fma_f32 v221, v221, v236, v237
    v_fma_f32 v220, v220, v188, v196
    v_mfma_f32_32x32x16_bf16 v[80:95], a[52:55], v[180:183], v[80:95]
    v_fma_f32 v221, v221, v189, v197
    v_cvt_pk_bf16_f32 v178, v220, v221
    v_lshlrev_b32 v222, 16, v155
    v_and_b32 v223, 0xffff0000, v155
    v_fma_f32 v222, v222, v236, v237
    v_fma_f32 v223, v223, v236, v237
    v_fma_f32 v222, v222, v190, v198
    v_mfma_f32_32x32x16_bf16 v[96:111], a[56:59], v[180:183], v[96:111]
    s_add_u32 m0, s49, 10240
    s_nop 0
    buffer_load_dwordx4 v251, s[12:15], s55 offen sc1 lds
    buffer_load_dwordx4 v251, s[12:15], s55 offen offset:1024 sc1 lds
    s_add_u32 s55, s55, 2048
    v_fma_f32 v223, v223, v191, v199
    v_cvt_pk_bf16_f32 v179, v222, v223
    v_mfma_f32_32x32x16_bf16 v[112:127], a[60:63], v[180:183], v[112:127]
    s_waitcnt lgkmcnt(0)
    v_mfma_f32_32x32x16_bf16 v[0:15], a[0:3], v[176:179], v[0:15]
    s_waitcnt vmcnt(12)
    ds_read_b64_tr_b16 a[32:33], v228 offset:28672
    ds_read_b64_tr_b16 a[34:35], v228 offset:29696
    ds_read_b64_tr_b16 a[36:37], v229 offset:28672
    ds_read_b64_tr_b16 a[38:39], v229 offset:29696
    v_lshlrev_b32 v216, 16, v156
    v_and_b32 v217, 0xffff0000, v156
    v_fma_f32 v216, v216, v236, v237
    v_mfma_f32_32x32x16_bf16 v[16:31], a[4:7], v[176:179], v[16:31]
    ds_read_b64_tr_b16 a[40:41], v230 offset:28672
    ds_read_b64_tr_b16 a[42:43], v230 offset:29696
    ds_read_b64_tr_b16 a[44:45], v231 offset:28672
    ds_read_b64_tr_b16 a[46:47], v231 offset:29696
    v_fma_f32 v217, v217, v236, v237
    v_fma_f32 v216, v216, v200, v208
    v_fma_f32 v217, v217, v201, v209
    v_cvt_pk_bf16_f32 v180, v216, v217
    v_mfma_f32_32x32x16_bf16 v[32:47], a[8:11], v[176:179], v[32:47]
    ds_read_b64_tr_b16 a[48:49], v228 offset:61440
    ds_read_b64_tr_b16 a[50:51], v228 offset:62464
    ds_read_b64_tr_b16 a[52:53], v229 offset:61440
    ds_read_b64_tr_b16 a[54:55], v229 offset:62464
    v_lshlrev_b32 v218, 16, v157
    v_and_b32 v219, 0xffff0000, v157
    v_fma_f32 v218, v218, v236, v237
    v_mfma_f32_32x32x16_bf16 v[48:63], a[12:15], v[176:179], v[48:63]
    ds_read_b64_tr_b16 a[56:57], v230 offset:61440
    ds_read_b64_tr_b16 a[58:59], v230 offset:62464
    ds_read_b64_tr_b16 a[60:61], v231 offset:61440
    ds_read_b64_tr_b16 a[62:63], v231 offset:62464
    v_fma_f32 v219, v219, v236, v237
    v_fma_f32 v218, v218, v202, v210
    v_fma_f32 v219, v219, v203, v211
    v_mfma_f32_32x32x16_bf16 v[64:79], a[16:19], v[176:179], v[64:79]
    v_cvt_pk_bf16_f32 v181, v218, v219
    v_lshlrev_b32 v220, 16, v158
    v_and_b32 v221, 0xffff0000, v158
    v_fma_f32 v220, v220, v236, v237
    v_fma_f32 v221, v221, v236, v237
    v_fma_f32 v220, v220, v204, v212
    v_fma_f32 v221, v221, v205, v213
    v_mfma_f32_32x32x16_bf16 v[80:95], a[20:23], v[176:179], v[80:95]
    v_cvt_pk_bf16_f32 v182, v220, v221
    v_lshlrev_b32 v222, 16, v159
    v_and_b32 v223, 0xffff0000, v159
    v_fma_f32 v222, v222, v236, v237
    v_fma_f32 v223, v223, v236, v237
    v_fma_f32 v222, v222, v206, v214
    v_mfma_f32_32x32x16_bf16 v[96:111], a[24:27], v[176:179], v[96:111]
    s_add_u32 m0, s49, 12288
    s_nop 0
    buffer_load_dwordx4 v251, s[12:15], s55 offen sc1 lds
    buffer_load_dwordx4 v251, s[12:15], s55 offen offset:1024 sc1 lds
    s_add_u32 s55, s55, 2048
    v_fma_f32 v223, v223, v207, v215
    v_cvt_pk_bf16_f32 v183, v222, v223
    v_mfma_f32_32x32x16_bf16 v[112:127], a[28:31], v[176:179], v[112:127]
    s_waitcnt lgkmcnt(0)
    v_mfma_f32_32x32x16_bf16 v[0:15], a[32:35], v[180:183], v[0:15]
    v_mfma_f32_32x32x16_bf16 v[16:31], a[36:39], v[180:183], v[16:31]
    v_mfma_f32_32x32x16_bf16 v[32:47], a[40:43], v[180:183], v[32:47]
    v_mfma_f32_32x32x16_bf16 v[48:63], a[44:47], v[180:183], v[48:63]
    v_mfma_f32_32x32x16_bf16 v[64:79], a[48:51], v[180:183], v[64:79]
    v_mfma_f32_32x32x16_bf16 v[80:95], a[52:55], v[180:183], v[80:95]
    v_mfma_f32_32x32x16_bf16 v[96:111], a[56:59], v[180:183], v[96:111]
    s_add_u32 m0, s49, 14336
    s_nop 0
    buffer_load_dwordx4 v251, s[12:15], s55 offen sc1 lds
    buffer_load_dwordx4 v251, s[12:15], s55 offen offset:1024 sc1 lds
    s_add_u32 s55, s55, 2048
    v_mfma_f32_32x32x16_bf16 v[112:127], a[60:63], v[180:183], v[112:127]
    s_barrier
    s_add_u32 m0, s49, 16384
    s_nop 0
    buffer_load_dwordx4 v251, s[12:15], s55 offen sc1 lds
    buffer_load_dwordx4 v251, s[12:15], s55 offen offset:1024 sc1 lds
    s_add_u32 s55, s55, 2048
    s_add_u32 m0, s49, 18432
    s_nop 0
    buffer_load_dwordx4 v251, s[12:15], s55 offen sc1 lds
    buffer_load_dwordx4 v251, s[12:15], s55 offen offset:1024 sc1 lds
    s_add_u32 s55, s55, 2048
    s_add_u32 m0, s49, 20480
    s_nop 0
    buffer_load_dwordx4 v251, s[12:15], s55 offen sc1 lds
    buffer_load_dwordx4 v251, s[12:15], s55 offen offset:1024 sc1 lds
    s_add_u32 s55, s55, 2048
    s_add_u32 m0, s49, 22528
    s_nop 0
    buffer_load_dwordx4 v251, s[12:15], s55 offen sc1 lds
    buffer_load_dwordx4 v251, s[12:15], s55 offen offset:1024 sc1 lds
    s_add_u32 s55, s55, 2048
    s_add_u32 m0, s49, 24576
    s_nop 0
    buffer_load_dwordx4 v251, s[12:15], s55 offen sc1 lds
    buffer_load_dwordx4 v251, s[12:15], s55 offen offset:1024 sc1 lds
    s_add_u32 s55, s55, 2048
    s_mov_b32 s3, 0xbfb8aa3b
    s_add_u32 s33, s37, 4096
    v_mul_f32 v128, s3, v0
    v_mul_f32 v129, s3, v1
    v_mul_f32 v130, s3, v2
    v_mul_f32 v131, s3, v3
    v_mul_f32 v132, s3, v4
    v_mul_f32 v133, s3, v5
    v_mul_f32 v134, s3, v6
    v_mul_f32 v135, s3, v7
    v_exp_f32 v128, v128
    v_exp_f32 v129, v129
    v_exp_f32 v130, v130
    v_exp_f32 v131, v131
    v_exp_f32 v132, v132
    v_exp_f32 v133, v133
    v_exp_f32 v134, v134
    v_exp_f32 v135, v135
    v_add_f32 v128, 1.0, v128
    v_add_f32 v129, 1.0, v129
    v_add_f32 v130, 1.0, v130
    v_add_f32 v131, 1.0, v131
    v_add_f32 v132, 1.0, v132
    v_add_f32 v133, 1.0, v133
    v_add_f32 v134, 1.0, v134
    v_add_f32 v135, 1.0, v135
    v_rcp_f32 v128, v128
    v_rcp_f32 v129, v129
    v_rcp_f32 v130, v130
    v_rcp_f32 v131, v131
    v_rcp_f32 v132, v132
    v_rcp_f32 v133, v133
    v_rcp_f32 v134, v134
    v_rcp_f32 v135, v135
    v_mul_f32 v0, v0, v128
    v_mul_f32 v1, v1, v129
    v_mul_f32 v2, v2, v130
    v_mul_f32 v3, v3, v131
    v_mul_f32 v4, v4, v132
    v_mul_f32 v5, v5, v133
    v_mul_f32 v6, v6, v134
    v_mul_f32 v7, v7, v135
    v_mul_f32 v0, v0, v64
    v_mul_f32 v1, v1, v65
    v_mul_f32 v2, v2, v66
    v_mul_f32 v3, v3, v67
    v_mul_f32 v4, v4, v68
    v_mul_f32 v5, v5, v69
    v_mul_f32 v6, v6, v70
    v_mul_f32 v7, v7, v71
    v_cvt_pk_bf16_f32 v136, v0, v1
    v_cvt_pk_bf16_f32 v137, v2, v3
    v_cvt_pk_bf16_f32 v138, v4, v5
    v_cvt_pk_bf16_f32 v139, v6, v7
    buffer_store_dwordx4 v[136:139], v232, s[12:15], s37 offen offset:0 sc1
    v_mul_f32 v140, s3, v8
    v_mul_f32 v141, s3, v9
    v_mul_f32 v142, s3, v10
    v_mul_f32 v143, s3, v11
    v_mul_f32 v144, s3, v12
    v_mul_f32 v145, s3, v13
    v_mul_f32 v146, s3, v14
    v_mul_f32 v147, s3, v15
    v_exp_f32 v140, v140
    v_exp_f32 v141, v141
    v_exp_f32 v142, v142
    v_exp_f32 v143, v143
    v_exp_f32 v144, v144
    v_exp_f32 v145, v145
    v_exp_f32 v146, v146
    v_exp_f32 v147, v147
    v_add_f32 v140, 1.0, v140
    v_add_f32 v141, 1.0, v141
    v_add_f32 v142, 1.0, v142
    v_add_f32 v143, 1.0, v143
    v_add_f32 v144, 1.0, v144
    v_add_f32 v145, 1.0, v145
    v_add_f32 v146, 1.0, v146
    v_add_f32 v147, 1.0, v147
    v_rcp_f32 v140, v140
    v_rcp_f32 v141, v141
    v_rcp_f32 v142, v142
    v_rcp_f32 v143, v143
    v_rcp_f32 v144, v144
    v_rcp_f32 v145, v145
    v_rcp_f32 v146, v146
    v_rcp_f32 v147, v147
    v_mul_f32 v8, v8, v140
    v_mul_f32 v9, v9, v141
    v_mul_f32 v10, v10, v142
    v_mul_f32 v11, v11, v143
    v_mul_f32 v12, v12, v144
    v_mul_f32 v13, v13, v145
    v_mul_f32 v14, v14, v146
    v_mul_f32 v15, v15, v147
    v_mul_f32 v8, v8, v72
    v_mul_f32 v9, v9, v73
    v_mul_f32 v10, v10, v74
    v_mul_f32 v11, v11, v75
    v_mul_f32 v12, v12, v76
    v_mul_f32 v13, v13, v77
    v_mul_f32 v14, v14, v78
    v_mul_f32 v15, v15, v79
    v_cvt_pk_bf16_f32 v148, v8, v9
    v_cvt_pk_bf16_f32 v149, v10, v11
    v_cvt_pk_bf16_f32 v150, v12, v13
    v_cvt_pk_bf16_f32 v151, v14, v15
    buffer_store_dwordx4 v[148:151], v232, s[12:15], s37 offen offset:1024 sc1
    v_mul_f32 v152, s3, v16
    v_mul_f32 v153, s3, v17
    v_mul_f32 v154, s3, v18
    v_mul_f32 v155, s3, v19
    v_mul_f32 v156, s3, v20
    v_mul_f32 v157, s3, v21
    v_mul_f32 v158, s3, v22
    v_mul_f32 v159, s3, v23
    v_exp_f32 v152, v152
    v_exp_f32 v153, v153
    v_exp_f32 v154, v154
    v_exp_f32 v155, v155
    v_exp_f32 v156, v156
    v_exp_f32 v157, v157
    v_exp_f32 v158, v158
    v_exp_f32 v159, v159
    v_add_f32 v152, 1.0, v152
    v_add_f32 v153, 1.0, v153
    v_add_f32 v154, 1.0, v154
    v_add_f32 v155, 1.0, v155
    v_add_f32 v156, 1.0, v156
    v_add_f32 v157, 1.0, v157
    v_add_f32 v158, 1.0, v158
    v_add_f32 v159, 1.0, v159
    v_rcp_f32 v152, v152
    v_rcp_f32 v153, v153
    v_rcp_f32 v154, v154
    v_rcp_f32 v155, v155
    v_rcp_f32 v156, v156
    v_rcp_f32 v157, v157
    v_rcp_f32 v158, v158
    v_rcp_f32 v159, v159
    v_mul_f32 v16, v16, v152
    v_mul_f32 v17, v17, v153
    v_mul_f32 v18, v18, v154
    v_mul_f32 v19, v19, v155
    v_mul_f32 v20, v20, v156
    v_mul_f32 v21, v21, v157
    v_mul_f32 v22, v22, v158
    v_mul_f32 v23, v23, v159
    v_mul_f32 v16, v16, v80
    v_mul_f32 v17, v17, v81
    v_mul_f32 v18, v18, v82
    v_mul_f32 v19, v19, v83
    v_mul_f32 v20, v20, v84
    v_mul_f32 v21, v21, v85
    v_mul_f32 v22, v22, v86
    v_mul_f32 v23, v23, v87
    v_cvt_pk_bf16_f32 v160, v16, v17
    v_cvt_pk_bf16_f32 v161, v18, v19
    v_cvt_pk_bf16_f32 v162, v20, v21
    v_cvt_pk_bf16_f32 v163, v22, v23
    buffer_store_dwordx4 v[160:163], v232, s[12:15], s37 offen offset:2048 sc1
    v_mul_f32 v164, s3, v24
    v_mul_f32 v165, s3, v25
    v_mul_f32 v166, s3, v26
    v_mul_f32 v167, s3, v27
    v_mul_f32 v168, s3, v28
    v_mul_f32 v169, s3, v29
    v_mul_f32 v170, s3, v30
    v_mul_f32 v171, s3, v31
    v_exp_f32 v164, v164
    v_exp_f32 v165, v165
    v_exp_f32 v166, v166
    v_exp_f32 v167, v167
    v_exp_f32 v168, v168
    v_exp_f32 v169, v169
    v_exp_f32 v170, v170
    v_exp_f32 v171, v171
    v_add_f32 v164, 1.0, v164
    v_add_f32 v165, 1.0, v165
    v_add_f32 v166, 1.0, v166
    v_add_f32 v167, 1.0, v167
    v_add_f32 v168, 1.0, v168
    v_add_f32 v169, 1.0, v169
    v_add_f32 v170, 1.0, v170
    v_add_f32 v171, 1.0, v171
    v_rcp_f32 v164, v164
    v_rcp_f32 v165, v165
    v_rcp_f32 v166, v166
    v_rcp_f32 v167, v167
    v_rcp_f32 v168, v168
    v_rcp_f32 v169, v169
    v_rcp_f32 v170, v170
    v_rcp_f32 v171, v171
    v_mul_f32 v24, v24, v164
    v_mul_f32 v25, v25, v165
    v_mul_f32 v26, v26, v166
    v_mul_f32 v27, v27, v167
    v_mul_f32 v28, v28, v168
    v_mul_f32 v29, v29, v169
    v_mul_f32 v30, v30, v170
    v_mul_f32 v31, v31, v171
    v_mul_f32 v24, v24, v88
    v_mul_f32 v25, v25, v89
    v_mul_f32 v26, v26, v90
    v_mul_f32 v27, v27, v91
    v_mul_f32 v28, v28, v92
    v_mul_f32 v29, v29, v93
    v_mul_f32 v30, v30, v94
    v_mul_f32 v31, v31, v95
    v_cvt_pk_bf16_f32 v172, v24, v25
    v_cvt_pk_bf16_f32 v173, v26, v27
    v_cvt_pk_bf16_f32 v174, v28, v29
    v_cvt_pk_bf16_f32 v175, v30, v31
    buffer_store_dwordx4 v[172:175], v232, s[12:15], s37 offen offset:3072 sc1
    v_mul_f32 v128, s3, v32
    v_mul_f32 v129, s3, v33
    v_mul_f32 v130, s3, v34
    v_mul_f32 v131, s3, v35
    v_mul_f32 v132, s3, v36
    v_mul_f32 v133, s3, v37
    v_mul_f32 v134, s3, v38
    v_mul_f32 v135, s3, v39
    v_exp_f32 v128, v128
    v_exp_f32 v129, v129
    v_exp_f32 v130, v130
    v_exp_f32 v131, v131
    v_exp_f32 v132, v132
    v_exp_f32 v133, v133
    v_exp_f32 v134, v134
    v_exp_f32 v135, v135
    v_add_f32 v128, 1.0, v128
    v_add_f32 v129, 1.0, v129
    v_add_f32 v130, 1.0, v130
    v_add_f32 v131, 1.0, v131
    v_add_f32 v132, 1.0, v132
    v_add_f32 v133, 1.0, v133
    v_add_f32 v134, 1.0, v134
    v_add_f32 v135, 1.0, v135
    v_rcp_f32 v128, v128
    v_rcp_f32 v129, v129
    v_rcp_f32 v130, v130
    v_rcp_f32 v131, v131
    v_rcp_f32 v132, v132
    v_rcp_f32 v133, v133
    v_rcp_f32 v134, v134
    v_rcp_f32 v135, v135
    v_mul_f32 v32, v32, v128
    v_mul_f32 v33, v33, v129
    v_mul_f32 v34, v34, v130
    v_mul_f32 v35, v35, v131
    v_mul_f32 v36, v36, v132
    v_mul_f32 v37, v37, v133
    v_mul_f32 v38, v38, v134
    v_mul_f32 v39, v39, v135
    v_mul_f32 v32, v32, v96
    v_mul_f32 v33, v33, v97
    v_mul_f32 v34, v34, v98
    v_mul_f32 v35, v35, v99
    v_mul_f32 v36, v36, v100
    v_mul_f32 v37, v37, v101
    v_mul_f32 v38, v38, v102
    v_mul_f32 v39, v39, v103
    v_cvt_pk_bf16_f32 v136, v32, v33
    v_cvt_pk_bf16_f32 v137, v34, v35
    v_cvt_pk_bf16_f32 v138, v36, v37
    v_cvt_pk_bf16_f32 v139, v38, v39
    buffer_store_dwordx4 v[136:139], v232, s[12:15], s33 offen offset:0 sc1
    v_mul_f32 v140, s3, v40
    v_mul_f32 v141, s3, v41
    v_mul_f32 v142, s3, v42
    v_mul_f32 v143, s3, v43
    v_mul_f32 v144, s3, v44
    v_mul_f32 v145, s3, v45
    v_mul_f32 v146, s3, v46
    v_mul_f32 v147, s3, v47
    v_exp_f32 v140, v140
    v_exp_f32 v141, v141
    v_exp_f32 v142, v142
    v_exp_f32 v143, v143
    v_exp_f32 v144, v144
    v_exp_f32 v145, v145
    v_exp_f32 v146, v146
    v_exp_f32 v147, v147
    v_add_f32 v140, 1.0, v140
    v_add_f32 v141, 1.0, v141
    v_add_f32 v142, 1.0, v142
    v_add_f32 v143, 1.0, v143
    v_add_f32 v144, 1.0, v144
    v_add_f32 v145, 1.0, v145
    v_add_f32 v146, 1.0, v146
    v_add_f32 v147, 1.0, v147
    v_rcp_f32 v140, v140
    v_rcp_f32 v141, v141
    v_rcp_f32 v142, v142
    v_rcp_f32 v143, v143
    v_rcp_f32 v144, v144
    v_rcp_f32 v145, v145
    v_rcp_f32 v146, v146
    v_rcp_f32 v147, v147
    v_mul_f32 v40, v40, v140
    v_mul_f32 v41, v41, v141
    v_mul_f32 v42, v42, v142
    v_mul_f32 v43, v43, v143
    v_mul_f32 v44, v44, v144
    v_mul_f32 v45, v45, v145
    v_mul_f32 v46, v46, v146
    v_mul_f32 v47, v47, v147
    v_mul_f32 v40, v40, v104
    v_mul_f32 v41, v41, v105
    v_mul_f32 v42, v42, v106
    v_mul_f32 v43, v43, v107
    v_mul_f32 v44, v44, v108
    v_mul_f32 v45, v45, v109
    v_mul_f32 v46, v46, v110
    v_mul_f32 v47, v47, v111
    v_cvt_pk_bf16_f32 v148, v40, v41
    v_cvt_pk_bf16_f32 v149, v42, v43
    v_cvt_pk_bf16_f32 v150, v44, v45
    v_cvt_pk_bf16_f32 v151, v46, v47
    buffer_store_dwordx4 v[148:151], v232, s[12:15], s33 offen offset:1024 sc1
    v_mul_f32 v152, s3, v48
    v_mul_f32 v153, s3, v49
    v_mul_f32 v154, s3, v50
    v_mul_f32 v155, s3, v51
    v_mul_f32 v156, s3, v52
    v_mul_f32 v157, s3, v53
    v_mul_f32 v158, s3, v54
    v_mul_f32 v159, s3, v55
    v_exp_f32 v152, v152
    v_exp_f32 v153, v153
    v_exp_f32 v154, v154
    v_exp_f32 v155, v155
    v_exp_f32 v156, v156
    v_exp_f32 v157, v157
    v_exp_f32 v158, v158
    v_exp_f32 v159, v159
    v_add_f32 v152, 1.0, v152
    v_add_f32 v153, 1.0, v153
    v_add_f32 v154, 1.0, v154
    v_add_f32 v155, 1.0, v155
    v_add_f32 v156, 1.0, v156
    v_add_f32 v157, 1.0, v157
    v_add_f32 v158, 1.0, v158
    v_add_f32 v159, 1.0, v159
    v_rcp_f32 v152, v152
    v_rcp_f32 v153, v153
    v_rcp_f32 v154, v154
    v_rcp_f32 v155, v155
    v_rcp_f32 v156, v156
    v_rcp_f32 v157, v157
    v_rcp_f32 v158, v158
    v_rcp_f32 v159, v159
    v_mul_f32 v48, v48, v152
    v_mul_f32 v49, v49, v153
    v_mul_f32 v50, v50, v154
    v_mul_f32 v51, v51, v155
    v_mul_f32 v52, v52, v156
    v_mul_f32 v53, v53, v157
    v_mul_f32 v54, v54, v158
    v_mul_f32 v55, v55, v159
    v_mul_f32 v48, v48, v112
    v_mul_f32 v49, v49, v113
    v_mul_f32 v50, v50, v114
    v_mul_f32 v51, v51, v115
    v_mul_f32 v52, v52, v116
    v_mul_f32 v53, v53, v117
    v_mul_f32 v54, v54, v118
    v_mul_f32 v55, v55, v119
    v_cvt_pk_bf16_f32 v160, v48, v49
    v_cvt_pk_bf16_f32 v161, v50, v51
    v_cvt_pk_bf16_f32 v162, v52, v53
    v_cvt_pk_bf16_f32 v163, v54, v55
    buffer_store_dwordx4 v[160:163], v232, s[12:15], s33 offen offset:2048 sc1
    v_mul_f32 v164, s3, v56
    v_mul_f32 v165, s3, v57
    v_mul_f32 v166, s3, v58
    v_mul_f32 v167, s3, v59
    v_mul_f32 v168, s3, v60
    v_mul_f32 v169, s3, v61
    v_mul_f32 v170, s3, v62
    v_mul_f32 v171, s3, v63
    v_exp_f32 v164, v164
    v_exp_f32 v165, v165
    v_exp_f32 v166, v166
    v_exp_f32 v167, v167
    v_exp_f32 v168, v168
    v_exp_f32 v169, v169
    v_exp_f32 v170, v170
    v_exp_f32 v171, v171
    v_add_f32 v164, 1.0, v164
    v_add_f32 v165, 1.0, v165
    v_add_f32 v166, 1.0, v166
    v_add_f32 v167, 1.0, v167
    v_add_f32 v168, 1.0, v168
    v_add_f32 v169, 1.0, v169
    v_add_f32 v170, 1.0, v170
    v_add_f32 v171, 1.0, v171
    v_rcp_f32 v164, v164
    v_rcp_f32 v165, v165
    v_rcp_f32 v166, v166
    v_rcp_f32 v167, v167
    v_rcp_f32 v168, v168
    v_rcp_f32 v169, v169
    v_rcp_f32 v170, v170
    v_rcp_f32 v171, v171
    v_mul_f32 v56, v56, v164
    v_mul_f32 v57, v57, v165
    v_mul_f32 v58, v58, v166
    v_mul_f32 v59, v59, v167
    v_mul_f32 v60, v60, v168
    v_mul_f32 v61, v61, v169
    v_mul_f32 v62, v62, v170
    v_mul_f32 v63, v63, v171
    v_mul_f32 v56, v56, v120
    v_mul_f32 v57, v57, v121
    v_mul_f32 v58, v58, v122
    v_mul_f32 v59, v59, v123
    v_mul_f32 v60, v60, v124
    v_mul_f32 v61, v61, v125
    v_mul_f32 v62, v62, v126
    v_mul_f32 v63, v63, v127
    v_cvt_pk_bf16_f32 v172, v56, v57
    v_cvt_pk_bf16_f32 v173, v58, v59
    v_cvt_pk_bf16_f32 v174, v60, v61
    v_cvt_pk_bf16_f32 v175, v62, v63
    buffer_store_dwordx4 v[172:175], v232, s[12:15], s33 offen offset:3072 sc1
    s_lshl_b32 s46, s50, 8
    s_lshl_b32 s45, s51, 2
    s_add_u32 s46, s46, s45
    s_add_u32 s46, s46, 20480
    s_branch tail_joinb
tail_skipb:
    s_waitcnt vmcnt(0)
    s_barrier
    s_cmp_lg_u32 s32, 0
    s_cbranch_scc1 attn_kernel_nosig_24
    v_mov_b32 v252, 0
    v_mov_b32 v253, 1
    s_mov_b64 exec, 1
    buffer_store_dword v253, v252, s[12:15], s46 offen sc1
    s_mov_b64 exec, -1
attn_kernel_nosig_24:
    v_mbcnt_lo_u32_b32 v252, -1, 0
    v_mbcnt_hi_u32_b32 v252, -1, v252
    v_lshrrev_b32 v253, 3, v252
    v_lshlrev_b32 v251, 1, v253
    v_and_b32 v251, 4, v251
    v_and_b32 v252, 7, v252
    v_xor_b32 v251, v251, v252
    v_lshlrev_b32 v251, 4, v251
    v_lshl_add_u32 v251, v253, 7, v251
    s_lshl_b32 s49, s32, 15
    s_and_b32 s55, s2, 1
    s_lshl_b32 s55, s55, 2
    s_lshr_b32 s47, s2, 6
    s_add_u32 s55, s55, s47
    s_lshl_b32 s55, s55, 18
    s_mul_i32 s47, s32, 57344
    s_add_u32 s55, s55, s47
    s_add_u32 s55, s55, 37748736
    s_add_u32 m0, s49, 0
    s_nop 0
    buffer_load_dwordx4 v251, s[12:15], s55 offen sc1 lds
    buffer_load_dwordx4 v251, s[12:15], s55 offen offset:1024 sc1 lds
    s_add_u32 s55, s55, 2048
    s_add_u32 m0, s49, 2048
    s_nop 0
    buffer_load_dwordx4 v251, s[12:15], s55 offen sc1 lds
    buffer_load_dwordx4 v251, s[12:15], s55 offen offset:1024 sc1 lds
    s_add_u32 s55, s55, 2048
    s_add_u32 m0, s49, 4096
    s_nop 0
    buffer_load_dwordx4 v251, s[12:15], s55 offen sc1 lds
    buffer_load_dwordx4 v251, s[12:15], s55 offen offset:1024 sc1 lds
    s_add_u32 s55, s55, 2048
    s_add_u32 m0, s49, 6144
    s_nop 0
    buffer_load_dwordx4 v251, s[12:15], s55 offen sc1 lds
    buffer_load_dwordx4 v251, s[12:15], s55 offen offset:1024 sc1 lds
    s_add_u32 s55, s55, 2048
    s_add_u32 m0, s49, 8192
    s_nop 0
    buffer_load_dwordx4 v251, s[12:15], s55 offen sc1 lds
    buffer_load_dwordx4 v251, s[12:15], s55 offen offset:1024 sc1 lds
    s_add_u32 s55, s55, 2048
    s_add_u32 m0, s49, 10240
    s_nop 0
    buffer_load_dwordx4 v251, s[12:15], s55 offen sc1 lds
    buffer_load_dwordx4 v251, s[12:15], s55 offen offset:1024 sc1 lds
    s_add_u32 s55, s55, 2048
    s_add_u32 m0, s49, 12288
    s_nop 0
    buffer_load_dwordx4 v251, s[12:15], s55 offen sc1 lds
    buffer_load_dwordx4 v251, s[12:15], s55 offen offset:1024 sc1 lds
    s_add_u32 s55, s55, 2048
    s_add_u32 m0, s49, 14336
    s_nop 0
    buffer_load_dwordx4 v251, s[12:15], s55 offen sc1 lds
    buffer_load_dwordx4 v251, s[12:15], s55 offen offset:1024 sc1 lds
    s_add_u32 s55, s55, 2048
    s_add_u32 m0, s49, 16384
    s_nop 0
    buffer_load_dwordx4 v251, s[12:15], s55 offen sc1 lds
    buffer_load_dwordx4 v251, s[12:15], s55 offen offset:1024 sc1 lds
    s_add_u32 s55, s55, 2048
    s_add_u32 m0, s49, 18432
    s_nop 0
    buffer_load_dwordx4 v251, s[12:15], s55 offen sc1 lds
    buffer_load_dwordx4 v251, s[12:15], s55 offen offset:1024 sc1 lds
    s_add_u32 s55, s55, 2048
    s_add_u32 m0, s49, 20480
    s_nop 0
    buffer_load_dwordx4 v251, s[12:15], s55 offen sc1 lds
    buffer_load_dwordx4 v251, s[12:15], s55 offen offset:1024 sc1 lds
    s_add_u32 s55, s55, 2048
    s_add_u32 m0, s49, 22528
    s_nop 0
    buffer_load_dwordx4 v251, s[12:15], s55 offen sc1 lds
    buffer_load_dwordx4 v251, s[12:15], s55 offen offset:1024 sc1 lds
    s_add_u32 s55, s55, 2048
    s_add_u32 m0, s49, 24576
    s_nop 0
    buffer_load_dwordx4 v251, s[12:15], s55 offen sc1 lds
    buffer_load_dwordx4 v251, s[12:15], s55 offen offset:1024 sc1 lds
    s_add_u32 s55, s55, 2048
    s_mov_b32 s46, 32768
tail_joinb:
    s_bfe_u32 s28, s2, 0x20001
    s_lshl_b32 s28, s28, 3
    s_bfe_u32 s30, s2, 0x30003
    s_add_u32 s28, s28, s30
    s_and_b32 s29, s2, 1
    s_lshl_b32 s29, s29, 2
    s_lshr_b32 s30, s2, 6
    s_add_u32 s29, s29, s30
    v_mbcnt_lo_u32_b32 v2, -1, 0
    v_mbcnt_hi_u32_b32 v2, -1, v2
    v_lshlrev_b32 v216, 4, v2
    s_mul_i32 s33, s28, 229376
    s_mul_i32 s35, s32, 28672
    s_add_u32 s33, s33, s35
    s_add_u32 s33, s33, 25165824
    s_add_u32 s39, s33, 114688
    s_lshr_b32 s40, s32, 1
    s_and_b32 s47, s32, 1
    s_lshl_b32 s41, s29, 6
    s_lshl_b32 s42, s40, 5
    s_add_u32 s41, s41, s42
    s_lshl_b32 s42, s28, 6
    s_lshl_b32 s43, s47, 5
    s_add_u32 s42, s42, s43
    v_lshrrev_b32 v4, 5, v2
    v_and_b32 v5, 31, v2
    v_add_u32 v6, s42, v5
    v_lshlrev_b32 v6, 10, v6
    v_lshl_add_u32 v6, v4, 4, v6
    s_lshl_b32 s43, s41, 1
    v_add_u32 v6, s43, v6
    s_lshl_b32 s43, s42, 10
    s_lshl_b32 s44, s41, 6
    s_add_u32 s43, s43, s44
    s_add_u32 s43, s43, 20971520
    v_lshlrev_b32 v7, 5, v4
    s_lshl_b32 s44, s41, 2
    s_add_u32 s44, s44, 12288
    s_waitcnt vmcnt(0)
    s_barrier
    s_cmp_lg_u32 s32, 0
    s_cbranch_scc1 attn_kernel_nosig_25
    v_mov_b32 v244, 0
    v_mov_b32 v245, 1
    s_mov_b64 exec, 1
    buffer_store_dword v245, v244, s[12:15], s46 offen sc1
    s_mov_b64 exec, -1
attn_kernel_nosig_25:
    s_mov_b32 s16, s62
    s_and_b32 s17, s63, 0xffff
    s_mov_b32 s18, 2097152
    s_mov_b32 s19, 0x00020000
    buffer_load_dwordx4 v[220:223], v7, s[12:15], s44 offen offset:0
    buffer_load_dwordx4 v[224:227], v7, s[12:15], s44 offen offset:16
    buffer_load_dwordx4 v[228:231], v7, s[12:15], s44 offen offset:64
    buffer_load_dwordx4 v[232:235], v7, s[12:15], s44 offen offset:80
    v_bfe_u32 v3, v2, 2, 2
    v_lshl_add_u32 v1, v4, 3, v3
    v_lshlrev_b32 v1, 7, v1
    v_bfe_u32 v218, v2, 4, 1
    v_lshl_add_u32 v1, v218, 5, v1
    v_and_b32 v218, 1, v2
    v_lshl_add_u32 v1, v218, 4, v1
    v_bfe_u32 v218, v2, 1, 1
    v_lshl_add_u32 v1, v218, 3, v1
    v_add_u32 v1, s49, v1
    v_lshrrev_b32 v3, 1, v3
    v_lshl_add_u32 v218, v3, 6, v1
    v_xor_b32 v3, 1, v3
    v_lshl_add_u32 v219, v3, 6, v1
    v_mov_b32 v8, 0
    v_mov_b32 v9, 0
    v_mov_b32 v10, 0
    v_mov_b32 v11, 0
    v_mov_b32 v12, 0
    v_mov_b32 v13, 0
    v_mov_b32 v14, 0
    v_mov_b32 v15, 0
    v_mov_b32 v16, 0
    v_mov_b32 v17, 0
    v_mov_b32 v18, 0
    v_mov_b32 v19, 0
    v_mov_b32 v20, 0
    v_mov_b32 v21, 0
    v_mov_b32 v22, 0
    v_mov_b32 v23, 0
    v_mov_b32 v24, 0
    v_mov_b32 v25, 0
    v_mov_b32 v26, 0
    v_mov_b32 v27, 0
    v_mov_b32 v28, 0
    v_mov_b32 v29, 0
    v_mov_b32 v30, 0
    v_mov_b32 v31, 0
    v_mov_b32 v32, 0
    v_mov_b32 v33, 0
    v_mov_b32 v34, 0
    v_mov_b32 v35, 0
    v_mov_b32 v36, 0
    v_mov_b32 v37, 0
    v_mov_b32 v38, 0
    v_mov_b32 v39, 0
    v_mov_b32 v40, 0
    v_mov_b32 v41, 0
    v_mov_b32 v42, 0
    v_mov_b32 v43, 0
    v_mov_b32 v44, 0
    v_mov_b32 v45, 0
    v_mov_b32 v46, 0
    v_mov_b32 v47, 0
    v_mov_b32 v48, 0
    v_mov_b32 v49, 0
    v_mov_b32 v50, 0
    v_mov_b32 v51, 0
    v_mov_b32 v52, 0
    v_mov_b32 v53, 0
    v_mov_b32 v54, 0
    v_mov_b32 v55, 0
    v_mov_b32 v56, 0
    v_mov_b32 v57, 0
    v_mov_b32 v58, 0
    v_mov_b32 v59, 0
    v_mov_b32 v60, 0
    v_mov_b32 v61, 0
    v_mov_b32 v62, 0
    v_mov_b32 v63, 0
    v_mov_b32 v64, 0
    v_mov_b32 v65, 0
    v_mov_b32 v66, 0
    v_mov_b32 v67, 0
    v_mov_b32 v68, 0
    v_mov_b32 v69, 0
    v_mov_b32 v70, 0
    v_mov_b32 v71, 0
    s_mov_b32 s38, 1
    s_lshr_b32 s45, s28, 1
    s_lshl_b32 s45, s45, 8
    s_add_u32 s45, s45, 20480
    s_cmp_lg_u32 s32, 0
    s_cbranch_scc1 pc_go
    v_min_u32 v246, 13, v2
    v_lshlrev_b32 v246, 2, v246
    s_mov_b32 s48, 0x40000
pc_poll:
    buffer_load_dword v247, v246, s[12:15], s45 offen sc1
    s_waitcnt vmcnt(0)
    v_cmp_eq_u32 vcc, 0, v247
    s_nop 0
    s_cbranch_vccz pc_go
    s_sleep 2
    s_sub_u32 s48, s48, 1
    s_cmp_lg_u32 s48, 0
    s_cbranch_scc1 pc_poll
pc_go:
    s_waitcnt vmcnt(0)
    s_barrier
    buffer_load_dwordx4 v[72:75], v216, s[12:15], s33 offen offset:0 sc1
    buffer_load_dwordx4 v[76:79], v216, s[12:15], s39 offen offset:0 sc1
    buffer_load_dwordx4 v[80:83], v216, s[12:15], s33 offen offset:1024 sc1
    buffer_load_dwordx4 v[84:87], v216, s[12:15], s39 offen offset:1024 sc1
    s_add_u32 s33, s33, 2048
    s_add_u32 s39, s39, 2048
    buffer_load_dwordx4 v[88:91], v216, s[12:15], s33 offen offset:0 sc1
    buffer_load_dwordx4 v[92:95], v216, s[12:15], s39 offen offset:0 sc1
    buffer_load_dwordx4 v[96:99], v216, s[12:15], s33 offen offset:1024 sc1
    buffer_load_dwordx4 v[100:103], v216, s[12:15], s39 offen offset:1024 sc1
    s_add_u32 s33, s33, 2048
    s_add_u32 s39, s39, 2048
    buffer_load_dwordx4 v[104:107], v216, s[12:15], s33 offen offset:0 sc1
    buffer_load_dwordx4 v[108:111], v216, s[12:15], s39 offen offset:0 sc1
    buffer_load_dwordx4 v[112:115], v216, s[12:15], s33 offen offset:1024 sc1
    buffer_load_dwordx4 v[116:119], v216, s[12:15], s39 offen offset:1024 sc1
    s_add_u32 s33, s33, 2048
    s_add_u32 s39, s39, 2048
    buffer_load_dwordx4 v[120:123], v216, s[12:15], s33 offen offset:0 sc1
    buffer_load_dwordx4 v[124:127], v216, s[12:15], s39 offen offset:0 sc1
    buffer_load_dwordx4 v[128:131], v216, s[12:15], s33 offen offset:1024 sc1
    buffer_load_dwordx4 v[132:135], v216, s[12:15], s39 offen offset:1024 sc1
    s_add_u32 s33, s33, 2048
    s_add_u32 s39, s39, 2048
    buffer_load_dwordx4 v[136:139], v216, s[12:15], s33 offen offset:0 sc1
    buffer_load_dwordx4 v[140:143], v216, s[12:15], s39 offen offset:0 sc1
    buffer_load_dwordx4 v[144:147], v216, s[12:15], s33 offen offset:1024 sc1
    buffer_load_dwordx4 v[148:151], v216, s[12:15], s39 offen offset:1024 sc1
    s_add_u32 s33, s33, 2048
    s_add_u32 s39, s39, 2048
    buffer_load_dwordx4 v[152:155], v216, s[12:15], s33 offen offset:0 sc1
    buffer_load_dwordx4 v[156:159], v216, s[12:15], s39 offen offset:0 sc1
    buffer_load_dwordx4 v[160:163], v216, s[12:15], s33 offen offset:1024 sc1
    buffer_load_dwordx4 v[164:167], v216, s[12:15], s39 offen offset:1024 sc1
    s_add_u32 s33, s33, 2048
    s_add_u32 s39, s39, 2048
    buffer_load_dwordx4 v[168:171], v216, s[12:15], s33 offen offset:0 sc1
    buffer_load_dwordx4 v[172:175], v216, s[12:15], s39 offen offset:0 sc1
    s_waitcnt vmcnt(24)
    ds_read_b64_tr_b16 v[200:201], v218 offset:0
    ds_read_b64_tr_b16 v[202:203], v218 offset:512
    ds_read_b64_tr_b16 v[204:205], v219 offset:0
    ds_read_b64_tr_b16 v[206:207], v219 offset:512
    s_waitcnt lgkmcnt(0)
pc_loop:
    v_mfma_f32_32x32x16_bf16 v[8:23], v[200:203], v[72:75], v[8:23]
    s_waitcnt vmcnt(22)
    ds_read_b64_tr_b16 v[208:209], v218 offset:2048
    ds_read_b64_tr_b16 v[210:211], v218 offset:2560
    ds_read_b64_tr_b16 v[212:213], v219 offset:2048
    ds_read_b64_tr_b16 v[214:215], v219 offset:2560
    s_add_u32 m0, s49, 26624
    v_mfma_f32_32x32x16_bf16 v[24:39], v[200:203], v[76:79], v[24:39]
    buffer_load_dwordx4 v[176:179], v216, s[12:15], s33 offen offset:1024 sc1
    buffer_load_dwordx4 v251, s[12:15], s55 offen sc1 lds
    v_mfma_f32_32x32x16_bf16 v[40:55], v[204:207], v[72:75], v[40:55]
    buffer_load_dwordx4 v251, s[12:15], s55 offen offset:1024 sc1 lds
    buffer_load_dwordx4 v[180:183], v216, s[12:15], s39 offen offset:1024 sc1
    s_add_u32 s55, s55, 2048
    s_add_u32 s33, s33, 2048
    s_add_u32 s39, s39, 2048
    v_mfma_f32_32x32x16_bf16 v[56:71], v[204:207], v[76:79], v[56:71]
    s_waitcnt lgkmcnt(0)
    v_mfma_f32_32x32x16_bf16 v[8:23], v[208:211], v[80:83], v[8:23]
    s_waitcnt vmcnt(24)
    ds_read_b64_tr_b16 v[200:201], v218 offset:4096
    ds_read_b64_tr_b16 v[202:203], v218 offset:4608
    ds_read_b64_tr_b16 v[204:205], v219 offset:4096
    ds_read_b64_tr_b16 v[206:207], v219 offset:4608
    s_add_u32 m0, s49, 0
    v_mfma_f32_32x32x16_bf16 v[24:39], v[208:211], v[84:87], v[24:39]
    buffer_load_dwordx4 v[72:75], v216, s[12:15], s33 offen offset:0 sc1
    buffer_load_dwordx4 v251, s[12:15], s55 offen sc1 lds
    v_mfma_f32_32x32x16_bf16 v[40:55], v[212:215], v[80:83], v[40:55]
    buffer_load_dwordx4 v251, s[12:15], s55 offen offset:1024 sc1 lds
    buffer_load_dwordx4 v[76:79], v216, s[12:15], s39 offen offset:0 sc1
    s_add_u32 s55, s55, 2048
    v_mfma_f32_32x32x16_bf16 v[56:71], v[212:215], v[84:87], v[56:71]
    s_waitcnt lgkmcnt(0)
    v_mfma_f32_32x32x16_bf16 v[8:23], v[200:203], v[88:91], v[8:23]
    s_waitcnt vmcnt(26)
    ds_read_b64_tr_b16 v[208:209], v218 offset:6144
    ds_read_b64_tr_b16 v[210:211], v218 offset:6656
    ds_read_b64_tr_b16 v[212:213], v219 offset:6144
    ds_read_b64_tr_b16 v[214:215], v219 offset:6656
    s_add_u32 m0, s49, 2048
    v_mfma_f32_32x32x16_bf16 v[24:39], v[200:203], v[92:95], v[24:39]
    buffer_load_dwordx4 v[80:83], v216, s[12:15], s33 offen offset:1024 sc1
    buffer_load_dwordx4 v251, s[12:15], s55 offen sc1 lds
    v_mfma_f32_32x32x16_bf16 v[40:55], v[204:207], v[88:91], v[40:55]
    buffer_load_dwordx4 v251, s[12:15], s55 offen offset:1024 sc1 lds
    buffer_load_dwordx4 v[84:87], v216, s[12:15], s39 offen offset:1024 sc1
    s_add_u32 s55, s55, 2048
    s_add_u32 s33, s33, 2048
    s_add_u32 s39, s39, 2048
    v_mfma_f32_32x32x16_bf16 v[56:71], v[204:207], v[92:95], v[56:71]
    s_waitcnt lgkmcnt(0)
    v_mfma_f32_32x32x16_bf16 v[8:23], v[208:211], v[96:99], v[8:23]
    s_waitcnt vmcnt(28)
    ds_read_b64_tr_b16 v[200:201], v218 offset:8192
    ds_read_b64_tr_b16 v[202:203], v218 offset:8704
    ds_read_b64_tr_b16 v[204:205], v219 offset:8192
    ds_read_b64_tr_b16 v[206:207], v219 offset:8704
    s_add_u32 m0, s49, 4096
    v_mfma_f32_32x32x16_bf16 v[24:39], v[208:211], v[100:103], v[24:39]
    buffer_load_dwordx4 v[88:91], v216, s[12:15], s33 offen offset:0 sc1
    buffer_load_dwordx4 v251, s[12:15], s55 offen sc1 lds
    v_mfma_f32_32x32x16_bf16 v[40:55], v[212:215], v[96:99], v[40:55]
    buffer_load_dwordx4 v251, s[12:15], s55 offen offset:1024 sc1 lds
    buffer_load_dwordx4 v[92:95], v216, s[12:15], s39 offen offset:0 sc1
    s_add_u32 s55, s55, 2048
    v_mfma_f32_32x32x16_bf16 v[56:71], v[212:215], v[100:103], v[56:71]
    s_waitcnt lgkmcnt(0)
    v_mfma_f32_32x32x16_bf16 v[8:23], v[200:203], v[104:107], v[8:23]
    s_waitcnt vmcnt(30)
    ds_read_b64_tr_b16 v[208:209], v218 offset:10240
    ds_read_b64_tr_b16 v[210:211], v218 offset:10752
    ds_read_b64_tr_b16 v[212:213], v219 offset:10240
    ds_read_b64_tr_b16 v[214:215], v219 offset:10752
    s_add_u32 m0, s49, 6144
    v_mfma_f32_32x32x16_bf16 v[24:39], v[200:203], v[108:111], v[24:39]
    buffer_load_dwordx4 v[96:99], v216, s[12:15], s33 offen offset:1024 sc1
    buffer_load_dwordx4 v251, s[12:15], s55 offen sc1 lds
    v_mfma_f32_32x32x16_bf16 v[40:55], v[204:207], v[104:107], v[40:55]
    buffer_load_dwordx4 v251, s[12:15], s55 offen offset:1024 sc1 lds
    buffer_load_dwordx4 v[100:103], v216, s[12:15], s39 offen offset:1024 sc1
    s_add_u32 s55, s55, 2048
    s_add_u32 s33, s33, 2048
    s_add_u32 s39, s39, 2048
    v_mfma_f32_32x32x16_bf16 v[56:71], v[204:207], v[108:111], v[56:71]
    s_waitcnt lgkmcnt(0)
    v_mfma_f32_32x32x16_bf16 v[8:23], v[208:211], v[112:115], v[8:23]
    s_waitcnt vmcnt(32)
    ds_read_b64_tr_b16 v[200:201], v218 offset:12288
    ds_read_b64_tr_b16 v[202:203], v218 offset:12800
    ds_read_b64_tr_b16 v[204:205], v219 offset:12288
    ds_read_b64_tr_b16 v[206:207], v219 offset:12800
    s_add_u32 m0, s49, 8192
    v_mfma_f32_32x32x16_bf16 v[24:39], v[208:211], v[116:119], v[24:39]
    buffer_load_dwordx4 v[104:107], v216, s[12:15], s33 offen offset:0 sc1
    buffer_load_dwordx4 v251, s[12:15], s55 offen sc1 lds
    v_mfma_f32_32x32x16_bf16 v[40:55], v[212:215], v[112:115], v[40:55]
    buffer_load_dwordx4 v251, s[12:15], s55 offen offset:1024 sc1 lds
    buffer_load_dwordx4 v[108:111], v216, s[12:15], s39 offen offset:0 sc1
    s_add_u32 s55, s55, 2048
    v_mfma_f32_32x32x16_bf16 v[56:71], v[212:215], v[116:119], v[56:71]
    s_waitcnt lgkmcnt(0)
    v_mfma_f32_32x32x16_bf16 v[8:23], v[200:203], v[120:123], v[8:23]
    s_waitcnt vmcnt(34)
    ds_read_b64_tr_b16 v[208:209], v218 offset:14336
    ds_read_b64_tr_b16 v[210:211], v218 offset:14848
    ds_read_b64_tr_b16 v[212:213], v219 offset:14336
    ds_read_b64_tr_b16 v[214:215], v219 offset:14848
    s_add_u32 m0, s49, 10240
    v_mfma_f32_32x32x16_bf16 v[24:39], v[200:203], v[124:127], v[24:39]
    buffer_load_dwordx4 v[112:115], v216, s[12:15], s33 offen offset:1024 sc1
    buffer_load_dwordx4 v251, s[12:15], s55 offen sc1 lds
    v_mfma_f32_32x32x16_bf16 v[40:55], v[204:207], v[120:123], v[40:55]
    buffer_load_dwordx4 v251, s[12:15], s55 offen offset:1024 sc1 lds
    buffer_load_dwordx4 v[116:119], v216, s[12:15], s39 offen offset:1024 sc1
    s_add_u32 s55, s55, 2048
    s_add_u32 s33, s33, 2048
    s_add_u32 s39, s39, 2048
    v_mfma_f32_32x32x16_bf16 v[56:71], v[204:207], v[124:127], v[56:71]
    s_waitcnt lgkmcnt(0)
    v_mfma_f32_32x32x16_bf16 v[8:23], v[208:211], v[128:131], v[8:23]
    s_waitcnt vmcnt(36)
    ds_read_b64_tr_b16 v[200:201], v218 offset:16384
    ds_read_b64_tr_b16 v[202:203], v218 offset:16896
    ds_read_b64_tr_b16 v[204:205], v219 offset:16384
    ds_read_b64_tr_b16 v[206:207], v219 offset:16896
    s_add_u32 m0, s49, 12288
    v_mfma_f32_32x32x16_bf16 v[24:39], v[208:211], v[132:135], v[24:39]
    buffer_load_dwordx4 v[120:123], v216, s[12:15], s33 offen offset:0 sc1
    buffer_load_dwordx4 v251, s[12:15], s55 offen sc1 lds
    v_mfma_f32_32x32x16_bf16 v[40:55], v[212:215], v[128:131], v[40:55]
    buffer_load_dwordx4 v251, s[12:15], s55 offen offset:1024 sc1 lds
    buffer_load_dwordx4 v[124:127], v216, s[12:15], s39 offen offset:0 sc1
    s_add_u32 s55, s55, 2048
    v_mfma_f32_32x32x16_bf16 v[56:71], v[212:215], v[132:135], v[56:71]
    s_waitcnt lgkmcnt(0)
    v_mfma_f32_32x32x16_bf16 v[8:23], v[200:203], v[136:139], v[8:23]
    s_waitcnt vmcnt(38)
    ds_read_b64_tr_b16 v[208:209], v218 offset:18432
    ds_read_b64_tr_b16 v[210:211], v218 offset:18944
    ds_read_b64_tr_b16 v[212:213], v219 offset:18432
    ds_read_b64_tr_b16 v[214:215], v219 offset:18944
    s_add_u32 m0, s49, 14336
    v_mfma_f32_32x32x16_bf16 v[24:39], v[200:203], v[140:143], v[24:39]
    buffer_load_dwordx4 v[128:131], v216, s[12:15], s33 offen offset:1024 sc1
    buffer_load_dwordx4 v251, s[12:15], s55 offen sc1 lds
    v_mfma_f32_32x32x16_bf16 v[40:55], v[204:207], v[136:139], v[40:55]
    buffer_load_dwordx4 v251, s[12:15], s55 offen offset:1024 sc1 lds
    buffer_load_dwordx4 v[132:135], v216, s[12:15], s39 offen offset:1024 sc1
    s_add_u32 s55, s55, 2048
    s_add_u32 s33, s33, 2048
    s_add_u32 s39, s39, 2048
    v_mfma_f32_32x32x16_bf16 v[56:71], v[204:207], v[140:143], v[56:71]
    s_waitcnt lgkmcnt(0)
    v_mfma_f32_32x32x16_bf16 v[8:23], v[208:211], v[144:147], v[8:23]
    s_waitcnt vmcnt(40)
    ds_read_b64_tr_b16 v[200:201], v218 offset:20480
    ds_read_b64_tr_b16 v[202:203], v218 offset:20992
    ds_read_b64_tr_b16 v[204:205], v219 offset:20480
    ds_read_b64_tr_b16 v[206:207], v219 offset:20992
    s_add_u32 m0, s49, 16384
    v_mfma_f32_32x32x16_bf16 v[24:39], v[208:211], v[148:151], v[24:39]
    buffer_load_dwordx4 v[136:139], v216, s[12:15], s33 offen offset:0 sc1
    buffer_load_dwordx4 v251, s[12:15], s55 offen sc1 lds
    v_mfma_f32_32x32x16_bf16 v[40:55], v[212:215], v[144:147], v[40:55]
    buffer_load_dwordx4 v251, s[12:15], s55 offen offset:1024 sc1 lds
    buffer_load_dwordx4 v[140:143], v216, s[12:15], s39 offen offset:0 sc1
    s_add_u32 s55, s55, 2048
    v_mfma_f32_32x32x16_bf16 v[56:71], v[212:215], v[148:151], v[56:71]
    s_waitcnt lgkmcnt(0)
    v_mfma_f32_32x32x16_bf16 v[8:23], v[200:203], v[152:155], v[8:23]
    s_waitcnt vmcnt(42)
    ds_read_b64_tr_b16 v[208:209], v218 offset:22528
    ds_read_b64_tr_b16 v[210:211], v218 offset:23040
    ds_read_b64_tr_b16 v[212:213], v219 offset:22528
    ds_read_b64_tr_b16 v[214:215], v219 offset:23040
    s_add_u32 m0, s49, 18432
    v_mfma_f32_32x32x16_bf16 v[24:39], v[200:203], v[156:159], v[24:39]
    buffer_load_dwordx4 v[144:147], v216, s[12:15], s33 offen offset:1024 sc1
    buffer_load_dwordx4 v251, s[12:15], s55 offen sc1 lds
    v_mfma_f32_32x32x16_bf16 v[40:55], v[204:207], v[152:155], v[40:55]
    buffer_load_dwordx4 v251, s[12:15], s55 offen offset:1024 sc1 lds
    buffer_load_dwordx4 v[148:151], v216, s[12:15], s39 offen offset:1024 sc1
    s_add_u32 s55, s55, 2048
    s_add_u32 s33, s33, 2048
    s_add_u32 s39, s39, 2048
    v_mfma_f32_32x32x16_bf16 v[56:71], v[204:207], v[156:159], v[56:71]
    s_waitcnt lgkmcnt(0)
    v_mfma_f32_32x32x16_bf16 v[8:23], v[208:211], v[160:163], v[8:23]
    s_waitcnt vmcnt(44)
    ds_read_b64_tr_b16 v[200:201], v218 offset:24576
    ds_read_b64_tr_b16 v[202:203], v218 offset:25088
    ds_read_b64_tr_b16 v[204:205], v219 offset:24576
    ds_read_b64_tr_b16 v[206:207], v219 offset:25088
    s_add_u32 m0, s49, 20480
    v_mfma_f32_32x32x16_bf16 v[24:39], v[208:211], v[164:167], v[24:39]
    buffer_load_dwordx4 v[152:155], v216, s[12:15], s33 offen offset:0 sc1
    buffer_load_dwordx4 v251, s[12:15], s55 offen sc1 lds
    v_mfma_f32_32x32x16_bf16 v[40:55], v[212:215], v[160:163], v[40:55]
    buffer_load_dwordx4 v251, s[12:15], s55 offen offset:1024 sc1 lds
    buffer_load_dwordx4 v[156:159], v216, s[12:15], s39 offen offset:0 sc1
    s_add_u32 s55, s55, 2048
    v_mfma_f32_32x32x16_bf16 v[56:71], v[212:215], v[164:167], v[56:71]
    s_waitcnt lgkmcnt(0)
    v_mfma_f32_32x32x16_bf16 v[8:23], v[200:203], v[168:171], v[8:23]
    s_waitcnt vmcnt(44)
    ds_read_b64_tr_b16 v[208:209], v218 offset:26624
    ds_read_b64_tr_b16 v[210:211], v218 offset:27136
    ds_read_b64_tr_b16 v[212:213], v219 offset:26624
    ds_read_b64_tr_b16 v[214:215], v219 offset:27136
    s_add_u32 m0, s49, 22528
    v_mfma_f32_32x32x16_bf16 v[24:39], v[200:203], v[172:175], v[24:39]
    buffer_load_dwordx4 v[160:163], v216, s[12:15], s33 offen offset:1024 sc1
    buffer_load_dwordx4 v251, s[12:15], s55 offen sc1 lds
    v_mfma_f32_32x32x16_bf16 v[40:55], v[204:207], v[168:171], v[40:55]
    buffer_load_dwordx4 v251, s[12:15], s55 offen offset:1024 sc1 lds
    buffer_load_dwordx4 v[164:167], v216, s[12:15], s39 offen offset:1024 sc1
    s_add_u32 s55, s55, 2048
    s_add_u32 s33, s33, 2048
    s_add_u32 s39, s39, 2048
    v_mfma_f32_32x32x16_bf16 v[56:71], v[204:207], v[172:175], v[56:71]
    s_waitcnt lgkmcnt(0)
    v_mfma_f32_32x32x16_bf16 v[8:23], v[208:211], v[176:179], v[8:23]
    s_waitcnt vmcnt(44)
    ds_read_b64_tr_b16 v[200:201], v218 offset:0
    ds_read_b64_tr_b16 v[202:203], v218 offset:512
    ds_read_b64_tr_b16 v[204:205], v219 offset:0
    ds_read_b64_tr_b16 v[206:207], v219 offset:512
    s_add_u32 m0, s49, 24576
    v_mfma_f32_32x32x16_bf16 v[24:39], v[208:211], v[180:183], v[24:39]
    buffer_load_dwordx4 v[168:171], v216, s[12:15], s33 offen offset:0 sc1
    buffer_load_dwordx4 v251, s[12:15], s55 offen sc1 lds
    v_mfma_f32_32x32x16_bf16 v[40:55], v[212:215], v[176:179], v[40:55]
    buffer_load_dwordx4 v251, s[12:15], s55 offen offset:1024 sc1 lds
    buffer_load_dwordx4 v[172:175], v216, s[12:15], s39 offen offset:0 sc1
    s_add_u32 s55, s55, 2048
    v_mfma_f32_32x32x16_bf16 v[56:71], v[212:215], v[180:183], v[56:71]
    s_waitcnt lgkmcnt(0)
    v_mfma_f32_32x32x16_bf16 v[8:23], v[200:203], v[72:75], v[8:23]
    s_waitcnt vmcnt(44)
    ds_read_b64_tr_b16 v[208:209], v218 offset:2048
    ds_read_b64_tr_b16 v[210:211], v218 offset:2560
    ds_read_b64_tr_b16 v[212:213], v219 offset:2048
    ds_read_b64_tr_b16 v[214:215], v219 offset:2560
    s_add_u32 m0, s49, 26624
    v_mfma_f32_32x32x16_bf16 v[24:39], v[200:203], v[76:79], v[24:39]
    buffer_load_dwordx4 v[176:179], v216, s[12:15], s33 offen offset:1024 sc1
    buffer_load_dwordx4 v251, s[12:15], s55 offen sc1 lds
    v_mfma_f32_32x32x16_bf16 v[40:55], v[204:207], v[72:75], v[40:55]
    buffer_load_dwordx4 v251, s[12:15], s55 offen offset:1024 sc1 lds
    buffer_load_dwordx4 v[180:183], v216, s[12:15], s39 offen offset:1024 sc1
    s_add_u32 s55, s55, 2048
    s_add_u32 s33, s33, 2048
    s_add_u32 s39, s39, 2048
    v_mfma_f32_32x32x16_bf16 v[56:71], v[204:207], v[76:79], v[56:71]
    s_waitcnt lgkmcnt(0)
    v_mfma_f32_32x32x16_bf16 v[8:23], v[208:211], v[80:83], v[8:23]
    s_waitcnt vmcnt(44)
    ds_read_b64_tr_b16 v[200:201], v218 offset:4096
    ds_read_b64_tr_b16 v[202:203], v218 offset:4608
    ds_read_b64_tr_b16 v[204:205], v219 offset:4096
    ds_read_b64_tr_b16 v[206:207], v219 offset:4608
    v_mfma_f32_32x32x16_bf16 v[24:39], v[208:211], v[84:87], v[24:39]
    v_mfma_f32_32x32x16_bf16 v[40:55], v[212:215], v[80:83], v[40:55]
    v_mfma_f32_32x32x16_bf16 v[56:71], v[212:215], v[84:87], v[56:71]
    s_waitcnt lgkmcnt(0)
    v_mfma_f32_32x32x16_bf16 v[8:23], v[200:203], v[88:91], v[8:23]
    s_waitcnt vmcnt(40)
    ds_read_b64_tr_b16 v[208:209], v218 offset:6144
    ds_read_b64_tr_b16 v[210:211], v218 offset:6656
    ds_read_b64_tr_b16 v[212:213], v219 offset:6144
    ds_read_b64_tr_b16 v[214:215], v219 offset:6656
    v_mfma_f32_32x32x16_bf16 v[24:39], v[200:203], v[92:95], v[24:39]
    v_mfma_f32_32x32x16_bf16 v[40:55], v[204:207], v[88:91], v[40:55]
    v_mfma_f32_32x32x16_bf16 v[56:71], v[204:207], v[92:95], v[56:71]
    s_waitcnt lgkmcnt(0)
    v_mfma_f32_32x32x16_bf16 v[8:23], v[208:211], v[96:99], v[8:23]
    s_waitcnt vmcnt(36)
    ds_read_b64_tr_b16 v[200:201], v218 offset:8192
    ds_read_b64_tr_b16 v[202:203], v218 offset:8704
    ds_read_b64_tr_b16 v[204:205], v219 offset:8192
    ds_read_b64_tr_b16 v[206:207], v219 offset:8704
    v_mfma_f32_32x32x16_bf16 v[24:39], v[208:211], v[100:103], v[24:39]
    v_mfma_f32_32x32x16_bf16 v[40:55], v[212:215], v[96:99], v[40:55]
    v_mfma_f32_32x32x16_bf16 v[56:71], v[212:215], v[100:103], v[56:71]
    s_waitcnt lgkmcnt(0)
    v_mfma_f32_32x32x16_bf16 v[8:23], v[200:203], v[104:107], v[8:23]
    s_waitcnt vmcnt(32)
    ds_read_b64_tr_b16 v[208:209], v218 offset:10240
    ds_read_b64_tr_b16 v[210:211], v218 offset:10752
    ds_read_b64_tr_b16 v[212:213], v219 offset:10240
    ds_read_b64_tr_b16 v[214:215], v219 offset:10752
    v_mfma_f32_32x32x16_bf16 v[24:39], v[200:203], v[108:111], v[24:39]
    v_mfma_f32_32x32x16_bf16 v[40:55], v[204:207], v[104:107], v[40:55]
    v_mfma_f32_32x32x16_bf16 v[56:71], v[204:207], v[108:111], v[56:71]
    s_waitcnt lgkmcnt(0)
    v_mfma_f32_32x32x16_bf16 v[8:23], v[208:211], v[112:115], v[8:23]
    s_waitcnt vmcnt(28)
    ds_read_b64_tr_b16 v[200:201], v218 offset:12288
    ds_read_b64_tr_b16 v[202:203], v218 offset:12800
    ds_read_b64_tr_b16 v[204:205], v219 offset:12288
    ds_read_b64_tr_b16 v[206:207], v219 offset:12800
    v_mfma_f32_32x32x16_bf16 v[24:39], v[208:211], v[116:119], v[24:39]
    v_mfma_f32_32x32x16_bf16 v[40:55], v[212:215], v[112:115], v[40:55]
    v_mfma_f32_32x32x16_bf16 v[56:71], v[212:215], v[116:119], v[56:71]
    s_waitcnt lgkmcnt(0)
    v_mfma_f32_32x32x16_bf16 v[8:23], v[200:203], v[120:123], v[8:23]
    s_waitcnt vmcnt(24)
    ds_read_b64_tr_b16 v[208:209], v218 offset:14336
    ds_read_b64_tr_b16 v[210:211], v218 offset:14848
    ds_read_b64_tr_b16 v[212:213], v219 offset:14336
    ds_read_b64_tr_b16 v[214:215], v219 offset:14848
    v_mfma_f32_32x32x16_bf16 v[24:39], v[200:203], v[124:127], v[24:39]
    v_mfma_f32_32x32x16_bf16 v[40:55], v[204:207], v[120:123], v[40:55]
    v_mfma_f32_32x32x16_bf16 v[56:71], v[204:207], v[124:127], v[56:71]
    s_waitcnt lgkmcnt(0)
    v_mfma_f32_32x32x16_bf16 v[8:23], v[208:211], v[128:131], v[8:23]
    s_waitcnt vmcnt(20)
    ds_read_b64_tr_b16 v[200:201], v218 offset:16384
    ds_read_b64_tr_b16 v[202:203], v218 offset:16896
    ds_read_b64_tr_b16 v[204:205], v219 offset:16384
    ds_read_b64_tr_b16 v[206:207], v219 offset:16896
    v_mfma_f32_32x32x16_bf16 v[24:39], v[208:211], v[132:135], v[24:39]
    v_mfma_f32_32x32x16_bf16 v[40:55], v[212:215], v[128:131], v[40:55]
    v_mfma_f32_32x32x16_bf16 v[56:71], v[212:215], v[132:135], v[56:71]
    s_waitcnt lgkmcnt(0)
    v_mfma_f32_32x32x16_bf16 v[8:23], v[200:203], v[136:139], v[8:23]
    s_waitcnt vmcnt(16)
    ds_read_b64_tr_b16 v[208:209], v218 offset:18432
    ds_read_b64_tr_b16 v[210:211], v218 offset:18944
    ds_read_b64_tr_b16 v[212:213], v219 offset:18432
    ds_read_b64_tr_b16 v[214:215], v219 offset:18944
    v_mfma_f32_32x32x16_bf16 v[24:39], v[200:203], v[140:143], v[24:39]
    v_mfma_f32_32x32x16_bf16 v[40:55], v[204:207], v[136:139], v[40:55]
    v_mfma_f32_32x32x16_bf16 v[56:71], v[204:207], v[140:143], v[56:71]
    s_waitcnt lgkmcnt(0)
    v_mfma_f32_32x32x16_bf16 v[8:23], v[208:211], v[144:147], v[8:23]
    s_waitcnt vmcnt(12)
    ds_read_b64_tr_b16 v[200:201], v218 offset:20480
    ds_read_b64_tr_b16 v[202:203], v218 offset:20992
    ds_read_b64_tr_b16 v[204:205], v219 offset:20480
    ds_read_b64_tr_b16 v[206:207], v219 offset:20992
    v_mfma_f32_32x32x16_bf16 v[24:39], v[208:211], v[148:151], v[24:39]
    v_mfma_f32_32x32x16_bf16 v[40:55], v[212:215], v[144:147], v[40:55]
    v_mfma_f32_32x32x16_bf16 v[56:71], v[212:215], v[148:151], v[56:71]
    s_waitcnt lgkmcnt(0)
    v_mfma_f32_32x32x16_bf16 v[8:23], v[200:203], v[152:155], v[8:23]
    s_waitcnt vmcnt(8)
    ds_read_b64_tr_b16 v[208:209], v218 offset:22528
    ds_read_b64_tr_b16 v[210:211], v218 offset:23040
    ds_read_b64_tr_b16 v[212:213], v219 offset:22528
    ds_read_b64_tr_b16 v[214:215], v219 offset:23040
    v_mfma_f32_32x32x16_bf16 v[24:39], v[200:203], v[156:159], v[24:39]
    v_mfma_f32_32x32x16_bf16 v[40:55], v[204:207], v[152:155], v[40:55]
    v_mfma_f32_32x32x16_bf16 v[56:71], v[204:207], v[156:159], v[56:71]
    s_waitcnt lgkmcnt(0)
    v_mfma_f32_32x32x16_bf16 v[8:23], v[208:211], v[160:163], v[8:23]
    s_waitcnt vmcnt(4)
    ds_read_b64_tr_b16 v[200:201], v218 offset:24576
    ds_read_b64_tr_b16 v[202:203], v218 offset:25088
    ds_read_b64_tr_b16 v[204:205], v219 offset:24576
    ds_read_b64_tr_b16 v[206:207], v219 offset:25088
    v_mfma_f32_32x32x16_bf16 v[24:39], v[208:211], v[164:167], v[24:39]
    v_mfma_f32_32x32x16_bf16 v[40:55], v[212:215], v[160:163], v[40:55]
    v_mfma_f32_32x32x16_bf16 v[56:71], v[212:215], v[164:167], v[56:71]
    s_waitcnt lgkmcnt(0)
    v_mfma_f32_32x32x16_bf16 v[8:23], v[200:203], v[168:171], v[8:23]
    s_waitcnt vmcnt(0)
    ds_read_b64_tr_b16 v[208:209], v218 offset:26624
    ds_read_b64_tr_b16 v[210:211], v218 offset:27136
    ds_read_b64_tr_b16 v[212:213], v219 offset:26624
    ds_read_b64_tr_b16 v[214:215], v219 offset:27136
    v_mfma_f32_32x32x16_bf16 v[24:39], v[200:203], v[172:175], v[24:39]
    v_mfma_f32_32x32x16_bf16 v[40:55], v[204:207], v[168:171], v[40:55]
    v_mfma_f32_32x32x16_bf16 v[56:71], v[204:207], v[172:175], v[56:71]
    s_waitcnt lgkmcnt(0)
    v_mfma_f32_32x32x16_bf16 v[8:23], v[208:211], v[176:179], v[8:23]
    v_mfma_f32_32x32x16_bf16 v[24:39], v[208:211], v[180:183], v[24:39]
    v_mfma_f32_32x32x16_bf16 v[40:55], v[212:215], v[176:179], v[40:55]
    v_mfma_f32_32x32x16_bf16 v[56:71], v[212:215], v[180:183], v[56:71]
    v_add_u32 v3, s49, v216
    s_nop 7
    ds_write_b128 v3, v[8:11] offset:16384
    ds_write_b128 v3, v[12:15] offset:17408
    ds_write_b128 v3, v[16:19] offset:18432
    ds_write_b128 v3, v[20:23] offset:19456
    ds_write_b128 v3, v[24:27] offset:20480
    ds_write_b128 v3, v[28:31] offset:21504
    ds_write_b128 v3, v[32:35] offset:22528
    ds_write_b128 v3, v[36:39] offset:23552
    ds_write_b128 v3, v[40:43] offset:24576
    ds_write_b128 v3, v[44:47] offset:25600
    ds_write_b128 v3, v[48:51] offset:26624
    ds_write_b128 v3, v[52:55] offset:27648
    ds_write_b128 v3, v[56:59] offset:28672
    ds_write_b128 v3, v[60:63] offset:29696
    ds_write_b128 v3, v[64:67] offset:30720
    ds_write_b128 v3, v[68:71] offset:31744
    s_waitcnt lgkmcnt(0)
    s_barrier
    s_lshl_b32 s35, s32, 12
    v_add_u32 v3, s35, v216
    v_add_u32 v1, 0x10000, v3
    ds_read_b128 v[72:75], v3 offset:16384
    ds_read_b128 v[76:79], v3 offset:17408
    ds_read_b128 v[80:83], v3 offset:18432
    ds_read_b128 v[84:87], v3 offset:19456
    ds_read_b128 v[88:91], v3 offset:49152
    ds_read_b128 v[92:95], v3 offset:50176
    ds_read_b128 v[96:99], v3 offset:51200
    ds_read_b128 v[100:103], v3 offset:52224
    ds_read_b128 v[104:107], v1 offset:16384
    ds_read_b128 v[108:111], v1 offset:17408
    ds_read_b128 v[112:115], v1 offset:18432
    ds_read_b128 v[116:119], v1 offset:19456
    ds_read_b128 v[120:123], v1 offset:49152
    ds_read_b128 v[124:127], v1 offset:50176
    ds_read_b128 v[128:131], v1 offset:51200
    ds_read_b128 v[132:135], v1 offset:52224
    s_waitcnt lgkmcnt(8)
    v_add_f32 v72, v72, v88
    v_add_f32 v73, v73, v89
    v_add_f32 v74, v74, v90
    v_add_f32 v75, v75, v91
    v_add_f32 v76, v76, v92
    v_add_f32 v77, v77, v93
    v_add_f32 v78, v78, v94
    v_add_f32 v79, v79, v95
    v_add_f32 v80, v80, v96
    v_add_f32 v81, v81, v97
    v_add_f32 v82, v82, v98
    v_add_f32 v83, v83, v99
    v_add_f32 v84, v84, v100
    v_add_f32 v85, v85, v101
    v_add_f32 v86, v86, v102
    v_add_f32 v87, v87, v103
    s_waitcnt lgkmcnt(4)
    v_add_f32 v72, v72, v104
    v_add_f32 v73, v73, v105
    v_add_f32 v74, v74, v106
    v_add_f32 v75, v75, v107
    v_add_f32 v76, v76, v108
    v_add_f32 v77, v77, v109
    v_add_f32 v78, v78, v110
    v_add_f32 v79, v79, v111
    v_add_f32 v80, v80, v112
    v_add_f32 v81, v81, v113
    v_add_f32 v82, v82, v114
    v_add_f32 v83, v83, v115
    v_add_f32 v84, v84, v116
    v_add_f32 v85, v85, v117
    v_add_f32 v86, v86, v118
    v_add_f32 v87, v87, v119
    s_waitcnt lgkmcnt(0)
    v_add_f32 v72, v72, v120
    v_add_f32 v73, v73, v121
    v_add_f32 v74, v74, v122
    v_add_f32 v75, v75, v123
    v_add_f32 v76, v76, v124
    v_add_f32 v77, v77, v125
    v_add_f32 v78, v78, v126
    v_add_f32 v79, v79, v127
    v_add_f32 v80, v80, v128
    v_add_f32 v81, v81, v129
    v_add_f32 v82, v82, v130
    v_add_f32 v83, v83, v131
    v_add_f32 v84, v84, v132
    v_add_f32 v85, v85, v133
    v_add_f32 v86, v86, v134
    v_add_f32 v87, v87, v135
    v_accvgpr_read_b32 v236, a64
    v_accvgpr_read_b32 v237, a65
    v_accvgpr_read_b32 v238, a66
    v_accvgpr_read_b32 v239, a67
    v_accvgpr_read_b32 v240, a68
    v_accvgpr_read_b32 v241, a69
    v_accvgpr_read_b32 v242, a70
    v_accvgpr_read_b32 v243, a71
    v_cvt_pk_bf16_f32 v72, 0, v72
    v_cvt_pk_bf16_f32 v73, 0, v73
    v_cvt_pk_bf16_f32 v74, 0, v74
    v_cvt_pk_bf16_f32 v75, 0, v75
    v_cvt_pk_bf16_f32 v76, 0, v76
    v_cvt_pk_bf16_f32 v77, 0, v77
    v_cvt_pk_bf16_f32 v78, 0, v78
    v_cvt_pk_bf16_f32 v79, 0, v79
    v_cvt_pk_bf16_f32 v80, 0, v80
    v_cvt_pk_bf16_f32 v81, 0, v81
    v_cvt_pk_bf16_f32 v82, 0, v82
    v_cvt_pk_bf16_f32 v83, 0, v83
    v_cvt_pk_bf16_f32 v84, 0, v84
    v_cvt_pk_bf16_f32 v85, 0, v85
    v_cvt_pk_bf16_f32 v86, 0, v86
    v_cvt_pk_bf16_f32 v87, 0, v87
    v_mul_f32 v72, v72, v220
    v_mul_f32 v73, v73, v221
    v_mul_f32 v74, v74, v222
    v_mul_f32 v75, v75, v223
    v_mul_f32 v76, v76, v224
    v_mul_f32 v77, v77, v225
    v_mul_f32 v78, v78, v226
    v_mul_f32 v79, v79, v227
    v_mul_f32 v80, v80, v228
    v_mul_f32 v81, v81, v229
    v_mul_f32 v82, v82, v230
    v_mul_f32 v83, v83, v231
    v_mul_f32 v84, v84, v232
    v_mul_f32 v85, v85, v233
    v_mul_f32 v86, v86, v234
    v_mul_f32 v87, v87, v235
    v_cvt_pk_bf16_f32 v72, 0, v72
    v_cvt_pk_bf16_f32 v73, 0, v73
    v_cvt_pk_bf16_f32 v74, 0, v74
    v_cvt_pk_bf16_f32 v75, 0, v75
    v_cvt_pk_bf16_f32 v76, 0, v76
    v_cvt_pk_bf16_f32 v77, 0, v77
    v_cvt_pk_bf16_f32 v78, 0, v78
    v_cvt_pk_bf16_f32 v79, 0, v79
    v_cvt_pk_bf16_f32 v80, 0, v80
    v_cvt_pk_bf16_f32 v81, 0, v81
    v_cvt_pk_bf16_f32 v82, 0, v82
    v_cvt_pk_bf16_f32 v83, 0, v83
    v_cvt_pk_bf16_f32 v84, 0, v84
    v_cvt_pk_bf16_f32 v85, 0, v85
    v_cvt_pk_bf16_f32 v86, 0, v86
    v_cvt_pk_bf16_f32 v87, 0, v87
    v_lshlrev_b32 v88, 16, v236
    v_and_b32 v89, 0xffff0000, v236
    v_lshlrev_b32 v90, 16, v237
    v_and_b32 v91, 0xffff0000, v237
    v_lshlrev_b32 v92, 16, v238
    v_and_b32 v93, 0xffff0000, v238
    v_lshlrev_b32 v94, 16, v239
    v_and_b32 v95, 0xffff0000, v239
    v_lshlrev_b32 v96, 16, v240
    v_and_b32 v97, 0xffff0000, v240
    v_lshlrev_b32 v98, 16, v241
    v_and_b32 v99, 0xffff0000, v241
    v_lshlrev_b32 v100, 16, v242
    v_and_b32 v101, 0xffff0000, v242
    v_lshlrev_b32 v102, 16, v243
    v_and_b32 v103, 0xffff0000, v243
    v_add_f32 v72, v72, v88
    v_add_f32 v73, v73, v89
    v_add_f32 v74, v74, v90
    v_add_f32 v75, v75, v91
    v_add_f32 v76, v76, v92
    v_add_f32 v77, v77, v93
    v_add_f32 v78, v78, v94
    v_add_f32 v79, v79, v95
    v_add_f32 v80, v80, v96
    v_add_f32 v81, v81, v97
    v_add_f32 v82, v82, v98
    v_add_f32 v83, v83, v99
    v_add_f32 v84, v84, v100
    v_add_f32 v85, v85, v101
    v_add_f32 v86, v86, v102
    v_add_f32 v87, v87, v103
    v_cvt_pk_bf16_f32 v104, v72, v73
    v_cvt_pk_bf16_f32 v105, v74, v75
    v_cvt_pk_bf16_f32 v106, v76, v77
    v_cvt_pk_bf16_f32 v107, v78, v79
    v_cvt_pk_bf16_f32 v108, v80, v81
    v_cvt_pk_bf16_f32 v109, v82, v83
    v_cvt_pk_bf16_f32 v110, v84, v85
    v_cvt_pk_bf16_f32 v111, v86, v87
    buffer_store_dwordx4 v[104:107], v6, s[16:19], 0 offen offset:0
    buffer_store_dwordx4 v[108:111], v6, s[16:19], 0 offen offset:32
attn_end:
    s_endpgm
attn_copy:
    s_cmp_le_u32 s36, 2
    s_cbranch_scc1 attn_copy_flag
    s_lshl_b32 s39, s2, 2
    s_add_u32 s39, s39, s32
    s_cmp_eq_u32 s36, 3
    s_cbranch_scc1 attn_copy_st
    s_lshl_b32 s40, s39, 12
    buffer_load_dwordx4 a[192:195], v233, s[80:83], s40 offen offset:0
    buffer_load_dwordx4 a[196:199], v233, s[80:83], s40 offen offset:1024
    buffer_load_dwordx4 a[200:203], v233, s[80:83], s40 offen offset:2048
    buffer_load_dwordx4 a[204:207], v233, s[80:83], s40 offen offset:3072
    s_lshl_b32 s40, s39, 11
    buffer_load_dwordx4 a[208:211], v233, s[92:95], s40 offen offset:0
    buffer_load_dwordx4 a[212:215], v233, s[92:95], s40 offen offset:1024
    s_branch attn_copy_ret
attn_copy_st:
    v_lshrrev_b32 v238, 3, v235
    v_and_b32 v239, 7, v235
    v_lshlrev_b32 v239, 4, v239
    v_lshl_add_u32 v237, v238, 19, v239
    v_lshl_add_u32 v238, v238, 18, v239
    s_lshl_b32 s40, s39, 9
    s_add_u32 s40, s40, 33554432
    buffer_store_dwordx4 a[192:195], v237, s[20:23], s40 offen offset:0 sc1
    buffer_store_dwordx4 a[196:199], v237, s[20:23], s40 offen offset:128 sc1
    buffer_store_dwordx4 a[200:203], v237, s[20:23], s40 offen offset:256 sc1
    buffer_store_dwordx4 a[204:207], v237, s[20:23], s40 offen offset:384 sc1
    s_lshl_b32 s40, s39, 8
    s_add_u32 s40, s40, 37748736
    buffer_store_dwordx4 a[208:211], v238, s[20:23], s40 offen offset:0 sc1
    buffer_store_dwordx4 a[212:215], v238, s[20:23], s40 offen offset:128 sc1
    s_branch attn_copy_ret
attn_copy_flag:
    s_cmp_lg_u32 s36, 2
    s_cbranch_scc1 attn_copy_ret
    s_cmp_lg_u32 s32, 0
    s_cbranch_scc1 attn_copy_ret
    s_lshl_b32 s40, s2, 2
    s_add_u32 s40, s40, 28672
    v_mov_b32 v238, 0
    v_mov_b32 v239, 1
    s_mov_b64 exec, 1
    buffer_store_dword v239, v238, s[20:23], s40 offen sc1
    s_mov_b64 exec, -1
    s_branch attn_copy_ret
attn_kernel_slow_1:
    s_call_b64 s[44:45], attn_slow0
    s_branch attn_kernel_ret_2
attn_kernel_slow_3:
    s_call_b64 s[44:45], attn_slow1
    s_branch attn_kernel_ret_4
attn_kernel_slow_5:
    s_call_b64 s[44:45], attn_slow0
    s_branch attn_kernel_ret_6
attn_kernel_slow_7:
    s_call_b64 s[44:45], attn_slow1
    s_branch attn_kernel_ret_8
attn_kernel_slow_9:
    s_call_b64 s[44:45], attn_slow0
    s_branch attn_kernel_ret_10
attn_kernel_slow_11:
    s_call_b64 s[44:45], attn_slow1
    s_branch attn_kernel_ret_12
attn_kernel_slow_13:
    s_call_b64 s[44:45], attn_slow0
    s_branch attn_kernel_ret_14
attn_kernel_slow_15:
    s_call_b64 s[44:45], attn_slow1
    s_branch attn_kernel_ret_16
attn_kernel_slow_17:
    s_call_b64 s[44:45], attn_slow0
    s_branch attn_kernel_ret_18
attn_kernel_slow_19:
    s_call_b64 s[44:45], attn_slow1
    s_branch attn_kernel_ret_20
attn_kernel_slow_21:
    s_call_b64 s[44:45], attn_slow1
    s_branch attn_kernel_ret_22
attn_slow0:
    s_nop 15
    s_nop 15
    v_max3_f32 v212, v8, v9, v10
    v_max3_f32 v212, v212, v11, v12
    v_max3_f32 v212, v212, v13, v14
    v_max3_f32 v212, v212, v15, v16
    v_max3_f32 v212, v212, v17, v18
    v_max3_f32 v212, v212, v19, v20
    v_max3_f32 v212, v212, v21, v22
    v_max_f32 v212, v212, v23
    v_mov_b32 v213, v212
    s_nop 1
    v_permlane32_swap_b32 v212, v213
    v_max_f32 v212, v212, v213
    v_add_f32 v212, 0x42c80000, v212
    v_max_f32 v212, 0, v212
    v_ceil_f32 v212, v212
    v_sub_f32 v213, 0, v212
    v_cvt_i32_f32 v214, v213
    v_sub_f32 v72, v72, v212
    v_sub_f32 v8, v8, v212
    v_sub_f32 v40, v40, v212
    v_sub_f32 v73, v73, v212
    v_sub_f32 v9, v9, v212
    v_sub_f32 v41, v41, v212
    v_sub_f32 v74, v74, v212
    v_sub_f32 v10, v10, v212
    v_sub_f32 v42, v42, v212
    v_sub_f32 v75, v75, v212
    v_sub_f32 v11, v11, v212
    v_sub_f32 v43, v43, v212
    v_sub_f32 v76, v76, v212
    v_sub_f32 v12, v12, v212
    v_sub_f32 v44, v44, v212
    v_sub_f32 v77, v77, v212
    v_sub_f32 v13, v13, v212
    v_sub_f32 v45, v45, v212
    v_sub_f32 v78, v78, v212
    v_sub_f32 v14, v14, v212
    v_sub_f32 v46, v46, v212
    v_sub_f32 v79, v79, v212
    v_sub_f32 v15, v15, v212
    v_sub_f32 v47, v47, v212
    v_sub_f32 v80, v80, v212
    v_sub_f32 v16, v16, v212
    v_sub_f32 v48, v48, v212
    v_sub_f32 v81, v81, v212
    v_sub_f32 v17, v17, v212
    v_sub_f32 v49, v49, v212
    v_sub_f32 v82, v82, v212
    v_sub_f32 v18, v18, v212
    v_sub_f32 v50, v50, v212
    v_sub_f32 v83, v83, v212
    v_sub_f32 v19, v19, v212
    v_sub_f32 v51, v51, v212
    v_sub_f32 v84, v84, v212
    v_sub_f32 v20, v20, v212
    v_sub_f32 v52, v52, v212
    v_sub_f32 v85, v85, v212
    v_sub_f32 v21, v21, v212
    v_sub_f32 v53, v53, v212
    v_sub_f32 v86, v86, v212
    v_sub_f32 v22, v22, v212
    v_sub_f32 v54, v54, v212
    v_sub_f32 v87, v87, v212
    v_sub_f32 v23, v23, v212
    v_sub_f32 v55, v55, v212
    v_ldexp_f32 v210, v210, v214
    v_accvgpr_read_b32 v200, a0
    v_ldexp_f32 v200, v200, v214
    v_accvgpr_write_b32 a0, v200
    v_accvgpr_read_b32 v201, a1
    v_ldexp_f32 v201, v201, v214
    v_accvgpr_write_b32 a1, v201
    v_accvgpr_read_b32 v202, a2
    v_ldexp_f32 v202, v202, v214
    v_accvgpr_write_b32 a2, v202
    v_accvgpr_read_b32 v203, a3
    v_ldexp_f32 v203, v203, v214
    v_accvgpr_write_b32 a3, v203
    v_accvgpr_read_b32 v204, a4
    v_ldexp_f32 v204, v204, v214
    v_accvgpr_write_b32 a4, v204
    v_accvgpr_read_b32 v205, a5
    v_ldexp_f32 v205, v205, v214
    v_accvgpr_write_b32 a5, v205
    v_accvgpr_read_b32 v206, a6
    v_ldexp_f32 v206, v206, v214
    v_accvgpr_write_b32 a6, v206
    v_accvgpr_read_b32 v207, a7
    v_ldexp_f32 v207, v207, v214
    v_accvgpr_write_b32 a7, v207
    v_accvgpr_read_b32 v200, a8
    v_ldexp_f32 v200, v200, v214
    v_accvgpr_write_b32 a8, v200
    v_accvgpr_read_b32 v201, a9
    v_ldexp_f32 v201, v201, v214
    v_accvgpr_write_b32 a9, v201
    v_accvgpr_read_b32 v202, a10
    v_ldexp_f32 v202, v202, v214
    v_accvgpr_write_b32 a10, v202
    v_accvgpr_read_b32 v203, a11
    v_ldexp_f32 v203, v203, v214
    v_accvgpr_write_b32 a11, v203
    v_accvgpr_read_b32 v204, a12
    v_ldexp_f32 v204, v204, v214
    v_accvgpr_write_b32 a12, v204
    v_accvgpr_read_b32 v205, a13
    v_ldexp_f32 v205, v205, v214
    v_accvgpr_write_b32 a13, v205
    v_accvgpr_read_b32 v206, a14
    v_ldexp_f32 v206, v206, v214
    v_accvgpr_write_b32 a14, v206
    v_accvgpr_read_b32 v207, a15
    v_ldexp_f32 v207, v207, v214
    v_accvgpr_write_b32 a15, v207
    v_accvgpr_read_b32 v200, a32
    v_ldexp_f32 v200, v200, v214
    v_accvgpr_write_b32 a32, v200
    v_accvgpr_read_b32 v201, a33
    v_ldexp_f32 v201, v201, v214
    v_accvgpr_write_b32 a33, v201
    v_accvgpr_read_b32 v202, a34
    v_ldexp_f32 v202, v202, v214
    v_accvgpr_write_b32 a34, v202
    v_accvgpr_read_b32 v203, a35
    v_ldexp_f32 v203, v203, v214
    v_accvgpr_write_b32 a35, v203
    v_accvgpr_read_b32 v204, a36
    v_ldexp_f32 v204, v204, v214
    v_accvgpr_write_b32 a36, v204
    v_accvgpr_read_b32 v205, a37
    v_ldexp_f32 v205, v205, v214
    v_accvgpr_write_b32 a37, v205
    v_accvgpr_read_b32 v206, a38
    v_ldexp_f32 v206, v206, v214
    v_accvgpr_write_b32 a38, v206
    v_accvgpr_read_b32 v207, a39
    v_ldexp_f32 v207, v207, v214
    v_accvgpr_write_b32 a39, v207
    v_accvgpr_read_b32 v200, a40
    v_ldexp_f32 v200, v200, v214
    v_accvgpr_write_b32 a40, v200
    v_accvgpr_read_b32 v201, a41
    v_ldexp_f32 v201, v201, v214
    v_accvgpr_write_b32 a41, v201
    v_accvgpr_read_b32 v202, a42
    v_ldexp_f32 v202, v202, v214
    v_accvgpr_write_b32 a42, v202
    v_accvgpr_read_b32 v203, a43
    v_ldexp_f32 v203, v203, v214
    v_accvgpr_write_b32 a43, v203
    v_accvgpr_read_b32 v204, a44
    v_ldexp_f32 v204, v204, v214
    v_accvgpr_write_b32 a44, v204
    v_accvgpr_read_b32 v205, a45
    v_ldexp_f32 v205, v205, v214
    v_accvgpr_write_b32 a45, v205
    v_accvgpr_read_b32 v206, a46
    v_ldexp_f32 v206, v206, v214
    v_accvgpr_write_b32 a46, v206
    v_accvgpr_read_b32 v207, a47
    v_ldexp_f32 v207, v207, v214
    v_accvgpr_write_b32 a47, v207
    v_accvgpr_read_b32 v200, a64
    v_ldexp_f32 v200, v200, v214
    v_accvgpr_write_b32 a64, v200
    v_accvgpr_read_b32 v201, a65
    v_ldexp_f32 v201, v201, v214
    v_accvgpr_write_b32 a65, v201
    v_accvgpr_read_b32 v202, a66
    v_ldexp_f32 v202, v202, v214
    v_accvgpr_write_b32 a66, v202
    v_accvgpr_read_b32 v203, a67
    v_ldexp_f32 v203, v203, v214
    v_accvgpr_write_b32 a67, v203
    v_accvgpr_read_b32 v204, a68
    v_ldexp_f32 v204, v204, v214
    v_accvgpr_write_b32 a68, v204
    v_accvgpr_read_b32 v205, a69
    v_ldexp_f32 v205, v205, v214
    v_accvgpr_write_b32 a69, v205
    v_accvgpr_read_b32 v206, a70
    v_ldexp_f32 v206, v206, v214
    v_accvgpr_write_b32 a70, v206
    v_accvgpr_read_b32 v207, a71
    v_ldexp_f32 v207, v207, v214
    v_accvgpr_write_b32 a71, v207
    v_accvgpr_read_b32 v200, a72
    v_ldexp_f32 v200, v200, v214
    v_accvgpr_write_b32 a72, v200
    v_accvgpr_read_b32 v201, a73
    v_ldexp_f32 v201, v201, v214
    v_accvgpr_write_b32 a73, v201
    v_accvgpr_read_b32 v202, a74
    v_ldexp_f32 v202, v202, v214
    v_accvgpr_write_b32 a74, v202
    v_accvgpr_read_b32 v203, a75
    v_ldexp_f32 v203, v203, v214
    v_accvgpr_write_b32 a75, v203
    v_accvgpr_read_b32 v204, a76
    v_ldexp_f32 v204, v204, v214
    v_accvgpr_write_b32 a76, v204
    v_accvgpr_read_b32 v205, a77
    v_ldexp_f32 v205, v205, v214
    v_accvgpr_write_b32 a77, v205
    v_accvgpr_read_b32 v206, a78
    v_ldexp_f32 v206, v206, v214
    v_accvgpr_write_b32 a78, v206
    v_accvgpr_read_b32 v207, a79
    v_ldexp_f32 v207, v207, v214
    v_accvgpr_write_b32 a79, v207
    v_accvgpr_read_b32 v200, a96
    v_ldexp_f32 v200, v200, v214
    v_accvgpr_write_b32 a96, v200
    v_accvgpr_read_b32 v201, a97
    v_ldexp_f32 v201, v201, v214
    v_accvgpr_write_b32 a97, v201
    v_accvgpr_read_b32 v202, a98
    v_ldexp_f32 v202, v202, v214
    v_accvgpr_write_b32 a98, v202
    v_accvgpr_read_b32 v203, a99
    v_ldexp_f32 v203, v203, v214
    v_accvgpr_write_b32 a99, v203
    v_accvgpr_read_b32 v204, a100
    v_ldexp_f32 v204, v204, v214
    v_accvgpr_write_b32 a100, v204
    v_accvgpr_read_b32 v205, a101
    v_ldexp_f32 v205, v205, v214
    v_accvgpr_write_b32 a101, v205
    v_accvgpr_read_b32 v206, a102
    v_ldexp_f32 v206, v206, v214
    v_accvgpr_write_b32 a102, v206
    v_accvgpr_read_b32 v207, a103
    v_ldexp_f32 v207, v207, v214
    v_accvgpr_write_b32 a103, v207
    v_accvgpr_read_b32 v200, a104
    v_ldexp_f32 v200, v200, v214
    v_accvgpr_write_b32 a104, v200
    v_accvgpr_read_b32 v201, a105
    v_ldexp_f32 v201, v201, v214
    v_accvgpr_write_b32 a105, v201
    v_accvgpr_read_b32 v202, a106
    v_ldexp_f32 v202, v202, v214
    v_accvgpr_write_b32 a106, v202
    v_accvgpr_read_b32 v203, a107
    v_ldexp_f32 v203, v203, v214
    v_accvgpr_write_b32 a107, v203
    v_accvgpr_read_b32 v204, a108
    v_ldexp_f32 v204, v204, v214
    v_accvgpr_write_b32 a108, v204
    v_accvgpr_read_b32 v205, a109
    v_ldexp_f32 v205, v205, v214
    v_accvgpr_write_b32 a109, v205
    v_accvgpr_read_b32 v206, a110
    v_ldexp_f32 v206, v206, v214
    v_accvgpr_write_b32 a110, v206
    v_accvgpr_read_b32 v207, a111
    v_ldexp_f32 v207, v207, v214
    v_accvgpr_write_b32 a111, v207
    v_max3_f32 v212, v24, v25, v26
    v_max3_f32 v212, v212, v27, v28
    v_max3_f32 v212, v212, v29, v30
    v_max3_f32 v212, v212, v31, v32
    v_max3_f32 v212, v212, v33, v34
    v_max3_f32 v212, v212, v35, v36
    v_max3_f32 v212, v212, v37, v38
    v_max_f32 v212, v212, v39
    v_mov_b32 v213, v212
    s_nop 1
    v_permlane32_swap_b32 v212, v213
    v_max_f32 v212, v212, v213
    v_add_f32 v212, 0x42c80000, v212
    v_max_f32 v212, 0, v212
    v_ceil_f32 v212, v212
    v_sub_f32 v213, 0, v212
    v_cvt_i32_f32 v215, v213
    v_sub_f32 v88, v88, v212
    v_sub_f32 v24, v24, v212
    v_sub_f32 v56, v56, v212
    v_sub_f32 v89, v89, v212
    v_sub_f32 v25, v25, v212
    v_sub_f32 v57, v57, v212
    v_sub_f32 v90, v90, v212
    v_sub_f32 v26, v26, v212
    v_sub_f32 v58, v58, v212
    v_sub_f32 v91, v91, v212
    v_sub_f32 v27, v27, v212
    v_sub_f32 v59, v59, v212
    v_sub_f32 v92, v92, v212
    v_sub_f32 v28, v28, v212
    v_sub_f32 v60, v60, v212
    v_sub_f32 v93, v93, v212
    v_sub_f32 v29, v29, v212
    v_sub_f32 v61, v61, v212
    v_sub_f32 v94, v94, v212
    v_sub_f32 v30, v30, v212
    v_sub_f32 v62, v62, v212
    v_sub_f32 v95, v95, v212
    v_sub_f32 v31, v31, v212
    v_sub_f32 v63, v63, v212
    v_sub_f32 v96, v96, v212
    v_sub_f32 v32, v32, v212
    v_sub_f32 v64, v64, v212
    v_sub_f32 v97, v97, v212
    v_sub_f32 v33, v33, v212
    v_sub_f32 v65, v65, v212
    v_sub_f32 v98, v98, v212
    v_sub_f32 v34, v34, v212
    v_sub_f32 v66, v66, v212
    v_sub_f32 v99, v99, v212
    v_sub_f32 v35, v35, v212
    v_sub_f32 v67, v67, v212
    v_sub_f32 v100, v100, v212
    v_sub_f32 v36, v36, v212
    v_sub_f32 v68, v68, v212
    v_sub_f32 v101, v101, v212
    v_sub_f32 v37, v37, v212
    v_sub_f32 v69, v69, v212
    v_sub_f32 v102, v102, v212
    v_sub_f32 v38, v38, v212
    v_sub_f32 v70, v70, v212
    v_sub_f32 v103, v103, v212
    v_sub_f32 v39, v39, v212
    v_sub_f32 v71, v71, v212
    v_ldexp_f32 v211, v211, v215
    v_accvgpr_read_b32 v200, a16
    v_ldexp_f32 v200, v200, v215
    v_accvgpr_write_b32 a16, v200
    v_accvgpr_read_b32 v201, a17
    v_ldexp_f32 v201, v201, v215
    v_accvgpr_write_b32 a17, v201
    v_accvgpr_read_b32 v202, a18
    v_ldexp_f32 v202, v202, v215
    v_accvgpr_write_b32 a18, v202
    v_accvgpr_read_b32 v203, a19
    v_ldexp_f32 v203, v203, v215
    v_accvgpr_write_b32 a19, v203
    v_accvgpr_read_b32 v204, a20
    v_ldexp_f32 v204, v204, v215
    v_accvgpr_write_b32 a20, v204
    v_accvgpr_read_b32 v205, a21
    v_ldexp_f32 v205, v205, v215
    v_accvgpr_write_b32 a21, v205
    v_accvgpr_read_b32 v206, a22
    v_ldexp_f32 v206, v206, v215
    v_accvgpr_write_b32 a22, v206
    v_accvgpr_read_b32 v207, a23
    v_ldexp_f32 v207, v207, v215
    v_accvgpr_write_b32 a23, v207
    v_accvgpr_read_b32 v200, a24
    v_ldexp_f32 v200, v200, v215
    v_accvgpr_write_b32 a24, v200
    v_accvgpr_read_b32 v201, a25
    v_ldexp_f32 v201, v201, v215
    v_accvgpr_write_b32 a25, v201
    v_accvgpr_read_b32 v202, a26
    v_ldexp_f32 v202, v202, v215
    v_accvgpr_write_b32 a26, v202
    v_accvgpr_read_b32 v203, a27
    v_ldexp_f32 v203, v203, v215
    v_accvgpr_write_b32 a27, v203
    v_accvgpr_read_b32 v204, a28
    v_ldexp_f32 v204, v204, v215
    v_accvgpr_write_b32 a28, v204
    v_accvgpr_read_b32 v205, a29
    v_ldexp_f32 v205, v205, v215
    v_accvgpr_write_b32 a29, v205
    v_accvgpr_read_b32 v206, a30
    v_ldexp_f32 v206, v206, v215
    v_accvgpr_write_b32 a30, v206
    v_accvgpr_read_b32 v207, a31
    v_ldexp_f32 v207, v207, v215
    v_accvgpr_write_b32 a31, v207
    v_accvgpr_read_b32 v200, a48
    v_ldexp_f32 v200, v200, v215
    v_accvgpr_write_b32 a48, v200
    v_accvgpr_read_b32 v201, a49
    v_ldexp_f32 v201, v201, v215
    v_accvgpr_write_b32 a49, v201
    v_accvgpr_read_b32 v202, a50
    v_ldexp_f32 v202, v202, v215
    v_accvgpr_write_b32 a50, v202
    v_accvgpr_read_b32 v203, a51
    v_ldexp_f32 v203, v203, v215
    v_accvgpr_write_b32 a51, v203
    v_accvgpr_read_b32 v204, a52
    v_ldexp_f32 v204, v204, v215
    v_accvgpr_write_b32 a52, v204
    v_accvgpr_read_b32 v205, a53
    v_ldexp_f32 v205, v205, v215
    v_accvgpr_write_b32 a53, v205
    v_accvgpr_read_b32 v206, a54
    v_ldexp_f32 v206, v206, v215
    v_accvgpr_write_b32 a54, v206
    v_accvgpr_read_b32 v207, a55
    v_ldexp_f32 v207, v207, v215
    v_accvgpr_write_b32 a55, v207
    v_accvgpr_read_b32 v200, a56
    v_ldexp_f32 v200, v200, v215
    v_accvgpr_write_b32 a56, v200
    v_accvgpr_read_b32 v201, a57
    v_ldexp_f32 v201, v201, v215
    v_accvgpr_write_b32 a57, v201
    v_accvgpr_read_b32 v202, a58
    v_ldexp_f32 v202, v202, v215
    v_accvgpr_write_b32 a58, v202
    v_accvgpr_read_b32 v203, a59
    v_ldexp_f32 v203, v203, v215
    v_accvgpr_write_b32 a59, v203
    v_accvgpr_read_b32 v204, a60
    v_ldexp_f32 v204, v204, v215
    v_accvgpr_write_b32 a60, v204
    v_accvgpr_read_b32 v205, a61
    v_ldexp_f32 v205, v205, v215
    v_accvgpr_write_b32 a61, v205
    v_accvgpr_read_b32 v206, a62
    v_ldexp_f32 v206, v206, v215
    v_accvgpr_write_b32 a62, v206
    v_accvgpr_read_b32 v207, a63
    v_ldexp_f32 v207, v207, v215
    v_accvgpr_write_b32 a63, v207
    v_accvgpr_read_b32 v200, a80
    v_ldexp_f32 v200, v200, v215
    v_accvgpr_write_b32 a80, v200
    v_accvgpr_read_b32 v201, a81
    v_ldexp_f32 v201, v201, v215
    v_accvgpr_write_b32 a81, v201
    v_accvgpr_read_b32 v202, a82
    v_ldexp_f32 v202, v202, v215
    v_accvgpr_write_b32 a82, v202
    v_accvgpr_read_b32 v203, a83
    v_ldexp_f32 v203, v203, v215
    v_accvgpr_write_b32 a83, v203
    v_accvgpr_read_b32 v204, a84
    v_ldexp_f32 v204, v204, v215
    v_accvgpr_write_b32 a84, v204
    v_accvgpr_read_b32 v205, a85
    v_ldexp_f32 v205, v205, v215
    v_accvgpr_write_b32 a85, v205
    v_accvgpr_read_b32 v206, a86
    v_ldexp_f32 v206, v206, v215
    v_accvgpr_write_b32 a86, v206
    v_accvgpr_read_b32 v207, a87
    v_ldexp_f32 v207, v207, v215
    v_accvgpr_write_b32 a87, v207
    v_accvgpr_read_b32 v200, a88
    v_ldexp_f32 v200, v200, v215
    v_accvgpr_write_b32 a88, v200
    v_accvgpr_read_b32 v201, a89
    v_ldexp_f32 v201, v201, v215
    v_accvgpr_write_b32 a89, v201
    v_accvgpr_read_b32 v202, a90
    v_ldexp_f32 v202, v202, v215
    v_accvgpr_write_b32 a90, v202
    v_accvgpr_read_b32 v203, a91
    v_ldexp_f32 v203, v203, v215
    v_accvgpr_write_b32 a91, v203
    v_accvgpr_read_b32 v204, a92
    v_ldexp_f32 v204, v204, v215
    v_accvgpr_write_b32 a92, v204
    v_accvgpr_read_b32 v205, a93
    v_ldexp_f32 v205, v205, v215
    v_accvgpr_write_b32 a93, v205
    v_accvgpr_read_b32 v206, a94
    v_ldexp_f32 v206, v206, v215
    v_accvgpr_write_b32 a94, v206
    v_accvgpr_read_b32 v207, a95
    v_ldexp_f32 v207, v207, v215
    v_accvgpr_write_b32 a95, v207
    v_accvgpr_read_b32 v200, a112
    v_ldexp_f32 v200, v200, v215
    v_accvgpr_write_b32 a112, v200
    v_accvgpr_read_b32 v201, a113
    v_ldexp_f32 v201, v201, v215
    v_accvgpr_write_b32 a113, v201
    v_accvgpr_read_b32 v202, a114
    v_ldexp_f32 v202, v202, v215
    v_accvgpr_write_b32 a114, v202
    v_accvgpr_read_b32 v203, a115
    v_ldexp_f32 v203, v203, v215
    v_accvgpr_write_b32 a115, v203
    v_accvgpr_read_b32 v204, a116
    v_ldexp_f32 v204, v204, v215
    v_accvgpr_write_b32 a116, v204
    v_accvgpr_read_b32 v205, a117
    v_ldexp_f32 v205, v205, v215
    v_accvgpr_write_b32 a117, v205
    v_accvgpr_read_b32 v206, a118
    v_ldexp_f32 v206, v206, v215
    v_accvgpr_write_b32 a118, v206
    v_accvgpr_read_b32 v207, a119
    v_ldexp_f32 v207, v207, v215
    v_accvgpr_write_b32 a119, v207
    v_accvgpr_read_b32 v200, a120
    v_ldexp_f32 v200, v200, v215
    v_accvgpr_write_b32 a120, v200
    v_accvgpr_read_b32 v201, a121
    v_ldexp_f32 v201, v201, v215
    v_accvgpr_write_b32 a121, v201
    v_accvgpr_read_b32 v202, a122
    v_ldexp_f32 v202, v202, v215
    v_accvgpr_write_b32 a122, v202
    v_accvgpr_read_b32 v203, a123
    v_ldexp_f32 v203, v203, v215
    v_accvgpr_write_b32 a123, v203
    v_accvgpr_read_b32 v204, a124
    v_ldexp_f32 v204, v204, v215
    v_accvgpr_write_b32 a124, v204
    v_accvgpr_read_b32 v205, a125
    v_ldexp_f32 v205, v205, v215
    v_accvgpr_write_b32 a125, v205
    v_accvgpr_read_b32 v206, a126
    v_ldexp_f32 v206, v206, v215
    v_accvgpr_write_b32 a126, v206
    v_accvgpr_read_b32 v207, a127
    v_ldexp_f32 v207, v207, v215
    v_accvgpr_write_b32 a127, v207
    v_exp_f32 v200, v8
    v_exp_f32 v201, v9
    v_exp_f32 v202, v10
    v_add_f32 v208, v200, v201
    v_exp_f32 v203, v11
    v_cvt_pk_bf16_f32 v104, v200, v201
    v_exp_f32 v204, v12
    v_add_f32 v208, v208, v202
    v_exp_f32 v205, v13
    v_add_f32 v208, v208, v203
    v_cvt_pk_bf16_f32 v105, v202, v203
    v_exp_f32 v206, v14
    v_add_f32 v208, v208, v204
    v_exp_f32 v207, v15
    v_add_f32 v208, v208, v205
    v_cvt_pk_bf16_f32 v106, v204, v205
    v_exp_f32 v200, v16
    v_add_f32 v208, v208, v206
    v_exp_f32 v201, v17
    v_add_f32 v208, v208, v207
    v_cvt_pk_bf16_f32 v107, v206, v207
    v_exp_f32 v202, v18
    v_add_f32 v208, v208, v200
    v_exp_f32 v203, v19
    v_add_f32 v208, v208, v201
    v_cvt_pk_bf16_f32 v108, v200, v201
    v_exp_f32 v204, v20
    v_add_f32 v208, v208, v202
    v_exp_f32 v205, v21
    v_add_f32 v208, v208, v203
    v_cvt_pk_bf16_f32 v109, v202, v203
    v_exp_f32 v206, v22
    v_add_f32 v208, v208, v204
    v_exp_f32 v207, v23
    v_add_f32 v208, v208, v205
    v_cvt_pk_bf16_f32 v110, v204, v205
    v_exp_f32 v200, v24
    v_add_f32 v208, v208, v206
    v_exp_f32 v201, v25
    v_add_f32 v208, v208, v207
    v_cvt_pk_bf16_f32 v111, v206, v207
    v_exp_f32 v202, v26
    v_add_f32 v209, v200, v201
    v_exp_f32 v203, v27
    v_cvt_pk_bf16_f32 v112, v200, v201
    v_exp_f32 v204, v28
    v_add_f32 v209, v209, v202
    v_exp_f32 v205, v29
    v_add_f32 v209, v209, v203
    v_cvt_pk_bf16_f32 v113, v202, v203
    v_exp_f32 v206, v30
    v_add_f32 v209, v209, v204
    v_exp_f32 v207, v31
    v_add_f32 v209, v209, v205
    v_cvt_pk_bf16_f32 v114, v204, v205
    v_exp_f32 v200, v32
    v_add_f32 v209, v209, v206
    v_exp_f32 v201, v33
    v_add_f32 v209, v209, v207
    v_cvt_pk_bf16_f32 v115, v206, v207
    v_exp_f32 v202, v34
    v_add_f32 v209, v209, v200
    v_exp_f32 v203, v35
    v_add_f32 v209, v209, v201
    v_cvt_pk_bf16_f32 v116, v200, v201
    v_exp_f32 v204, v36
    v_add_f32 v209, v209, v202
    v_exp_f32 v205, v37
    v_add_f32 v209, v209, v203
    v_cvt_pk_bf16_f32 v117, v202, v203
    v_exp_f32 v206, v38
    v_add_f32 v209, v209, v204
    v_exp_f32 v207, v39
    v_add_f32 v209, v209, v205
    v_cvt_pk_bf16_f32 v118, v204, v205
    v_add_f32 v209, v209, v206
    v_add_f32 v209, v209, v207
    v_cvt_pk_bf16_f32 v119, v206, v207
    s_nop 3
    s_setpc_b64 s[44:45]
attn_slow1:
    s_nop 15
    s_nop 15
    v_max3_f32 v212, v40, v41, v42
    v_max3_f32 v212, v212, v43, v44
    v_max3_f32 v212, v212, v45, v46
    v_max3_f32 v212, v212, v47, v48
    v_max3_f32 v212, v212, v49, v50
    v_max3_f32 v212, v212, v51, v52
    v_max3_f32 v212, v212, v53, v54
    v_max_f32 v212, v212, v55
    v_mov_b32 v213, v212
    s_nop 1
    v_permlane32_swap_b32 v212, v213
    v_max_f32 v212, v212, v213
    v_add_f32 v212, 0x42c80000, v212
    v_max_f32 v212, 0, v212
    v_ceil_f32 v212, v212
    v_sub_f32 v213, 0, v212
    v_cvt_i32_f32 v214, v213
    v_sub_f32 v72, v72, v212
    v_sub_f32 v40, v40, v212
    v_sub_f32 v8, v8, v212
    v_sub_f32 v73, v73, v212
    v_sub_f32 v41, v41, v212
    v_sub_f32 v9, v9, v212
    v_sub_f32 v74, v74, v212
    v_sub_f32 v42, v42, v212
    v_sub_f32 v10, v10, v212
    v_sub_f32 v75, v75, v212
    v_sub_f32 v43, v43, v212
    v_sub_f32 v11, v11, v212
    v_sub_f32 v76, v76, v212
    v_sub_f32 v44, v44, v212
    v_sub_f32 v12, v12, v212
    v_sub_f32 v77, v77, v212
    v_sub_f32 v45, v45, v212
    v_sub_f32 v13, v13, v212
    v_sub_f32 v78, v78, v212
    v_sub_f32 v46, v46, v212
    v_sub_f32 v14, v14, v212
    v_sub_f32 v79, v79, v212
    v_sub_f32 v47, v47, v212
    v_sub_f32 v15, v15, v212
    v_sub_f32 v80, v80, v212
    v_sub_f32 v48, v48, v212
    v_sub_f32 v16, v16, v212
    v_sub_f32 v81, v81, v212
    v_sub_f32 v49, v49, v212
    v_sub_f32 v17, v17, v212
    v_sub_f32 v82, v82, v212
    v_sub_f32 v50, v50, v212
    v_sub_f32 v18, v18, v212
    v_sub_f32 v83, v83, v212
    v_sub_f32 v51, v51, v212
    v_sub_f32 v19, v19, v212
    v_sub_f32 v84, v84, v212
    v_sub_f32 v52, v52, v212
    v_sub_f32 v20, v20, v212
    v_sub_f32 v85, v85, v212
    v_sub_f32 v53, v53, v212
    v_sub_f32 v21, v21, v212
    v_sub_f32 v86, v86, v212
    v_sub_f32 v54, v54, v212
    v_sub_f32 v22, v22, v212
    v_sub_f32 v87, v87, v212
    v_sub_f32 v55, v55, v212
    v_sub_f32 v23, v23, v212
    v_ldexp_f32 v210, v210, v214
    v_accvgpr_read_b32 v200, a0
    v_ldexp_f32 v200, v200, v214
    v_accvgpr_write_b32 a0, v200
    v_accvgpr_read_b32 v201, a1
    v_ldexp_f32 v201, v201, v214
    v_accvgpr_write_b32 a1, v201
    v_accvgpr_read_b32 v202, a2
    v_ldexp_f32 v202, v202, v214
    v_accvgpr_write_b32 a2, v202
    v_accvgpr_read_b32 v203, a3
    v_ldexp_f32 v203, v203, v214
    v_accvgpr_write_b32 a3, v203
    v_accvgpr_read_b32 v204, a4
    v_ldexp_f32 v204, v204, v214
    v_accvgpr_write_b32 a4, v204
    v_accvgpr_read_b32 v205, a5
    v_ldexp_f32 v205, v205, v214
    v_accvgpr_write_b32 a5, v205
    v_accvgpr_read_b32 v206, a6
    v_ldexp_f32 v206, v206, v214
    v_accvgpr_write_b32 a6, v206
    v_accvgpr_read_b32 v207, a7
    v_ldexp_f32 v207, v207, v214
    v_accvgpr_write_b32 a7, v207
    v_accvgpr_read_b32 v200, a8
    v_ldexp_f32 v200, v200, v214
    v_accvgpr_write_b32 a8, v200
    v_accvgpr_read_b32 v201, a9
    v_ldexp_f32 v201, v201, v214
    v_accvgpr_write_b32 a9, v201
    v_accvgpr_read_b32 v202, a10
    v_ldexp_f32 v202, v202, v214
    v_accvgpr_write_b32 a10, v202
    v_accvgpr_read_b32 v203, a11
    v_ldexp_f32 v203, v203, v214
    v_accvgpr_write_b32 a11, v203
    v_accvgpr_read_b32 v204, a12
    v_ldexp_f32 v204, v204, v214
    v_accvgpr_write_b32 a12, v204
    v_accvgpr_read_b32 v205, a13
    v_ldexp_f32 v205, v205, v214
    v_accvgpr_write_b32 a13, v205
    v_accvgpr_read_b32 v206, a14
    v_ldexp_f32 v206, v206, v214
    v_accvgpr_write_b32 a14, v206
    v_accvgpr_read_b32 v207, a15
    v_ldexp_f32 v207, v207, v214
    v_accvgpr_write_b32 a15, v207
    v_accvgpr_read_b32 v200, a32
    v_ldexp_f32 v200, v200, v214
    v_accvgpr_write_b32 a32, v200
    v_accvgpr_read_b32 v201, a33
    v_ldexp_f32 v201, v201, v214
    v_accvgpr_write_b32 a33, v201
    v_accvgpr_read_b32 v202, a34
    v_ldexp_f32 v202, v202, v214
    v_accvgpr_write_b32 a34, v202
    v_accvgpr_read_b32 v203, a35
    v_ldexp_f32 v203, v203, v214
    v_accvgpr_write_b32 a35, v203
    v_accvgpr_read_b32 v204, a36
    v_ldexp_f32 v204, v204, v214
    v_accvgpr_write_b32 a36, v204
    v_accvgpr_read_b32 v205, a37
    v_ldexp_f32 v205, v205, v214
    v_accvgpr_write_b32 a37, v205
    v_accvgpr_read_b32 v206, a38
    v_ldexp_f32 v206, v206, v214
    v_accvgpr_write_b32 a38, v206
    v_accvgpr_read_b32 v207, a39
    v_ldexp_f32 v207, v207, v214
    v_accvgpr_write_b32 a39, v207
    v_accvgpr_read_b32 v200, a40
    v_ldexp_f32 v200, v200, v214
    v_accvgpr_write_b32 a40, v200
    v_accvgpr_read_b32 v201, a41
    v_ldexp_f32 v201, v201, v214
    v_accvgpr_write_b32 a41, v201
    v_accvgpr_read_b32 v202, a42
    v_ldexp_f32 v202, v202, v214
    v_accvgpr_write_b32 a42, v202
    v_accvgpr_read_b32 v203, a43
    v_ldexp_f32 v203, v203, v214
    v_accvgpr_write_b32 a43, v203
    v_accvgpr_read_b32 v204, a44
    v_ldexp_f32 v204, v204, v214
    v_accvgpr_write_b32 a44, v204
    v_accvgpr_read_b32 v205, a45
    v_ldexp_f32 v205, v205, v214
    v_accvgpr_write_b32 a45, v205
    v_accvgpr_read_b32 v206, a46
    v_ldexp_f32 v206, v206, v214
    v_accvgpr_write_b32 a46, v206
    v_accvgpr_read_b32 v207, a47
    v_ldexp_f32 v207, v207, v214
    v_accvgpr_write_b32 a47, v207
    v_accvgpr_read_b32 v200, a64
    v_ldexp_f32 v200, v200, v214
    v_accvgpr_write_b32 a64, v200
    v_accvgpr_read_b32 v201, a65
    v_ldexp_f32 v201, v201, v214
    v_accvgpr_write_b32 a65, v201
    v_accvgpr_read_b32 v202, a66
    v_ldexp_f32 v202, v202, v214
    v_accvgpr_write_b32 a66, v202
    v_accvgpr_read_b32 v203, a67
    v_ldexp_f32 v203, v203, v214
    v_accvgpr_write_b32 a67, v203
    v_accvgpr_read_b32 v204, a68
    v_ldexp_f32 v204, v204, v214
    v_accvgpr_write_b32 a68, v204
    v_accvgpr_read_b32 v205, a69
    v_ldexp_f32 v205, v205, v214
    v_accvgpr_write_b32 a69, v205
    v_accvgpr_read_b32 v206, a70
    v_ldexp_f32 v206, v206, v214
    v_accvgpr_write_b32 a70, v206
    v_accvgpr_read_b32 v207, a71
    v_ldexp_f32 v207, v207, v214
    v_accvgpr_write_b32 a71, v207
    v_accvgpr_read_b32 v200, a72
    v_ldexp_f32 v200, v200, v214
    v_accvgpr_write_b32 a72, v200
    v_accvgpr_read_b32 v201, a73
    v_ldexp_f32 v201, v201, v214
    v_accvgpr_write_b32 a73, v201
    v_accvgpr_read_b32 v202, a74
    v_ldexp_f32 v202, v202, v214
    v_accvgpr_write_b32 a74, v202
    v_accvgpr_read_b32 v203, a75
    v_ldexp_f32 v203, v203, v214
    v_accvgpr_write_b32 a75, v203
    v_accvgpr_read_b32 v204, a76
    v_ldexp_f32 v204, v204, v214
    v_accvgpr_write_b32 a76, v204
    v_accvgpr_read_b32 v205, a77
    v_ldexp_f32 v205, v205, v214
    v_accvgpr_write_b32 a77, v205
    v_accvgpr_read_b32 v206, a78
    v_ldexp_f32 v206, v206, v214
    v_accvgpr_write_b32 a78, v206
    v_accvgpr_read_b32 v207, a79
    v_ldexp_f32 v207, v207, v214
    v_accvgpr_write_b32 a79, v207
    v_accvgpr_read_b32 v200, a96
    v_ldexp_f32 v200, v200, v214
    v_accvgpr_write_b32 a96, v200
    v_accvgpr_read_b32 v201, a97
    v_ldexp_f32 v201, v201, v214
    v_accvgpr_write_b32 a97, v201
    v_accvgpr_read_b32 v202, a98
    v_ldexp_f32 v202, v202, v214
    v_accvgpr_write_b32 a98, v202
    v_accvgpr_read_b32 v203, a99
    v_ldexp_f32 v203, v203, v214
    v_accvgpr_write_b32 a99, v203
    v_accvgpr_read_b32 v204, a100
    v_ldexp_f32 v204, v204, v214
    v_accvgpr_write_b32 a100, v204
    v_accvgpr_read_b32 v205, a101
    v_ldexp_f32 v205, v205, v214
    v_accvgpr_write_b32 a101, v205
    v_accvgpr_read_b32 v206, a102
    v_ldexp_f32 v206, v206, v214
    v_accvgpr_write_b32 a102, v206
    v_accvgpr_read_b32 v207, a103
    v_ldexp_f32 v207, v207, v214
    v_accvgpr_write_b32 a103, v207
    v_accvgpr_read_b32 v200, a104
    v_ldexp_f32 v200, v200, v214
    v_accvgpr_write_b32 a104, v200
    v_accvgpr_read_b32 v201, a105
    v_ldexp_f32 v201, v201, v214
    v_accvgpr_write_b32 a105, v201
    v_accvgpr_read_b32 v202, a106
    v_ldexp_f32 v202, v202, v214
    v_accvgpr_write_b32 a106, v202
    v_accvgpr_read_b32 v203, a107
    v_ldexp_f32 v203, v203, v214
    v_accvgpr_write_b32 a107, v203
    v_accvgpr_read_b32 v204, a108
    v_ldexp_f32 v204, v204, v214
    v_accvgpr_write_b32 a108, v204
    v_accvgpr_read_b32 v205, a109
    v_ldexp_f32 v205, v205, v214
    v_accvgpr_write_b32 a109, v205
    v_accvgpr_read_b32 v206, a110
    v_ldexp_f32 v206, v206, v214
    v_accvgpr_write_b32 a110, v206
    v_accvgpr_read_b32 v207, a111
    v_ldexp_f32 v207, v207, v214
    v_accvgpr_write_b32 a111, v207
    v_max3_f32 v212, v56, v57, v58
    v_max3_f32 v212, v212, v59, v60
    v_max3_f32 v212, v212, v61, v62
    v_max3_f32 v212, v212, v63, v64
    v_max3_f32 v212, v212, v65, v66
    v_max3_f32 v212, v212, v67, v68
    v_max3_f32 v212, v212, v69, v70
    v_max_f32 v212, v212, v71
    v_mov_b32 v213, v212
    s_nop 1
    v_permlane32_swap_b32 v212, v213
    v_max_f32 v212, v212, v213
    v_add_f32 v212, 0x42c80000, v212
    v_max_f32 v212, 0, v212
    v_ceil_f32 v212, v212
    v_sub_f32 v213, 0, v212
    v_cvt_i32_f32 v215, v213
    v_sub_f32 v88, v88, v212
    v_sub_f32 v56, v56, v212
    v_sub_f32 v24, v24, v212
    v_sub_f32 v89, v89, v212
    v_sub_f32 v57, v57, v212
    v_sub_f32 v25, v25, v212
    v_sub_f32 v90, v90, v212
    v_sub_f32 v58, v58, v212
    v_sub_f32 v26, v26, v212
    v_sub_f32 v91, v91, v212
    v_sub_f32 v59, v59, v212
    v_sub_f32 v27, v27, v212
    v_sub_f32 v92, v92, v212
    v_sub_f32 v60, v60, v212
    v_sub_f32 v28, v28, v212
    v_sub_f32 v93, v93, v212
    v_sub_f32 v61, v61, v212
    v_sub_f32 v29, v29, v212
    v_sub_f32 v94, v94, v212
    v_sub_f32 v62, v62, v212
    v_sub_f32 v30, v30, v212
    v_sub_f32 v95, v95, v212
    v_sub_f32 v63, v63, v212
    v_sub_f32 v31, v31, v212
    v_sub_f32 v96, v96, v212
    v_sub_f32 v64, v64, v212
    v_sub_f32 v32, v32, v212
    v_sub_f32 v97, v97, v212
    v_sub_f32 v65, v65, v212
    v_sub_f32 v33, v33, v212
    v_sub_f32 v98, v98, v212
    v_sub_f32 v66, v66, v212
    v_sub_f32 v34, v34, v212
    v_sub_f32 v99, v99, v212
    v_sub_f32 v67, v67, v212
    v_sub_f32 v35, v35, v212
    v_sub_f32 v100, v100, v212
    v_sub_f32 v68, v68, v212
    v_sub_f32 v36, v36, v212
    v_sub_f32 v101, v101, v212
    v_sub_f32 v69, v69, v212
    v_sub_f32 v37, v37, v212
    v_sub_f32 v102, v102, v212
    v_sub_f32 v70, v70, v212
    v_sub_f32 v38, v38, v212
    v_sub_f32 v103, v103, v212
    v_sub_f32 v71, v71, v212
    v_sub_f32 v39, v39, v212
    v_ldexp_f32 v211, v211, v215
    v_accvgpr_read_b32 v200, a16
    v_ldexp_f32 v200, v200, v215
    v_accvgpr_write_b32 a16, v200
    v_accvgpr_read_b32 v201, a17
    v_ldexp_f32 v201, v201, v215
    v_accvgpr_write_b32 a17, v201
    v_accvgpr_read_b32 v202, a18
    v_ldexp_f32 v202, v202, v215
    v_accvgpr_write_b32 a18, v202
    v_accvgpr_read_b32 v203, a19
    v_ldexp_f32 v203, v203, v215
    v_accvgpr_write_b32 a19, v203
    v_accvgpr_read_b32 v204, a20
    v_ldexp_f32 v204, v204, v215
    v_accvgpr_write_b32 a20, v204
    v_accvgpr_read_b32 v205, a21
    v_ldexp_f32 v205, v205, v215
    v_accvgpr_write_b32 a21, v205
    v_accvgpr_read_b32 v206, a22
    v_ldexp_f32 v206, v206, v215
    v_accvgpr_write_b32 a22, v206
    v_accvgpr_read_b32 v207, a23
    v_ldexp_f32 v207, v207, v215
    v_accvgpr_write_b32 a23, v207
    v_accvgpr_read_b32 v200, a24
    v_ldexp_f32 v200, v200, v215
    v_accvgpr_write_b32 a24, v200
    v_accvgpr_read_b32 v201, a25
    v_ldexp_f32 v201, v201, v215
    v_accvgpr_write_b32 a25, v201
    v_accvgpr_read_b32 v202, a26
    v_ldexp_f32 v202, v202, v215
    v_accvgpr_write_b32 a26, v202
    v_accvgpr_read_b32 v203, a27
    v_ldexp_f32 v203, v203, v215
    v_accvgpr_write_b32 a27, v203
    v_accvgpr_read_b32 v204, a28
    v_ldexp_f32 v204, v204, v215
    v_accvgpr_write_b32 a28, v204
    v_accvgpr_read_b32 v205, a29
    v_ldexp_f32 v205, v205, v215
    v_accvgpr_write_b32 a29, v205
    v_accvgpr_read_b32 v206, a30
    v_ldexp_f32 v206, v206, v215
    v_accvgpr_write_b32 a30, v206
    v_accvgpr_read_b32 v207, a31
    v_ldexp_f32 v207, v207, v215
    v_accvgpr_write_b32 a31, v207
    v_accvgpr_read_b32 v200, a48
    v_ldexp_f32 v200, v200, v215
    v_accvgpr_write_b32 a48, v200
    v_accvgpr_read_b32 v201, a49
    v_ldexp_f32 v201, v201, v215
    v_accvgpr_write_b32 a49, v201
    v_accvgpr_read_b32 v202, a50
    v_ldexp_f32 v202, v202, v215
    v_accvgpr_write_b32 a50, v202
    v_accvgpr_read_b32 v203, a51
    v_ldexp_f32 v203, v203, v215
    v_accvgpr_write_b32 a51, v203
    v_accvgpr_read_b32 v204, a52
    v_ldexp_f32 v204, v204, v215
    v_accvgpr_write_b32 a52, v204
    v_accvgpr_read_b32 v205, a53
    v_ldexp_f32 v205, v205, v215
    v_accvgpr_write_b32 a53, v205
    v_accvgpr_read_b32 v206, a54
    v_ldexp_f32 v206, v206, v215
    v_accvgpr_write_b32 a54, v206
    v_accvgpr_read_b32 v207, a55
    v_ldexp_f32 v207, v207, v215
    v_accvgpr_write_b32 a55, v207
    v_accvgpr_read_b32 v200, a56
    v_ldexp_f32 v200, v200, v215
    v_accvgpr_write_b32 a56, v200
    v_accvgpr_read_b32 v201, a57
    v_ldexp_f32 v201, v201, v215
    v_accvgpr_write_b32 a57, v201
    v_accvgpr_read_b32 v202, a58
    v_ldexp_f32 v202, v202, v215
    v_accvgpr_write_b32 a58, v202
    v_accvgpr_read_b32 v203, a59
    v_ldexp_f32 v203, v203, v215
    v_accvgpr_write_b32 a59, v203
    v_accvgpr_read_b32 v204, a60
    v_ldexp_f32 v204, v204, v215
    v_accvgpr_write_b32 a60, v204
    v_accvgpr_read_b32 v205, a61
    v_ldexp_f32 v205, v205, v215
    v_accvgpr_write_b32 a61, v205
    v_accvgpr_read_b32 v206, a62
    v_ldexp_f32 v206, v206, v215
    v_accvgpr_write_b32 a62, v206
    v_accvgpr_read_b32 v207, a63
    v_ldexp_f32 v207, v207, v215
    v_accvgpr_write_b32 a63, v207
    v_accvgpr_read_b32 v200, a80
    v_ldexp_f32 v200, v200, v215
    v_accvgpr_write_b32 a80, v200
    v_accvgpr_read_b32 v201, a81
    v_ldexp_f32 v201, v201, v215
    v_accvgpr_write_b32 a81, v201
    v_accvgpr_read_b32 v202, a82
    v_ldexp_f32 v202, v202, v215
    v_accvgpr_write_b32 a82, v202
    v_accvgpr_read_b32 v203, a83
    v_ldexp_f32 v203, v203, v215
    v_accvgpr_write_b32 a83, v203
    v_accvgpr_read_b32 v204, a84
    v_ldexp_f32 v204, v204, v215
    v_accvgpr_write_b32 a84, v204
    v_accvgpr_read_b32 v205, a85
    v_ldexp_f32 v205, v205, v215
    v_accvgpr_write_b32 a85, v205
    v_accvgpr_read_b32 v206, a86
    v_ldexp_f32 v206, v206, v215
    v_accvgpr_write_b32 a86, v206
    v_accvgpr_read_b32 v207, a87
    v_ldexp_f32 v207, v207, v215
    v_accvgpr_write_b32 a87, v207
    v_accvgpr_read_b32 v200, a88
    v_ldexp_f32 v200, v200, v215
    v_accvgpr_write_b32 a88, v200
    v_accvgpr_read_b32 v201, a89
    v_ldexp_f32 v201, v201, v215
    v_accvgpr_write_b32 a89, v201
    v_accvgpr_read_b32 v202, a90
    v_ldexp_f32 v202, v202, v215
    v_accvgpr_write_b32 a90, v202
    v_accvgpr_read_b32 v203, a91
    v_ldexp_f32 v203, v203, v215
    v_accvgpr_write_b32 a91, v203
    v_accvgpr_read_b32 v204, a92
    v_ldexp_f32 v204, v204, v215
    v_accvgpr_write_b32 a92, v204
    v_accvgpr_read_b32 v205, a93
    v_ldexp_f32 v205, v205, v215
    v_accvgpr_write_b32 a93, v205
    v_accvgpr_read_b32 v206, a94
    v_ldexp_f32 v206, v206, v215
    v_accvgpr_write_b32 a94, v206
    v_accvgpr_read_b32 v207, a95
    v_ldexp_f32 v207, v207, v215
    v_accvgpr_write_b32 a95, v207
    v_accvgpr_read_b32 v200, a112
    v_ldexp_f32 v200, v200, v215
    v_accvgpr_write_b32 a112, v200
    v_accvgpr_read_b32 v201, a113
    v_ldexp_f32 v201, v201, v215
    v_accvgpr_write_b32 a113, v201
    v_accvgpr_read_b32 v202, a114
    v_ldexp_f32 v202, v202, v215
    v_accvgpr_write_b32 a114, v202
    v_accvgpr_read_b32 v203, a115
    v_ldexp_f32 v203, v203, v215
    v_accvgpr_write_b32 a115, v203
    v_accvgpr_read_b32 v204, a116
    v_ldexp_f32 v204, v204, v215
    v_accvgpr_write_b32 a116, v204
    v_accvgpr_read_b32 v205, a117
    v_ldexp_f32 v205, v205, v215
    v_accvgpr_write_b32 a117, v205
    v_accvgpr_read_b32 v206, a118
    v_ldexp_f32 v206, v206, v215
    v_accvgpr_write_b32 a118, v206
    v_accvgpr_read_b32 v207, a119
    v_ldexp_f32 v207, v207, v215
    v_accvgpr_write_b32 a119, v207
    v_accvgpr_read_b32 v200, a120
    v_ldexp_f32 v200, v200, v215
    v_accvgpr_write_b32 a120, v200
    v_accvgpr_read_b32 v201, a121
    v_ldexp_f32 v201, v201, v215
    v_accvgpr_write_b32 a121, v201
    v_accvgpr_read_b32 v202, a122
    v_ldexp_f32 v202, v202, v215
    v_accvgpr_write_b32 a122, v202
    v_accvgpr_read_b32 v203, a123
    v_ldexp_f32 v203, v203, v215
    v_accvgpr_write_b32 a123, v203
    v_accvgpr_read_b32 v204, a124
    v_ldexp_f32 v204, v204, v215
    v_accvgpr_write_b32 a124, v204
    v_accvgpr_read_b32 v205, a125
    v_ldexp_f32 v205, v205, v215
    v_accvgpr_write_b32 a125, v205
    v_accvgpr_read_b32 v206, a126
    v_ldexp_f32 v206, v206, v215
    v_accvgpr_write_b32 a126, v206
    v_accvgpr_read_b32 v207, a127
    v_ldexp_f32 v207, v207, v215
    v_accvgpr_write_b32 a127, v207
    v_exp_f32 v200, v40
    v_exp_f32 v201, v41
    v_exp_f32 v202, v42
    v_add_f32 v208, v200, v201
    v_exp_f32 v203, v43
    v_cvt_pk_bf16_f32 v120, v200, v201
    v_exp_f32 v204, v44
    v_add_f32 v208, v208, v202
    v_exp_f32 v205, v45
    v_add_f32 v208, v208, v203
    v_cvt_pk_bf16_f32 v121, v202, v203
    v_exp_f32 v206, v46
    v_add_f32 v208, v208, v204
    v_exp_f32 v207, v47
    v_add_f32 v208, v208, v205
    v_cvt_pk_bf16_f32 v122, v204, v205
    v_exp_f32 v200, v48
    v_add_f32 v208, v208, v206
    v_exp_f32 v201, v49
    v_add_f32 v208, v208, v207
    v_cvt_pk_bf16_f32 v123, v206, v207
    v_exp_f32 v202, v50
    v_add_f32 v208, v208, v200
    v_exp_f32 v203, v51
    v_add_f32 v208, v208, v201
    v_cvt_pk_bf16_f32 v124, v200, v201
    v_exp_f32 v204, v52
    v_add_f32 v208, v208, v202
    v_exp_f32 v205, v53
    v_add_f32 v208, v208, v203
    v_cvt_pk_bf16_f32 v125, v202, v203
    v_exp_f32 v206, v54
    v_add_f32 v208, v208, v204
    v_exp_f32 v207, v55
    v_add_f32 v208, v208, v205
    v_cvt_pk_bf16_f32 v126, v204, v205
    v_exp_f32 v200, v56
    v_add_f32 v208, v208, v206
    v_exp_f32 v201, v57
    v_add_f32 v208, v208, v207
    v_cvt_pk_bf16_f32 v127, v206, v207
    v_exp_f32 v202, v58
    v_add_f32 v209, v200, v201
    v_exp_f32 v203, v59
    v_cvt_pk_bf16_f32 v128, v200, v201
    v_exp_f32 v204, v60
    v_add_f32 v209, v209, v202
    v_exp_f32 v205, v61
    v_add_f32 v209, v209, v203
    v_cvt_pk_bf16_f32 v129, v202, v203
    v_exp_f32 v206, v62
    v_add_f32 v209, v209, v204
    v_exp_f32 v207, v63
    v_add_f32 v209, v209, v205
    v_cvt_pk_bf16_f32 v130, v204, v205
    v_exp_f32 v200, v64
    v_add_f32 v209, v209, v206
    v_exp_f32 v201, v65
    v_add_f32 v209, v209, v207
    v_cvt_pk_bf16_f32 v131, v206, v207
    v_exp_f32 v202, v66
    v_add_f32 v209, v209, v200
    v_exp_f32 v203, v67
    v_add_f32 v209, v209, v201
    v_cvt_pk_bf16_f32 v132, v200, v201
    v_exp_f32 v204, v68
    v_add_f32 v209, v209, v202
    v_exp_f32 v205, v69
    v_add_f32 v209, v209, v203
    v_cvt_pk_bf16_f32 v133, v202, v203
    v_exp_f32 v206, v70
    v_add_f32 v209, v209, v204
    v_exp_f32 v207, v71
    v_add_f32 v209, v209, v205
    v_cvt_pk_bf16_f32 v134, v204, v205
    v_add_f32 v209, v209, v206
    v_add_f32 v209, v209, v207
    v_cvt_pk_bf16_f32 v135, v206, v207
    s_nop 3
    s_setpc_b64 s[44:45]

code_end:
.section .rodata,"a"
.p2align 6
.amdhsa_kernel prep_kernel
  .amdhsa_next_free_vgpr 79
  .amdhsa_next_free_sgpr 52
  .amdhsa_accum_offset 80
  .amdhsa_group_segment_fixed_size 0
  .amdhsa_kernarg_size 112
  .amdhsa_user_sgpr_count 2
  .amdhsa_user_sgpr_kernarg_segment_ptr 1
  .amdhsa_system_sgpr_workgroup_id_x 1
.end_amdhsa_kernel

.p2align 6
.amdhsa_kernel attn_kernel
  .amdhsa_next_free_vgpr 472
  .amdhsa_next_free_sgpr 96
  .amdhsa_accum_offset 256
  .amdhsa_group_segment_fixed_size 0
  .amdhsa_kernarg_size 112
  .amdhsa_user_sgpr_count 2
  .amdhsa_user_sgpr_kernarg_segment_ptr 1
  .amdhsa_system_sgpr_workgroup_id_x 1
.end_amdhsa_kernel
```
